```python
import torch

def _softmax(x, axis=-1):
    return torch.softmax(x, dim=axis)
def _gelu(x):
    return torch.nn.functional.gelu(x, approximate="tanh")
def _silu(x):
    return torch.nn.functional.silu(x)
def _sigmoid(x):
    return torch.sigmoid(x)
def _layernorm(x, axis=-1, eps=1e-5):
    m = x.mean(dim=axis, keepdim=True)
    v = x.var(dim=axis, keepdim=True, unbiased=False)
    return (x - m) / torch.sqrt(v + eps)
def _scatter_add(tgt, idx, src, axis=0):
    return tgt.clone().index_add_(axis, idx, src)
def _segment_sum(src, seg, n):
    out = torch.zeros((n,) + src.shape[1:], dtype=src.dtype)
    return out.index_add_(0, seg, src)
def _pad(x, pw):
    flat = tuple(v for pair in reversed(pw) for v in pair)
    return torch.nn.functional.pad(x, flat)

kernel_name = 'sequential_preLN__linear_attn_block__geglu_ffn__prompt'

def setup_inputs():

    _w = (lambda a: (lambda t: t.to(torch.bfloat16) if t.is_floating_point() else t)(torch.as_tensor(a)))
    def _A_setup():
        B, S, D = 1, 2048, 576
        return {
            "x": _w((lambda *s: torch.randn(*s, dtype=torch.bfloat16) * 0.05)(B, S, D)),
            "wqkv": _w((lambda *s: torch.randn(*s, dtype=torch.bfloat16) * 0.05)(D, 3 * D)),
            "wo": _w((lambda *s: torch.randn(*s, dtype=torch.bfloat16) * 0.05)(D, D)),
        }
    _A_in = _A_setup()

    def _B_setup():
        B, S, D, F = 1, 2048, 576, 4608
        return {
            "x": _w((lambda *s: torch.randn(*s, dtype=torch.bfloat16) * 0.05)(B, S, D)),
            "w_gate": _w((lambda *s: torch.randn(*s, dtype=torch.bfloat16) * 0.05)(D, F)),
            "w_up": _w((lambda *s: torch.randn(*s, dtype=torch.bfloat16) * 0.05)(D, F)),
            "w_down": _w((lambda *s: torch.randn(*s, dtype=torch.bfloat16) * 0.05)(F, D)),
        }
    _B_in = _B_setup()

    return {
        "A_x": _A_in["x"],
        "A_wqkv": _A_in["wqkv"],
        "A_wo": _A_in["wo"],
        "B_x": _B_in["x"],
        "B_w_gate": _B_in["w_gate"],
        "B_w_up": _B_in["w_up"],
        "B_w_down": _B_in["w_down"],
    }

def reference(A_x, A_wqkv, A_wo, B_x, B_w_gate, B_w_up, B_w_down):
    def _A_ref(x, wqkv, wo):
        B, S, D = x.shape
        H = 32; Dh = D // H
        qkv = (lambda x, *d: x.permute(*d))((x @ wqkv).reshape(B, S, 3, H, Dh), 2, 0, 3, 1, 4)
        q, k, v = qkv[0], qkv[1], qkv[2]
        phi = lambda t: torch.where(t > 0, t + 1, torch.exp(t)) + 1e-6
        pq, pk = phi(q), phi(k)
        kv = torch.einsum("bhsd,bhse->bhde", pk, v)
        z = torch.einsum("bhsd->bhd", pk)
        num = torch.einsum("bhqd,bhde->bhqe", pq, kv)
        den = torch.einsum("bhqd,bhd->bhq", pq, z)[..., None] + 1e-6
        o = num / den
        return (lambda x, *d: x.permute(*d))(o, 0, 2, 1, 3).reshape(B, S, D) @ wo

    def _B_ref(x, w_gate, w_up, w_down):
        return (_gelu(x @ w_gate) * (x @ w_up)) @ w_down

    x = A_x
    h = x + _A_ref(_layernorm(x, axis=-1), A_wqkv, A_wo)
    h2 = h + _B_ref(_layernorm(h, axis=-1), B_w_gate, B_w_up, B_w_down)
    return h2
```

```asm
; @launch grid=(256,1,1) block=(256,1,1) lds=160768
.amdgcn_target "amdgcn-amd-amdhsa--gfx950"
.text
.globl sequential_preLN__linear_attn_block__geglu_ffn__prompt_kernel
.p2align 8
.type sequential_preLN__linear_attn_block__geglu_ffn__prompt_kernel,@function
sequential_preLN__linear_attn_block__geglu_ffn__prompt_kernel:
  s_cmp_ge_u32 s2, 256
  s_cbranch_scc1 K3_end
  s_load_dwordx4 s[40:43], s[0:1], 0
  s_load_dwordx4 s[44:47], s[0:1], 64
  s_load_dwordx2 s[48:49], s[0:1], 16
  v_lshrrev_b32 v1, 6, v0
  v_and_b32 v2, 63, v0
  s_nop 0
  v_readfirstlane_b32 s34, v1
  s_lshr_b32 s6, s2, 3
  s_lshl_b32 s6, s6, 10
  v_lshrrev_b32 v3, 5, v0
  s_getpc_b64 s[4:5]
F_pc:
  s_add_u32 s4, s4, F_pc-F_pc
  s_addc_u32 s5, s5, 0
  v_lshlrev_b32 v252, 7, v3
  v_add_u32 v252, s6, v252
  v_min_u32 v252, F_k2-F_pc, v252
  v_mov_b32 v253, 0
  v_lshl_add_u64 v[252:253], v[252:253], 0, s[4:5]
  global_load_dword v254, v[252:253], off
  s_cmp_lt_u32 s2, 64
  s_cbranch_scc1 F_spare
  s_lshr_b32 s4, s2, 3
  s_and_b32 s3, s2, 7
  s_sub_u32 s4, s4, 8
  s_lshr_b32 s5, s3, 1
  s_lshl_b32 s5, s5, 2
  s_and_b32 s6, s4, 3
  s_add_u32 s28, s5, s6
  s_lshr_b32 s4, s4, 2
  s_and_b32 s3, s3, 1
  s_lshl_b32 s5, s3, 2
  s_add_u32 s5, s5, s4
  s_lshl_b32 s6, s3, 1
  s_add_u32 s6, s6, s4
  s_sub_u32 s6, s6, 4
  s_cmp_lt_u32 s4, 4
  s_cselect_b32 s29, s5, s6
  s_cselect_b32 s30, 1, 0
  v_lshrrev_b32 v3, 3, v2
  v_and_b32 v20, 7, v2
  v_lshrrev_b32 v21, 1, v3
  v_xor_b32 v20, v20, v21
  v_mul_u32_u24 v3, 1152, v3
  v_lshl_add_u32 v204, v20, 4, v3
  v_xor_b32 v20, 4, v20
  v_lshl_add_u32 v205, v20, 4, v3
  v_add_u32 v205, 8192, v205
  v_add_u32 v206, 16384, v204
  v_add_u32 v207, 16384, v205
  s_lshl_b32 s5, s28, 2
  s_add_u32 s52, s5, s34
  s_mul_i32 s31, s52, 36864
  s_mul_i32 s35, s34, 9216
  s_mul_i32 s5, s29, 144
  s_add_u32 s6, s5, 1152
  s_lshl_b32 s5, s5, 1
  s_cmp_eq_u32 s30, 1
  s_cselect_b32 s53, s6, s5
  s_movk_i32 s7, 144
  s_cselect_b32 s7, 1152, s7
  s_mul_i32 s36, s34, 55296
  s_add_u32 s36, s36, s53
  s_movk_i32 s50, 3456
  v_add_u32 v3, 0, v2
  v_mul_u32_u24 v20, 7282, v3
  v_lshrrev_b32 v20, 16, v20
  v_mul_u32_u24 v21, 9, v20
  v_sub_u32 v3, v3, v21
  v_and_b32 v21, 1, v20
  v_mul_u32_u24 v21, s7, v21
  v_lshl_add_u32 v3, v3, 4, v21
  v_lshrrev_b32 v20, 1, v20
  v_mad_u32_u24 v208, v20, s50, v3
  v_add_u32 v3, 64, v2
  v_mul_u32_u24 v20, 7282, v3
  v_lshrrev_b32 v20, 16, v20
  v_mul_u32_u24 v21, 9, v20
  v_sub_u32 v3, v3, v21
  v_and_b32 v21, 1, v20
  v_mul_u32_u24 v21, s7, v21
  v_lshl_add_u32 v3, v3, 4, v21
  v_lshrrev_b32 v20, 1, v20
  v_mad_u32_u24 v209, v20, s50, v3
  v_subrev_u32 v209, 1024, v209
  v_add_u32 v3, 128, v2
  v_mul_u32_u24 v20, 7282, v3
  v_lshrrev_b32 v20, 16, v20
  v_mul_u32_u24 v21, 9, v20
  v_sub_u32 v3, v3, v21
  v_and_b32 v21, 1, v20
  v_mul_u32_u24 v21, s7, v21
  v_lshl_add_u32 v3, v3, 4, v21
  v_lshrrev_b32 v20, 1, v20
  v_lshrrev_b32 v21, 1, v20
  v_and_b32 v21, 4, v21
  v_xor_b32 v20, v20, v21
  v_mad_u32_u24 v210, v20, s50, v3
  v_subrev_u32 v210, 2048, v210
  v_add_u32 v3, 192, v2
  v_mul_u32_u24 v20, 7282, v3
  v_lshrrev_b32 v20, 16, v20
  v_mul_u32_u24 v21, 9, v20
  v_sub_u32 v3, v3, v21
  v_and_b32 v21, 1, v20
  v_mul_u32_u24 v21, s7, v21
  v_lshl_add_u32 v3, v3, 4, v21
  v_lshrrev_b32 v20, 1, v20
  v_lshrrev_b32 v21, 1, v20
  v_and_b32 v21, 4, v21
  v_xor_b32 v20, v20, v21
  v_mad_u32_u24 v211, v20, s50, v3
  v_subrev_u32 v211, 3072, v211
  v_add_u32 v3, 256, v2
  v_mul_u32_u24 v20, 7282, v3
  v_lshrrev_b32 v20, 16, v20
  v_mul_u32_u24 v21, 9, v20
  v_sub_u32 v3, v3, v21
  v_and_b32 v21, 1, v20
  v_mul_u32_u24 v21, s7, v21
  v_lshl_add_u32 v3, v3, 4, v21
  v_lshrrev_b32 v20, 1, v20
  v_lshrrev_b32 v21, 1, v20
  v_and_b32 v21, 4, v21
  v_xor_b32 v20, v20, v21
  v_mad_u32_u24 v212, v20, s50, v3
  v_cmp_gt_u32 s[50:51], 32, v2
  v_mov_b32 v3, 1073741824
  s_waitcnt lgkmcnt(0)
  v_cndmask_b32 v212, v3, v212, s[50:51]
  s_mov_b32 s20, s40
  s_and_b32 s21, s41, 0xffff
  s_mov_b32 s22, 2359296
  s_mov_b32 s23, 0x20000
  s_mov_b32 s12, s42
  s_and_b32 s13, s43, 0xffff
  s_mov_b32 s14, 1990656
  s_mov_b32 s15, 0x20000
  s_add_u32 m0, s35, 0
  s_add_u32 s54, s31, 0
  buffer_load_dwordx4 v204, s[20:23], s54 offen lds
  buffer_load_dwordx4 v205, s[20:23], s54 offen offset:1024 lds
  buffer_load_dwordx4 v206, s[20:23], s54 offen offset:2048 lds
  buffer_load_dwordx4 v207, s[20:23], s54 offen offset:3072 lds
  s_add_u32 m0, s35, 4096
  s_add_u32 s55, s36, 0
  buffer_load_dwordx4 v208, s[12:15], s55 offen lds
  buffer_load_dwordx4 v209, s[12:15], s55 offen offset:1024 lds
  buffer_load_dwordx4 v210, s[12:15], s55 offen offset:2048 lds
  buffer_load_dwordx4 v211, s[12:15], s55 offen offset:3072 lds
  s_add_u32 m0, s35, 8192
  s_nop 0
  buffer_load_dwordx4 v212, s[12:15], s55 offen lds
  s_mov_b32 s8, s46
  s_and_b32 s9, s47, 0xffff
  s_mov_b32 s10, 268435456
  s_mov_b32 s11, 0x20000
  s_mov_b32 s24, s44
  s_and_b32 s25, s45, 0xffff
  s_mov_b32 s26, 256
  s_mov_b32 s27, 0x20000
  v_and_b32 v20, 15, v2
  v_lshrrev_b32 v21, 4, v2
  v_lshrrev_b32 v3, 1, v20
  v_xor_b32 v3, v3, v21
  v_lshlrev_b32 v3, 4, v3
  v_lshl_add_u32 v3, v20, 7, v3
  v_add_u32 v12, s35, v3
  v_xor_b32 v3, 64, v3
  v_add_u32 v13, s35, v3
  v_and_b32 v3, 1, v21
  v_mul_u32_u24 v3, 12, v3
  v_bfe_u32 v22, v2, 2, 2
  v_add_u32 v3, v3, v22
  v_xor_b32 v22, 4, v3
  v_mul_u32_u24 v3, 288, v3
  v_mul_u32_u24 v22, 288, v22
  v_lshrrev_b32 v1, 5, v2
  v_mul_u32_u24 v1, 9216, v1
  v_and_b32 v23, 3, v2
  v_lshl_add_u32 v1, v23, 3, v1
  v_add_u32 v1, 4096, v1
  v_add_u32 v14, v1, v3
  v_add_u32 v15, v1, v22
  v_add_u32 v16, 73728, v12
  v_add_u32 v17, 73728, v13
  v_add_u32 v18, 73728, v14
  v_add_u32 v19, 73728, v15
  s_mov_b32 s56, 0x3f317218
  s_mov_b32 s57, 0x3f317218
  s_mov_b32 s58, 0x35c1a2a0
  s_mov_b32 s59, 0x35c1a2a0
  s_lshr_b32 s4, s2, 3
  s_sub_u32 s5, s4, 8
  s_cmp_lt_u32 s4, 8
  s_cselect_b32 s5, s4, s5
  s_lshr_b32 s33, s5, 2
  s_and_b32 s5, s5, 3
  s_and_b32 s4, s2, 7
  s_lshl_b32 s4, s4, 2
  s_add_u32 s32, s4, s5
  v_add_u32 v3, 0, v2
  v_mul_u32_u24 v1, 5462, v3
  v_lshrrev_b32 v1, 16, v1
  v_mul_u32_u24 v5, 12, v1
  v_sub_u32 v3, v3, v5
  v_mul_u32_u24 v1, 1152, v1
  v_lshl_add_u32 v5, v3, 4, v1
  v_add_u32 v3, 64, v2
  v_mul_u32_u24 v1, 5462, v3
  v_lshrrev_b32 v1, 16, v1
  v_mul_u32_u24 v6, 12, v1
  v_sub_u32 v3, v3, v6
  v_mul_u32_u24 v1, 1152, v1
  v_lshl_add_u32 v6, v3, 4, v1
  v_subrev_u32 v6, 1024, v6
  v_add_u32 v3, 128, v2
  v_mul_u32_u24 v1, 5462, v3
  v_lshrrev_b32 v1, 16, v1
  v_mul_u32_u24 v7, 12, v1
  v_sub_u32 v3, v3, v7
  v_mul_u32_u24 v1, 1152, v1
  v_lshl_add_u32 v7, v3, 4, v1
  v_subrev_u32 v7, 2048, v7
  s_mul_i32 s37, s34, 165888
  s_mul_i32 s5, s33, 192
  s_add_u32 s37, s37, s5
  s_mul_i32 s38, s34, 9216
  s_mov_b32 s16, s48
  s_and_b32 s17, s49, 0xffff
  s_mov_b32 s19, 0x20000
  s_lshr_b32 s5, s2, 6
  s_cmp_eq_u32 s5, 1
  s_cselect_b32 s18, 0, 663552
  v_and_b32 v215, 15, v2
  v_lshrrev_b32 v213, 5, v2
  v_lshl_add_u32 v215, v213, 4, v215
  v_mul_u32_u24 v213, 1152, v215
  v_bfe_u32 v214, v2, 4, 1
  v_lshl_add_u32 v213, v214, 4, v213
  v_lshlrev_b32 v215, 2, v215
  v_lshrrev_b32 v214, 4, v2
  v_mul_u32_u24 v214, 80, v214
  s_lshr_b32 s5, s34, 1
  s_lshl_b32 s101, s32, 1
  s_add_u32 s101, s101, s5
  s_mul_i32 s99, s101, 36864
  s_lshl_b32 s101, s101, 7
  s_add_u32 s101, s101, 2686976
  s_mul_i32 s5, s33, 192
  s_add_u32 s99, s99, s5
  s_and_b32 s5, s34, 1
  s_mul_i32 s5, s5, 96
  s_add_u32 s99, s99, s5
  s_mul_i32 s100, s34, 320
  s_add_u32 s100, s100, 2703360
  s_add_u32 m0, s35, 36864
  s_add_u32 s54, s31, 128
  buffer_load_dwordx4 v204, s[20:23], s54 offen lds
  buffer_load_dwordx4 v205, s[20:23], s54 offen offset:1024 lds
  buffer_load_dwordx4 v206, s[20:23], s54 offen offset:2048 lds
  buffer_load_dwordx4 v207, s[20:23], s54 offen offset:3072 lds
  s_add_u32 m0, s35, 40960
  s_add_u32 s55, s36, 221184
  buffer_load_dwordx4 v208, s[12:15], s55 offen lds
  buffer_load_dwordx4 v209, s[12:15], s55 offen offset:1024 lds
  buffer_load_dwordx4 v210, s[12:15], s55 offen offset:2048 lds
  buffer_load_dwordx4 v211, s[12:15], s55 offen offset:3072 lds
  s_add_u32 m0, s35, 45056
  s_nop 0
  buffer_load_dwordx4 v212, s[12:15], s55 offen lds
  s_cmp_eq_u32 s30, 0
  s_cbranch_scc1 F_q
  s_branch F_kv
.p2align 12
F_kv:
  v_mov_b32 v11, 0
  v_mov_b32 v24, 0x3f803f80
  s_mul_i32 s6, s34, 12288
  s_add_u32 s6, s6, 110592
  v_mul_u32_u24 v3, 80, v20
  v_lshl_add_u32 v3, v21, 4, v3
  v_add_u32 v3, s6, v3
  v_mov_b32 v23, 196608
  v_lshlrev_b32 v8, 4, v21
  v_lshlrev_b32 v9, 2, v20
  s_mov_b32 s50, 0xff00ff00
  s_mov_b32 s51, 0xff00ff00
  v_add_u32 v22, 4294966656, v3
  v_cndmask_b32 v216, v23, v22, s[50:51]
  s_mov_b32 s50, 0x3ff03ff
  s_mov_b32 s51, 0x3ff03ff
  v_add_u32 v22, 640, v3
  v_cndmask_b32 v217, v23, v22, s[50:51]
  s_mov_b32 s50, 0xff00
  s_mov_b32 s51, 0x0
  v_add_u32 v22, 4294966720, v3
  v_cndmask_b32 v218, v23, v22, s[50:51]
  s_mov_b32 s50, 0x3ff
  s_mov_b32 s51, 0x0
  v_add_u32 v22, 704, v3
  v_cndmask_b32 v219, v23, v22, s[50:51]
  s_mov_b32 s50, 0xfc00fc00
  s_mov_b32 s51, 0xfc00fc00
  v_add_u32 v22, 720, v3
  v_cndmask_b32 v219, v219, v22, s[50:51]
  s_mov_b32 s50, 0xfff0fff
  s_mov_b32 s51, 0xfff0fff
  v_add_u32 v22, 2000, v3
  v_cndmask_b32 v220, v23, v22, s[50:51]
  s_mov_b32 s50, 0xfc00
  s_mov_b32 s51, 0x0
  v_add_u32 v22, 784, v3
  v_cndmask_b32 v221, v23, v22, s[50:51]
  s_mov_b32 s50, 0xfff
  s_mov_b32 s51, 0x0
  v_add_u32 v22, 2064, v3
  v_cndmask_b32 v222, v23, v22, s[50:51]
  s_mov_b32 s50, 0xf0000000
  s_mov_b32 s51, 0xf000f000
  v_add_u32 v22, 2064, v3
  v_cndmask_b32 v222, v222, v22, s[50:51]
  s_mov_b32 s50, 0x3fff0000
  s_mov_b32 s51, 0x3fff3fff
  v_add_u32 v22, 3344, v3
  v_cndmask_b32 v223, v23, v22, s[50:51]
  s_mov_b32 s50, 0xf000f000
  s_mov_b32 s51, 0x0
  v_add_u32 v22, 2128, v3
  v_cndmask_b32 v224, v23, v22, s[50:51]
  s_mov_b32 s50, 0x3fff3fff
  s_mov_b32 s51, 0x0
  v_add_u32 v22, 3408, v3
  v_cndmask_b32 v225, v23, v22, s[50:51]
  s_mov_b32 s50, 0xc0000000
  s_mov_b32 s51, 0xc000c000
  s_mov_b64 exec, 0
  s_cmp_eq_u32 s34, 0
  s_cbranch_scc1 HP_kv_p0
  s_cmp_eq_u32 s34, 1
  s_cbranch_scc1 HP_kv_p1
  s_cmp_eq_u32 s34, 2
  s_cbranch_scc1 HP_kv_ret
  s_cmp_eq_u32 s34, 3
  s_cbranch_scc1 HP_kv_ret
HP_kv_ret:
  s_mov_b64 exec, -1
F_kv_s:
  s_waitcnt vmcnt(9)
  s_barrier
  ds_read_b128 a[0:3], v12 offset:0
  ds_read_b128 a[4:7], v12 offset:2048
  ds_read_b64_tr_b16 a[16:17], v14 offset:0
  ds_read_b64_tr_b16 a[18:19], v15 offset:0
  ds_read_b64_tr_b16 a[20:21], v14 offset:32
  ds_read_b64_tr_b16 a[22:23], v15 offset:32
  ds_read_b64_tr_b16 a[24:25], v14 offset:64
  ds_read_b64_tr_b16 a[26:27], v15 offset:64
  ds_read_b64_tr_b16 a[28:29], v14 offset:96
  ds_read_b64_tr_b16 a[30:31], v15 offset:96
  ds_read_b64_tr_b16 a[32:33], v14 offset:128
  ds_read_b64_tr_b16 a[34:35], v15 offset:128
  ds_read_b64_tr_b16 a[36:37], v14 offset:160
  ds_read_b64_tr_b16 a[38:39], v15 offset:160
  ds_read_b64_tr_b16 a[40:41], v14 offset:192
  ds_read_b64_tr_b16 a[42:43], v15 offset:192
  ds_read_b64_tr_b16 a[44:45], v14 offset:224
  ds_read_b64_tr_b16 a[46:47], v15 offset:224
  ds_read_b64_tr_b16 a[48:49], v14 offset:256
  ds_read_b64_tr_b16 a[50:51], v15 offset:256
  s_add_u32 m0, s35, 73728
  s_add_u32 s54, s31, 256
  buffer_load_dwordx4 v204, s[20:23], s54 offen lds
  buffer_load_dwordx4 v205, s[20:23], s54 offen offset:1024 lds
  buffer_load_dwordx4 v206, s[20:23], s54 offen offset:2048 lds
  buffer_load_dwordx4 v207, s[20:23], s54 offen offset:3072 lds
  s_waitcnt lgkmcnt(6)
  v_mfma_f32_16x16x32_bf16 v[116:119], a[0:3], a[16:19], 0
  ds_read_b128 a[8:11], v13 offset:0
  ds_read_b128 a[12:15], v13 offset:2048
  v_add_u32 v22, 3424, v3
  v_mfma_f32_16x16x32_bf16 v[152:155], a[4:7], a[16:19], 0
  ds_read_b64_tr_b16 a[52:53], v14 offset:18432
  v_cndmask_b32 v225, v225, v22, s[50:51]
  v_mfma_f32_16x16x32_bf16 v[120:123], a[0:3], a[20:23], 0
  ds_read_b64_tr_b16 a[54:55], v15 offset:18432
  ds_read_b64_tr_b16 a[56:57], v14 offset:18464
  s_mov_b32 s50, 0xffff0000
  v_mfma_f32_16x16x32_bf16 v[156:159], a[4:7], a[20:23], 0
  ds_read_b64_tr_b16 a[58:59], v15 offset:18464
  s_add_u32 m0, s35, 77824
  s_add_u32 s55, s36, 442368
  buffer_load_dwordx4 v208, s[12:15], s55 offen lds
  v_mfma_f32_16x16x32_bf16 v[124:127], a[0:3], a[24:27], 0
  ds_read_b64_tr_b16 a[60:61], v14 offset:18496
  ds_read_b64_tr_b16 a[62:63], v15 offset:18496
  s_mov_b32 s51, 0xffffffff
  v_mfma_f32_16x16x32_bf16 v[160:163], a[4:7], a[24:27], 0
  ds_read_b64_tr_b16 a[64:65], v14 offset:18528
  v_add_u32 v22, 4704, v3
  v_mfma_f32_16x16x32_bf16 v[128:131], a[0:3], a[28:31], 0
  ds_read_b64_tr_b16 a[66:67], v15 offset:18528
  ds_read_b64_tr_b16 a[68:69], v14 offset:18560
  v_cndmask_b32 v226, v23, v22, s[50:51]
  v_mfma_f32_16x16x32_bf16 v[164:167], a[4:7], a[28:31], 0
  ds_read_b64_tr_b16 a[70:71], v15 offset:18560
  buffer_load_dwordx4 v209, s[12:15], s55 offen offset:1024 lds
  s_waitcnt lgkmcnt(12)
  v_mfma_f32_16x16x32_bf16 v[132:135], a[0:3], a[32:35], 0
  ds_read_b64_tr_b16 a[72:73], v14 offset:18592
  ds_read_b64_tr_b16 a[74:75], v15 offset:18592
  s_mov_b32 s50, 0xc000c000
  v_mfma_f32_16x16x32_bf16 v[168:171], a[4:7], a[32:35], 0
  ds_read_b64_tr_b16 a[76:77], v14 offset:18624
  s_mov_b32 s51, 0x0
  v_mfma_f32_16x16x32_bf16 v[136:139], a[0:3], a[36:39], 0
  ds_read_b64_tr_b16 a[78:79], v15 offset:18624
  ds_read_b64_tr_b16 a[80:81], v14 offset:18656
  v_add_u32 v22, 3488, v3
  v_mfma_f32_16x16x32_bf16 v[172:175], a[4:7], a[36:39], 0
  ds_read_b64_tr_b16 a[82:83], v15 offset:18656
  buffer_load_dwordx4 v210, s[12:15], s55 offen offset:2048 lds
  v_mfma_f32_16x16x32_bf16 v[140:143], a[0:3], a[40:43], 0
  ds_read_b64_tr_b16 a[84:85], v14 offset:18688
  ds_read_b64_tr_b16 a[86:87], v15 offset:18688
  v_cndmask_b32 v227, v23, v22, s[50:51]
  s_mov_b32 s50, 0xffffffff
  v_mfma_f32_16x16x32_bf16 v[176:179], a[4:7], a[40:43], 0
  s_mov_b32 s51, 0x0
  v_add_u32 v22, 4768, v3
  v_mfma_f32_16x16x32_bf16 v[144:147], a[0:3], a[44:47], 0
  v_cndmask_b32 v228, v23, v22, s[50:51]
  v_add_u32 v3, 1, v20
  v_mfma_f32_16x16x32_bf16 v[180:183], a[4:7], a[44:47], 0
  buffer_load_dwordx4 v211, s[12:15], s55 offen offset:3072 lds
  v_mfma_f32_16x16x32_bf16 v[148:151], a[0:3], a[48:51], 0
  v_lshrrev_b32 v3, 1, v3
  v_lshrrev_b32 v22, 1, v20
  v_mfma_f32_16x16x32_bf16 v[184:187], a[4:7], a[48:51], 0
  v_lshl_add_u32 v3, v3, 2, v21
  v_mul_u32_u24 v1, 9, v22
  s_waitcnt lgkmcnt(0)
  v_mfma_f32_16x16x32_bf16 v[116:119], a[8:11], a[52:55], v[116:119]
  s_add_u32 m0, s35, 81920
  s_nop 0
  buffer_load_dwordx4 v212, s[12:15], s55 offen lds
  s_waitcnt vmcnt(9)
  s_barrier
  ds_read_b128 a[0:3], v12 offset:36864
  ds_read_b128 a[4:7], v12 offset:38912
  v_lshrrev_b32 v1, 1, v1
  v_mfma_f32_16x16x32_bf16 v[152:155], a[12:15], a[52:55], v[152:155]
  ds_read_b64_tr_b16 a[16:17], v14 offset:36864
  v_sub_u32 v3, v3, v1
  v_mfma_f32_16x16x32_bf16 v[120:123], a[8:11], a[56:59], v[120:123]
  ds_read_b64_tr_b16 a[18:19], v15 offset:36864
  ds_read_b64_tr_b16 a[20:21], v14 offset:36896
  s_mov_b32 s50, 0xf500af
  v_mfma_f32_16x16x32_bf16 v[156:159], a[12:15], a[56:59], v[156:159]
  ds_read_b64_tr_b16 a[22:23], v15 offset:36896
  s_add_u32 m0, s35, 110592
  s_add_u32 s54, s31, 384
  buffer_load_dwordx4 v204, s[20:23], s54 offen lds
  v_mfma_f32_16x16x32_bf16 v[124:127], a[8:11], a[60:63], v[124:127]
  ds_read_b64_tr_b16 a[24:25], v14 offset:36928
  ds_read_b64_tr_b16 a[26:27], v15 offset:36928
  s_mov_b32 s51, 0x550055
  v_mfma_f32_16x16x32_bf16 v[160:163], a[12:15], a[60:63], v[160:163]
  ds_read_b64_tr_b16 a[28:29], v14 offset:36960
  v_mul_u32_u24 v22, 1520, v22
  v_mfma_f32_16x16x32_bf16 v[128:131], a[8:11], a[64:67], v[128:131]
  ds_read_b64_tr_b16 a[30:31], v15 offset:36960
  ds_read_b64_tr_b16 a[32:33], v14 offset:36992
  v_lshl_add_u32 v3, v3, 4, v22
  v_mfma_f32_16x16x32_bf16 v[164:167], a[12:15], a[64:67], v[164:167]
  ds_read_b64_tr_b16 a[34:35], v15 offset:36992
  buffer_load_dwordx4 v205, s[20:23], s54 offen offset:1024 lds
  v_mfma_f32_16x16x32_bf16 v[132:135], a[8:11], a[68:71], v[132:135]
  ds_read_b64_tr_b16 a[36:37], v14 offset:37024
  ds_read_b64_tr_b16 a[38:39], v15 offset:37024
  s_add_u32 s6, s6, 1440
  v_mfma_f32_16x16x32_bf16 v[168:171], a[12:15], a[68:71], v[168:171]
  ds_read_b64_tr_b16 a[40:41], v14 offset:37056
  v_add_u32 v3, s6, v3
  v_mfma_f32_16x16x32_bf16 v[136:139], a[8:11], a[72:75], v[136:139]
  ds_read_b64_tr_b16 a[42:43], v15 offset:37056
  ds_read_b64_tr_b16 a[44:45], v14 offset:37088
  v_cndmask_b32 v229, v23, v3, s[50:51]
  v_mfma_f32_16x16x32_bf16 v[172:175], a[12:15], a[72:75], v[172:175]
  ds_read_b64_tr_b16 a[46:47], v15 offset:37088
  buffer_load_dwordx4 v206, s[20:23], s54 offen offset:2048 lds
  v_mfma_f32_16x16x32_bf16 v[140:143], a[8:11], a[76:79], v[140:143]
  ds_read_b64_tr_b16 a[48:49], v14 offset:37120
  ds_read_b64_tr_b16 a[50:51], v15 offset:37120
  s_mov_b32 s50, 0x10001
  s_mov_b32 s51, 0x10001
  v_mfma_f32_16x16x32_bf16 v[176:179], a[12:15], a[76:79], v[176:179]
  v_cndmask_b32 v236, 0, v24, s[50:51]
  v_cndmask_b32 v237, 0, v24, s[50:51]
  v_mfma_f32_16x16x32_bf16 v[144:147], a[8:11], a[80:83], v[144:147]
  v_cndmask_b32 v238, 0, v24, s[50:51]
  v_cndmask_b32 v239, 0, v24, s[50:51]
  v_mfma_f32_16x16x32_bf16 v[180:183], a[12:15], a[80:83], v[180:183]
  buffer_load_dwordx4 v207, s[20:23], s54 offen offset:3072 lds
  v_mfma_f32_16x16x32_bf16 v[148:151], a[8:11], a[84:87], v[148:151]
  s_mov_b32 s50, 0x60006
  s_mov_b32 s51, 0x60006
  v_mfma_f32_16x16x32_bf16 v[184:187], a[12:15], a[84:87], v[184:187]
  v_cndmask_b32 v240, 0, v24, s[50:51]
  v_cndmask_b32 v241, 0, v24, s[50:51]
  s_waitcnt lgkmcnt(6)
  v_mfma_f32_16x16x32_bf16 v[116:119], a[0:3], a[16:19], v[116:119]
  ds_read_b128 a[8:11], v13 offset:36864
  ds_read_b128 a[12:15], v13 offset:38912
  v_cndmask_b32 v242, 0, v24, s[50:51]
  v_mfma_f32_16x16x32_bf16 v[152:155], a[4:7], a[16:19], v[152:155]
  ds_read_b64_tr_b16 a[52:53], v14 offset:55296
  v_cndmask_b32 v243, 0, v24, s[50:51]
  v_mfma_f32_16x16x32_bf16 v[120:123], a[0:3], a[20:23], v[120:123]
  ds_read_b64_tr_b16 a[54:55], v15 offset:55296
  ds_read_b64_tr_b16 a[56:57], v14 offset:55328
  s_mov_b32 s50, 0x180018
  v_mfma_f32_16x16x32_bf16 v[156:159], a[4:7], a[20:23], v[156:159]
  ds_read_b64_tr_b16 a[58:59], v15 offset:55328
  s_add_u32 m0, s35, 114688
  s_add_u32 s55, s36, 663552
  buffer_load_dwordx4 v208, s[12:15], s55 offen lds
  v_mfma_f32_16x16x32_bf16 v[124:127], a[0:3], a[24:27], v[124:127]
  ds_read_b64_tr_b16 a[60:61], v14 offset:55360
  ds_read_b64_tr_b16 a[62:63], v15 offset:55360
  s_mov_b32 s51, 0x180018
  v_mfma_f32_16x16x32_bf16 v[160:163], a[4:7], a[24:27], v[160:163]
  ds_read_b64_tr_b16 a[64:65], v14 offset:55392
  v_cndmask_b32 v244, 0, v24, s[50:51]
  v_mfma_f32_16x16x32_bf16 v[128:131], a[0:3], a[28:31], v[128:131]
  ds_read_b64_tr_b16 a[66:67], v15 offset:55392
  ds_read_b64_tr_b16 a[68:69], v14 offset:55424
  v_cndmask_b32 v245, 0, v24, s[50:51]
  v_mfma_f32_16x16x32_bf16 v[164:167], a[4:7], a[28:31], v[164:167]
  ds_read_b64_tr_b16 a[70:71], v15 offset:55424
  buffer_load_dwordx4 v209, s[12:15], s55 offen offset:1024 lds
  s_waitcnt lgkmcnt(12)
  v_mfma_f32_16x16x32_bf16 v[132:135], a[0:3], a[32:35], v[132:135]
  ds_read_b64_tr_b16 a[72:73], v14 offset:55456
  ds_read_b64_tr_b16 a[74:75], v15 offset:55456
  v_cndmask_b32 v246, 0, v24, s[50:51]
  v_mfma_f32_16x16x32_bf16 v[168:171], a[4:7], a[32:35], v[168:171]
  ds_read_b64_tr_b16 a[76:77], v14 offset:55488
  v_cndmask_b32 v247, 0, v24, s[50:51]
  v_mfma_f32_16x16x32_bf16 v[136:139], a[0:3], a[36:39], v[136:139]
  ds_read_b64_tr_b16 a[78:79], v15 offset:55488
  ds_read_b64_tr_b16 a[80:81], v14 offset:55520
  s_mov_b32 s50, 0x600060
  v_mfma_f32_16x16x32_bf16 v[172:175], a[4:7], a[36:39], v[172:175]
  ds_read_b64_tr_b16 a[82:83], v15 offset:55520
  buffer_load_dwordx4 v210, s[12:15], s55 offen offset:2048 lds
  v_mfma_f32_16x16x32_bf16 v[140:143], a[0:3], a[40:43], v[140:143]
  ds_read_b64_tr_b16 a[84:85], v14 offset:55552
  ds_read_b64_tr_b16 a[86:87], v15 offset:55552
  s_mov_b32 s51, 0x600060
  v_cndmask_b32 v248, 0, v24, s[50:51]
  v_mfma_f32_16x16x32_bf16 v[176:179], a[4:7], a[40:43], v[176:179]
  v_cndmask_b32 v249, 0, v24, s[50:51]
  v_cndmask_b32 v250, 0, v24, s[50:51]
  v_mfma_f32_16x16x32_bf16 v[144:147], a[0:3], a[44:47], v[144:147]
  v_cndmask_b32 v251, 0, v24, s[50:51]
  s_mov_b32 s50, 0x800080
  v_mfma_f32_16x16x32_bf16 v[180:183], a[4:7], a[44:47], v[180:183]
  buffer_load_dwordx4 v211, s[12:15], s55 offen offset:3072 lds
  v_mfma_f32_16x16x32_bf16 v[148:151], a[0:3], a[48:51], v[148:151]
  s_mov_b32 s51, 0x800080
  v_cndmask_b32 v252, 0, v24, s[50:51]
  v_mfma_f32_16x16x32_bf16 v[184:187], a[4:7], a[48:51], v[184:187]
  v_cndmask_b32 v253, 0, v24, s[50:51]
  v_cndmask_b32 v254, 0, v24, s[50:51]
  s_waitcnt lgkmcnt(0)
  v_mfma_f32_16x16x32_bf16 v[116:119], a[8:11], a[52:55], v[116:119]
  s_add_u32 m0, s35, 118784
  s_nop 0
  buffer_load_dwordx4 v212, s[12:15], s55 offen lds
  s_waitcnt vmcnt(9)
  s_barrier
  ds_read_b128 a[0:3], v16 offset:0
  ds_read_b128 a[4:7], v16 offset:2048
  v_cndmask_b32 v255, 0, v24, s[50:51]
  v_mfma_f32_16x16x32_bf16 v[152:155], a[12:15], a[52:55], v[152:155]
  ds_read_b64_tr_b16 a[16:17], v18 offset:0
  s_mul_i32 s6, s29, 6080
  v_mfma_f32_16x16x32_bf16 v[120:123], a[8:11], a[56:59], v[120:123]
  ds_read_b64_tr_b16 a[18:19], v19 offset:0
  ds_read_b64_tr_b16 a[20:21], v18 offset:32
  v_mov_b32 v23, 1073741824
  v_mfma_f32_16x16x32_bf16 v[156:159], a[12:15], a[56:59], v[156:159]
  ds_read_b64_tr_b16 a[22:23], v19 offset:32
  s_add_u32 m0, s35, 0
  s_add_u32 s54, s31, 512
  buffer_load_dwordx4 v204, s[20:23], s54 offen lds
  v_mfma_f32_16x16x32_bf16 v[124:127], a[8:11], a[60:63], v[124:127]
  ds_read_b64_tr_b16 a[24:25], v18 offset:64
  ds_read_b64_tr_b16 a[26:27], v19 offset:64
  v_add_u32 v3, 0, v0
  v_mfma_f32_16x16x32_bf16 v[160:163], a[12:15], a[60:63], v[160:163]
  ds_read_b64_tr_b16 a[28:29], v18 offset:96
  v_mul_u32_u24 v22, 3277, v3
  v_mfma_f32_16x16x32_bf16 v[128:131], a[8:11], a[64:67], v[128:131]
  ds_read_b64_tr_b16 a[30:31], v19 offset:96
  ds_read_b64_tr_b16 a[32:33], v18 offset:128
  v_lshrrev_b32 v22, 16, v22
  v_mfma_f32_16x16x32_bf16 v[164:167], a[12:15], a[64:67], v[164:167]
  ds_read_b64_tr_b16 a[34:35], v19 offset:128
  buffer_load_dwordx4 v205, s[20:23], s54 offen offset:1024 lds
  v_mfma_f32_16x16x32_bf16 v[132:135], a[8:11], a[68:71], v[132:135]
  ds_read_b64_tr_b16 a[36:37], v18 offset:160
  ds_read_b64_tr_b16 a[38:39], v19 offset:160
  v_mul_u32_u24 v1, 20, v22
  v_mfma_f32_16x16x32_bf16 v[168:171], a[12:15], a[68:71], v[168:171]
  ds_read_b64_tr_b16 a[40:41], v18 offset:192
  v_sub_u32 v1, v3, v1
  v_mfma_f32_16x16x32_bf16 v[136:139], a[8:11], a[72:75], v[136:139]
  ds_read_b64_tr_b16 a[42:43], v19 offset:192
  ds_read_b64_tr_b16 a[44:45], v18 offset:224
  v_mul_u32_u24 v22, 27, v22
  v_mfma_f32_16x16x32_bf16 v[172:175], a[12:15], a[72:75], v[172:175]
  ds_read_b64_tr_b16 a[46:47], v19 offset:224
  buffer_load_dwordx4 v206, s[20:23], s54 offen offset:2048 lds
  v_mfma_f32_16x16x32_bf16 v[140:143], a[8:11], a[76:79], v[140:143]
  ds_read_b64_tr_b16 a[48:49], v18 offset:256
  ds_read_b64_tr_b16 a[50:51], v19 offset:256
  v_lshrrev_b32 v22, 8, v22
  v_and_b32 v22, 2, v22
  v_mfma_f32_16x16x32_bf16 v[176:179], a[12:15], a[76:79], v[176:179]
  v_sub_u32 v1, v1, v22
  v_cmp_gt_u32 s[50:51], 18, v1
  v_mfma_f32_16x16x32_bf16 v[144:147], a[8:11], a[80:83], v[144:147]
  v_lshlrev_b32 v3, 2, v3
  v_add_u32 v3, s6, v3
  v_mfma_f32_16x16x32_bf16 v[180:183], a[12:15], a[80:83], v[180:183]
  buffer_load_dwordx4 v207, s[20:23], s54 offen offset:3072 lds
  v_mfma_f32_16x16x32_bf16 v[148:151], a[8:11], a[84:87], v[148:151]
  v_cndmask_b32 v230, v23, v3, s[50:51]
  v_add_u32 v3, 256, v0
  v_mfma_f32_16x16x32_bf16 v[184:187], a[12:15], a[84:87], v[184:187]
  v_mul_u32_u24 v22, 3277, v3
  v_lshrrev_b32 v22, 16, v22
  s_waitcnt lgkmcnt(6)
  v_mfma_f32_16x16x32_bf16 v[116:119], a[0:3], a[16:19], v[116:119]
  ds_read_b128 a[8:11], v17 offset:0
  ds_read_b128 a[12:15], v17 offset:2048
  v_mul_u32_u24 v1, 20, v22
  v_mfma_f32_16x16x32_bf16 v[152:155], a[4:7], a[16:19], v[152:155]
  ds_read_b64_tr_b16 a[52:53], v18 offset:18432
  v_sub_u32 v1, v3, v1
  v_mfma_f32_16x16x32_bf16 v[120:123], a[0:3], a[20:23], v[120:123]
  ds_read_b64_tr_b16 a[54:55], v19 offset:18432
  ds_read_b64_tr_b16 a[56:57], v18 offset:18464
  v_mul_u32_u24 v22, 27, v22
  v_mfma_f32_16x16x32_bf16 v[156:159], a[4:7], a[20:23], v[156:159]
  ds_read_b64_tr_b16 a[58:59], v19 offset:18464
  s_add_u32 m0, s35, 4096
  s_add_u32 s55, s36, 884736
  buffer_load_dwordx4 v208, s[12:15], s55 offen lds
  v_mfma_f32_16x16x32_bf16 v[124:127], a[0:3], a[24:27], v[124:127]
  ds_read_b64_tr_b16 a[60:61], v18 offset:18496
  ds_read_b64_tr_b16 a[62:63], v19 offset:18496
  v_lshrrev_b32 v22, 8, v22
  v_mfma_f32_16x16x32_bf16 v[160:163], a[4:7], a[24:27], v[160:163]
  ds_read_b64_tr_b16 a[64:65], v18 offset:18528
  v_and_b32 v22, 2, v22
  v_mfma_f32_16x16x32_bf16 v[128:131], a[0:3], a[28:31], v[128:131]
  ds_read_b64_tr_b16 a[66:67], v19 offset:18528
  ds_read_b64_tr_b16 a[68:69], v18 offset:18560
  v_sub_u32 v1, v1, v22
  v_mfma_f32_16x16x32_bf16 v[164:167], a[4:7], a[28:31], v[164:167]
  ds_read_b64_tr_b16 a[70:71], v19 offset:18560
  buffer_load_dwordx4 v209, s[12:15], s55 offen offset:1024 lds
  s_waitcnt lgkmcnt(12)
  v_mfma_f32_16x16x32_bf16 v[132:135], a[0:3], a[32:35], v[132:135]
  ds_read_b64_tr_b16 a[72:73], v18 offset:18592
  ds_read_b64_tr_b16 a[74:75], v19 offset:18592
  v_cmp_gt_u32 s[50:51], 18, v1
  v_mfma_f32_16x16x32_bf16 v[168:171], a[4:7], a[32:35], v[168:171]
  ds_read_b64_tr_b16 a[76:77], v18 offset:18624
  v_lshlrev_b32 v3, 2, v3
  v_mfma_f32_16x16x32_bf16 v[136:139], a[0:3], a[36:39], v[136:139]
  ds_read_b64_tr_b16 a[78:79], v19 offset:18624
  ds_read_b64_tr_b16 a[80:81], v18 offset:18656
  v_add_u32 v3, s6, v3
  v_mfma_f32_16x16x32_bf16 v[172:175], a[4:7], a[36:39], v[172:175]
  ds_read_b64_tr_b16 a[82:83], v19 offset:18656
  buffer_load_dwordx4 v210, s[12:15], s55 offen offset:2048 lds
  v_mfma_f32_16x16x32_bf16 v[140:143], a[0:3], a[40:43], v[140:143]
  ds_read_b64_tr_b16 a[84:85], v18 offset:18688
  ds_read_b64_tr_b16 a[86:87], v19 offset:18688
  v_cndmask_b32 v231, v23, v3, s[50:51]
  v_add_u32 v3, 512, v0
  v_mfma_f32_16x16x32_bf16 v[176:179], a[4:7], a[40:43], v[176:179]
  v_mul_u32_u24 v22, 3277, v3
  v_lshrrev_b32 v22, 16, v22
  v_mfma_f32_16x16x32_bf16 v[144:147], a[0:3], a[44:47], v[144:147]
  v_mul_u32_u24 v1, 20, v22
  v_sub_u32 v1, v3, v1
  v_mfma_f32_16x16x32_bf16 v[180:183], a[4:7], a[44:47], v[180:183]
  buffer_load_dwordx4 v211, s[12:15], s55 offen offset:3072 lds
  v_mfma_f32_16x16x32_bf16 v[148:151], a[0:3], a[48:51], v[148:151]
  v_mul_u32_u24 v22, 27, v22
  v_lshrrev_b32 v22, 8, v22
  v_mfma_f32_16x16x32_bf16 v[184:187], a[4:7], a[48:51], v[184:187]
  v_and_b32 v22, 2, v22
  v_sub_u32 v1, v1, v22
  s_waitcnt lgkmcnt(0)
  v_mfma_f32_16x16x32_bf16 v[116:119], a[8:11], a[52:55], v[116:119]
  s_add_u32 m0, s35, 8192
  s_nop 0
  buffer_load_dwordx4 v212, s[12:15], s55 offen lds
  s_waitcnt vmcnt(9)
  s_barrier
  ds_read_b128 a[0:3], v16 offset:36864
  ds_read_b128 a[4:7], v16 offset:38912
  v_cmp_gt_u32 s[50:51], 18, v1
  v_mfma_f32_16x16x32_bf16 v[152:155], a[12:15], a[52:55], v[152:155]
  ds_read_b64_tr_b16 a[16:17], v18 offset:36864
  v_lshlrev_b32 v3, 2, v3
  v_mfma_f32_16x16x32_bf16 v[120:123], a[8:11], a[56:59], v[120:123]
  ds_read_b64_tr_b16 a[18:19], v19 offset:36864
  ds_read_b64_tr_b16 a[20:21], v18 offset:36896
  v_add_u32 v3, s6, v3
  v_mfma_f32_16x16x32_bf16 v[156:159], a[12:15], a[56:59], v[156:159]
  ds_read_b64_tr_b16 a[22:23], v19 offset:36896
  s_add_u32 m0, s35, 36864
  s_add_u32 s54, s31, 640
  buffer_load_dwordx4 v204, s[20:23], s54 offen lds
  v_mfma_f32_16x16x32_bf16 v[124:127], a[8:11], a[60:63], v[124:127]
  ds_read_b64_tr_b16 a[24:25], v18 offset:36928
  ds_read_b64_tr_b16 a[26:27], v19 offset:36928
  v_cndmask_b32 v232, v23, v3, s[50:51]
  v_mfma_f32_16x16x32_bf16 v[160:163], a[12:15], a[60:63], v[160:163]
  ds_read_b64_tr_b16 a[28:29], v18 offset:36960
  v_add_u32 v3, 768, v0
  v_mfma_f32_16x16x32_bf16 v[128:131], a[8:11], a[64:67], v[128:131]
  ds_read_b64_tr_b16 a[30:31], v19 offset:36960
  ds_read_b64_tr_b16 a[32:33], v18 offset:36992
  v_mul_u32_u24 v22, 3277, v3
  v_mfma_f32_16x16x32_bf16 v[164:167], a[12:15], a[64:67], v[164:167]
  ds_read_b64_tr_b16 a[34:35], v19 offset:36992
  buffer_load_dwordx4 v205, s[20:23], s54 offen offset:1024 lds
  v_mfma_f32_16x16x32_bf16 v[132:135], a[8:11], a[68:71], v[132:135]
  ds_read_b64_tr_b16 a[36:37], v18 offset:37024
  ds_read_b64_tr_b16 a[38:39], v19 offset:37024
  v_lshrrev_b32 v22, 16, v22
  v_mfma_f32_16x16x32_bf16 v[168:171], a[12:15], a[68:71], v[168:171]
  ds_read_b64_tr_b16 a[40:41], v18 offset:37056
  v_mul_u32_u24 v1, 20, v22
  v_mfma_f32_16x16x32_bf16 v[136:139], a[8:11], a[72:75], v[136:139]
  ds_read_b64_tr_b16 a[42:43], v19 offset:37056
  ds_read_b64_tr_b16 a[44:45], v18 offset:37088
  v_sub_u32 v1, v3, v1
  v_mfma_f32_16x16x32_bf16 v[172:175], a[12:15], a[72:75], v[172:175]
  ds_read_b64_tr_b16 a[46:47], v19 offset:37088
  buffer_load_dwordx4 v206, s[20:23], s54 offen offset:2048 lds
  v_mfma_f32_16x16x32_bf16 v[140:143], a[8:11], a[76:79], v[140:143]
  ds_read_b64_tr_b16 a[48:49], v18 offset:37120
  ds_read_b64_tr_b16 a[50:51], v19 offset:37120
  v_mul_u32_u24 v22, 27, v22
  v_lshrrev_b32 v22, 8, v22
  v_mfma_f32_16x16x32_bf16 v[176:179], a[12:15], a[76:79], v[176:179]
  v_and_b32 v22, 2, v22
  v_sub_u32 v1, v1, v22
  v_mfma_f32_16x16x32_bf16 v[144:147], a[8:11], a[80:83], v[144:147]
  v_cmp_gt_u32 s[50:51], 18, v1
  v_lshlrev_b32 v3, 2, v3
  v_mfma_f32_16x16x32_bf16 v[180:183], a[12:15], a[80:83], v[180:183]
  buffer_load_dwordx4 v207, s[20:23], s54 offen offset:3072 lds
  v_mfma_f32_16x16x32_bf16 v[148:151], a[8:11], a[84:87], v[148:151]
  v_add_u32 v3, s6, v3
  v_cndmask_b32 v233, v23, v3, s[50:51]
  v_mfma_f32_16x16x32_bf16 v[184:187], a[12:15], a[84:87], v[184:187]
  v_add_u32 v3, 1024, v0
  v_mul_u32_u24 v22, 3277, v3
  s_waitcnt lgkmcnt(6)
  v_mfma_f32_16x16x32_bf16 v[116:119], a[0:3], a[16:19], v[116:119]
  ds_read_b128 a[8:11], v17 offset:36864
  ds_read_b128 a[12:15], v17 offset:38912
  v_lshrrev_b32 v22, 16, v22
  v_mfma_f32_16x16x32_bf16 v[152:155], a[4:7], a[16:19], v[152:155]
  ds_read_b64_tr_b16 a[52:53], v18 offset:55296
  v_mul_u32_u24 v1, 20, v22
  v_mfma_f32_16x16x32_bf16 v[120:123], a[0:3], a[20:23], v[120:123]
  ds_read_b64_tr_b16 a[54:55], v19 offset:55296
  ds_read_b64_tr_b16 a[56:57], v18 offset:55328
  v_sub_u32 v1, v3, v1
  v_mfma_f32_16x16x32_bf16 v[156:159], a[4:7], a[20:23], v[156:159]
  ds_read_b64_tr_b16 a[58:59], v19 offset:55328
  s_add_u32 m0, s35, 40960
  s_add_u32 s55, s36, 1105920
  buffer_load_dwordx4 v208, s[12:15], s55 offen lds
  v_mfma_f32_16x16x32_bf16 v[124:127], a[0:3], a[24:27], v[124:127]
  ds_read_b64_tr_b16 a[60:61], v18 offset:55360
  ds_read_b64_tr_b16 a[62:63], v19 offset:55360
  v_mul_u32_u24 v22, 27, v22
  v_mfma_f32_16x16x32_bf16 v[160:163], a[4:7], a[24:27], v[160:163]
  ds_read_b64_tr_b16 a[64:65], v18 offset:55392
  v_lshrrev_b32 v22, 8, v22
  v_mfma_f32_16x16x32_bf16 v[128:131], a[0:3], a[28:31], v[128:131]
  ds_read_b64_tr_b16 a[66:67], v19 offset:55392
  ds_read_b64_tr_b16 a[68:69], v18 offset:55424
  v_and_b32 v22, 2, v22
  v_mfma_f32_16x16x32_bf16 v[164:167], a[4:7], a[28:31], v[164:167]
  ds_read_b64_tr_b16 a[70:71], v19 offset:55424
  buffer_load_dwordx4 v209, s[12:15], s55 offen offset:1024 lds
  s_waitcnt lgkmcnt(12)
  v_mfma_f32_16x16x32_bf16 v[132:135], a[0:3], a[32:35], v[132:135]
  ds_read_b64_tr_b16 a[72:73], v18 offset:55456
  ds_read_b64_tr_b16 a[74:75], v19 offset:55456
  v_sub_u32 v1, v1, v22
  v_mfma_f32_16x16x32_bf16 v[168:171], a[4:7], a[32:35], v[168:171]
  ds_read_b64_tr_b16 a[76:77], v18 offset:55488
  v_cmp_gt_u32 s[50:51], 18, v1
  v_mfma_f32_16x16x32_bf16 v[136:139], a[0:3], a[36:39], v[136:139]
  ds_read_b64_tr_b16 a[78:79], v19 offset:55488
  ds_read_b64_tr_b16 a[80:81], v18 offset:55520
  v_lshlrev_b32 v3, 2, v3
  v_mfma_f32_16x16x32_bf16 v[172:175], a[4:7], a[36:39], v[172:175]
  ds_read_b64_tr_b16 a[82:83], v19 offset:55520
  buffer_load_dwordx4 v210, s[12:15], s55 offen offset:2048 lds
  v_mfma_f32_16x16x32_bf16 v[140:143], a[0:3], a[40:43], v[140:143]
  ds_read_b64_tr_b16 a[84:85], v18 offset:55552
  ds_read_b64_tr_b16 a[86:87], v19 offset:55552
  v_add_u32 v3, s6, v3
  v_cndmask_b32 v234, v23, v3, s[50:51]
  v_mfma_f32_16x16x32_bf16 v[176:179], a[4:7], a[40:43], v[176:179]
  v_add_u32 v3, 1280, v0
  v_mul_u32_u24 v22, 3277, v3
  v_mfma_f32_16x16x32_bf16 v[144:147], a[0:3], a[44:47], v[144:147]
  v_lshrrev_b32 v22, 16, v22
  v_mul_u32_u24 v1, 20, v22
  v_mfma_f32_16x16x32_bf16 v[180:183], a[4:7], a[44:47], v[180:183]
  buffer_load_dwordx4 v211, s[12:15], s55 offen offset:3072 lds
  v_mfma_f32_16x16x32_bf16 v[148:151], a[0:3], a[48:51], v[148:151]
  v_sub_u32 v1, v3, v1
  v_mul_u32_u24 v22, 27, v22
  v_mfma_f32_16x16x32_bf16 v[184:187], a[4:7], a[48:51], v[184:187]
  v_lshrrev_b32 v22, 8, v22
  v_and_b32 v22, 2, v22
  s_waitcnt lgkmcnt(0)
  v_mfma_f32_16x16x32_bf16 v[116:119], a[8:11], a[52:55], v[116:119]
HP_kv_p0:
  s_cbranch_execz HP_kv_ret
  s_add_u32 m0, s35, 45056
  s_nop 0
  buffer_load_dwordx4 v212, s[12:15], s55 offen lds
  s_waitcnt vmcnt(9)
  s_barrier
  ds_read_b128 a[0:3], v12 offset:0
  ds_read_b128 a[4:7], v12 offset:2048
  v_sub_u32 v1, v1, v22
  v_mfma_f32_16x16x32_bf16 v[152:155], a[12:15], a[52:55], v[152:155]
  ds_read_b64_tr_b16 a[16:17], v14 offset:0
  v_cmp_gt_u32 s[50:51], 18, v1
  v_mfma_f32_16x16x32_bf16 v[120:123], a[8:11], a[56:59], v[120:123]
  ds_read_b64_tr_b16 a[18:19], v15 offset:0
  ds_read_b64_tr_b16 a[20:21], v14 offset:32
  v_lshlrev_b32 v3, 2, v3
  v_mfma_f32_16x16x32_bf16 v[156:159], a[12:15], a[56:59], v[156:159]
  ds_read_b64_tr_b16 a[22:23], v15 offset:32
  s_add_u32 m0, s35, 73728
  s_add_u32 s54, s31, 768
  buffer_load_dwordx4 v204, s[20:23], s54 offen lds
  v_mfma_f32_16x16x32_bf16 v[124:127], a[8:11], a[60:63], v[124:127]
  ds_read_b64_tr_b16 a[24:25], v14 offset:64
  ds_read_b64_tr_b16 a[26:27], v15 offset:64
  v_add_u32 v3, s6, v3
  v_mfma_f32_16x16x32_bf16 v[160:163], a[12:15], a[60:63], v[160:163]
  ds_read_b64_tr_b16 a[28:29], v14 offset:96
  v_cndmask_b32 v235, v23, v3, s[50:51]
  v_mfma_f32_16x16x32_bf16 v[128:131], a[8:11], a[64:67], v[128:131]
  ds_read_b64_tr_b16 a[30:31], v15 offset:96
  ds_read_b64_tr_b16 a[32:33], v14 offset:128
  v_cmp_gt_u32 vcc, 240, v0
  v_mfma_f32_16x16x32_bf16 v[164:167], a[12:15], a[64:67], v[164:167]
  ds_read_b64_tr_b16 a[34:35], v15 offset:128
  buffer_load_dwordx4 v205, s[20:23], s54 offen offset:1024 lds
  v_mfma_f32_16x16x32_bf16 v[132:135], a[8:11], a[68:71], v[132:135]
  ds_read_b64_tr_b16 a[36:37], v14 offset:160
  ds_read_b64_tr_b16 a[38:39], v15 offset:160
  s_lshr_b32 s39, s29, 1
  v_mfma_f32_16x16x32_bf16 v[168:171], a[12:15], a[68:71], v[168:171]
  ds_read_b64_tr_b16 a[40:41], v14 offset:192
  s_lshl_b32 s39, s39, 12
  v_mfma_f32_16x16x32_bf16 v[136:139], a[8:11], a[72:75], v[136:139]
  ds_read_b64_tr_b16 a[42:43], v15 offset:192
  ds_read_b64_tr_b16 a[44:45], v14 offset:224
  v_cndmask_b32 v235, v23, v235, vcc
  v_mfma_f32_16x16x32_bf16 v[172:175], a[12:15], a[72:75], v[172:175]
  ds_read_b64_tr_b16 a[46:47], v15 offset:224
  buffer_load_dwordx4 v206, s[20:23], s54 offen offset:2048 lds
  v_mfma_f32_16x16x32_bf16 v[140:143], a[8:11], a[76:79], v[140:143]
  ds_read_b64_tr_b16 a[48:49], v14 offset:256
  ds_read_b64_tr_b16 a[50:51], v15 offset:256
  s_add_u32 s39, s39, 2867200
  s_lshl_b32 s52, s52, 7
  v_mfma_f32_16x16x32_bf16 v[176:179], a[12:15], a[76:79], v[176:179]
  s_add_u32 s52, s52, 2719744
  s_lshl_b32 s53, s53, 1
  v_mfma_f32_16x16x32_bf16 v[144:147], a[8:11], a[80:83], v[144:147]
  s_add_u32 s53, s53, 2621184
  v_lshlrev_b32 v4, 4, v2
  v_mfma_f32_16x16x32_bf16 v[180:183], a[12:15], a[80:83], v[180:183]
  buffer_load_dwordx4 v207, s[20:23], s54 offen offset:3072 lds
  v_mfma_f32_16x16x32_bf16 v[148:151], a[8:11], a[84:87], v[148:151]
  v_cmp_lt_u32 vcc, 33, v2
  v_add_u32 v1, s53, v4
  v_mfma_f32_16x16x32_bf16 v[184:187], a[12:15], a[84:87], v[184:187]
  v_add_u32 v3, 2016, v1
  v_cndmask_b32 v1, v1, v3, vcc
  s_waitcnt lgkmcnt(6)
  v_mfma_f32_16x16x32_bf16 v[116:119], a[0:3], a[16:19], v[116:119]
  ds_read_b128 a[8:11], v13 offset:0
  ds_read_b128 a[12:15], v13 offset:2048
  v_cmp_lt_u32 vcc, 7, v2
  v_mfma_f32_16x16x32_bf16 v[152:155], a[4:7], a[16:19], v[152:155]
  ds_read_b64_tr_b16 a[52:53], v14 offset:18432
  v_add_u32 v4, s52, v4
  v_mfma_f32_16x16x32_bf16 v[120:123], a[0:3], a[20:23], v[120:123]
  ds_read_b64_tr_b16 a[54:55], v15 offset:18432
  ds_read_b64_tr_b16 a[56:57], v14 offset:18464
  v_add_u32 v3, 8064, v4
  v_mfma_f32_16x16x32_bf16 v[156:159], a[4:7], a[20:23], v[156:159]
  ds_read_b64_tr_b16 a[58:59], v15 offset:18464
  s_add_u32 m0, s35, 77824
  s_add_u32 s55, s36, 1327104
  buffer_load_dwordx4 v208, s[12:15], s55 offen lds
  v_mfma_f32_16x16x32_bf16 v[124:127], a[0:3], a[24:27], v[124:127]
  ds_read_b64_tr_b16 a[60:61], v14 offset:18496
  ds_read_b64_tr_b16 a[62:63], v15 offset:18496
  v_cndmask_b32 v4, v4, v3, vcc
  v_mfma_f32_16x16x32_bf16 v[160:163], a[4:7], a[24:27], v[160:163]
  ds_read_b64_tr_b16 a[64:65], v14 offset:18528
  v_cmp_lt_u32 vcc, 15, v2
  v_mfma_f32_16x16x32_bf16 v[128:131], a[0:3], a[28:31], v[128:131]
  ds_read_b64_tr_b16 a[66:67], v15 offset:18528
  ds_read_b64_tr_b16 a[68:69], v14 offset:18560
  s_lshl_b32 s7, s34, 10
  v_mfma_f32_16x16x32_bf16 v[164:167], a[4:7], a[28:31], v[164:167]
  ds_read_b64_tr_b16 a[70:71], v15 offset:18560
  buffer_load_dwordx4 v209, s[12:15], s55 offen offset:1024 lds
  s_waitcnt lgkmcnt(12)
  v_mfma_f32_16x16x32_bf16 v[132:135], a[0:3], a[32:35], v[132:135]
  ds_read_b64_tr_b16 a[72:73], v14 offset:18592
  ds_read_b64_tr_b16 a[74:75], v15 offset:18592
  s_add_u32 s7, s7, 153600
  v_mfma_f32_16x16x32_bf16 v[168:171], a[4:7], a[32:35], v[168:171]
  ds_read_b64_tr_b16 a[76:77], v14 offset:18624
  v_cndmask_b32 v4, v4, v1, vcc
  v_mfma_f32_16x16x32_bf16 v[136:139], a[0:3], a[36:39], v[136:139]
  ds_read_b64_tr_b16 a[78:79], v15 offset:18624
  ds_read_b64_tr_b16 a[80:81], v14 offset:18656
  v_cmp_lt_u32 vcc, 51, v2
  v_mfma_f32_16x16x32_bf16 v[172:175], a[4:7], a[36:39], v[172:175]
  ds_read_b64_tr_b16 a[82:83], v15 offset:18656
  buffer_load_dwordx4 v210, s[12:15], s55 offen offset:2048 lds
  v_mfma_f32_16x16x32_bf16 v[140:143], a[0:3], a[40:43], v[140:143]
  ds_read_b64_tr_b16 a[84:85], v14 offset:18688
  ds_read_b64_tr_b16 a[86:87], v15 offset:18688
  v_mov_b32 v1, 1073741824
  v_add_u32 v8, s7, v8
  v_mfma_f32_16x16x32_bf16 v[176:179], a[4:7], a[40:43], v[176:179]
  v_cndmask_b32 v4, v4, v1, vcc
  v_add_u32 v9, s7, v9
  v_mfma_f32_16x16x32_bf16 v[144:147], a[0:3], a[44:47], v[144:147]
  s_mov_b32 s50, 0x3fb8aa3b
  s_mov_b32 s51, 0x3fb8aa3b
  v_mfma_f32_16x16x32_bf16 v[180:183], a[4:7], a[44:47], v[180:183]
  buffer_load_dwordx4 v211, s[12:15], s55 offen offset:3072 lds
  v_mfma_f32_16x16x32_bf16 v[148:151], a[0:3], a[48:51], v[148:151]
  v_mfma_f32_16x16x32_bf16 v[184:187], a[4:7], a[48:51], v[184:187]
  s_waitcnt lgkmcnt(0)
  v_mfma_f32_16x16x32_bf16 v[116:119], a[8:11], a[52:55], v[116:119]
  s_add_u32 m0, s35, 81920
  s_nop 0
  buffer_load_dwordx4 v212, s[12:15], s55 offen lds
  s_waitcnt vmcnt(9)
  s_barrier
  ds_read_b128 a[0:3], v12 offset:36864
  ds_read_b128 a[4:7], v12 offset:38912
  v_mfma_f32_16x16x32_bf16 v[152:155], a[12:15], a[52:55], v[152:155]
  ds_read_b64_tr_b16 a[16:17], v14 offset:36864
  v_mfma_f32_16x16x32_bf16 v[120:123], a[8:11], a[56:59], v[120:123]
  ds_read_b64_tr_b16 a[18:19], v15 offset:36864
  ds_read_b64_tr_b16 a[20:21], v14 offset:36896
  v_mfma_f32_16x16x32_bf16 v[156:159], a[12:15], a[56:59], v[156:159]
  ds_read_b64_tr_b16 a[22:23], v15 offset:36896
  s_add_u32 m0, s35, 110592
  s_add_u32 s54, s31, 896
  buffer_load_dwordx4 v204, s[20:23], s54 offen lds
  v_mfma_f32_16x16x32_bf16 v[124:127], a[8:11], a[60:63], v[124:127]
  ds_read_b64_tr_b16 a[24:25], v14 offset:36928
  ds_read_b64_tr_b16 a[26:27], v15 offset:36928
  v_mfma_f32_16x16x32_bf16 v[160:163], a[12:15], a[60:63], v[160:163]
  ds_read_b64_tr_b16 a[28:29], v14 offset:36960
  v_mfma_f32_16x16x32_bf16 v[128:131], a[8:11], a[64:67], v[128:131]
  ds_read_b64_tr_b16 a[30:31], v15 offset:36960
  ds_read_b64_tr_b16 a[32:33], v14 offset:36992
  v_mfma_f32_16x16x32_bf16 v[164:167], a[12:15], a[64:67], v[164:167]
  ds_read_b64_tr_b16 a[34:35], v15 offset:36992
  buffer_load_dwordx4 v205, s[20:23], s54 offen offset:1024 lds
  v_mfma_f32_16x16x32_bf16 v[132:135], a[8:11], a[68:71], v[132:135]
  ds_read_b64_tr_b16 a[36:37], v14 offset:37024
  ds_read_b64_tr_b16 a[38:39], v15 offset:37024
  v_mfma_f32_16x16x32_bf16 v[168:171], a[12:15], a[68:71], v[168:171]
  ds_read_b64_tr_b16 a[40:41], v14 offset:37056
  v_mfma_f32_16x16x32_bf16 v[136:139], a[8:11], a[72:75], v[136:139]
  ds_read_b64_tr_b16 a[42:43], v15 offset:37056
  ds_read_b64_tr_b16 a[44:45], v14 offset:37088
  v_mfma_f32_16x16x32_bf16 v[172:175], a[12:15], a[72:75], v[172:175]
  ds_read_b64_tr_b16 a[46:47], v15 offset:37088
  buffer_load_dwordx4 v206, s[20:23], s54 offen offset:2048 lds
  v_mfma_f32_16x16x32_bf16 v[140:143], a[8:11], a[76:79], v[140:143]
  ds_read_b64_tr_b16 a[48:49], v14 offset:37120
  ds_read_b64_tr_b16 a[50:51], v15 offset:37120
  v_mfma_f32_16x16x32_bf16 v[176:179], a[12:15], a[76:79], v[176:179]
  v_mfma_f32_16x16x32_bf16 v[144:147], a[8:11], a[80:83], v[144:147]
  v_mfma_f32_16x16x32_bf16 v[180:183], a[12:15], a[80:83], v[180:183]
  buffer_load_dwordx4 v207, s[20:23], s54 offen offset:3072 lds
  v_mfma_f32_16x16x32_bf16 v[148:151], a[8:11], a[84:87], v[148:151]
  v_mfma_f32_16x16x32_bf16 v[184:187], a[12:15], a[84:87], v[184:187]
  s_waitcnt lgkmcnt(6)
  v_mfma_f32_16x16x32_bf16 v[116:119], a[0:3], a[16:19], v[116:119]
  ds_read_b128 a[8:11], v13 offset:36864
  ds_read_b128 a[12:15], v13 offset:38912
  v_mfma_f32_16x16x32_bf16 v[152:155], a[4:7], a[16:19], v[152:155]
  ds_read_b64_tr_b16 a[52:53], v14 offset:55296
  v_mfma_f32_16x16x32_bf16 v[120:123], a[0:3], a[20:23], v[120:123]
  ds_read_b64_tr_b16 a[54:55], v15 offset:55296
  ds_read_b64_tr_b16 a[56:57], v14 offset:55328
  v_mfma_f32_16x16x32_bf16 v[156:159], a[4:7], a[20:23], v[156:159]
  ds_read_b64_tr_b16 a[58:59], v15 offset:55328
  s_add_u32 m0, s35, 114688
  s_add_u32 s55, s36, 1548288
  buffer_load_dwordx4 v208, s[12:15], s55 offen lds
  v_mfma_f32_16x16x32_bf16 v[124:127], a[0:3], a[24:27], v[124:127]
  ds_read_b64_tr_b16 a[60:61], v14 offset:55360
  ds_read_b64_tr_b16 a[62:63], v15 offset:55360
  v_mfma_f32_16x16x32_bf16 v[160:163], a[4:7], a[24:27], v[160:163]
  ds_read_b64_tr_b16 a[64:65], v14 offset:55392
  v_mfma_f32_16x16x32_bf16 v[128:131], a[0:3], a[28:31], v[128:131]
  ds_read_b64_tr_b16 a[66:67], v15 offset:55392
  ds_read_b64_tr_b16 a[68:69], v14 offset:55424
  v_mfma_f32_16x16x32_bf16 v[164:167], a[4:7], a[28:31], v[164:167]
  ds_read_b64_tr_b16 a[70:71], v15 offset:55424
  buffer_load_dwordx4 v209, s[12:15], s55 offen offset:1024 lds
  s_waitcnt lgkmcnt(12)
  v_mfma_f32_16x16x32_bf16 v[132:135], a[0:3], a[32:35], v[132:135]
  ds_read_b64_tr_b16 a[72:73], v14 offset:55456
  ds_read_b64_tr_b16 a[74:75], v15 offset:55456
  v_mfma_f32_16x16x32_bf16 v[168:171], a[4:7], a[32:35], v[168:171]
  ds_read_b64_tr_b16 a[76:77], v14 offset:55488
  v_mfma_f32_16x16x32_bf16 v[136:139], a[0:3], a[36:39], v[136:139]
  ds_read_b64_tr_b16 a[78:79], v15 offset:55488
  ds_read_b64_tr_b16 a[80:81], v14 offset:55520
  v_mfma_f32_16x16x32_bf16 v[172:175], a[4:7], a[36:39], v[172:175]
  ds_read_b64_tr_b16 a[82:83], v15 offset:55520
  buffer_load_dwordx4 v210, s[12:15], s55 offen offset:2048 lds
  v_mfma_f32_16x16x32_bf16 v[140:143], a[0:3], a[40:43], v[140:143]
  ds_read_b64_tr_b16 a[84:85], v14 offset:55552
  ds_read_b64_tr_b16 a[86:87], v15 offset:55552
  v_mfma_f32_16x16x32_bf16 v[176:179], a[4:7], a[40:43], v[176:179]
  v_mfma_f32_16x16x32_bf16 v[144:147], a[0:3], a[44:47], v[144:147]
  v_mfma_f32_16x16x32_bf16 v[180:183], a[4:7], a[44:47], v[180:183]
  buffer_load_dwordx4 v211, s[12:15], s55 offen offset:3072 lds
  v_mfma_f32_16x16x32_bf16 v[148:151], a[0:3], a[48:51], v[148:151]
  v_mfma_f32_16x16x32_bf16 v[184:187], a[4:7], a[48:51], v[184:187]
  s_waitcnt lgkmcnt(0)
  v_mfma_f32_16x16x32_bf16 v[116:119], a[8:11], a[52:55], v[116:119]
  s_add_u32 m0, s35, 118784
  s_nop 0
  buffer_load_dwordx4 v212, s[12:15], s55 offen lds
  s_waitcnt vmcnt(9)
  s_barrier
  buffer_load_dword v10, v11, s[24:27], 0 offen sc0 sc1
  ds_read_b128 a[0:3], v16 offset:0
  ds_read_b128 a[4:7], v16 offset:2048
  v_mfma_f32_16x16x32_bf16 v[152:155], a[12:15], a[52:55], v[152:155]
  ds_read_b64_tr_b16 a[16:17], v18 offset:0
  v_mfma_f32_16x16x32_bf16 v[120:123], a[8:11], a[56:59], v[120:123]
  ds_read_b64_tr_b16 a[18:19], v19 offset:0
  ds_read_b64_tr_b16 a[20:21], v18 offset:32
  v_mfma_f32_16x16x32_bf16 v[156:159], a[12:15], a[56:59], v[156:159]
  ds_read_b64_tr_b16 a[22:23], v19 offset:32
  s_add_u32 m0, s35, 0
  s_add_u32 s54, s31, 1024
  buffer_load_dwordx4 v204, s[20:23], s54 offen lds
  v_mfma_f32_16x16x32_bf16 v[124:127], a[8:11], a[60:63], v[124:127]
  ds_read_b64_tr_b16 a[24:25], v18 offset:64
  ds_read_b64_tr_b16 a[26:27], v19 offset:64
  v_mfma_f32_16x16x32_bf16 v[160:163], a[12:15], a[60:63], v[160:163]
  ds_read_b64_tr_b16 a[28:29], v18 offset:96
  v_mfma_f32_16x16x32_bf16 v[128:131], a[8:11], a[64:67], v[128:131]
  ds_read_b64_tr_b16 a[30:31], v19 offset:96
  ds_read_b64_tr_b16 a[32:33], v18 offset:128
  v_mfma_f32_16x16x32_bf16 v[164:167], a[12:15], a[64:67], v[164:167]
  ds_read_b64_tr_b16 a[34:35], v19 offset:128
  buffer_load_dwordx4 v205, s[20:23], s54 offen offset:1024 lds
  v_mfma_f32_16x16x32_bf16 v[132:135], a[8:11], a[68:71], v[132:135]
  ds_read_b64_tr_b16 a[36:37], v18 offset:160
  ds_read_b64_tr_b16 a[38:39], v19 offset:160
  v_mfma_f32_16x16x32_bf16 v[168:171], a[12:15], a[68:71], v[168:171]
  ds_read_b64_tr_b16 a[40:41], v18 offset:192
  v_mfma_f32_16x16x32_bf16 v[136:139], a[8:11], a[72:75], v[136:139]
  ds_read_b64_tr_b16 a[42:43], v19 offset:192
  ds_read_b64_tr_b16 a[44:45], v18 offset:224
  v_mfma_f32_16x16x32_bf16 v[172:175], a[12:15], a[72:75], v[172:175]
  ds_read_b64_tr_b16 a[46:47], v19 offset:224
  buffer_load_dwordx4 v206, s[20:23], s54 offen offset:2048 lds
  v_mfma_f32_16x16x32_bf16 v[140:143], a[8:11], a[76:79], v[140:143]
  ds_read_b64_tr_b16 a[48:49], v18 offset:256
  ds_read_b64_tr_b16 a[50:51], v19 offset:256
  v_mfma_f32_16x16x32_bf16 v[176:179], a[12:15], a[76:79], v[176:179]
  v_mfma_f32_16x16x32_bf16 v[144:147], a[8:11], a[80:83], v[144:147]
  v_mfma_f32_16x16x32_bf16 v[180:183], a[12:15], a[80:83], v[180:183]
  buffer_load_dwordx4 v207, s[20:23], s54 offen offset:3072 lds
  v_mfma_f32_16x16x32_bf16 v[148:151], a[8:11], a[84:87], v[148:151]
  v_mfma_f32_16x16x32_bf16 v[184:187], a[12:15], a[84:87], v[184:187]
  s_waitcnt lgkmcnt(6)
  v_mfma_f32_16x16x32_bf16 v[116:119], a[0:3], a[16:19], v[116:119]
  ds_read_b128 a[8:11], v17 offset:0
  ds_read_b128 a[12:15], v17 offset:2048
  v_mfma_f32_16x16x32_bf16 v[152:155], a[4:7], a[16:19], v[152:155]
  ds_read_b64_tr_b16 a[52:53], v18 offset:18432
  v_mfma_f32_16x16x32_bf16 v[120:123], a[0:3], a[20:23], v[120:123]
  ds_read_b64_tr_b16 a[54:55], v19 offset:18432
  ds_read_b64_tr_b16 a[56:57], v18 offset:18464
  v_mfma_f32_16x16x32_bf16 v[156:159], a[4:7], a[20:23], v[156:159]
  ds_read_b64_tr_b16 a[58:59], v19 offset:18464
  s_add_u32 m0, s35, 4096
  s_add_u32 s55, s36, 1769472
  buffer_load_dwordx4 v208, s[12:15], s55 offen lds
  v_mfma_f32_16x16x32_bf16 v[124:127], a[0:3], a[24:27], v[124:127]
  ds_read_b64_tr_b16 a[60:61], v18 offset:18496
  ds_read_b64_tr_b16 a[62:63], v19 offset:18496
  v_mfma_f32_16x16x32_bf16 v[160:163], a[4:7], a[24:27], v[160:163]
  ds_read_b64_tr_b16 a[64:65], v18 offset:18528
  v_mfma_f32_16x16x32_bf16 v[128:131], a[0:3], a[28:31], v[128:131]
  ds_read_b64_tr_b16 a[66:67], v19 offset:18528
  ds_read_b64_tr_b16 a[68:69], v18 offset:18560
  v_mfma_f32_16x16x32_bf16 v[164:167], a[4:7], a[28:31], v[164:167]
  ds_read_b64_tr_b16 a[70:71], v19 offset:18560
  buffer_load_dwordx4 v209, s[12:15], s55 offen offset:1024 lds
  s_waitcnt lgkmcnt(12)
  v_mfma_f32_16x16x32_bf16 v[132:135], a[0:3], a[32:35], v[132:135]
  ds_read_b64_tr_b16 a[72:73], v18 offset:18592
  ds_read_b64_tr_b16 a[74:75], v19 offset:18592
  v_mfma_f32_16x16x32_bf16 v[168:171], a[4:7], a[32:35], v[168:171]
  ds_read_b64_tr_b16 a[76:77], v18 offset:18624
  v_mfma_f32_16x16x32_bf16 v[136:139], a[0:3], a[36:39], v[136:139]
  ds_read_b64_tr_b16 a[78:79], v19 offset:18624
  ds_read_b64_tr_b16 a[80:81], v18 offset:18656
  v_mfma_f32_16x16x32_bf16 v[172:175], a[4:7], a[36:39], v[172:175]
  ds_read_b64_tr_b16 a[82:83], v19 offset:18656
  buffer_load_dwordx4 v210, s[12:15], s55 offen offset:2048 lds
  v_mfma_f32_16x16x32_bf16 v[140:143], a[0:3], a[40:43], v[140:143]
  ds_read_b64_tr_b16 a[84:85], v18 offset:18688
  ds_read_b64_tr_b16 a[86:87], v19 offset:18688
  v_mfma_f32_16x16x32_bf16 v[176:179], a[4:7], a[40:43], v[176:179]
  v_mfma_f32_16x16x32_bf16 v[144:147], a[0:3], a[44:47], v[144:147]
  v_mfma_f32_16x16x32_bf16 v[180:183], a[4:7], a[44:47], v[180:183]
  buffer_load_dwordx4 v211, s[12:15], s55 offen offset:3072 lds
  v_mfma_f32_16x16x32_bf16 v[148:151], a[0:3], a[48:51], v[148:151]
  v_mfma_f32_16x16x32_bf16 v[184:187], a[4:7], a[48:51], v[184:187]
  s_waitcnt lgkmcnt(0)
  v_mfma_f32_16x16x32_bf16 v[116:119], a[8:11], a[52:55], v[116:119]
  s_add_u32 m0, s35, 8192
  s_nop 0
  buffer_load_dwordx4 v212, s[12:15], s55 offen lds
  s_waitcnt vmcnt(10)
  s_barrier
  s_waitcnt vmcnt(9)
  v_readfirstlane_b32 s5, v10
  s_nop 1
  s_cmp_eq_u32 s5, 64
  s_cbranch_scc0 F_spkv
F_rtkv:
  ds_read_b128 a[0:3], v16 offset:36864
  ds_read_b128 a[4:7], v16 offset:38912
  s_mov_b32 m0, s7
  s_nop 0
  buffer_load_dwordx4 v4, s[8:11], 0 offen sc0 sc1 lds
  v_mfma_f32_16x16x32_bf16 v[152:155], a[12:15], a[52:55], v[152:155]
  ds_read_b64_tr_b16 a[16:17], v18 offset:36864
  v_mfma_f32_16x16x32_bf16 v[120:123], a[8:11], a[56:59], v[120:123]
  ds_read_b64_tr_b16 a[18:19], v19 offset:36864
  ds_read_b64_tr_b16 a[20:21], v18 offset:36896
  v_mfma_f32_16x16x32_bf16 v[156:159], a[12:15], a[56:59], v[156:159]
  ds_read_b64_tr_b16 a[22:23], v19 offset:36896
  s_add_u32 m0, s38, 36864
  s_add_u32 s54, s37, 0
  buffer_load_dwordx4 v5, s[16:19], s54 offen lds
  v_mfma_f32_16x16x32_bf16 v[124:127], a[8:11], a[60:63], v[124:127]
  ds_read_b64_tr_b16 a[24:25], v18 offset:36928
  ds_read_b64_tr_b16 a[26:27], v19 offset:36928
  v_mfma_f32_16x16x32_bf16 v[160:163], a[12:15], a[60:63], v[160:163]
  ds_read_b64_tr_b16 a[28:29], v18 offset:36960
  v_mfma_f32_16x16x32_bf16 v[128:131], a[8:11], a[64:67], v[128:131]
  ds_read_b64_tr_b16 a[30:31], v19 offset:36960
  ds_read_b64_tr_b16 a[32:33], v18 offset:36992
  v_mfma_f32_16x16x32_bf16 v[164:167], a[12:15], a[64:67], v[164:167]
  ds_read_b64_tr_b16 a[34:35], v19 offset:36992
  buffer_load_dwordx4 v6, s[16:19], s54 offen offset:1024 lds
  v_mfma_f32_16x16x32_bf16 v[132:135], a[8:11], a[68:71], v[132:135]
  ds_read_b64_tr_b16 a[36:37], v18 offset:37024
  ds_read_b64_tr_b16 a[38:39], v19 offset:37024
  v_mfma_f32_16x16x32_bf16 v[168:171], a[12:15], a[68:71], v[168:171]
  ds_read_b64_tr_b16 a[40:41], v18 offset:37056
  v_mfma_f32_16x16x32_bf16 v[136:139], a[8:11], a[72:75], v[136:139]
  ds_read_b64_tr_b16 a[42:43], v19 offset:37056
  ds_read_b64_tr_b16 a[44:45], v18 offset:37088
  v_mfma_f32_16x16x32_bf16 v[172:175], a[12:15], a[72:75], v[172:175]
  ds_read_b64_tr_b16 a[46:47], v19 offset:37088
  buffer_load_dwordx4 v7, s[16:19], s54 offen offset:2048 lds
  v_mfma_f32_16x16x32_bf16 v[140:143], a[8:11], a[76:79], v[140:143]
  ds_read_b64_tr_b16 a[48:49], v18 offset:37120
  ds_read_b64_tr_b16 a[50:51], v19 offset:37120
  v_mfma_f32_16x16x32_bf16 v[176:179], a[12:15], a[76:79], v[176:179]
  v_mfma_f32_16x16x32_bf16 v[144:147], a[8:11], a[80:83], v[144:147]
  v_mfma_f32_16x16x32_bf16 v[180:183], a[12:15], a[80:83], v[180:183]
  s_add_u32 m0, s38, 39936
  s_add_u32 s54, s37, 18432
  buffer_load_dwordx4 v5, s[16:19], s54 offen lds
  v_mfma_f32_16x16x32_bf16 v[148:151], a[8:11], a[84:87], v[148:151]
  v_mfma_f32_16x16x32_bf16 v[184:187], a[12:15], a[84:87], v[184:187]
  s_waitcnt lgkmcnt(6)
  v_mfma_f32_16x16x32_bf16 v[116:119], a[0:3], a[16:19], v[116:119]
  ds_read_b128 a[8:11], v17 offset:36864
  ds_read_b128 a[12:15], v17 offset:38912
  v_mfma_f32_16x16x32_bf16 v[152:155], a[4:7], a[16:19], v[152:155]
  ds_read_b64_tr_b16 a[52:53], v18 offset:55296
  v_mfma_f32_16x16x32_bf16 v[120:123], a[0:3], a[20:23], v[120:123]
  ds_read_b64_tr_b16 a[54:55], v19 offset:55296
  ds_read_b64_tr_b16 a[56:57], v18 offset:55328
  v_mfma_f32_16x16x32_bf16 v[156:159], a[4:7], a[20:23], v[156:159]
  ds_read_b64_tr_b16 a[58:59], v19 offset:55328
  buffer_load_dwordx4 v6, s[16:19], s54 offen offset:1024 lds
  v_mfma_f32_16x16x32_bf16 v[124:127], a[0:3], a[24:27], v[124:127]
  ds_read_b64_tr_b16 a[60:61], v18 offset:55360
  ds_read_b64_tr_b16 a[62:63], v19 offset:55360
  v_mfma_f32_16x16x32_bf16 v[160:163], a[4:7], a[24:27], v[160:163]
  ds_read_b64_tr_b16 a[64:65], v18 offset:55392
  v_mfma_f32_16x16x32_bf16 v[128:131], a[0:3], a[28:31], v[128:131]
  ds_read_b64_tr_b16 a[66:67], v19 offset:55392
  ds_read_b64_tr_b16 a[68:69], v18 offset:55424
  v_mfma_f32_16x16x32_bf16 v[164:167], a[4:7], a[28:31], v[164:167]
  ds_read_b64_tr_b16 a[70:71], v19 offset:55424
  buffer_load_dwordx4 v7, s[16:19], s54 offen offset:2048 lds
  s_waitcnt lgkmcnt(12)
  v_mfma_f32_16x16x32_bf16 v[132:135], a[0:3], a[32:35], v[132:135]
  ds_read_b64_tr_b16 a[72:73], v18 offset:55456
  ds_read_b64_tr_b16 a[74:75], v19 offset:55456
  v_mfma_f32_16x16x32_bf16 v[168:171], a[4:7], a[32:35], v[168:171]
  ds_read_b64_tr_b16 a[76:77], v18 offset:55488
  v_mfma_f32_16x16x32_bf16 v[136:139], a[0:3], a[36:39], v[136:139]
  ds_read_b64_tr_b16 a[78:79], v19 offset:55488
  ds_read_b64_tr_b16 a[80:81], v18 offset:55520
  v_mfma_f32_16x16x32_bf16 v[172:175], a[4:7], a[36:39], v[172:175]
  ds_read_b64_tr_b16 a[82:83], v19 offset:55520
  v_mfma_f32_16x16x32_bf16 v[140:143], a[0:3], a[40:43], v[140:143]
  ds_read_b64_tr_b16 a[84:85], v18 offset:55552
  ds_read_b64_tr_b16 a[86:87], v19 offset:55552
  v_mfma_f32_16x16x32_bf16 v[176:179], a[4:7], a[40:43], v[176:179]
  v_mfma_f32_16x16x32_bf16 v[144:147], a[0:3], a[44:47], v[144:147]
  v_mfma_f32_16x16x32_bf16 v[180:183], a[4:7], a[44:47], v[180:183]
  v_mfma_f32_16x16x32_bf16 v[148:151], a[0:3], a[48:51], v[148:151]
  v_mfma_f32_16x16x32_bf16 v[184:187], a[4:7], a[48:51], v[184:187]
  s_waitcnt lgkmcnt(0)
  v_mfma_f32_16x16x32_bf16 v[116:119], a[8:11], a[52:55], v[116:119]
  s_waitcnt vmcnt(7)
  s_barrier
  ds_read_b128 a[0:3], v12 offset:0
  ds_read_b128 a[4:7], v12 offset:2048
  v_mfma_f32_16x16x32_bf16 v[152:155], a[12:15], a[52:55], v[152:155]
  ds_read_b64_tr_b16 a[16:17], v14 offset:0
  v_mfma_f32_16x16x32_bf16 v[120:123], a[8:11], a[56:59], v[120:123]
  ds_read_b64_tr_b16 a[18:19], v15 offset:0
  ds_read_b64_tr_b16 a[20:21], v14 offset:32
  v_mfma_f32_16x16x32_bf16 v[156:159], a[12:15], a[56:59], v[156:159]
  ds_read_b64_tr_b16 a[22:23], v15 offset:32
  s_add_u32 m0, s38, 43008
  s_add_u32 s54, s37, 36864
  buffer_load_dwordx4 v5, s[16:19], s54 offen lds
  v_mfma_f32_16x16x32_bf16 v[124:127], a[8:11], a[60:63], v[124:127]
  ds_read_b64_tr_b16 a[24:25], v14 offset:64
  ds_read_b64_tr_b16 a[26:27], v15 offset:64
  v_mfma_f32_16x16x32_bf16 v[160:163], a[12:15], a[60:63], v[160:163]
  ds_read_b64_tr_b16 a[28:29], v14 offset:96
  v_mfma_f32_16x16x32_bf16 v[128:131], a[8:11], a[64:67], v[128:131]
  ds_read_b64_tr_b16 a[30:31], v15 offset:96
  ds_read_b64_tr_b16 a[32:33], v14 offset:128
  v_mfma_f32_16x16x32_bf16 v[164:167], a[12:15], a[64:67], v[164:167]
  ds_read_b64_tr_b16 a[34:35], v15 offset:128
  buffer_load_dwordx4 v6, s[16:19], s54 offen offset:1024 lds
  v_mfma_f32_16x16x32_bf16 v[132:135], a[8:11], a[68:71], v[132:135]
  ds_read_b64_tr_b16 a[36:37], v14 offset:160
  ds_read_b64_tr_b16 a[38:39], v15 offset:160
  v_mfma_f32_16x16x32_bf16 v[168:171], a[12:15], a[68:71], v[168:171]
  ds_read_b64_tr_b16 a[40:41], v14 offset:192
  v_mfma_f32_16x16x32_bf16 v[136:139], a[8:11], a[72:75], v[136:139]
  ds_read_b64_tr_b16 a[42:43], v15 offset:192
  ds_read_b64_tr_b16 a[44:45], v14 offset:224
  v_mfma_f32_16x16x32_bf16 v[172:175], a[12:15], a[72:75], v[172:175]
  ds_read_b64_tr_b16 a[46:47], v15 offset:224
  buffer_load_dwordx4 v7, s[16:19], s54 offen offset:2048 lds
  v_mfma_f32_16x16x32_bf16 v[140:143], a[8:11], a[76:79], v[140:143]
  ds_read_b64_tr_b16 a[48:49], v14 offset:256
  ds_read_b64_tr_b16 a[50:51], v15 offset:256
  v_mfma_f32_16x16x32_bf16 v[176:179], a[12:15], a[76:79], v[176:179]
  v_mfma_f32_16x16x32_bf16 v[144:147], a[8:11], a[80:83], v[144:147]
  v_mfma_f32_16x16x32_bf16 v[180:183], a[12:15], a[80:83], v[180:183]
  s_add_u32 m0, s38, 73728
  s_add_u32 s54, s37, 55296
  buffer_load_dwordx4 v5, s[16:19], s54 offen lds
  v_mfma_f32_16x16x32_bf16 v[148:151], a[8:11], a[84:87], v[148:151]
  v_mfma_f32_16x16x32_bf16 v[184:187], a[12:15], a[84:87], v[184:187]
  s_waitcnt lgkmcnt(6)
  v_mfma_f32_16x16x32_bf16 v[116:119], a[0:3], a[16:19], v[116:119]
  ds_read_b128 a[8:11], v13 offset:0
  ds_read_b128 a[12:15], v13 offset:2048
  v_mfma_f32_16x16x32_bf16 v[152:155], a[4:7], a[16:19], v[152:155]
  ds_read_b64_tr_b16 a[52:53], v14 offset:18432
  v_mfma_f32_16x16x32_bf16 v[120:123], a[0:3], a[20:23], v[120:123]
  ds_read_b64_tr_b16 a[54:55], v15 offset:18432
  ds_read_b64_tr_b16 a[56:57], v14 offset:18464
  v_mfma_f32_16x16x32_bf16 v[156:159], a[4:7], a[20:23], v[156:159]
  ds_read_b64_tr_b16 a[58:59], v15 offset:18464
  buffer_load_dwordx4 v6, s[16:19], s54 offen offset:1024 lds
  v_mfma_f32_16x16x32_bf16 v[124:127], a[0:3], a[24:27], v[124:127]
  ds_read_b64_tr_b16 a[60:61], v14 offset:18496
  ds_read_b64_tr_b16 a[62:63], v15 offset:18496
  v_mfma_f32_16x16x32_bf16 v[160:163], a[4:7], a[24:27], v[160:163]
  ds_read_b64_tr_b16 a[64:65], v14 offset:18528
  v_mfma_f32_16x16x32_bf16 v[128:131], a[0:3], a[28:31], v[128:131]
  ds_read_b64_tr_b16 a[66:67], v15 offset:18528
  ds_read_b64_tr_b16 a[68:69], v14 offset:18560
  v_mfma_f32_16x16x32_bf16 v[164:167], a[4:7], a[28:31], v[164:167]
  ds_read_b64_tr_b16 a[70:71], v15 offset:18560
  buffer_load_dwordx4 v7, s[16:19], s54 offen offset:2048 lds
  s_waitcnt lgkmcnt(12)
  v_mfma_f32_16x16x32_bf16 v[132:135], a[0:3], a[32:35], v[132:135]
  ds_read_b64_tr_b16 a[72:73], v14 offset:18592
  ds_read_b64_tr_b16 a[74:75], v15 offset:18592
  v_mfma_f32_16x16x32_bf16 v[168:171], a[4:7], a[32:35], v[168:171]
  ds_read_b64_tr_b16 a[76:77], v14 offset:18624
  v_mfma_f32_16x16x32_bf16 v[136:139], a[0:3], a[36:39], v[136:139]
  ds_read_b64_tr_b16 a[78:79], v15 offset:18624
  ds_read_b64_tr_b16 a[80:81], v14 offset:18656
  v_mfma_f32_16x16x32_bf16 v[172:175], a[4:7], a[36:39], v[172:175]
  ds_read_b64_tr_b16 a[82:83], v15 offset:18656
  s_add_u32 m0, s38, 76800
  s_add_u32 s54, s37, 73728
  buffer_load_dwordx4 v5, s[16:19], s54 offen lds
  v_mfma_f32_16x16x32_bf16 v[140:143], a[0:3], a[40:43], v[140:143]
  ds_read_b64_tr_b16 a[84:85], v14 offset:18688
  ds_read_b64_tr_b16 a[86:87], v15 offset:18688
  v_mfma_f32_16x16x32_bf16 v[176:179], a[4:7], a[40:43], v[176:179]
  v_mfma_f32_16x16x32_bf16 v[144:147], a[0:3], a[44:47], v[144:147]
  v_mfma_f32_16x16x32_bf16 v[180:183], a[4:7], a[44:47], v[180:183]
  buffer_load_dwordx4 v6, s[16:19], s54 offen offset:1024 lds
  v_mfma_f32_16x16x32_bf16 v[148:151], a[0:3], a[48:51], v[148:151]
  v_mfma_f32_16x16x32_bf16 v[184:187], a[4:7], a[48:51], v[184:187]
  s_waitcnt lgkmcnt(0)
  v_mfma_f32_16x16x32_bf16 v[116:119], a[8:11], a[52:55], v[116:119]
  buffer_load_dwordx4 v7, s[16:19], s54 offen offset:2048 lds
  s_waitcnt vmcnt(15)
  s_barrier
  ds_read_b128 v[80:83], v8 offset:0
  ds_read_b128 v[96:99], v8 offset:64
  v_mfma_f32_16x16x32_bf16 v[152:155], a[12:15], a[52:55], v[152:155]
  ds_read_b128 v[84:87], v8 offset:128
  v_mfma_f32_16x16x32_bf16 v[120:123], a[8:11], a[56:59], v[120:123]
  ds_read_b128 v[100:103], v8 offset:192
  ds_read_b32 v44, v9 offset:256
  v_mfma_f32_16x16x32_bf16 v[156:159], a[12:15], a[56:59], v[156:159]
  ds_read_b32 v45, v9 offset:320
  v_mfma_f32_16x16x32_bf16 v[124:127], a[8:11], a[60:63], v[124:127]
  ds_read_b32 v46, v9 offset:384
  ds_read_b32 v47, v9 offset:448
  v_mfma_f32_16x16x32_bf16 v[160:163], a[12:15], a[60:63], v[160:163]
  ds_read_b32 v48, v9 offset:512
  s_add_u32 m0, s38, 79872
  s_add_u32 s54, s37, 92160
  buffer_load_dwordx4 v5, s[16:19], s54 offen lds
  v_mfma_f32_16x16x32_bf16 v[128:131], a[8:11], a[64:67], v[128:131]
  ds_read_b32 v49, v9 offset:576
  ds_read_b32 v50, v9 offset:640
HP_kv_p1:
  s_cbranch_execz HP_kv_ret
  v_mfma_f32_16x16x32_bf16 v[164:167], a[12:15], a[64:67], v[164:167]
  ds_read_b32 v51, v9 offset:704
  v_mfma_f32_16x16x32_bf16 v[132:135], a[8:11], a[68:71], v[132:135]
  ds_read_b32 v52, v9 offset:768
  v_mfma_f32_16x16x32_bf16 v[168:171], a[12:15], a[68:71], v[168:171]
  v_mfma_f32_16x16x32_bf16 v[136:139], a[8:11], a[72:75], v[136:139]
  v_mfma_f32_16x16x32_bf16 v[172:175], a[12:15], a[72:75], v[172:175]
  buffer_load_dwordx4 v6, s[16:19], s54 offen offset:1024 lds
  v_mfma_f32_16x16x32_bf16 v[140:143], a[8:11], a[76:79], v[140:143]
  v_mfma_f32_16x16x32_bf16 v[176:179], a[12:15], a[76:79], v[176:179]
  v_mfma_f32_16x16x32_bf16 v[144:147], a[8:11], a[80:83], v[144:147]
  v_mfma_f32_16x16x32_bf16 v[180:183], a[12:15], a[80:83], v[180:183]
  v_mfma_f32_16x16x32_bf16 v[148:151], a[8:11], a[84:87], v[148:151]
  v_mfma_f32_16x16x32_bf16 v[184:187], a[12:15], a[84:87], v[184:187]
  buffer_load_dwordx4 v7, s[16:19], s54 offen offset:2048 lds
  s_waitcnt lgkmcnt(0)
  v_pk_mul_f32 v[88:89], v[80:81], s[50:51]
  v_pk_mul_f32 v[90:91], v[82:83], s[50:51]
  v_pk_mul_f32 v[92:93], v[84:85], s[50:51]
  v_pk_mul_f32 v[94:95], v[86:87], s[50:51]
  v_pk_mul_f32 v[104:105], v[96:97], s[50:51]
  v_pk_mul_f32 v[106:107], v[98:99], s[50:51]
  v_pk_mul_f32 v[108:109], v[100:101], s[50:51]
  v_pk_mul_f32 v[110:111], v[102:103], s[50:51]
  s_nop 1
  v_pk_mul_f32 v[196:197], v[84:85], v[48:49] op_sel:[0,0] op_sel_hi:[1,0]
  v_pk_mul_f32 v[200:201], v[100:101], v[48:49] op_sel:[0,0] op_sel_hi:[1,0]
  v_pk_mul_f32 v[198:199], v[86:87], v[48:49] op_sel:[0,0] op_sel_hi:[1,0]
  v_pk_mul_f32 v[202:203], v[102:103], v[48:49] op_sel:[0,0] op_sel_hi:[1,0]
  v_pk_fma_f32 v[196:197], v[132:133], v[80:81], v[196:197]
  v_pk_fma_f32 v[200:201], v[168:169], v[96:97], v[200:201]
  v_pk_fma_f32 v[198:199], v[134:135], v[82:83], v[198:199]
  v_pk_fma_f32 v[202:203], v[170:171], v[98:99], v[202:203]
  v_cvt_pk_bf16_f32 v24, v196, v197
  v_cvt_pk_bf16_f32 v26, v200, v201
  v_cvt_pk_bf16_f32 v25, v198, v199
  v_cvt_pk_bf16_f32 v27, v202, v203
  v_pk_mul_f32 v[196:197], v[84:85], v[48:49] op_sel:[0,1] op_sel_hi:[1,1]
  v_pk_mul_f32 v[200:201], v[100:101], v[48:49] op_sel:[0,1] op_sel_hi:[1,1]
  v_pk_mul_f32 v[198:199], v[86:87], v[48:49] op_sel:[0,1] op_sel_hi:[1,1]
  v_pk_mul_f32 v[202:203], v[102:103], v[48:49] op_sel:[0,1] op_sel_hi:[1,1]
  v_pk_fma_f32 v[196:197], v[136:137], v[80:81], v[196:197]
  v_pk_fma_f32 v[200:201], v[172:173], v[96:97], v[200:201]
  v_pk_fma_f32 v[198:199], v[138:139], v[82:83], v[198:199]
  s_add_u32 m0, s38, 0
  s_add_u32 s54, s37, 110592
  buffer_load_dwordx4 v5, s[16:19], s54 offen lds
  v_pk_fma_f32 v[202:203], v[174:175], v[98:99], v[202:203]
  v_cvt_pk_bf16_f32 v28, v196, v197
  v_cvt_pk_bf16_f32 v30, v200, v201
  v_cvt_pk_bf16_f32 v29, v198, v199
  v_cvt_pk_bf16_f32 v31, v202, v203
  v_pk_fma_f32 v[188:189], v[92:93], v[44:45], s[58:59] op_sel:[0,0,0] op_sel_hi:[1,0,1]
  v_pk_fma_f32 v[192:193], v[108:109], v[44:45], s[58:59] op_sel:[0,0,0] op_sel_hi:[1,0,1]
  v_pk_fma_f32 v[190:191], v[94:95], v[44:45], s[58:59] op_sel:[0,0,0] op_sel_hi:[1,0,1]
  v_pk_fma_f32 v[194:195], v[110:111], v[44:45], s[58:59] op_sel:[0,0,0] op_sel_hi:[1,0,1]
  v_pk_fma_f32 v[116:117], v[116:117], v[88:89], v[188:189]
  v_pk_fma_f32 v[152:153], v[152:153], v[104:105], v[192:193]
  v_pk_fma_f32 v[118:119], v[118:119], v[90:91], v[190:191]
  v_pk_fma_f32 v[154:155], v[154:155], v[106:107], v[194:195]
  v_exp_f32_e64 v188, v116 clamp
  v_exp_f32_e64 v192, v152 clamp
  v_exp_f32_e64 v189, v117 clamp
  v_exp_f32_e64 v193, v153 clamp
  v_exp_f32_e64 v190, v118 clamp
  v_exp_f32_e64 v194, v154 clamp
  v_exp_f32_e64 v191, v119 clamp
  v_exp_f32_e64 v195, v155 clamp
  v_max_f32 v116, s58, v116
  v_max_f32 v152, s58, v152
  v_max_f32 v117, s58, v117
  v_max_f32 v153, s58, v153
  v_max_f32 v118, s58, v118
  v_max_f32 v154, s58, v154
  v_max_f32 v119, s58, v119
  v_max_f32 v155, s58, v155
  v_pk_fma_f32 v[116:117], v[116:117], s[56:57], v[188:189]
  buffer_load_dwordx4 v6, s[16:19], s54 offen offset:1024 lds
  v_pk_fma_f32 v[152:153], v[152:153], s[56:57], v[192:193]
  v_pk_fma_f32 v[118:119], v[118:119], s[56:57], v[190:191]
  v_pk_fma_f32 v[154:155], v[154:155], s[56:57], v[194:195]
  v_cvt_pk_bf16_f32 v54, v116, v117
  v_cvt_pk_bf16_f32 v56, v152, v153
  v_cvt_pk_bf16_f32 v55, v118, v119
  v_cvt_pk_bf16_f32 v57, v154, v155
  v_pk_mul_f32 v[196:197], v[84:85], v[50:51] op_sel:[0,0] op_sel_hi:[1,0]
  v_pk_mul_f32 v[200:201], v[100:101], v[50:51] op_sel:[0,0] op_sel_hi:[1,0]
  v_pk_mul_f32 v[198:199], v[86:87], v[50:51] op_sel:[0,0] op_sel_hi:[1,0]
  v_pk_mul_f32 v[202:203], v[102:103], v[50:51] op_sel:[0,0] op_sel_hi:[1,0]
  v_pk_fma_f32 v[196:197], v[140:141], v[80:81], v[196:197]
  v_pk_fma_f32 v[200:201], v[176:177], v[96:97], v[200:201]
  v_pk_fma_f32 v[198:199], v[142:143], v[82:83], v[198:199]
  v_pk_fma_f32 v[202:203], v[178:179], v[98:99], v[202:203]
  v_cvt_pk_bf16_f32 v32, v196, v197
  v_cvt_pk_bf16_f32 v34, v200, v201
  v_cvt_pk_bf16_f32 v33, v198, v199
  v_cvt_pk_bf16_f32 v35, v202, v203
  v_pk_fma_f32 v[188:189], v[92:93], v[44:45], s[58:59] op_sel:[0,1,0] op_sel_hi:[1,1,1]
  v_pk_fma_f32 v[192:193], v[108:109], v[44:45], s[58:59] op_sel:[0,1,0] op_sel_hi:[1,1,1]
  v_pk_fma_f32 v[190:191], v[94:95], v[44:45], s[58:59] op_sel:[0,1,0] op_sel_hi:[1,1,1]
  v_pk_fma_f32 v[194:195], v[110:111], v[44:45], s[58:59] op_sel:[0,1,0] op_sel_hi:[1,1,1]
  v_pk_fma_f32 v[120:121], v[120:121], v[88:89], v[188:189]
  v_pk_fma_f32 v[156:157], v[156:157], v[104:105], v[192:193]
  v_pk_fma_f32 v[122:123], v[122:123], v[90:91], v[190:191]
  v_pk_fma_f32 v[158:159], v[158:159], v[106:107], v[194:195]
  v_mfma_f32_16x16x32_bf16 v[136:139], v[54:57], v[24:27], 0
  v_mfma_f32_16x16x32_bf16 v[172:175], v[54:57], v[28:31], 0
  v_mfma_f32_16x16x32_bf16 v[112:115], v[54:57], v[236:239], 0
  v_exp_f32_e64 v188, v120 clamp
  buffer_load_dwordx4 v7, s[16:19], s54 offen offset:2048 lds
  v_exp_f32_e64 v192, v156 clamp
  v_exp_f32_e64 v189, v121 clamp
  v_exp_f32_e64 v193, v157 clamp
  v_exp_f32_e64 v190, v122 clamp
  v_exp_f32_e64 v194, v158 clamp
  ds_write_b128 v216, v[136:139]
  v_exp_f32_e64 v191, v123 clamp
  v_exp_f32_e64 v195, v159 clamp
  v_max_f32 v120, s58, v120
  v_max_f32 v156, s58, v156
  v_max_f32 v121, s58, v121
  v_max_f32 v157, s58, v157
  v_max_f32 v122, s58, v122
  v_max_f32 v158, s58, v158
  v_max_f32 v123, s58, v123
  v_max_f32 v159, s58, v159
  v_pk_fma_f32 v[120:121], v[120:121], s[56:57], v[188:189]
  v_pk_fma_f32 v[156:157], v[156:157], s[56:57], v[192:193]
  ds_write_b128 v217, v[172:175]
  v_pk_fma_f32 v[122:123], v[122:123], s[56:57], v[190:191]
  v_pk_fma_f32 v[158:159], v[158:159], s[56:57], v[194:195]
  v_cvt_pk_bf16_f32 v58, v120, v121
  v_cvt_pk_bf16_f32 v60, v156, v157
  v_cvt_pk_bf16_f32 v59, v122, v123
  v_cvt_pk_bf16_f32 v61, v158, v159
  v_pk_mul_f32 v[196:197], v[84:85], v[50:51] op_sel:[0,1] op_sel_hi:[1,1]
  v_pk_mul_f32 v[200:201], v[100:101], v[50:51] op_sel:[0,1] op_sel_hi:[1,1]
  v_pk_mul_f32 v[198:199], v[86:87], v[50:51] op_sel:[0,1] op_sel_hi:[1,1]
  v_pk_mul_f32 v[202:203], v[102:103], v[50:51] op_sel:[0,1] op_sel_hi:[1,1]
  v_pk_fma_f32 v[196:197], v[144:145], v[80:81], v[196:197]
  s_add_u32 m0, s38, 3072
  s_add_u32 s54, s37, 129024
  buffer_load_dwordx4 v5, s[16:19], s54 offen lds
  v_pk_fma_f32 v[200:201], v[180:181], v[96:97], v[200:201]
  v_pk_fma_f32 v[198:199], v[146:147], v[82:83], v[198:199]
  v_pk_fma_f32 v[202:203], v[182:183], v[98:99], v[202:203]
  v_cvt_pk_bf16_f32 v36, v196, v197
  v_cvt_pk_bf16_f32 v38, v200, v201
  v_cvt_pk_bf16_f32 v37, v198, v199
  v_cvt_pk_bf16_f32 v39, v202, v203
  v_pk_fma_f32 v[188:189], v[92:93], v[46:47], s[58:59] op_sel:[0,0,0] op_sel_hi:[1,0,1]
  v_pk_fma_f32 v[192:193], v[108:109], v[46:47], s[58:59] op_sel:[0,0,0] op_sel_hi:[1,0,1]
  v_pk_fma_f32 v[190:191], v[94:95], v[46:47], s[58:59] op_sel:[0,0,0] op_sel_hi:[1,0,1]
  v_pk_fma_f32 v[194:195], v[110:111], v[46:47], s[58:59] op_sel:[0,0,0] op_sel_hi:[1,0,1]
  v_pk_fma_f32 v[124:125], v[124:125], v[88:89], v[188:189]
  v_pk_fma_f32 v[160:161], v[160:161], v[104:105], v[192:193]
  v_pk_fma_f32 v[126:127], v[126:127], v[90:91], v[190:191]
  v_pk_fma_f32 v[162:163], v[162:163], v[106:107], v[194:195]
  v_mfma_f32_16x16x32_bf16 v[116:119], v[58:61], v[24:27], 0
  v_mfma_f32_16x16x32_bf16 v[152:155], v[58:61], v[28:31], 0
  v_mfma_f32_16x16x32_bf16 v[140:143], v[58:61], v[32:35], 0
  v_mfma_f32_16x16x32_bf16 v[112:115], v[58:61], v[240:243], v[112:115]
  v_exp_f32_e64 v188, v124 clamp
  v_exp_f32_e64 v192, v160 clamp
  v_exp_f32_e64 v189, v125 clamp
  v_exp_f32_e64 v193, v161 clamp
  v_exp_f32_e64 v190, v126 clamp
  v_exp_f32_e64 v194, v162 clamp
  ds_write_b128 v218, v[116:119]
  v_exp_f32_e64 v191, v127 clamp
  v_exp_f32_e64 v195, v163 clamp
  v_max_f32 v124, s58, v124
  v_max_f32 v160, s58, v160
  buffer_load_dwordx4 v6, s[16:19], s54 offen offset:1024 lds
  v_max_f32 v125, s58, v125
  v_max_f32 v161, s58, v161
  v_max_f32 v126, s58, v126
  v_max_f32 v162, s58, v162
  v_max_f32 v127, s58, v127
  v_max_f32 v163, s58, v163
  v_pk_fma_f32 v[124:125], v[124:125], s[56:57], v[188:189]
  ds_write_b128 v219, v[152:155]
  v_pk_fma_f32 v[160:161], v[160:161], s[56:57], v[192:193]
  v_pk_fma_f32 v[126:127], v[126:127], s[56:57], v[190:191]
  v_pk_fma_f32 v[162:163], v[162:163], s[56:57], v[194:195]
  v_cvt_pk_bf16_f32 v62, v124, v125
  v_cvt_pk_bf16_f32 v64, v160, v161
  v_cvt_pk_bf16_f32 v63, v126, v127
  v_cvt_pk_bf16_f32 v65, v162, v163
  v_pk_mul_f32 v[196:197], v[84:85], v[52:53] op_sel:[0,0] op_sel_hi:[1,0]
  v_pk_mul_f32 v[200:201], v[100:101], v[52:53] op_sel:[0,0] op_sel_hi:[1,0]
  v_pk_mul_f32 v[198:199], v[86:87], v[52:53] op_sel:[0,0] op_sel_hi:[1,0]
  v_pk_mul_f32 v[202:203], v[102:103], v[52:53] op_sel:[0,0] op_sel_hi:[1,0]
  v_pk_fma_f32 v[196:197], v[148:149], v[80:81], v[196:197]
  ds_write_b128 v220, v[140:143]
  v_pk_fma_f32 v[200:201], v[184:185], v[96:97], v[200:201]
  v_pk_fma_f32 v[198:199], v[150:151], v[82:83], v[198:199]
  v_pk_fma_f32 v[202:203], v[186:187], v[98:99], v[202:203]
  v_cvt_pk_bf16_f32 v40, v196, v197
  v_cvt_pk_bf16_f32 v42, v200, v201
  v_cvt_pk_bf16_f32 v41, v198, v199
  v_cvt_pk_bf16_f32 v43, v202, v203
  v_pk_fma_f32 v[188:189], v[92:93], v[46:47], s[58:59] op_sel:[0,1,0] op_sel_hi:[1,1,1]
  v_pk_fma_f32 v[192:193], v[108:109], v[46:47], s[58:59] op_sel:[0,1,0] op_sel_hi:[1,1,1]
  buffer_load_dwordx4 v7, s[16:19], s54 offen offset:2048 lds
  v_pk_fma_f32 v[190:191], v[94:95], v[46:47], s[58:59] op_sel:[0,1,0] op_sel_hi:[1,1,1]
  v_pk_fma_f32 v[194:195], v[110:111], v[46:47], s[58:59] op_sel:[0,1,0] op_sel_hi:[1,1,1]
  v_pk_fma_f32 v[128:129], v[128:129], v[88:89], v[188:189]
  v_pk_fma_f32 v[164:165], v[164:165], v[104:105], v[192:193]
  v_pk_fma_f32 v[130:131], v[130:131], v[90:91], v[190:191]
  v_pk_fma_f32 v[166:167], v[166:167], v[106:107], v[194:195]
  v_mfma_f32_16x16x32_bf16 v[176:179], v[62:65], v[28:31], 0
  v_mfma_f32_16x16x32_bf16 v[120:123], v[62:65], v[32:35], 0
  v_mfma_f32_16x16x32_bf16 v[156:159], v[62:65], v[36:39], 0
  v_mfma_f32_16x16x32_bf16 v[112:115], v[62:65], v[244:247], v[112:115]
  v_exp_f32_e64 v188, v128 clamp
  v_exp_f32_e64 v192, v164 clamp
  v_exp_f32_e64 v189, v129 clamp
  v_exp_f32_e64 v193, v165 clamp
  v_exp_f32_e64 v190, v130 clamp
  v_exp_f32_e64 v194, v166 clamp
  ds_write_b128 v221, v[176:179]
  v_exp_f32_e64 v191, v131 clamp
  v_exp_f32_e64 v195, v167 clamp
  v_max_f32 v128, s58, v128
  v_max_f32 v164, s58, v164
  v_max_f32 v129, s58, v129
  v_max_f32 v165, s58, v165
  v_max_f32 v130, s58, v130
  v_max_f32 v166, s58, v166
  v_max_f32 v131, s58, v131
  v_max_f32 v167, s58, v167
  v_pk_fma_f32 v[128:129], v[128:129], s[56:57], v[188:189]
  v_pk_fma_f32 v[164:165], v[164:165], s[56:57], v[192:193]
  ds_write_b128 v222, v[120:123]
  v_pk_fma_f32 v[130:131], v[130:131], s[56:57], v[190:191]
  v_pk_fma_f32 v[166:167], v[166:167], s[56:57], v[194:195]
  v_cvt_pk_bf16_f32 v66, v128, v129
  v_cvt_pk_bf16_f32 v68, v164, v165
  v_cvt_pk_bf16_f32 v67, v130, v131
  v_cvt_pk_bf16_f32 v69, v166, v167
  v_pk_fma_f32 v[188:189], v[92:93], v[48:49], s[58:59] op_sel:[0,0,0] op_sel_hi:[1,0,1]
  v_pk_fma_f32 v[192:193], v[108:109], v[48:49], s[58:59] op_sel:[0,0,0] op_sel_hi:[1,0,1]
  v_pk_fma_f32 v[190:191], v[94:95], v[48:49], s[58:59] op_sel:[0,0,0] op_sel_hi:[1,0,1]
  v_pk_fma_f32 v[194:195], v[110:111], v[48:49], s[58:59] op_sel:[0,0,0] op_sel_hi:[1,0,1]
  v_pk_fma_f32 v[132:133], v[132:133], v[88:89], v[188:189]
  v_pk_fma_f32 v[168:169], v[168:169], v[104:105], v[192:193]
  ds_write_b128 v223, v[156:159]
  v_pk_fma_f32 v[134:135], v[134:135], v[90:91], v[190:191]
  v_pk_fma_f32 v[170:171], v[170:171], v[106:107], v[194:195]
  v_mfma_f32_16x16x32_bf16 v[144:147], v[66:69], v[32:35], 0
  v_mfma_f32_16x16x32_bf16 v[180:183], v[66:69], v[36:39], 0
  v_mfma_f32_16x16x32_bf16 v[124:127], v[66:69], v[40:43], 0
  v_mfma_f32_16x16x32_bf16 v[112:115], v[66:69], v[248:251], v[112:115]
  v_exp_f32_e64 v188, v132 clamp
  v_exp_f32_e64 v192, v168 clamp
  v_exp_f32_e64 v189, v133 clamp
  v_exp_f32_e64 v193, v169 clamp
  v_exp_f32_e64 v190, v134 clamp
  v_exp_f32_e64 v194, v170 clamp
  ds_write_b128 v224, v[144:147]
  v_exp_f32_e64 v191, v135 clamp
  v_exp_f32_e64 v195, v171 clamp
  v_max_f32 v132, s58, v132
  v_max_f32 v168, s58, v168
  v_max_f32 v133, s58, v133
  v_max_f32 v169, s58, v169
  v_max_f32 v134, s58, v134
  v_max_f32 v170, s58, v170
  v_max_f32 v135, s58, v135
  v_max_f32 v171, s58, v171
  v_pk_fma_f32 v[132:133], v[132:133], s[56:57], v[188:189]
  v_pk_fma_f32 v[168:169], v[168:169], s[56:57], v[192:193]
  ds_write_b128 v225, v[180:183]
  v_pk_fma_f32 v[134:135], v[134:135], s[56:57], v[190:191]
  v_pk_fma_f32 v[170:171], v[170:171], s[56:57], v[194:195]
  v_cvt_pk_bf16_f32 v70, v132, v133
  v_cvt_pk_bf16_f32 v72, v168, v169
  v_cvt_pk_bf16_f32 v71, v134, v135
  v_cvt_pk_bf16_f32 v73, v170, v171
  v_lshlrev_b32 v3, 2, v0
  v_add_u32 v3, 110592, v3
  v_mfma_f32_16x16x32_bf16 v[160:163], v[70:73], v[36:39], 0
  v_mfma_f32_16x16x32_bf16 v[148:151], v[70:73], v[40:43], 0
  v_mfma_f32_16x16x32_bf16 v[112:115], v[70:73], v[252:255], v[112:115]
  ds_write_b128 v226, v[124:127]
  s_nop 0
  s_nop 0
  s_nop 0
  s_nop 0
  s_nop 0
  s_nop 0
  ds_write_b128 v227, v[160:163]
  ds_write_b128 v228, v[148:151]
  ds_write_b128 v229, v[112:115]
  s_waitcnt lgkmcnt(0)
  s_barrier
  ds_read2st64_b32 v[80:81], v3 offset0:0 offset1:48
  ds_read2st64_b32 v[82:83], v3 offset0:96 offset1:144
  ds_read2st64_b32 v[84:85], v3 offset0:4 offset1:52
  ds_read2st64_b32 v[86:87], v3 offset0:100 offset1:148
  ds_read2st64_b32 v[88:89], v3 offset0:8 offset1:56
  ds_read2st64_b32 v[90:91], v3 offset0:104 offset1:152
  ds_read2st64_b32 v[92:93], v3 offset0:12 offset1:60
  ds_read2st64_b32 v[94:95], v3 offset0:108 offset1:156
  ds_read2st64_b32 v[96:97], v3 offset0:16 offset1:64
  ds_read2st64_b32 v[98:99], v3 offset0:112 offset1:160
  ds_read2st64_b32 v[100:101], v3 offset0:20 offset1:68
  ds_read2st64_b32 v[102:103], v3 offset0:116 offset1:164
  s_waitcnt lgkmcnt(10)
  v_pk_add_f32 v[80:81], v[80:81], v[82:83]
  v_add_f32 v80, v80, v81
  buffer_atomic_add_f32 v80, v230, s[8:11], 0 offen sc1
  s_waitcnt lgkmcnt(8)
  v_pk_add_f32 v[84:85], v[84:85], v[86:87]
  v_add_f32 v84, v84, v85
  buffer_atomic_add_f32 v84, v231, s[8:11], 0 offen sc1
  s_waitcnt lgkmcnt(6)
  v_pk_add_f32 v[88:89], v[88:89], v[90:91]
  v_add_f32 v88, v88, v89
  buffer_atomic_add_f32 v88, v232, s[8:11], 0 offen sc1
  s_waitcnt lgkmcnt(4)
  v_pk_add_f32 v[92:93], v[92:93], v[94:95]
  v_add_f32 v92, v92, v93
  buffer_atomic_add_f32 v92, v233, s[8:11], 0 offen sc1
  s_waitcnt lgkmcnt(2)
  v_pk_add_f32 v[96:97], v[96:97], v[98:99]
  v_add_f32 v96, v96, v97
  buffer_atomic_add_f32 v96, v234, s[8:11], 0 offen sc1
  s_waitcnt lgkmcnt(0)
  v_pk_add_f32 v[100:101], v[100:101], v[102:103]
  v_add_f32 v100, v100, v101
  buffer_atomic_add_f32 v100, v235, s[8:11], 0 offen sc1
  v_cmp_gt_u32 vcc, 32, v0
  v_lshlrev_b32 v23, 7, v0
  v_mov_b32 v22, 1073741824
  v_cndmask_b32 v23, v22, v23, vcc
  v_mov_b32 v22, 1
  s_branch F_k2
F_q:
  v_mov_b32 v11, 0
  v_lshlrev_b32 v8, 2, v20
  v_lshlrev_b32 v9, 4, v21
  s_lshl_b32 s5, s52, 2
  s_add_u32 s5, s5, s29
  s_mul_i32 s5, s5, 9216
  s_add_u32 s40, s5, 262144
  s_add_u32 s41, s40, 4096
  s_add_u32 s42, s40, 8192
  s_lshl_b32 s39, s29, 5
  s_lshr_b32 s5, s52, 1
  s_add_u32 s39, s39, s5
  s_lshl_b32 s39, s39, 7
  s_add_u32 s39, s39, 2867200
  s_lshl_b32 s52, s52, 7
  s_add_u32 s52, s52, 2736128
  s_lshl_b32 s53, s53, 1
  s_add_u32 s53, s53, 2621184
  v_lshlrev_b32 v4, 4, v2
  v_cmp_lt_u32 vcc, 33, v2
  v_add_u32 v1, s53, v4
  v_add_u32 v3, 0, v1
  v_cndmask_b32 v1, v1, v3, vcc
  v_cmp_lt_u32 vcc, 7, v2
  v_add_u32 v4, s52, v4
  v_add_u32 v3, 8064, v4
  v_cndmask_b32 v4, v4, v3, vcc
  v_cmp_lt_u32 vcc, 15, v2
  s_lshl_b32 s7, s34, 10
  s_add_u32 s7, s7, 153600
  v_cndmask_b32 v4, v4, v1, vcc
  v_cmp_lt_u32 vcc, 51, v2
  v_mov_b32 v1, 1073741824
  v_add_u32 v8, s7, v8
  v_cndmask_b32 v4, v4, v1, vcc
  v_add_u32 v9, s7, v9
  s_mov_b64 exec, 0
  s_cmp_eq_u32 s34, 0
  s_cbranch_scc1 HP_q_p0
  s_cmp_eq_u32 s34, 1
  s_cbranch_scc1 HP_q_p1
  s_cmp_eq_u32 s34, 2
  s_cbranch_scc1 HP_q_ret
  s_cmp_eq_u32 s34, 3
  s_cbranch_scc1 HP_q_ret
HP_q_ret:
  s_mov_b64 exec, -1
F_q_s:
  s_waitcnt vmcnt(9)
  s_barrier
  ds_read_b128 a[0:3], v12 offset:0
  ds_read_b128 a[4:7], v12 offset:2048
  ds_read_b64_tr_b16 a[16:17], v14 offset:0
  ds_read_b64_tr_b16 a[18:19], v15 offset:0
  ds_read_b64_tr_b16 a[20:21], v14 offset:32
  ds_read_b64_tr_b16 a[22:23], v15 offset:32
  ds_read_b64_tr_b16 a[24:25], v14 offset:64
  ds_read_b64_tr_b16 a[26:27], v15 offset:64
  ds_read_b64_tr_b16 a[28:29], v14 offset:96
  ds_read_b64_tr_b16 a[30:31], v15 offset:96
  ds_read_b64_tr_b16 a[32:33], v14 offset:128
  ds_read_b64_tr_b16 a[34:35], v15 offset:128
  ds_read_b64_tr_b16 a[36:37], v14 offset:160
  ds_read_b64_tr_b16 a[38:39], v15 offset:160
  ds_read_b64_tr_b16 a[40:41], v14 offset:192
  ds_read_b64_tr_b16 a[42:43], v15 offset:192
  ds_read_b64_tr_b16 a[44:45], v14 offset:224
  ds_read_b64_tr_b16 a[46:47], v15 offset:224
  ds_read_b64_tr_b16 a[48:49], v14 offset:256
  ds_read_b64_tr_b16 a[50:51], v15 offset:256
  s_add_u32 m0, s35, 73728
  s_add_u32 s54, s31, 256
  buffer_load_dwordx4 v204, s[20:23], s54 offen lds
  buffer_load_dwordx4 v205, s[20:23], s54 offen offset:1024 lds
  buffer_load_dwordx4 v206, s[20:23], s54 offen offset:2048 lds
  buffer_load_dwordx4 v207, s[20:23], s54 offen offset:3072 lds
  s_waitcnt lgkmcnt(6)
  v_mfma_f32_16x16x32_bf16 v[116:119], a[16:19], a[0:3], 0
  ds_read_b128 a[8:11], v13 offset:0
  ds_read_b128 a[12:15], v13 offset:2048
  v_mfma_f32_16x16x32_bf16 v[152:155], a[16:19], a[4:7], 0
  ds_read_b64_tr_b16 a[52:53], v14 offset:18432
  v_mfma_f32_16x16x32_bf16 v[120:123], a[20:23], a[0:3], 0
  ds_read_b64_tr_b16 a[54:55], v15 offset:18432
  ds_read_b64_tr_b16 a[56:57], v14 offset:18464
  v_mfma_f32_16x16x32_bf16 v[156:159], a[20:23], a[4:7], 0
  ds_read_b64_tr_b16 a[58:59], v15 offset:18464
  s_add_u32 m0, s35, 77824
  s_add_u32 s55, s36, 442368
  buffer_load_dwordx4 v208, s[12:15], s55 offen lds
  v_mfma_f32_16x16x32_bf16 v[124:127], a[24:27], a[0:3], 0
  ds_read_b64_tr_b16 a[60:61], v14 offset:18496
  ds_read_b64_tr_b16 a[62:63], v15 offset:18496
  v_mfma_f32_16x16x32_bf16 v[160:163], a[24:27], a[4:7], 0
  ds_read_b64_tr_b16 a[64:65], v14 offset:18528
  v_mfma_f32_16x16x32_bf16 v[128:131], a[28:31], a[0:3], 0
  ds_read_b64_tr_b16 a[66:67], v15 offset:18528
  ds_read_b64_tr_b16 a[68:69], v14 offset:18560
  v_mfma_f32_16x16x32_bf16 v[164:167], a[28:31], a[4:7], 0
  ds_read_b64_tr_b16 a[70:71], v15 offset:18560
  buffer_load_dwordx4 v209, s[12:15], s55 offen offset:1024 lds
  s_waitcnt lgkmcnt(12)
  v_mfma_f32_16x16x32_bf16 v[132:135], a[32:35], a[0:3], 0
  ds_read_b64_tr_b16 a[72:73], v14 offset:18592
  ds_read_b64_tr_b16 a[74:75], v15 offset:18592
  v_mfma_f32_16x16x32_bf16 v[168:171], a[32:35], a[4:7], 0
  ds_read_b64_tr_b16 a[76:77], v14 offset:18624
  v_mfma_f32_16x16x32_bf16 v[136:139], a[36:39], a[0:3], 0
  ds_read_b64_tr_b16 a[78:79], v15 offset:18624
  ds_read_b64_tr_b16 a[80:81], v14 offset:18656
  v_mfma_f32_16x16x32_bf16 v[172:175], a[36:39], a[4:7], 0
  ds_read_b64_tr_b16 a[82:83], v15 offset:18656
  buffer_load_dwordx4 v210, s[12:15], s55 offen offset:2048 lds
  v_mfma_f32_16x16x32_bf16 v[140:143], a[40:43], a[0:3], 0
  ds_read_b64_tr_b16 a[84:85], v14 offset:18688
  ds_read_b64_tr_b16 a[86:87], v15 offset:18688
  v_mfma_f32_16x16x32_bf16 v[176:179], a[40:43], a[4:7], 0
  v_mfma_f32_16x16x32_bf16 v[144:147], a[44:47], a[0:3], 0
  v_mfma_f32_16x16x32_bf16 v[180:183], a[44:47], a[4:7], 0
  buffer_load_dwordx4 v211, s[12:15], s55 offen offset:3072 lds
  v_mfma_f32_16x16x32_bf16 v[148:151], a[48:51], a[0:3], 0
  v_mfma_f32_16x16x32_bf16 v[184:187], a[48:51], a[4:7], 0
  s_waitcnt lgkmcnt(0)
  v_mfma_f32_16x16x32_bf16 v[116:119], a[52:55], a[8:11], v[116:119]
  s_add_u32 m0, s35, 81920
  s_nop 0
  buffer_load_dwordx4 v212, s[12:15], s55 offen lds
  s_waitcnt vmcnt(9)
  s_barrier
  ds_read_b128 a[0:3], v12 offset:36864
  ds_read_b128 a[4:7], v12 offset:38912
  v_mfma_f32_16x16x32_bf16 v[152:155], a[52:55], a[12:15], v[152:155]
  ds_read_b64_tr_b16 a[16:17], v14 offset:36864
  v_mfma_f32_16x16x32_bf16 v[120:123], a[56:59], a[8:11], v[120:123]
  ds_read_b64_tr_b16 a[18:19], v15 offset:36864
  ds_read_b64_tr_b16 a[20:21], v14 offset:36896
  v_mfma_f32_16x16x32_bf16 v[156:159], a[56:59], a[12:15], v[156:159]
  ds_read_b64_tr_b16 a[22:23], v15 offset:36896
  s_add_u32 m0, s35, 110592
  s_add_u32 s54, s31, 384
  buffer_load_dwordx4 v204, s[20:23], s54 offen lds
  v_mfma_f32_16x16x32_bf16 v[124:127], a[60:63], a[8:11], v[124:127]
  ds_read_b64_tr_b16 a[24:25], v14 offset:36928
  ds_read_b64_tr_b16 a[26:27], v15 offset:36928
  v_mfma_f32_16x16x32_bf16 v[160:163], a[60:63], a[12:15], v[160:163]
  ds_read_b64_tr_b16 a[28:29], v14 offset:36960
  v_mfma_f32_16x16x32_bf16 v[128:131], a[64:67], a[8:11], v[128:131]
  ds_read_b64_tr_b16 a[30:31], v15 offset:36960
  ds_read_b64_tr_b16 a[32:33], v14 offset:36992
  v_mfma_f32_16x16x32_bf16 v[164:167], a[64:67], a[12:15], v[164:167]
  ds_read_b64_tr_b16 a[34:35], v15 offset:36992
  buffer_load_dwordx4 v205, s[20:23], s54 offen offset:1024 lds
  v_mfma_f32_16x16x32_bf16 v[132:135], a[68:71], a[8:11], v[132:135]
  ds_read_b64_tr_b16 a[36:37], v14 offset:37024
  ds_read_b64_tr_b16 a[38:39], v15 offset:37024
  v_mfma_f32_16x16x32_bf16 v[168:171], a[68:71], a[12:15], v[168:171]
  ds_read_b64_tr_b16 a[40:41], v14 offset:37056
  v_mfma_f32_16x16x32_bf16 v[136:139], a[72:75], a[8:11], v[136:139]
  ds_read_b64_tr_b16 a[42:43], v15 offset:37056
  ds_read_b64_tr_b16 a[44:45], v14 offset:37088
  v_mfma_f32_16x16x32_bf16 v[172:175], a[72:75], a[12:15], v[172:175]
  ds_read_b64_tr_b16 a[46:47], v15 offset:37088
  buffer_load_dwordx4 v206, s[20:23], s54 offen offset:2048 lds
  v_mfma_f32_16x16x32_bf16 v[140:143], a[76:79], a[8:11], v[140:143]
  ds_read_b64_tr_b16 a[48:49], v14 offset:37120
  ds_read_b64_tr_b16 a[50:51], v15 offset:37120
  v_mfma_f32_16x16x32_bf16 v[176:179], a[76:79], a[12:15], v[176:179]
  v_mfma_f32_16x16x32_bf16 v[144:147], a[80:83], a[8:11], v[144:147]
  v_mfma_f32_16x16x32_bf16 v[180:183], a[80:83], a[12:15], v[180:183]
  buffer_load_dwordx4 v207, s[20:23], s54 offen offset:3072 lds
  v_mfma_f32_16x16x32_bf16 v[148:151], a[84:87], a[8:11], v[148:151]
  v_mfma_f32_16x16x32_bf16 v[184:187], a[84:87], a[12:15], v[184:187]
  s_waitcnt lgkmcnt(6)
  v_mfma_f32_16x16x32_bf16 v[116:119], a[16:19], a[0:3], v[116:119]
  ds_read_b128 a[8:11], v13 offset:36864
  ds_read_b128 a[12:15], v13 offset:38912
  v_mfma_f32_16x16x32_bf16 v[152:155], a[16:19], a[4:7], v[152:155]
  ds_read_b64_tr_b16 a[52:53], v14 offset:55296
  v_mfma_f32_16x16x32_bf16 v[120:123], a[20:23], a[0:3], v[120:123]
  ds_read_b64_tr_b16 a[54:55], v15 offset:55296
  ds_read_b64_tr_b16 a[56:57], v14 offset:55328
  v_mfma_f32_16x16x32_bf16 v[156:159], a[20:23], a[4:7], v[156:159]
  ds_read_b64_tr_b16 a[58:59], v15 offset:55328
  s_add_u32 m0, s35, 114688
  s_add_u32 s55, s36, 663552
  buffer_load_dwordx4 v208, s[12:15], s55 offen lds
  v_mfma_f32_16x16x32_bf16 v[124:127], a[24:27], a[0:3], v[124:127]
  ds_read_b64_tr_b16 a[60:61], v14 offset:55360
  ds_read_b64_tr_b16 a[62:63], v15 offset:55360
  v_mfma_f32_16x16x32_bf16 v[160:163], a[24:27], a[4:7], v[160:163]
  ds_read_b64_tr_b16 a[64:65], v14 offset:55392
  v_mfma_f32_16x16x32_bf16 v[128:131], a[28:31], a[0:3], v[128:131]
  ds_read_b64_tr_b16 a[66:67], v15 offset:55392
  ds_read_b64_tr_b16 a[68:69], v14 offset:55424
  v_mfma_f32_16x16x32_bf16 v[164:167], a[28:31], a[4:7], v[164:167]
  ds_read_b64_tr_b16 a[70:71], v15 offset:55424
  buffer_load_dwordx4 v209, s[12:15], s55 offen offset:1024 lds
  s_waitcnt lgkmcnt(12)
  v_mfma_f32_16x16x32_bf16 v[132:135], a[32:35], a[0:3], v[132:135]
  ds_read_b64_tr_b16 a[72:73], v14 offset:55456
  ds_read_b64_tr_b16 a[74:75], v15 offset:55456
  v_mfma_f32_16x16x32_bf16 v[168:171], a[32:35], a[4:7], v[168:171]
  ds_read_b64_tr_b16 a[76:77], v14 offset:55488
  v_mfma_f32_16x16x32_bf16 v[136:139], a[36:39], a[0:3], v[136:139]
  ds_read_b64_tr_b16 a[78:79], v15 offset:55488
  ds_read_b64_tr_b16 a[80:81], v14 offset:55520
  v_mfma_f32_16x16x32_bf16 v[172:175], a[36:39], a[4:7], v[172:175]
  ds_read_b64_tr_b16 a[82:83], v15 offset:55520
  buffer_load_dwordx4 v210, s[12:15], s55 offen offset:2048 lds
  v_mfma_f32_16x16x32_bf16 v[140:143], a[40:43], a[0:3], v[140:143]
  ds_read_b64_tr_b16 a[84:85], v14 offset:55552
  ds_read_b64_tr_b16 a[86:87], v15 offset:55552
  v_mfma_f32_16x16x32_bf16 v[176:179], a[40:43], a[4:7], v[176:179]
  v_mfma_f32_16x16x32_bf16 v[144:147], a[44:47], a[0:3], v[144:147]
  v_mfma_f32_16x16x32_bf16 v[180:183], a[44:47], a[4:7], v[180:183]
  buffer_load_dwordx4 v211, s[12:15], s55 offen offset:3072 lds
  v_mfma_f32_16x16x32_bf16 v[148:151], a[48:51], a[0:3], v[148:151]
  v_mfma_f32_16x16x32_bf16 v[184:187], a[48:51], a[4:7], v[184:187]
  s_waitcnt lgkmcnt(0)
  v_mfma_f32_16x16x32_bf16 v[116:119], a[52:55], a[8:11], v[116:119]
  s_add_u32 m0, s35, 118784
  s_nop 0
  buffer_load_dwordx4 v212, s[12:15], s55 offen lds
  s_waitcnt vmcnt(9)
  s_barrier
  ds_read_b128 a[0:3], v16 offset:0
  ds_read_b128 a[4:7], v16 offset:2048
  v_mfma_f32_16x16x32_bf16 v[152:155], a[52:55], a[12:15], v[152:155]
  ds_read_b64_tr_b16 a[16:17], v18 offset:0
  v_mfma_f32_16x16x32_bf16 v[120:123], a[56:59], a[8:11], v[120:123]
  ds_read_b64_tr_b16 a[18:19], v19 offset:0
  ds_read_b64_tr_b16 a[20:21], v18 offset:32
  v_mfma_f32_16x16x32_bf16 v[156:159], a[56:59], a[12:15], v[156:159]
  ds_read_b64_tr_b16 a[22:23], v19 offset:32
  s_add_u32 m0, s35, 0
HP_q_p0:
  s_cbranch_execz HP_q_ret
  s_add_u32 s54, s31, 512
  buffer_load_dwordx4 v204, s[20:23], s54 offen lds
  v_mfma_f32_16x16x32_bf16 v[124:127], a[60:63], a[8:11], v[124:127]
  ds_read_b64_tr_b16 a[24:25], v18 offset:64
  ds_read_b64_tr_b16 a[26:27], v19 offset:64
  v_mfma_f32_16x16x32_bf16 v[160:163], a[60:63], a[12:15], v[160:163]
  ds_read_b64_tr_b16 a[28:29], v18 offset:96
  v_mfma_f32_16x16x32_bf16 v[128:131], a[64:67], a[8:11], v[128:131]
  ds_read_b64_tr_b16 a[30:31], v19 offset:96
  ds_read_b64_tr_b16 a[32:33], v18 offset:128
  v_mfma_f32_16x16x32_bf16 v[164:167], a[64:67], a[12:15], v[164:167]
  ds_read_b64_tr_b16 a[34:35], v19 offset:128
  buffer_load_dwordx4 v205, s[20:23], s54 offen offset:1024 lds
  v_mfma_f32_16x16x32_bf16 v[132:135], a[68:71], a[8:11], v[132:135]
  ds_read_b64_tr_b16 a[36:37], v18 offset:160
  ds_read_b64_tr_b16 a[38:39], v19 offset:160
  v_mfma_f32_16x16x32_bf16 v[168:171], a[68:71], a[12:15], v[168:171]
  ds_read_b64_tr_b16 a[40:41], v18 offset:192
  v_mfma_f32_16x16x32_bf16 v[136:139], a[72:75], a[8:11], v[136:139]
  ds_read_b64_tr_b16 a[42:43], v19 offset:192
  ds_read_b64_tr_b16 a[44:45], v18 offset:224
  v_mfma_f32_16x16x32_bf16 v[172:175], a[72:75], a[12:15], v[172:175]
  ds_read_b64_tr_b16 a[46:47], v19 offset:224
  buffer_load_dwordx4 v206, s[20:23], s54 offen offset:2048 lds
  v_mfma_f32_16x16x32_bf16 v[140:143], a[76:79], a[8:11], v[140:143]
  ds_read_b64_tr_b16 a[48:49], v18 offset:256
  ds_read_b64_tr_b16 a[50:51], v19 offset:256
  v_mfma_f32_16x16x32_bf16 v[176:179], a[76:79], a[12:15], v[176:179]
  v_mfma_f32_16x16x32_bf16 v[144:147], a[80:83], a[8:11], v[144:147]
  v_mfma_f32_16x16x32_bf16 v[180:183], a[80:83], a[12:15], v[180:183]
  buffer_load_dwordx4 v207, s[20:23], s54 offen offset:3072 lds
  v_mfma_f32_16x16x32_bf16 v[148:151], a[84:87], a[8:11], v[148:151]
  v_mfma_f32_16x16x32_bf16 v[184:187], a[84:87], a[12:15], v[184:187]
  s_waitcnt lgkmcnt(6)
  v_mfma_f32_16x16x32_bf16 v[116:119], a[16:19], a[0:3], v[116:119]
  ds_read_b128 a[8:11], v17 offset:0
  ds_read_b128 a[12:15], v17 offset:2048
  v_mfma_f32_16x16x32_bf16 v[152:155], a[16:19], a[4:7], v[152:155]
  ds_read_b64_tr_b16 a[52:53], v18 offset:18432
  v_mfma_f32_16x16x32_bf16 v[120:123], a[20:23], a[0:3], v[120:123]
  ds_read_b64_tr_b16 a[54:55], v19 offset:18432
  ds_read_b64_tr_b16 a[56:57], v18 offset:18464
  v_mfma_f32_16x16x32_bf16 v[156:159], a[20:23], a[4:7], v[156:159]
  ds_read_b64_tr_b16 a[58:59], v19 offset:18464
  s_add_u32 m0, s35, 4096
  s_add_u32 s55, s36, 884736
  buffer_load_dwordx4 v208, s[12:15], s55 offen lds
  v_mfma_f32_16x16x32_bf16 v[124:127], a[24:27], a[0:3], v[124:127]
  ds_read_b64_tr_b16 a[60:61], v18 offset:18496
  ds_read_b64_tr_b16 a[62:63], v19 offset:18496
  v_mfma_f32_16x16x32_bf16 v[160:163], a[24:27], a[4:7], v[160:163]
  ds_read_b64_tr_b16 a[64:65], v18 offset:18528
  v_mfma_f32_16x16x32_bf16 v[128:131], a[28:31], a[0:3], v[128:131]
  ds_read_b64_tr_b16 a[66:67], v19 offset:18528
  ds_read_b64_tr_b16 a[68:69], v18 offset:18560
  v_mfma_f32_16x16x32_bf16 v[164:167], a[28:31], a[4:7], v[164:167]
  ds_read_b64_tr_b16 a[70:71], v19 offset:18560
  buffer_load_dwordx4 v209, s[12:15], s55 offen offset:1024 lds
  s_waitcnt lgkmcnt(12)
  v_mfma_f32_16x16x32_bf16 v[132:135], a[32:35], a[0:3], v[132:135]
  ds_read_b64_tr_b16 a[72:73], v18 offset:18592
  ds_read_b64_tr_b16 a[74:75], v19 offset:18592
  v_mfma_f32_16x16x32_bf16 v[168:171], a[32:35], a[4:7], v[168:171]
  ds_read_b64_tr_b16 a[76:77], v18 offset:18624
  v_mfma_f32_16x16x32_bf16 v[136:139], a[36:39], a[0:3], v[136:139]
  ds_read_b64_tr_b16 a[78:79], v19 offset:18624
  ds_read_b64_tr_b16 a[80:81], v18 offset:18656
  v_mfma_f32_16x16x32_bf16 v[172:175], a[36:39], a[4:7], v[172:175]
  ds_read_b64_tr_b16 a[82:83], v19 offset:18656
  buffer_load_dwordx4 v210, s[12:15], s55 offen offset:2048 lds
  v_mfma_f32_16x16x32_bf16 v[140:143], a[40:43], a[0:3], v[140:143]
  ds_read_b64_tr_b16 a[84:85], v18 offset:18688
  ds_read_b64_tr_b16 a[86:87], v19 offset:18688
  v_mfma_f32_16x16x32_bf16 v[176:179], a[40:43], a[4:7], v[176:179]
  v_mfma_f32_16x16x32_bf16 v[144:147], a[44:47], a[0:3], v[144:147]
  v_mfma_f32_16x16x32_bf16 v[180:183], a[44:47], a[4:7], v[180:183]
  buffer_load_dwordx4 v211, s[12:15], s55 offen offset:3072 lds
  v_mfma_f32_16x16x32_bf16 v[148:151], a[48:51], a[0:3], v[148:151]
  v_mfma_f32_16x16x32_bf16 v[184:187], a[48:51], a[4:7], v[184:187]
  s_waitcnt lgkmcnt(0)
  v_mfma_f32_16x16x32_bf16 v[116:119], a[52:55], a[8:11], v[116:119]
  s_add_u32 m0, s35, 8192
  s_nop 0
  buffer_load_dwordx4 v212, s[12:15], s55 offen lds
  s_waitcnt vmcnt(9)
  s_barrier
  ds_read_b128 a[0:3], v16 offset:36864
  ds_read_b128 a[4:7], v16 offset:38912
  v_mfma_f32_16x16x32_bf16 v[152:155], a[52:55], a[12:15], v[152:155]
  ds_read_b64_tr_b16 a[16:17], v18 offset:36864
  v_mfma_f32_16x16x32_bf16 v[120:123], a[56:59], a[8:11], v[120:123]
  ds_read_b64_tr_b16 a[18:19], v19 offset:36864
  ds_read_b64_tr_b16 a[20:21], v18 offset:36896
  v_mfma_f32_16x16x32_bf16 v[156:159], a[56:59], a[12:15], v[156:159]
  ds_read_b64_tr_b16 a[22:23], v19 offset:36896
  s_add_u32 m0, s35, 36864
  s_add_u32 s54, s31, 640
  buffer_load_dwordx4 v204, s[20:23], s54 offen lds
  v_mfma_f32_16x16x32_bf16 v[124:127], a[60:63], a[8:11], v[124:127]
  ds_read_b64_tr_b16 a[24:25], v18 offset:36928
  ds_read_b64_tr_b16 a[26:27], v19 offset:36928
  v_mfma_f32_16x16x32_bf16 v[160:163], a[60:63], a[12:15], v[160:163]
  ds_read_b64_tr_b16 a[28:29], v18 offset:36960
  v_mfma_f32_16x16x32_bf16 v[128:131], a[64:67], a[8:11], v[128:131]
  ds_read_b64_tr_b16 a[30:31], v19 offset:36960
  ds_read_b64_tr_b16 a[32:33], v18 offset:36992
  v_mfma_f32_16x16x32_bf16 v[164:167], a[64:67], a[12:15], v[164:167]
  ds_read_b64_tr_b16 a[34:35], v19 offset:36992
  buffer_load_dwordx4 v205, s[20:23], s54 offen offset:1024 lds
  v_mfma_f32_16x16x32_bf16 v[132:135], a[68:71], a[8:11], v[132:135]
  ds_read_b64_tr_b16 a[36:37], v18 offset:37024
  ds_read_b64_tr_b16 a[38:39], v19 offset:37024
  v_mfma_f32_16x16x32_bf16 v[168:171], a[68:71], a[12:15], v[168:171]
  ds_read_b64_tr_b16 a[40:41], v18 offset:37056
  v_mfma_f32_16x16x32_bf16 v[136:139], a[72:75], a[8:11], v[136:139]
  ds_read_b64_tr_b16 a[42:43], v19 offset:37056
  ds_read_b64_tr_b16 a[44:45], v18 offset:37088
  v_mfma_f32_16x16x32_bf16 v[172:175], a[72:75], a[12:15], v[172:175]
  ds_read_b64_tr_b16 a[46:47], v19 offset:37088
  buffer_load_dwordx4 v206, s[20:23], s54 offen offset:2048 lds
  v_mfma_f32_16x16x32_bf16 v[140:143], a[76:79], a[8:11], v[140:143]
  ds_read_b64_tr_b16 a[48:49], v18 offset:37120
  ds_read_b64_tr_b16 a[50:51], v19 offset:37120
  v_mfma_f32_16x16x32_bf16 v[176:179], a[76:79], a[12:15], v[176:179]
  v_mfma_f32_16x16x32_bf16 v[144:147], a[80:83], a[8:11], v[144:147]
  v_mfma_f32_16x16x32_bf16 v[180:183], a[80:83], a[12:15], v[180:183]
  buffer_load_dwordx4 v207, s[20:23], s54 offen offset:3072 lds
  v_mfma_f32_16x16x32_bf16 v[148:151], a[84:87], a[8:11], v[148:151]
  v_mfma_f32_16x16x32_bf16 v[184:187], a[84:87], a[12:15], v[184:187]
  s_waitcnt lgkmcnt(6)
  v_mfma_f32_16x16x32_bf16 v[116:119], a[16:19], a[0:3], v[116:119]
  ds_read_b128 a[8:11], v17 offset:36864
  ds_read_b128 a[12:15], v17 offset:38912
  v_mfma_f32_16x16x32_bf16 v[152:155], a[16:19], a[4:7], v[152:155]
  ds_read_b64_tr_b16 a[52:53], v18 offset:55296
  v_mfma_f32_16x16x32_bf16 v[120:123], a[20:23], a[0:3], v[120:123]
  ds_read_b64_tr_b16 a[54:55], v19 offset:55296
  ds_read_b64_tr_b16 a[56:57], v18 offset:55328
  v_mfma_f32_16x16x32_bf16 v[156:159], a[20:23], a[4:7], v[156:159]
  ds_read_b64_tr_b16 a[58:59], v19 offset:55328
  s_add_u32 m0, s35, 40960
  s_add_u32 s55, s36, 1105920
  buffer_load_dwordx4 v208, s[12:15], s55 offen lds
  v_mfma_f32_16x16x32_bf16 v[124:127], a[24:27], a[0:3], v[124:127]
  ds_read_b64_tr_b16 a[60:61], v18 offset:55360
  ds_read_b64_tr_b16 a[62:63], v19 offset:55360
  v_mfma_f32_16x16x32_bf16 v[160:163], a[24:27], a[4:7], v[160:163]
  ds_read_b64_tr_b16 a[64:65], v18 offset:55392
  v_mfma_f32_16x16x32_bf16 v[128:131], a[28:31], a[0:3], v[128:131]
  ds_read_b64_tr_b16 a[66:67], v19 offset:55392
  ds_read_b64_tr_b16 a[68:69], v18 offset:55424
  v_mfma_f32_16x16x32_bf16 v[164:167], a[28:31], a[4:7], v[164:167]
  ds_read_b64_tr_b16 a[70:71], v19 offset:55424
  buffer_load_dwordx4 v209, s[12:15], s55 offen offset:1024 lds
  s_waitcnt lgkmcnt(12)
  v_mfma_f32_16x16x32_bf16 v[132:135], a[32:35], a[0:3], v[132:135]
  ds_read_b64_tr_b16 a[72:73], v18 offset:55456
  ds_read_b64_tr_b16 a[74:75], v19 offset:55456
  v_mfma_f32_16x16x32_bf16 v[168:171], a[32:35], a[4:7], v[168:171]
  ds_read_b64_tr_b16 a[76:77], v18 offset:55488
  v_mfma_f32_16x16x32_bf16 v[136:139], a[36:39], a[0:3], v[136:139]
  ds_read_b64_tr_b16 a[78:79], v19 offset:55488
  ds_read_b64_tr_b16 a[80:81], v18 offset:55520
  v_mfma_f32_16x16x32_bf16 v[172:175], a[36:39], a[4:7], v[172:175]
  ds_read_b64_tr_b16 a[82:83], v19 offset:55520
  buffer_load_dwordx4 v210, s[12:15], s55 offen offset:2048 lds
  v_mfma_f32_16x16x32_bf16 v[140:143], a[40:43], a[0:3], v[140:143]
  ds_read_b64_tr_b16 a[84:85], v18 offset:55552
  ds_read_b64_tr_b16 a[86:87], v19 offset:55552
  v_mfma_f32_16x16x32_bf16 v[176:179], a[40:43], a[4:7], v[176:179]
  v_mfma_f32_16x16x32_bf16 v[144:147], a[44:47], a[0:3], v[144:147]
  v_mfma_f32_16x16x32_bf16 v[180:183], a[44:47], a[4:7], v[180:183]
  buffer_load_dwordx4 v211, s[12:15], s55 offen offset:3072 lds
  v_mfma_f32_16x16x32_bf16 v[148:151], a[48:51], a[0:3], v[148:151]
  v_mfma_f32_16x16x32_bf16 v[184:187], a[48:51], a[4:7], v[184:187]
  s_waitcnt lgkmcnt(0)
  v_mfma_f32_16x16x32_bf16 v[116:119], a[52:55], a[8:11], v[116:119]
  s_add_u32 m0, s35, 45056
  s_nop 0
  buffer_load_dwordx4 v212, s[12:15], s55 offen lds
  s_waitcnt vmcnt(9)
  s_barrier
  ds_read_b128 a[0:3], v12 offset:0
  ds_read_b128 a[4:7], v12 offset:2048
  v_mfma_f32_16x16x32_bf16 v[152:155], a[52:55], a[12:15], v[152:155]
  ds_read_b64_tr_b16 a[16:17], v14 offset:0
  v_mfma_f32_16x16x32_bf16 v[120:123], a[56:59], a[8:11], v[120:123]
  ds_read_b64_tr_b16 a[18:19], v15 offset:0
  ds_read_b64_tr_b16 a[20:21], v14 offset:32
  v_mfma_f32_16x16x32_bf16 v[156:159], a[56:59], a[12:15], v[156:159]
  ds_read_b64_tr_b16 a[22:23], v15 offset:32
  s_add_u32 m0, s35, 73728
  s_add_u32 s54, s31, 768
  buffer_load_dwordx4 v204, s[20:23], s54 offen lds
  v_mfma_f32_16x16x32_bf16 v[124:127], a[60:63], a[8:11], v[124:127]
  ds_read_b64_tr_b16 a[24:25], v14 offset:64
  ds_read_b64_tr_b16 a[26:27], v15 offset:64
  v_mfma_f32_16x16x32_bf16 v[160:163], a[60:63], a[12:15], v[160:163]
  ds_read_b64_tr_b16 a[28:29], v14 offset:96
  v_mfma_f32_16x16x32_bf16 v[128:131], a[64:67], a[8:11], v[128:131]
  ds_read_b64_tr_b16 a[30:31], v15 offset:96
  ds_read_b64_tr_b16 a[32:33], v14 offset:128
  v_mfma_f32_16x16x32_bf16 v[164:167], a[64:67], a[12:15], v[164:167]
  ds_read_b64_tr_b16 a[34:35], v15 offset:128
  buffer_load_dwordx4 v205, s[20:23], s54 offen offset:1024 lds
  v_mfma_f32_16x16x32_bf16 v[132:135], a[68:71], a[8:11], v[132:135]
  ds_read_b64_tr_b16 a[36:37], v14 offset:160
  ds_read_b64_tr_b16 a[38:39], v15 offset:160
  v_mfma_f32_16x16x32_bf16 v[168:171], a[68:71], a[12:15], v[168:171]
  ds_read_b64_tr_b16 a[40:41], v14 offset:192
  v_mfma_f32_16x16x32_bf16 v[136:139], a[72:75], a[8:11], v[136:139]
  ds_read_b64_tr_b16 a[42:43], v15 offset:192
  ds_read_b64_tr_b16 a[44:45], v14 offset:224
  v_mfma_f32_16x16x32_bf16 v[172:175], a[72:75], a[12:15], v[172:175]
  ds_read_b64_tr_b16 a[46:47], v15 offset:224
  buffer_load_dwordx4 v206, s[20:23], s54 offen offset:2048 lds
  v_mfma_f32_16x16x32_bf16 v[140:143], a[76:79], a[8:11], v[140:143]
  ds_read_b64_tr_b16 a[48:49], v14 offset:256
  ds_read_b64_tr_b16 a[50:51], v15 offset:256
  v_mfma_f32_16x16x32_bf16 v[176:179], a[76:79], a[12:15], v[176:179]
  v_mfma_f32_16x16x32_bf16 v[144:147], a[80:83], a[8:11], v[144:147]
  v_mfma_f32_16x16x32_bf16 v[180:183], a[80:83], a[12:15], v[180:183]
  buffer_load_dwordx4 v207, s[20:23], s54 offen offset:3072 lds
  v_mfma_f32_16x16x32_bf16 v[148:151], a[84:87], a[8:11], v[148:151]
  v_mfma_f32_16x16x32_bf16 v[184:187], a[84:87], a[12:15], v[184:187]
  s_waitcnt lgkmcnt(6)
  v_mfma_f32_16x16x32_bf16 v[116:119], a[16:19], a[0:3], v[116:119]
  ds_read_b128 a[8:11], v13 offset:0
  ds_read_b128 a[12:15], v13 offset:2048
  v_mfma_f32_16x16x32_bf16 v[152:155], a[16:19], a[4:7], v[152:155]
  ds_read_b64_tr_b16 a[52:53], v14 offset:18432
  v_mfma_f32_16x16x32_bf16 v[120:123], a[20:23], a[0:3], v[120:123]
  ds_read_b64_tr_b16 a[54:55], v15 offset:18432
  ds_read_b64_tr_b16 a[56:57], v14 offset:18464
  v_mfma_f32_16x16x32_bf16 v[156:159], a[20:23], a[4:7], v[156:159]
  ds_read_b64_tr_b16 a[58:59], v15 offset:18464
  s_add_u32 m0, s35, 77824
  s_add_u32 s55, s36, 1327104
  buffer_load_dwordx4 v208, s[12:15], s55 offen lds
  v_mfma_f32_16x16x32_bf16 v[124:127], a[24:27], a[0:3], v[124:127]
  ds_read_b64_tr_b16 a[60:61], v14 offset:18496
  ds_read_b64_tr_b16 a[62:63], v15 offset:18496
  v_mfma_f32_16x16x32_bf16 v[160:163], a[24:27], a[4:7], v[160:163]
  ds_read_b64_tr_b16 a[64:65], v14 offset:18528
  v_mfma_f32_16x16x32_bf16 v[128:131], a[28:31], a[0:3], v[128:131]
  ds_read_b64_tr_b16 a[66:67], v15 offset:18528
  ds_read_b64_tr_b16 a[68:69], v14 offset:18560
  v_mfma_f32_16x16x32_bf16 v[164:167], a[28:31], a[4:7], v[164:167]
  ds_read_b64_tr_b16 a[70:71], v15 offset:18560
  buffer_load_dwordx4 v209, s[12:15], s55 offen offset:1024 lds
  s_waitcnt lgkmcnt(12)
  v_mfma_f32_16x16x32_bf16 v[132:135], a[32:35], a[0:3], v[132:135]
  ds_read_b64_tr_b16 a[72:73], v14 offset:18592
  ds_read_b64_tr_b16 a[74:75], v15 offset:18592
  v_mfma_f32_16x16x32_bf16 v[168:171], a[32:35], a[4:7], v[168:171]
  ds_read_b64_tr_b16 a[76:77], v14 offset:18624
  v_mfma_f32_16x16x32_bf16 v[136:139], a[36:39], a[0:3], v[136:139]
  ds_read_b64_tr_b16 a[78:79], v15 offset:18624
  ds_read_b64_tr_b16 a[80:81], v14 offset:18656
  v_mfma_f32_16x16x32_bf16 v[172:175], a[36:39], a[4:7], v[172:175]
  ds_read_b64_tr_b16 a[82:83], v15 offset:18656
  buffer_load_dwordx4 v210, s[12:15], s55 offen offset:2048 lds
  v_mfma_f32_16x16x32_bf16 v[140:143], a[40:43], a[0:3], v[140:143]
  ds_read_b64_tr_b16 a[84:85], v14 offset:18688
  ds_read_b64_tr_b16 a[86:87], v15 offset:18688
  v_mfma_f32_16x16x32_bf16 v[176:179], a[40:43], a[4:7], v[176:179]
  v_mfma_f32_16x16x32_bf16 v[144:147], a[44:47], a[0:3], v[144:147]
  v_mfma_f32_16x16x32_bf16 v[180:183], a[44:47], a[4:7], v[180:183]
  buffer_load_dwordx4 v211, s[12:15], s55 offen offset:3072 lds
  v_mfma_f32_16x16x32_bf16 v[148:151], a[48:51], a[0:3], v[148:151]
  v_mfma_f32_16x16x32_bf16 v[184:187], a[48:51], a[4:7], v[184:187]
  s_waitcnt lgkmcnt(0)
  v_mfma_f32_16x16x32_bf16 v[116:119], a[52:55], a[8:11], v[116:119]
  s_add_u32 m0, s35, 81920
  s_nop 0
  buffer_load_dwordx4 v212, s[12:15], s55 offen lds
  s_waitcnt vmcnt(9)
  s_barrier
  ds_read_b128 a[0:3], v12 offset:36864
  ds_read_b128 a[4:7], v12 offset:38912
  v_mfma_f32_16x16x32_bf16 v[152:155], a[52:55], a[12:15], v[152:155]
  ds_read_b64_tr_b16 a[16:17], v14 offset:36864
  v_mfma_f32_16x16x32_bf16 v[120:123], a[56:59], a[8:11], v[120:123]
  ds_read_b64_tr_b16 a[18:19], v15 offset:36864
  ds_read_b64_tr_b16 a[20:21], v14 offset:36896
  v_mfma_f32_16x16x32_bf16 v[156:159], a[56:59], a[12:15], v[156:159]
  ds_read_b64_tr_b16 a[22:23], v15 offset:36896
  s_add_u32 m0, s35, 110592
  s_add_u32 s54, s31, 896
  buffer_load_dwordx4 v204, s[20:23], s54 offen lds
  v_mfma_f32_16x16x32_bf16 v[124:127], a[60:63], a[8:11], v[124:127]
  ds_read_b64_tr_b16 a[24:25], v14 offset:36928
  ds_read_b64_tr_b16 a[26:27], v15 offset:36928
  v_mfma_f32_16x16x32_bf16 v[160:163], a[60:63], a[12:15], v[160:163]
  ds_read_b64_tr_b16 a[28:29], v14 offset:36960
  v_mfma_f32_16x16x32_bf16 v[128:131], a[64:67], a[8:11], v[128:131]
  ds_read_b64_tr_b16 a[30:31], v15 offset:36960
  ds_read_b64_tr_b16 a[32:33], v14 offset:36992
  v_mfma_f32_16x16x32_bf16 v[164:167], a[64:67], a[12:15], v[164:167]
  ds_read_b64_tr_b16 a[34:35], v15 offset:36992
  buffer_load_dwordx4 v205, s[20:23], s54 offen offset:1024 lds
  v_mfma_f32_16x16x32_bf16 v[132:135], a[68:71], a[8:11], v[132:135]
  ds_read_b64_tr_b16 a[36:37], v14 offset:37024
  ds_read_b64_tr_b16 a[38:39], v15 offset:37024
  v_mfma_f32_16x16x32_bf16 v[168:171], a[68:71], a[12:15], v[168:171]
  ds_read_b64_tr_b16 a[40:41], v14 offset:37056
  v_mfma_f32_16x16x32_bf16 v[136:139], a[72:75], a[8:11], v[136:139]
  ds_read_b64_tr_b16 a[42:43], v15 offset:37056
  ds_read_b64_tr_b16 a[44:45], v14 offset:37088
  v_mfma_f32_16x16x32_bf16 v[172:175], a[72:75], a[12:15], v[172:175]
  ds_read_b64_tr_b16 a[46:47], v15 offset:37088
  buffer_load_dwordx4 v206, s[20:23], s54 offen offset:2048 lds
  v_mfma_f32_16x16x32_bf16 v[140:143], a[76:79], a[8:11], v[140:143]
  ds_read_b64_tr_b16 a[48:49], v14 offset:37120
  ds_read_b64_tr_b16 a[50:51], v15 offset:37120
  v_mfma_f32_16x16x32_bf16 v[176:179], a[76:79], a[12:15], v[176:179]
  v_mfma_f32_16x16x32_bf16 v[144:147], a[80:83], a[8:11], v[144:147]
  v_mfma_f32_16x16x32_bf16 v[180:183], a[80:83], a[12:15], v[180:183]
  buffer_load_dwordx4 v207, s[20:23], s54 offen offset:3072 lds
  v_mfma_f32_16x16x32_bf16 v[148:151], a[84:87], a[8:11], v[148:151]
  v_mfma_f32_16x16x32_bf16 v[184:187], a[84:87], a[12:15], v[184:187]
  s_waitcnt lgkmcnt(6)
  v_mfma_f32_16x16x32_bf16 v[116:119], a[16:19], a[0:3], v[116:119]
  ds_read_b128 a[8:11], v13 offset:36864
  ds_read_b128 a[12:15], v13 offset:38912
  v_mfma_f32_16x16x32_bf16 v[152:155], a[16:19], a[4:7], v[152:155]
  ds_read_b64_tr_b16 a[52:53], v14 offset:55296
  v_mfma_f32_16x16x32_bf16 v[120:123], a[20:23], a[0:3], v[120:123]
  ds_read_b64_tr_b16 a[54:55], v15 offset:55296
  ds_read_b64_tr_b16 a[56:57], v14 offset:55328
  v_mfma_f32_16x16x32_bf16 v[156:159], a[20:23], a[4:7], v[156:159]
  ds_read_b64_tr_b16 a[58:59], v15 offset:55328
  s_add_u32 m0, s35, 114688
  s_add_u32 s55, s36, 1548288
  buffer_load_dwordx4 v208, s[12:15], s55 offen lds
  v_mfma_f32_16x16x32_bf16 v[124:127], a[24:27], a[0:3], v[124:127]
  ds_read_b64_tr_b16 a[60:61], v14 offset:55360
  ds_read_b64_tr_b16 a[62:63], v15 offset:55360
  v_mfma_f32_16x16x32_bf16 v[160:163], a[24:27], a[4:7], v[160:163]
  ds_read_b64_tr_b16 a[64:65], v14 offset:55392
  v_mfma_f32_16x16x32_bf16 v[128:131], a[28:31], a[0:3], v[128:131]
  ds_read_b64_tr_b16 a[66:67], v15 offset:55392
  ds_read_b64_tr_b16 a[68:69], v14 offset:55424
  v_mfma_f32_16x16x32_bf16 v[164:167], a[28:31], a[4:7], v[164:167]
  ds_read_b64_tr_b16 a[70:71], v15 offset:55424
  buffer_load_dwordx4 v209, s[12:15], s55 offen offset:1024 lds
  s_waitcnt lgkmcnt(12)
  v_mfma_f32_16x16x32_bf16 v[132:135], a[32:35], a[0:3], v[132:135]
  ds_read_b64_tr_b16 a[72:73], v14 offset:55456
  ds_read_b64_tr_b16 a[74:75], v15 offset:55456
  v_mfma_f32_16x16x32_bf16 v[168:171], a[32:35], a[4:7], v[168:171]
  ds_read_b64_tr_b16 a[76:77], v14 offset:55488
  v_mfma_f32_16x16x32_bf16 v[136:139], a[36:39], a[0:3], v[136:139]
  ds_read_b64_tr_b16 a[78:79], v15 offset:55488
  ds_read_b64_tr_b16 a[80:81], v14 offset:55520
  v_mfma_f32_16x16x32_bf16 v[172:175], a[36:39], a[4:7], v[172:175]
  ds_read_b64_tr_b16 a[82:83], v15 offset:55520
  buffer_load_dwordx4 v210, s[12:15], s55 offen offset:2048 lds
  v_mfma_f32_16x16x32_bf16 v[140:143], a[40:43], a[0:3], v[140:143]
  ds_read_b64_tr_b16 a[84:85], v14 offset:55552
  ds_read_b64_tr_b16 a[86:87], v15 offset:55552
  v_mfma_f32_16x16x32_bf16 v[176:179], a[40:43], a[4:7], v[176:179]
  v_mfma_f32_16x16x32_bf16 v[144:147], a[44:47], a[0:3], v[144:147]
  v_mfma_f32_16x16x32_bf16 v[180:183], a[44:47], a[4:7], v[180:183]
  buffer_load_dwordx4 v211, s[12:15], s55 offen offset:3072 lds
  v_mfma_f32_16x16x32_bf16 v[148:151], a[48:51], a[0:3], v[148:151]
  v_mfma_f32_16x16x32_bf16 v[184:187], a[48:51], a[4:7], v[184:187]
  s_waitcnt lgkmcnt(0)
  v_mfma_f32_16x16x32_bf16 v[116:119], a[52:55], a[8:11], v[116:119]
  s_add_u32 m0, s35, 118784
  s_nop 0
  buffer_load_dwordx4 v212, s[12:15], s55 offen lds
  s_waitcnt vmcnt(9)
  s_barrier
  buffer_load_dword v10, v11, s[24:27], 0 offen sc0 sc1
  ds_read_b128 a[0:3], v16 offset:0
  ds_read_b128 a[4:7], v16 offset:2048
  v_mfma_f32_16x16x32_bf16 v[152:155], a[52:55], a[12:15], v[152:155]
  ds_read_b64_tr_b16 a[16:17], v18 offset:0
  v_mfma_f32_16x16x32_bf16 v[120:123], a[56:59], a[8:11], v[120:123]
  ds_read_b64_tr_b16 a[18:19], v19 offset:0
  ds_read_b64_tr_b16 a[20:21], v18 offset:32
  v_mfma_f32_16x16x32_bf16 v[156:159], a[56:59], a[12:15], v[156:159]
  ds_read_b64_tr_b16 a[22:23], v19 offset:32
  s_add_u32 m0, s35, 0
  s_add_u32 s54, s31, 1024
  buffer_load_dwordx4 v204, s[20:23], s54 offen lds
  v_mfma_f32_16x16x32_bf16 v[124:127], a[60:63], a[8:11], v[124:127]
  ds_read_b64_tr_b16 a[24:25], v18 offset:64
  ds_read_b64_tr_b16 a[26:27], v19 offset:64
  v_mfma_f32_16x16x32_bf16 v[160:163], a[60:63], a[12:15], v[160:163]
  ds_read_b64_tr_b16 a[28:29], v18 offset:96
  v_mfma_f32_16x16x32_bf16 v[128:131], a[64:67], a[8:11], v[128:131]
  ds_read_b64_tr_b16 a[30:31], v19 offset:96
  ds_read_b64_tr_b16 a[32:33], v18 offset:128
  v_mfma_f32_16x16x32_bf16 v[164:167], a[64:67], a[12:15], v[164:167]
  ds_read_b64_tr_b16 a[34:35], v19 offset:128
  buffer_load_dwordx4 v205, s[20:23], s54 offen offset:1024 lds
  v_mfma_f32_16x16x32_bf16 v[132:135], a[68:71], a[8:11], v[132:135]
  ds_read_b64_tr_b16 a[36:37], v18 offset:160
  ds_read_b64_tr_b16 a[38:39], v19 offset:160
  v_mfma_f32_16x16x32_bf16 v[168:171], a[68:71], a[12:15], v[168:171]
  ds_read_b64_tr_b16 a[40:41], v18 offset:192
  v_mfma_f32_16x16x32_bf16 v[136:139], a[72:75], a[8:11], v[136:139]
  ds_read_b64_tr_b16 a[42:43], v19 offset:192
  ds_read_b64_tr_b16 a[44:45], v18 offset:224
  v_mfma_f32_16x16x32_bf16 v[172:175], a[72:75], a[12:15], v[172:175]
  ds_read_b64_tr_b16 a[46:47], v19 offset:224
  buffer_load_dwordx4 v206, s[20:23], s54 offen offset:2048 lds
  v_mfma_f32_16x16x32_bf16 v[140:143], a[76:79], a[8:11], v[140:143]
  ds_read_b64_tr_b16 a[48:49], v18 offset:256
  ds_read_b64_tr_b16 a[50:51], v19 offset:256
  v_mfma_f32_16x16x32_bf16 v[176:179], a[76:79], a[12:15], v[176:179]
  v_mfma_f32_16x16x32_bf16 v[144:147], a[80:83], a[8:11], v[144:147]
  v_mfma_f32_16x16x32_bf16 v[180:183], a[80:83], a[12:15], v[180:183]
  buffer_load_dwordx4 v207, s[20:23], s54 offen offset:3072 lds
  v_mfma_f32_16x16x32_bf16 v[148:151], a[84:87], a[8:11], v[148:151]
  v_mfma_f32_16x16x32_bf16 v[184:187], a[84:87], a[12:15], v[184:187]
  s_waitcnt lgkmcnt(6)
  v_mfma_f32_16x16x32_bf16 v[116:119], a[16:19], a[0:3], v[116:119]
  ds_read_b128 a[8:11], v17 offset:0
  ds_read_b128 a[12:15], v17 offset:2048
  v_mfma_f32_16x16x32_bf16 v[152:155], a[16:19], a[4:7], v[152:155]
  ds_read_b64_tr_b16 a[52:53], v18 offset:18432
  v_mfma_f32_16x16x32_bf16 v[120:123], a[20:23], a[0:3], v[120:123]
  ds_read_b64_tr_b16 a[54:55], v19 offset:18432
  ds_read_b64_tr_b16 a[56:57], v18 offset:18464
  v_mfma_f32_16x16x32_bf16 v[156:159], a[20:23], a[4:7], v[156:159]
  ds_read_b64_tr_b16 a[58:59], v19 offset:18464
  s_add_u32 m0, s35, 4096
  s_add_u32 s55, s36, 1769472
  buffer_load_dwordx4 v208, s[12:15], s55 offen lds
  v_mfma_f32_16x16x32_bf16 v[124:127], a[24:27], a[0:3], v[124:127]
  ds_read_b64_tr_b16 a[60:61], v18 offset:18496
  ds_read_b64_tr_b16 a[62:63], v19 offset:18496
  v_mfma_f32_16x16x32_bf16 v[160:163], a[24:27], a[4:7], v[160:163]
  ds_read_b64_tr_b16 a[64:65], v18 offset:18528
  v_mfma_f32_16x16x32_bf16 v[128:131], a[28:31], a[0:3], v[128:131]
  ds_read_b64_tr_b16 a[66:67], v19 offset:18528
  ds_read_b64_tr_b16 a[68:69], v18 offset:18560
  v_mfma_f32_16x16x32_bf16 v[164:167], a[28:31], a[4:7], v[164:167]
  ds_read_b64_tr_b16 a[70:71], v19 offset:18560
  buffer_load_dwordx4 v209, s[12:15], s55 offen offset:1024 lds
  s_waitcnt lgkmcnt(12)
  v_mfma_f32_16x16x32_bf16 v[132:135], a[32:35], a[0:3], v[132:135]
  ds_read_b64_tr_b16 a[72:73], v18 offset:18592
  ds_read_b64_tr_b16 a[74:75], v19 offset:18592
  v_mfma_f32_16x16x32_bf16 v[168:171], a[32:35], a[4:7], v[168:171]
  ds_read_b64_tr_b16 a[76:77], v18 offset:18624
  v_mfma_f32_16x16x32_bf16 v[136:139], a[36:39], a[0:3], v[136:139]
  ds_read_b64_tr_b16 a[78:79], v19 offset:18624
  ds_read_b64_tr_b16 a[80:81], v18 offset:18656
  v_mfma_f32_16x16x32_bf16 v[172:175], a[36:39], a[4:7], v[172:175]
  ds_read_b64_tr_b16 a[82:83], v19 offset:18656
  buffer_load_dwordx4 v210, s[12:15], s55 offen offset:2048 lds
  v_mfma_f32_16x16x32_bf16 v[140:143], a[40:43], a[0:3], v[140:143]
  ds_read_b64_tr_b16 a[84:85], v18 offset:18688
  ds_read_b64_tr_b16 a[86:87], v19 offset:18688
  v_mfma_f32_16x16x32_bf16 v[176:179], a[40:43], a[4:7], v[176:179]
  v_mfma_f32_16x16x32_bf16 v[144:147], a[44:47], a[0:3], v[144:147]
  v_mfma_f32_16x16x32_bf16 v[180:183], a[44:47], a[4:7], v[180:183]
  buffer_load_dwordx4 v211, s[12:15], s55 offen offset:3072 lds
  v_mfma_f32_16x16x32_bf16 v[148:151], a[48:51], a[0:3], v[148:151]
  v_mfma_f32_16x16x32_bf16 v[184:187], a[48:51], a[4:7], v[184:187]
  s_waitcnt lgkmcnt(0)
  v_mfma_f32_16x16x32_bf16 v[116:119], a[52:55], a[8:11], v[116:119]
  s_add_u32 m0, s35, 8192
  s_nop 0
  buffer_load_dwordx4 v212, s[12:15], s55 offen lds
  s_waitcnt vmcnt(10)
  s_barrier
  s_waitcnt vmcnt(9)
  v_readfirstlane_b32 s5, v10
  s_nop 1
  s_cmp_eq_u32 s5, 64
  s_cbranch_scc0 F_spq
F_rtq:
  ds_read_b128 a[0:3], v16 offset:36864
  ds_read_b128 a[4:7], v16 offset:38912
  s_mov_b32 m0, s7
  s_nop 0
  buffer_load_dwordx4 v4, s[8:11], 0 offen sc0 sc1 lds
  v_mfma_f32_16x16x32_bf16 v[152:155], a[52:55], a[12:15], v[152:155]
  ds_read_b64_tr_b16 a[16:17], v18 offset:36864
  v_mfma_f32_16x16x32_bf16 v[120:123], a[56:59], a[8:11], v[120:123]
  ds_read_b64_tr_b16 a[18:19], v19 offset:36864
  ds_read_b64_tr_b16 a[20:21], v18 offset:36896
  v_mfma_f32_16x16x32_bf16 v[156:159], a[56:59], a[12:15], v[156:159]
  ds_read_b64_tr_b16 a[22:23], v19 offset:36896
  s_add_u32 m0, s38, 36864
  s_add_u32 s54, s37, 0
  buffer_load_dwordx4 v5, s[16:19], s54 offen lds
  v_mfma_f32_16x16x32_bf16 v[124:127], a[60:63], a[8:11], v[124:127]
  ds_read_b64_tr_b16 a[24:25], v18 offset:36928
  ds_read_b64_tr_b16 a[26:27], v19 offset:36928
  v_mfma_f32_16x16x32_bf16 v[160:163], a[60:63], a[12:15], v[160:163]
  ds_read_b64_tr_b16 a[28:29], v18 offset:36960
  v_mfma_f32_16x16x32_bf16 v[128:131], a[64:67], a[8:11], v[128:131]
  ds_read_b64_tr_b16 a[30:31], v19 offset:36960
  ds_read_b64_tr_b16 a[32:33], v18 offset:36992
  v_mfma_f32_16x16x32_bf16 v[164:167], a[64:67], a[12:15], v[164:167]
  ds_read_b64_tr_b16 a[34:35], v19 offset:36992
  buffer_load_dwordx4 v6, s[16:19], s54 offen offset:1024 lds
  v_mfma_f32_16x16x32_bf16 v[132:135], a[68:71], a[8:11], v[132:135]
  ds_read_b64_tr_b16 a[36:37], v18 offset:37024
  ds_read_b64_tr_b16 a[38:39], v19 offset:37024
  v_mfma_f32_16x16x32_bf16 v[168:171], a[68:71], a[12:15], v[168:171]
  ds_read_b64_tr_b16 a[40:41], v18 offset:37056
  v_mfma_f32_16x16x32_bf16 v[136:139], a[72:75], a[8:11], v[136:139]
  ds_read_b64_tr_b16 a[42:43], v19 offset:37056
  ds_read_b64_tr_b16 a[44:45], v18 offset:37088
  v_mfma_f32_16x16x32_bf16 v[172:175], a[72:75], a[12:15], v[172:175]
  ds_read_b64_tr_b16 a[46:47], v19 offset:37088
  buffer_load_dwordx4 v7, s[16:19], s54 offen offset:2048 lds
  v_mfma_f32_16x16x32_bf16 v[140:143], a[76:79], a[8:11], v[140:143]
  ds_read_b64_tr_b16 a[48:49], v18 offset:37120
  ds_read_b64_tr_b16 a[50:51], v19 offset:37120
  v_mfma_f32_16x16x32_bf16 v[176:179], a[76:79], a[12:15], v[176:179]
  v_mfma_f32_16x16x32_bf16 v[144:147], a[80:83], a[8:11], v[144:147]
  v_mfma_f32_16x16x32_bf16 v[180:183], a[80:83], a[12:15], v[180:183]
  s_add_u32 m0, s38, 39936
  s_add_u32 s54, s37, 18432
  buffer_load_dwordx4 v5, s[16:19], s54 offen lds
  v_mfma_f32_16x16x32_bf16 v[148:151], a[84:87], a[8:11], v[148:151]
  v_mfma_f32_16x16x32_bf16 v[184:187], a[84:87], a[12:15], v[184:187]
  s_waitcnt lgkmcnt(6)
  v_mfma_f32_16x16x32_bf16 v[116:119], a[16:19], a[0:3], v[116:119]
  ds_read_b128 a[8:11], v17 offset:36864
  ds_read_b128 a[12:15], v17 offset:38912
  v_mfma_f32_16x16x32_bf16 v[152:155], a[16:19], a[4:7], v[152:155]
  ds_read_b64_tr_b16 a[52:53], v18 offset:55296
  v_mfma_f32_16x16x32_bf16 v[120:123], a[20:23], a[0:3], v[120:123]
  ds_read_b64_tr_b16 a[54:55], v19 offset:55296
HP_q_p1:
  s_cbranch_execz HP_q_ret
  ds_read_b64_tr_b16 a[56:57], v18 offset:55328
  v_mfma_f32_16x16x32_bf16 v[156:159], a[20:23], a[4:7], v[156:159]
  ds_read_b64_tr_b16 a[58:59], v19 offset:55328
  buffer_load_dwordx4 v6, s[16:19], s54 offen offset:1024 lds
  v_mfma_f32_16x16x32_bf16 v[124:127], a[24:27], a[0:3], v[124:127]
  ds_read_b64_tr_b16 a[60:61], v18 offset:55360
  ds_read_b64_tr_b16 a[62:63], v19 offset:55360
  v_mfma_f32_16x16x32_bf16 v[160:163], a[24:27], a[4:7], v[160:163]
  ds_read_b64_tr_b16 a[64:65], v18 offset:55392
  v_mfma_f32_16x16x32_bf16 v[128:131], a[28:31], a[0:3], v[128:131]
  ds_read_b64_tr_b16 a[66:67], v19 offset:55392
  ds_read_b64_tr_b16 a[68:69], v18 offset:55424
  v_mfma_f32_16x16x32_bf16 v[164:167], a[28:31], a[4:7], v[164:167]
  ds_read_b64_tr_b16 a[70:71], v19 offset:55424
  buffer_load_dwordx4 v7, s[16:19], s54 offen offset:2048 lds
  s_waitcnt lgkmcnt(12)
  v_mfma_f32_16x16x32_bf16 v[132:135], a[32:35], a[0:3], v[132:135]
  ds_read_b64_tr_b16 a[72:73], v18 offset:55456
  ds_read_b64_tr_b16 a[74:75], v19 offset:55456
  v_mfma_f32_16x16x32_bf16 v[168:171], a[32:35], a[4:7], v[168:171]
  ds_read_b64_tr_b16 a[76:77], v18 offset:55488
  v_mfma_f32_16x16x32_bf16 v[136:139], a[36:39], a[0:3], v[136:139]
  ds_read_b64_tr_b16 a[78:79], v19 offset:55488
  ds_read_b64_tr_b16 a[80:81], v18 offset:55520
  v_mfma_f32_16x16x32_bf16 v[172:175], a[36:39], a[4:7], v[172:175]
  ds_read_b64_tr_b16 a[82:83], v19 offset:55520
  v_mfma_f32_16x16x32_bf16 v[140:143], a[40:43], a[0:3], v[140:143]
  ds_read_b64_tr_b16 a[84:85], v18 offset:55552
  ds_read_b64_tr_b16 a[86:87], v19 offset:55552
  v_mfma_f32_16x16x32_bf16 v[176:179], a[40:43], a[4:7], v[176:179]
  v_mfma_f32_16x16x32_bf16 v[144:147], a[44:47], a[0:3], v[144:147]
  v_mfma_f32_16x16x32_bf16 v[180:183], a[44:47], a[4:7], v[180:183]
  v_mfma_f32_16x16x32_bf16 v[148:151], a[48:51], a[0:3], v[148:151]
  v_mfma_f32_16x16x32_bf16 v[184:187], a[48:51], a[4:7], v[184:187]
  s_waitcnt lgkmcnt(0)
  v_mfma_f32_16x16x32_bf16 v[116:119], a[52:55], a[8:11], v[116:119]
  s_waitcnt vmcnt(7)
  s_barrier
  ds_read_b128 a[0:3], v12 offset:0
  ds_read_b128 a[4:7], v12 offset:2048
  v_mfma_f32_16x16x32_bf16 v[152:155], a[52:55], a[12:15], v[152:155]
  ds_read_b64_tr_b16 a[16:17], v14 offset:0
  v_mfma_f32_16x16x32_bf16 v[120:123], a[56:59], a[8:11], v[120:123]
  ds_read_b64_tr_b16 a[18:19], v15 offset:0
  ds_read_b64_tr_b16 a[20:21], v14 offset:32
  v_mfma_f32_16x16x32_bf16 v[156:159], a[56:59], a[12:15], v[156:159]
  ds_read_b64_tr_b16 a[22:23], v15 offset:32
  s_add_u32 m0, s38, 43008
  s_add_u32 s54, s37, 36864
  buffer_load_dwordx4 v5, s[16:19], s54 offen lds
  v_mfma_f32_16x16x32_bf16 v[124:127], a[60:63], a[8:11], v[124:127]
  ds_read_b64_tr_b16 a[24:25], v14 offset:64
  ds_read_b64_tr_b16 a[26:27], v15 offset:64
  v_mfma_f32_16x16x32_bf16 v[160:163], a[60:63], a[12:15], v[160:163]
  ds_read_b64_tr_b16 a[28:29], v14 offset:96
  v_mfma_f32_16x16x32_bf16 v[128:131], a[64:67], a[8:11], v[128:131]
  ds_read_b64_tr_b16 a[30:31], v15 offset:96
  ds_read_b64_tr_b16 a[32:33], v14 offset:128
  v_mfma_f32_16x16x32_bf16 v[164:167], a[64:67], a[12:15], v[164:167]
  ds_read_b64_tr_b16 a[34:35], v15 offset:128
  buffer_load_dwordx4 v6, s[16:19], s54 offen offset:1024 lds
  v_mfma_f32_16x16x32_bf16 v[132:135], a[68:71], a[8:11], v[132:135]
  ds_read_b64_tr_b16 a[36:37], v14 offset:160
  ds_read_b64_tr_b16 a[38:39], v15 offset:160
  v_mfma_f32_16x16x32_bf16 v[168:171], a[68:71], a[12:15], v[168:171]
  ds_read_b64_tr_b16 a[40:41], v14 offset:192
  v_mfma_f32_16x16x32_bf16 v[136:139], a[72:75], a[8:11], v[136:139]
  ds_read_b64_tr_b16 a[42:43], v15 offset:192
  ds_read_b64_tr_b16 a[44:45], v14 offset:224
  v_mfma_f32_16x16x32_bf16 v[172:175], a[72:75], a[12:15], v[172:175]
  ds_read_b64_tr_b16 a[46:47], v15 offset:224
  buffer_load_dwordx4 v7, s[16:19], s54 offen offset:2048 lds
  v_mfma_f32_16x16x32_bf16 v[140:143], a[76:79], a[8:11], v[140:143]
  ds_read_b64_tr_b16 a[48:49], v14 offset:256
  ds_read_b64_tr_b16 a[50:51], v15 offset:256
  v_mfma_f32_16x16x32_bf16 v[176:179], a[76:79], a[12:15], v[176:179]
  v_mfma_f32_16x16x32_bf16 v[144:147], a[80:83], a[8:11], v[144:147]
  v_mfma_f32_16x16x32_bf16 v[180:183], a[80:83], a[12:15], v[180:183]
  s_add_u32 m0, s38, 73728
  s_add_u32 s54, s37, 55296
  buffer_load_dwordx4 v5, s[16:19], s54 offen lds
  v_mfma_f32_16x16x32_bf16 v[148:151], a[84:87], a[8:11], v[148:151]
  v_mfma_f32_16x16x32_bf16 v[184:187], a[84:87], a[12:15], v[184:187]
  s_waitcnt lgkmcnt(6)
  v_mfma_f32_16x16x32_bf16 v[116:119], a[16:19], a[0:3], v[116:119]
  ds_read_b128 a[8:11], v13 offset:0
  ds_read_b128 a[12:15], v13 offset:2048
  v_mfma_f32_16x16x32_bf16 v[152:155], a[16:19], a[4:7], v[152:155]
  ds_read_b64_tr_b16 a[52:53], v14 offset:18432
  v_mfma_f32_16x16x32_bf16 v[120:123], a[20:23], a[0:3], v[120:123]
  ds_read_b64_tr_b16 a[54:55], v15 offset:18432
  ds_read_b64_tr_b16 a[56:57], v14 offset:18464
  v_mfma_f32_16x16x32_bf16 v[156:159], a[20:23], a[4:7], v[156:159]
  ds_read_b64_tr_b16 a[58:59], v15 offset:18464
  buffer_load_dwordx4 v6, s[16:19], s54 offen offset:1024 lds
  v_mfma_f32_16x16x32_bf16 v[124:127], a[24:27], a[0:3], v[124:127]
  ds_read_b64_tr_b16 a[60:61], v14 offset:18496
  ds_read_b64_tr_b16 a[62:63], v15 offset:18496
  v_mfma_f32_16x16x32_bf16 v[160:163], a[24:27], a[4:7], v[160:163]
  ds_read_b64_tr_b16 a[64:65], v14 offset:18528
  v_mfma_f32_16x16x32_bf16 v[128:131], a[28:31], a[0:3], v[128:131]
  ds_read_b64_tr_b16 a[66:67], v15 offset:18528
  ds_read_b64_tr_b16 a[68:69], v14 offset:18560
  v_mfma_f32_16x16x32_bf16 v[164:167], a[28:31], a[4:7], v[164:167]
  ds_read_b64_tr_b16 a[70:71], v15 offset:18560
  buffer_load_dwordx4 v7, s[16:19], s54 offen offset:2048 lds
  s_waitcnt lgkmcnt(12)
  v_mfma_f32_16x16x32_bf16 v[132:135], a[32:35], a[0:3], v[132:135]
  ds_read_b64_tr_b16 a[72:73], v14 offset:18592
  ds_read_b64_tr_b16 a[74:75], v15 offset:18592
  v_mfma_f32_16x16x32_bf16 v[168:171], a[32:35], a[4:7], v[168:171]
  ds_read_b64_tr_b16 a[76:77], v14 offset:18624
  v_mfma_f32_16x16x32_bf16 v[136:139], a[36:39], a[0:3], v[136:139]
  ds_read_b64_tr_b16 a[78:79], v15 offset:18624
  ds_read_b64_tr_b16 a[80:81], v14 offset:18656
  v_mfma_f32_16x16x32_bf16 v[172:175], a[36:39], a[4:7], v[172:175]
  ds_read_b64_tr_b16 a[82:83], v15 offset:18656
  s_add_u32 m0, s38, 76800
  s_add_u32 s54, s37, 73728
  buffer_load_dwordx4 v5, s[16:19], s54 offen lds
  v_mfma_f32_16x16x32_bf16 v[140:143], a[40:43], a[0:3], v[140:143]
  ds_read_b64_tr_b16 a[84:85], v14 offset:18688
  ds_read_b64_tr_b16 a[86:87], v15 offset:18688
  v_mfma_f32_16x16x32_bf16 v[176:179], a[40:43], a[4:7], v[176:179]
  v_mfma_f32_16x16x32_bf16 v[144:147], a[44:47], a[0:3], v[144:147]
  v_mfma_f32_16x16x32_bf16 v[180:183], a[44:47], a[4:7], v[180:183]
  buffer_load_dwordx4 v6, s[16:19], s54 offen offset:1024 lds
  v_mfma_f32_16x16x32_bf16 v[148:151], a[48:51], a[0:3], v[148:151]
  v_mfma_f32_16x16x32_bf16 v[184:187], a[48:51], a[4:7], v[184:187]
  s_waitcnt lgkmcnt(0)
  v_mfma_f32_16x16x32_bf16 v[116:119], a[52:55], a[8:11], v[116:119]
  buffer_load_dwordx4 v7, s[16:19], s54 offen offset:2048 lds
  s_waitcnt vmcnt(15)
  s_barrier
  ds_read_b32 v80, v8 offset:0
  ds_read_b32 v82, v8 offset:64
  v_mfma_f32_16x16x32_bf16 v[152:155], a[52:55], a[12:15], v[152:155]
  ds_read_b32 v81, v8 offset:128
  v_mfma_f32_16x16x32_bf16 v[120:123], a[56:59], a[8:11], v[120:123]
  ds_read_b32 v83, v8 offset:192
  ds_read_b128 v[44:47], v9 offset:256
  v_mfma_f32_16x16x32_bf16 v[156:159], a[56:59], a[12:15], v[156:159]
  ds_read_b128 v[48:51], v9 offset:320
  v_mfma_f32_16x16x32_bf16 v[124:127], a[60:63], a[8:11], v[124:127]
  ds_read_b128 v[52:55], v9 offset:384
  ds_read_b128 v[56:59], v9 offset:448
  v_mfma_f32_16x16x32_bf16 v[160:163], a[60:63], a[12:15], v[160:163]
  ds_read_b128 v[60:63], v9 offset:512
  s_add_u32 m0, s38, 79872
  s_add_u32 s54, s37, 92160
  buffer_load_dwordx4 v5, s[16:19], s54 offen lds
  v_mfma_f32_16x16x32_bf16 v[128:131], a[64:67], a[8:11], v[128:131]
  ds_read_b128 v[64:67], v9 offset:576
  ds_read_b128 v[68:71], v9 offset:640
  v_mfma_f32_16x16x32_bf16 v[164:167], a[64:67], a[12:15], v[164:167]
  ds_read_b128 v[72:75], v9 offset:704
  v_mfma_f32_16x16x32_bf16 v[132:135], a[68:71], a[8:11], v[132:135]
  ds_read_b128 v[76:79], v9 offset:768
  v_mfma_f32_16x16x32_bf16 v[168:171], a[68:71], a[12:15], v[168:171]
  v_mfma_f32_16x16x32_bf16 v[136:139], a[72:75], a[8:11], v[136:139]
  v_mfma_f32_16x16x32_bf16 v[172:175], a[72:75], a[12:15], v[172:175]
  buffer_load_dwordx4 v6, s[16:19], s54 offen offset:1024 lds
  v_mfma_f32_16x16x32_bf16 v[140:143], a[76:79], a[8:11], v[140:143]
  v_mfma_f32_16x16x32_bf16 v[176:179], a[76:79], a[12:15], v[176:179]
  v_mfma_f32_16x16x32_bf16 v[144:147], a[80:83], a[8:11], v[144:147]
  v_mfma_f32_16x16x32_bf16 v[180:183], a[80:83], a[12:15], v[180:183]
  v_mfma_f32_16x16x32_bf16 v[148:151], a[84:87], a[8:11], v[148:151]
  v_mfma_f32_16x16x32_bf16 v[184:187], a[84:87], a[12:15], v[184:187]
  buffer_load_dwordx4 v7, s[16:19], s54 offen offset:2048 lds
  v_lshlrev_b32 v4, 4, v2
  s_waitcnt lgkmcnt(0)
  v_pk_fma_f32 v[188:189], v[80:81], v[44:45], s[58:59] op_sel:[1,0,0] op_sel_hi:[1,1,1]
  v_pk_fma_f32 v[192:193], v[80:81], v[48:49], s[58:59] op_sel:[1,0,0] op_sel_hi:[1,1,1]
  v_pk_fma_f32 v[190:191], v[80:81], v[46:47], s[58:59] op_sel:[1,0,0] op_sel_hi:[1,1,1]
  v_pk_fma_f32 v[194:195], v[80:81], v[50:51], s[58:59] op_sel:[1,0,0] op_sel_hi:[1,1,1]
  v_pk_fma_f32 v[116:117], v[116:117], v[80:81], v[188:189] op_sel:[0,0,0] op_sel_hi:[1,0,1]
  v_pk_fma_f32 v[120:121], v[120:121], v[80:81], v[192:193] op_sel:[0,0,0] op_sel_hi:[1,0,1]
  v_pk_fma_f32 v[118:119], v[118:119], v[80:81], v[190:191] op_sel:[0,0,0] op_sel_hi:[1,0,1]
  v_pk_fma_f32 v[122:123], v[122:123], v[80:81], v[194:195] op_sel:[0,0,0] op_sel_hi:[1,0,1]
  v_exp_f32_e64 v188, v116 clamp
  v_exp_f32_e64 v192, v120 clamp
  v_exp_f32_e64 v189, v117 clamp
  v_exp_f32_e64 v193, v121 clamp
  v_exp_f32_e64 v190, v118 clamp
  v_exp_f32_e64 v194, v122 clamp
  v_exp_f32_e64 v191, v119 clamp
  v_exp_f32_e64 v195, v123 clamp
  v_max_f32 v116, s58, v116
  v_max_f32 v120, s58, v120
  v_max_f32 v117, s58, v117
  v_max_f32 v121, s58, v121
  v_max_f32 v118, s58, v118
  v_max_f32 v122, s58, v122
  v_max_f32 v119, s58, v119
  v_max_f32 v123, s58, v123
  v_pk_fma_f32 v[116:117], v[116:117], s[56:57], v[188:189]
  v_pk_fma_f32 v[120:121], v[120:121], s[56:57], v[192:193]
  v_pk_fma_f32 v[118:119], v[118:119], s[56:57], v[190:191]
  v_pk_fma_f32 v[122:123], v[122:123], s[56:57], v[194:195]
  s_add_u32 m0, s38, 0
  s_add_u32 s54, s37, 110592
  buffer_load_dwordx4 v5, s[16:19], s54 offen lds
  v_cvt_pk_bf16_f32 v216, v116, v117
  v_cvt_pk_bf16_f32 v218, v120, v121
  v_cvt_pk_bf16_f32 v217, v118, v119
  v_cvt_pk_bf16_f32 v219, v122, v123
  buffer_store_dwordx4 v[216:219], v4, s[8:11], s40 offen sc0 sc1
  v_pk_fma_f32 v[188:189], v[80:81], v[52:53], s[58:59] op_sel:[1,0,0] op_sel_hi:[1,1,1]
  v_pk_fma_f32 v[192:193], v[80:81], v[56:57], s[58:59] op_sel:[1,0,0] op_sel_hi:[1,1,1]
  v_pk_fma_f32 v[190:191], v[80:81], v[54:55], s[58:59] op_sel:[1,0,0] op_sel_hi:[1,1,1]
  v_pk_fma_f32 v[194:195], v[80:81], v[58:59], s[58:59] op_sel:[1,0,0] op_sel_hi:[1,1,1]
  v_pk_fma_f32 v[124:125], v[124:125], v[80:81], v[188:189] op_sel:[0,0,0] op_sel_hi:[1,0,1]
  v_pk_fma_f32 v[128:129], v[128:129], v[80:81], v[192:193] op_sel:[0,0,0] op_sel_hi:[1,0,1]
  v_pk_fma_f32 v[126:127], v[126:127], v[80:81], v[190:191] op_sel:[0,0,0] op_sel_hi:[1,0,1]
  v_pk_fma_f32 v[130:131], v[130:131], v[80:81], v[194:195] op_sel:[0,0,0] op_sel_hi:[1,0,1]
  v_exp_f32_e64 v188, v124 clamp
  v_exp_f32_e64 v192, v128 clamp
  v_exp_f32_e64 v189, v125 clamp
  v_exp_f32_e64 v193, v129 clamp
  v_exp_f32_e64 v190, v126 clamp
  v_exp_f32_e64 v194, v130 clamp
  v_exp_f32_e64 v191, v127 clamp
  v_exp_f32_e64 v195, v131 clamp
  v_max_f32 v124, s58, v124
  v_max_f32 v128, s58, v128
  v_max_f32 v125, s58, v125
  v_max_f32 v129, s58, v129
  v_max_f32 v126, s58, v126
  v_max_f32 v130, s58, v130
  v_max_f32 v127, s58, v127
  v_max_f32 v131, s58, v131
  v_pk_fma_f32 v[124:125], v[124:125], s[56:57], v[188:189]
  v_pk_fma_f32 v[128:129], v[128:129], s[56:57], v[192:193]
  buffer_load_dwordx4 v6, s[16:19], s54 offen offset:1024 lds
  v_pk_fma_f32 v[126:127], v[126:127], s[56:57], v[190:191]
  v_pk_fma_f32 v[130:131], v[130:131], s[56:57], v[194:195]
  v_cvt_pk_bf16_f32 v220, v124, v125
  v_cvt_pk_bf16_f32 v222, v128, v129
  v_cvt_pk_bf16_f32 v221, v126, v127
  v_cvt_pk_bf16_f32 v223, v130, v131
  buffer_store_dwordx4 v[220:223], v4, s[8:11], s40 offen offset:1024 sc0 sc1
  v_pk_fma_f32 v[188:189], v[80:81], v[60:61], s[58:59] op_sel:[1,0,0] op_sel_hi:[1,1,1]
  v_pk_fma_f32 v[192:193], v[80:81], v[64:65], s[58:59] op_sel:[1,0,0] op_sel_hi:[1,1,1]
  v_pk_fma_f32 v[190:191], v[80:81], v[62:63], s[58:59] op_sel:[1,0,0] op_sel_hi:[1,1,1]
  v_pk_fma_f32 v[194:195], v[80:81], v[66:67], s[58:59] op_sel:[1,0,0] op_sel_hi:[1,1,1]
  v_pk_fma_f32 v[132:133], v[132:133], v[80:81], v[188:189] op_sel:[0,0,0] op_sel_hi:[1,0,1]
  v_pk_fma_f32 v[136:137], v[136:137], v[80:81], v[192:193] op_sel:[0,0,0] op_sel_hi:[1,0,1]
  v_pk_fma_f32 v[134:135], v[134:135], v[80:81], v[190:191] op_sel:[0,0,0] op_sel_hi:[1,0,1]
  v_pk_fma_f32 v[138:139], v[138:139], v[80:81], v[194:195] op_sel:[0,0,0] op_sel_hi:[1,0,1]
  v_exp_f32_e64 v188, v132 clamp
  v_exp_f32_e64 v192, v136 clamp
  v_exp_f32_e64 v189, v133 clamp
  v_exp_f32_e64 v193, v137 clamp
  v_exp_f32_e64 v190, v134 clamp
  v_exp_f32_e64 v194, v138 clamp
  v_exp_f32_e64 v191, v135 clamp
  v_exp_f32_e64 v195, v139 clamp
  v_max_f32 v132, s58, v132
  v_max_f32 v136, s58, v136
  v_max_f32 v133, s58, v133
  v_max_f32 v137, s58, v137
  v_max_f32 v134, s58, v134
  v_max_f32 v138, s58, v138
  v_max_f32 v135, s58, v135
  v_max_f32 v139, s58, v139
  buffer_load_dwordx4 v7, s[16:19], s54 offen offset:2048 lds
  v_pk_fma_f32 v[132:133], v[132:133], s[56:57], v[188:189]
  v_pk_fma_f32 v[136:137], v[136:137], s[56:57], v[192:193]
  v_pk_fma_f32 v[134:135], v[134:135], s[56:57], v[190:191]
  v_pk_fma_f32 v[138:139], v[138:139], s[56:57], v[194:195]
  v_cvt_pk_bf16_f32 v224, v132, v133
  v_cvt_pk_bf16_f32 v226, v136, v137
  v_cvt_pk_bf16_f32 v225, v134, v135
  v_cvt_pk_bf16_f32 v227, v138, v139
  buffer_store_dwordx4 v[224:227], v4, s[8:11], s40 offen offset:2048 sc0 sc1
  v_pk_fma_f32 v[188:189], v[80:81], v[68:69], s[58:59] op_sel:[1,0,0] op_sel_hi:[1,1,1]
  v_pk_fma_f32 v[192:193], v[80:81], v[72:73], s[58:59] op_sel:[1,0,0] op_sel_hi:[1,1,1]
  v_pk_fma_f32 v[190:191], v[80:81], v[70:71], s[58:59] op_sel:[1,0,0] op_sel_hi:[1,1,1]
  v_pk_fma_f32 v[194:195], v[80:81], v[74:75], s[58:59] op_sel:[1,0,0] op_sel_hi:[1,1,1]
  v_pk_fma_f32 v[140:141], v[140:141], v[80:81], v[188:189] op_sel:[0,0,0] op_sel_hi:[1,0,1]
  v_pk_fma_f32 v[144:145], v[144:145], v[80:81], v[192:193] op_sel:[0,0,0] op_sel_hi:[1,0,1]
  v_pk_fma_f32 v[142:143], v[142:143], v[80:81], v[190:191] op_sel:[0,0,0] op_sel_hi:[1,0,1]
  v_pk_fma_f32 v[146:147], v[146:147], v[80:81], v[194:195] op_sel:[0,0,0] op_sel_hi:[1,0,1]
  v_exp_f32_e64 v188, v140 clamp
  v_exp_f32_e64 v192, v144 clamp
  v_exp_f32_e64 v189, v141 clamp
  v_exp_f32_e64 v193, v145 clamp
  v_exp_f32_e64 v190, v142 clamp
  v_exp_f32_e64 v194, v146 clamp
  v_exp_f32_e64 v191, v143 clamp
  v_exp_f32_e64 v195, v147 clamp
  v_max_f32 v140, s58, v140
  v_max_f32 v144, s58, v144
  v_max_f32 v141, s58, v141
  v_max_f32 v145, s58, v145
  v_max_f32 v142, s58, v142
  v_max_f32 v146, s58, v146
  s_add_u32 m0, s38, 3072
  s_add_u32 s54, s37, 129024
  buffer_load_dwordx4 v5, s[16:19], s54 offen lds
  v_max_f32 v143, s58, v143
  v_max_f32 v147, s58, v147
  v_pk_fma_f32 v[140:141], v[140:141], s[56:57], v[188:189]
  v_pk_fma_f32 v[144:145], v[144:145], s[56:57], v[192:193]
  v_pk_fma_f32 v[142:143], v[142:143], s[56:57], v[190:191]
  v_pk_fma_f32 v[146:147], v[146:147], s[56:57], v[194:195]
  v_cvt_pk_bf16_f32 v228, v140, v141
  v_cvt_pk_bf16_f32 v230, v144, v145
  v_cvt_pk_bf16_f32 v229, v142, v143
  v_cvt_pk_bf16_f32 v231, v146, v147
  buffer_store_dwordx4 v[228:231], v4, s[8:11], s40 offen offset:3072 sc0 sc1
  v_pk_fma_f32 v[188:189], v[80:81], v[76:77], s[58:59] op_sel:[1,0,0] op_sel_hi:[1,1,1]
  v_pk_fma_f32 v[192:193], v[82:83], v[44:45], s[58:59] op_sel:[1,0,0] op_sel_hi:[1,1,1]
  v_pk_fma_f32 v[190:191], v[80:81], v[78:79], s[58:59] op_sel:[1,0,0] op_sel_hi:[1,1,1]
  v_pk_fma_f32 v[194:195], v[82:83], v[46:47], s[58:59] op_sel:[1,0,0] op_sel_hi:[1,1,1]
  v_pk_fma_f32 v[148:149], v[148:149], v[80:81], v[188:189] op_sel:[0,0,0] op_sel_hi:[1,0,1]
  v_pk_fma_f32 v[152:153], v[152:153], v[82:83], v[192:193] op_sel:[0,0,0] op_sel_hi:[1,0,1]
  v_pk_fma_f32 v[150:151], v[150:151], v[80:81], v[190:191] op_sel:[0,0,0] op_sel_hi:[1,0,1]
  v_pk_fma_f32 v[154:155], v[154:155], v[82:83], v[194:195] op_sel:[0,0,0] op_sel_hi:[1,0,1]
  v_exp_f32_e64 v188, v148 clamp
  v_exp_f32_e64 v192, v152 clamp
  v_exp_f32_e64 v189, v149 clamp
  v_exp_f32_e64 v193, v153 clamp
  v_exp_f32_e64 v190, v150 clamp
  v_exp_f32_e64 v194, v154 clamp
  v_exp_f32_e64 v191, v151 clamp
  v_exp_f32_e64 v195, v155 clamp
  v_max_f32 v148, s58, v148
  v_max_f32 v152, s58, v152
  v_max_f32 v149, s58, v149
  v_max_f32 v153, s58, v153
  buffer_load_dwordx4 v6, s[16:19], s54 offen offset:1024 lds
  v_max_f32 v150, s58, v150
  v_max_f32 v154, s58, v154
  v_max_f32 v151, s58, v151
  v_max_f32 v155, s58, v155
  v_pk_fma_f32 v[148:149], v[148:149], s[56:57], v[188:189]
  v_pk_fma_f32 v[152:153], v[152:153], s[56:57], v[192:193]
  v_pk_fma_f32 v[150:151], v[150:151], s[56:57], v[190:191]
  v_pk_fma_f32 v[154:155], v[154:155], s[56:57], v[194:195]
  v_cvt_pk_bf16_f32 v232, v148, v149
  v_cvt_pk_bf16_f32 v234, v152, v153
  v_cvt_pk_bf16_f32 v233, v150, v151
  v_cvt_pk_bf16_f32 v235, v154, v155
  buffer_store_dwordx4 v[232:235], v4, s[8:11], s41 offen sc0 sc1
  v_pk_fma_f32 v[188:189], v[82:83], v[48:49], s[58:59] op_sel:[1,0,0] op_sel_hi:[1,1,1]
  v_pk_fma_f32 v[192:193], v[82:83], v[52:53], s[58:59] op_sel:[1,0,0] op_sel_hi:[1,1,1]
  v_pk_fma_f32 v[190:191], v[82:83], v[50:51], s[58:59] op_sel:[1,0,0] op_sel_hi:[1,1,1]
  v_pk_fma_f32 v[194:195], v[82:83], v[54:55], s[58:59] op_sel:[1,0,0] op_sel_hi:[1,1,1]
  v_pk_fma_f32 v[156:157], v[156:157], v[82:83], v[188:189] op_sel:[0,0,0] op_sel_hi:[1,0,1]
  v_pk_fma_f32 v[160:161], v[160:161], v[82:83], v[192:193] op_sel:[0,0,0] op_sel_hi:[1,0,1]
  v_pk_fma_f32 v[158:159], v[158:159], v[82:83], v[190:191] op_sel:[0,0,0] op_sel_hi:[1,0,1]
  v_pk_fma_f32 v[162:163], v[162:163], v[82:83], v[194:195] op_sel:[0,0,0] op_sel_hi:[1,0,1]
  v_exp_f32_e64 v188, v156 clamp
  v_exp_f32_e64 v192, v160 clamp
  v_exp_f32_e64 v189, v157 clamp
  v_exp_f32_e64 v193, v161 clamp
  v_exp_f32_e64 v190, v158 clamp
  v_exp_f32_e64 v194, v162 clamp
  v_exp_f32_e64 v191, v159 clamp
  v_exp_f32_e64 v195, v163 clamp
  v_max_f32 v156, s58, v156
  v_max_f32 v160, s58, v160
  buffer_load_dwordx4 v7, s[16:19], s54 offen offset:2048 lds
  v_max_f32 v157, s58, v157
  v_max_f32 v161, s58, v161
  v_max_f32 v158, s58, v158
  v_max_f32 v162, s58, v162
  v_max_f32 v159, s58, v159
  v_max_f32 v163, s58, v163
  v_pk_fma_f32 v[156:157], v[156:157], s[56:57], v[188:189]
  v_pk_fma_f32 v[160:161], v[160:161], s[56:57], v[192:193]
  v_pk_fma_f32 v[158:159], v[158:159], s[56:57], v[190:191]
  v_pk_fma_f32 v[162:163], v[162:163], s[56:57], v[194:195]
  v_cvt_pk_bf16_f32 v236, v156, v157
  v_cvt_pk_bf16_f32 v238, v160, v161
  v_cvt_pk_bf16_f32 v237, v158, v159
  v_cvt_pk_bf16_f32 v239, v162, v163
  buffer_store_dwordx4 v[236:239], v4, s[8:11], s41 offen offset:1024 sc0 sc1
  v_pk_fma_f32 v[188:189], v[82:83], v[56:57], s[58:59] op_sel:[1,0,0] op_sel_hi:[1,1,1]
  v_pk_fma_f32 v[192:193], v[82:83], v[60:61], s[58:59] op_sel:[1,0,0] op_sel_hi:[1,1,1]
  v_pk_fma_f32 v[190:191], v[82:83], v[58:59], s[58:59] op_sel:[1,0,0] op_sel_hi:[1,1,1]
  v_pk_fma_f32 v[194:195], v[82:83], v[62:63], s[58:59] op_sel:[1,0,0] op_sel_hi:[1,1,1]
  v_pk_fma_f32 v[164:165], v[164:165], v[82:83], v[188:189] op_sel:[0,0,0] op_sel_hi:[1,0,1]
  v_pk_fma_f32 v[168:169], v[168:169], v[82:83], v[192:193] op_sel:[0,0,0] op_sel_hi:[1,0,1]
  v_pk_fma_f32 v[166:167], v[166:167], v[82:83], v[190:191] op_sel:[0,0,0] op_sel_hi:[1,0,1]
  v_pk_fma_f32 v[170:171], v[170:171], v[82:83], v[194:195] op_sel:[0,0,0] op_sel_hi:[1,0,1]
  v_exp_f32_e64 v188, v164 clamp
  v_exp_f32_e64 v192, v168 clamp
  v_exp_f32_e64 v189, v165 clamp
  v_exp_f32_e64 v193, v169 clamp
  v_exp_f32_e64 v190, v166 clamp
  v_exp_f32_e64 v194, v170 clamp
  v_exp_f32_e64 v191, v167 clamp
  v_exp_f32_e64 v195, v171 clamp
  v_max_f32 v164, s58, v164
  v_max_f32 v168, s58, v168
  v_max_f32 v165, s58, v165
  v_max_f32 v169, s58, v169
  v_max_f32 v166, s58, v166
  v_max_f32 v170, s58, v170
  v_max_f32 v167, s58, v167
  v_max_f32 v171, s58, v171
  v_pk_fma_f32 v[164:165], v[164:165], s[56:57], v[188:189]
  v_pk_fma_f32 v[168:169], v[168:169], s[56:57], v[192:193]
  v_pk_fma_f32 v[166:167], v[166:167], s[56:57], v[190:191]
  v_pk_fma_f32 v[170:171], v[170:171], s[56:57], v[194:195]
  v_cvt_pk_bf16_f32 v240, v164, v165
  v_cvt_pk_bf16_f32 v242, v168, v169
  v_cvt_pk_bf16_f32 v241, v166, v167
  v_cvt_pk_bf16_f32 v243, v170, v171
  buffer_store_dwordx4 v[240:243], v4, s[8:11], s41 offen offset:2048 sc0 sc1
  v_pk_fma_f32 v[188:189], v[82:83], v[64:65], s[58:59] op_sel:[1,0,0] op_sel_hi:[1,1,1]
  v_pk_fma_f32 v[192:193], v[82:83], v[68:69], s[58:59] op_sel:[1,0,0] op_sel_hi:[1,1,1]
  v_pk_fma_f32 v[190:191], v[82:83], v[66:67], s[58:59] op_sel:[1,0,0] op_sel_hi:[1,1,1]
  v_pk_fma_f32 v[194:195], v[82:83], v[70:71], s[58:59] op_sel:[1,0,0] op_sel_hi:[1,1,1]
  v_pk_fma_f32 v[172:173], v[172:173], v[82:83], v[188:189] op_sel:[0,0,0] op_sel_hi:[1,0,1]
  v_pk_fma_f32 v[176:177], v[176:177], v[82:83], v[192:193] op_sel:[0,0,0] op_sel_hi:[1,0,1]
  v_pk_fma_f32 v[174:175], v[174:175], v[82:83], v[190:191] op_sel:[0,0,0] op_sel_hi:[1,0,1]
  v_pk_fma_f32 v[178:179], v[178:179], v[82:83], v[194:195] op_sel:[0,0,0] op_sel_hi:[1,0,1]
  v_exp_f32_e64 v188, v172 clamp
  v_exp_f32_e64 v192, v176 clamp
  v_exp_f32_e64 v189, v173 clamp
  v_exp_f32_e64 v193, v177 clamp
  v_exp_f32_e64 v190, v174 clamp
  v_exp_f32_e64 v194, v178 clamp
  v_exp_f32_e64 v191, v175 clamp
  v_exp_f32_e64 v195, v179 clamp
  v_max_f32 v172, s58, v172
  v_max_f32 v176, s58, v176
  v_max_f32 v173, s58, v173
  v_max_f32 v177, s58, v177
  v_max_f32 v174, s58, v174
  v_max_f32 v178, s58, v178
  v_max_f32 v175, s58, v175
  v_max_f32 v179, s58, v179
  v_pk_fma_f32 v[172:173], v[172:173], s[56:57], v[188:189]
  v_pk_fma_f32 v[176:177], v[176:177], s[56:57], v[192:193]
  v_pk_fma_f32 v[174:175], v[174:175], s[56:57], v[190:191]
  v_pk_fma_f32 v[178:179], v[178:179], s[56:57], v[194:195]
  v_cvt_pk_bf16_f32 v244, v172, v173
  v_cvt_pk_bf16_f32 v246, v176, v177
  v_cvt_pk_bf16_f32 v245, v174, v175
  v_cvt_pk_bf16_f32 v247, v178, v179
  buffer_store_dwordx4 v[244:247], v4, s[8:11], s41 offen offset:3072 sc0 sc1
  v_pk_fma_f32 v[188:189], v[82:83], v[72:73], s[58:59] op_sel:[1,0,0] op_sel_hi:[1,1,1]
  v_pk_fma_f32 v[192:193], v[82:83], v[76:77], s[58:59] op_sel:[1,0,0] op_sel_hi:[1,1,1]
  v_pk_fma_f32 v[190:191], v[82:83], v[74:75], s[58:59] op_sel:[1,0,0] op_sel_hi:[1,1,1]
  v_pk_fma_f32 v[194:195], v[82:83], v[78:79], s[58:59] op_sel:[1,0,0] op_sel_hi:[1,1,1]
  v_pk_fma_f32 v[180:181], v[180:181], v[82:83], v[188:189] op_sel:[0,0,0] op_sel_hi:[1,0,1]
  v_pk_fma_f32 v[184:185], v[184:185], v[82:83], v[192:193] op_sel:[0,0,0] op_sel_hi:[1,0,1]
  v_pk_fma_f32 v[182:183], v[182:183], v[82:83], v[190:191] op_sel:[0,0,0] op_sel_hi:[1,0,1]
  v_pk_fma_f32 v[186:187], v[186:187], v[82:83], v[194:195] op_sel:[0,0,0] op_sel_hi:[1,0,1]
  v_exp_f32_e64 v188, v180 clamp
  v_exp_f32_e64 v192, v184 clamp
  v_exp_f32_e64 v189, v181 clamp
  v_exp_f32_e64 v193, v185 clamp
  v_exp_f32_e64 v190, v182 clamp
  v_exp_f32_e64 v194, v186 clamp
  v_exp_f32_e64 v191, v183 clamp
  v_exp_f32_e64 v195, v187 clamp
  v_max_f32 v180, s58, v180
  v_max_f32 v184, s58, v184
  v_max_f32 v181, s58, v181
  v_max_f32 v185, s58, v185
  v_max_f32 v182, s58, v182
  v_max_f32 v186, s58, v186
  v_max_f32 v183, s58, v183
  v_max_f32 v187, s58, v187
  v_pk_fma_f32 v[180:181], v[180:181], s[56:57], v[188:189]
  v_pk_fma_f32 v[184:185], v[184:185], s[56:57], v[192:193]
  v_pk_fma_f32 v[182:183], v[182:183], s[56:57], v[190:191]
  v_pk_fma_f32 v[186:187], v[186:187], s[56:57], v[194:195]
  v_cvt_pk_bf16_f32 v248, v180, v181
  v_cvt_pk_bf16_f32 v250, v184, v185
  v_cvt_pk_bf16_f32 v249, v182, v183
  v_cvt_pk_bf16_f32 v251, v186, v187
  buffer_store_dwordx4 v[248:251], v4, s[8:11], s42 offen sc0 sc1
  v_cmp_eq_u32 vcc, 0, v2
  v_mov_b32 v22, 1073741824
  s_nop 0
  v_cndmask_b32_e64 v23, v22, 0, vcc
  v_mov_b32 v22, 0x100
  s_branch F_k2
F_spkv:
  buffer_load_dword v10, v11, s[24:27], 0 offen offset:128 sc0 sc1
  s_waitcnt vmcnt(0)
  v_readfirstlane_b32 s5, v10
  s_nop 1
  s_cmp_eq_u32 s5, 63
  s_cbranch_scc0 F_spkv
  s_branch F_rtkv
F_spq:
  buffer_load_dword v10, v11, s[24:27], 0 offen offset:128 sc0 sc1
  s_waitcnt vmcnt(0)
  v_readfirstlane_b32 s5, v10
  s_nop 1
  s_cmp_eq_u32 s5, 63
  s_cbranch_scc0 F_spq
  s_branch F_rtq
F_spare:
  v_lshrrev_b32 v3, 3, v2
  v_and_b32 v20, 7, v2
  v_lshlrev_b32 v20, 4, v20
  v_mov_b32 v8, 1073741824
  v_mov_b32 v10, 0x3f803f80
  v_cmp_eq_u32 s[52:53], 0, v20
  s_waitcnt lgkmcnt(0)
  s_mov_b32 s20, s40
  s_and_b32 s21, s41, 0xffff
  s_mov_b32 s22, 2359296
  s_mov_b32 s23, 0x20000
  s_mov_b32 s12, s42
  s_and_b32 s13, s43, 0xffff
  s_mov_b32 s14, 1990656
  s_mov_b32 s15, 0x20000
  s_mov_b32 s8, s46
  s_and_b32 s9, s47, 0xffff
  s_mov_b32 s10, 268435456
  s_mov_b32 s11, 0x20000
  s_cmp_ge_u32 s2, 37
  s_cbranch_scc1 F_cs
  v_mul_u32_u24 v9, 1152, v3
  v_add_u32 v9, v9, v20
  s_cmp_ge_u32 s2, 32
  s_cbranch_scc1 F_wb2
  s_and_b32 s6, s2, 7
  s_lshl_b32 s6, s6, 5
  s_and_b32 s5, s2, 24
  s_add_u32 s6, s6, s5
  s_lshl_b32 s5, s34, 1
  s_add_u32 s6, s6, s5
  s_mul_i32 s54, s6, 9216
  s_add_u32 s55, s54, 9216
  buffer_load_dwordx4 v[32:35], v9, s[20:23], s54 offen
  buffer_load_dwordx4 v[36:39], v9, s[20:23], s54 offen offset:128
  buffer_load_dwordx4 v[40:43], v9, s[20:23], s54 offen offset:256
  buffer_load_dwordx4 v[44:47], v9, s[20:23], s54 offen offset:384
  buffer_load_dwordx4 v[48:51], v9, s[20:23], s54 offen offset:512
  buffer_load_dwordx4 v[52:55], v9, s[20:23], s54 offen offset:640
  buffer_load_dwordx4 v[56:59], v9, s[20:23], s54 offen offset:768
  buffer_load_dwordx4 v[60:63], v9, s[20:23], s54 offen offset:896
  buffer_load_dwordx4 v[64:67], v9, s[20:23], s54 offen offset:1024
  buffer_load_dwordx4 v[68:71], v9, s[20:23], s55 offen
  buffer_load_dwordx4 v[72:75], v9, s[20:23], s55 offen offset:128
  buffer_load_dwordx4 v[76:79], v9, s[20:23], s55 offen offset:256
  buffer_load_dwordx4 v[80:83], v9, s[20:23], s55 offen offset:384
  buffer_load_dwordx4 v[84:87], v9, s[20:23], s55 offen offset:512
  buffer_load_dwordx4 v[88:91], v9, s[20:23], s55 offen offset:640
  buffer_load_dwordx4 v[92:95], v9, s[20:23], s55 offen offset:768
  buffer_load_dwordx4 v[96:99], v9, s[20:23], s55 offen offset:896
  buffer_load_dwordx4 v[100:103], v9, s[20:23], s55 offen offset:1024
  s_lshr_b32 s4, s2, 3
  s_sub_u32 s5, s4, 8
  s_cmp_lt_u32 s4, 8
  s_cselect_b32 s5, s4, s5
  s_lshr_b32 s33, s5, 2
  s_and_b32 s5, s5, 3
  s_and_b32 s4, s2, 7
  s_lshl_b32 s4, s4, 2
  s_add_u32 s32, s4, s5
  v_add_u32 v3, 0, v2
  v_mul_u32_u24 v1, 5462, v3
  v_lshrrev_b32 v1, 16, v1
  v_mul_u32_u24 v5, 12, v1
  v_sub_u32 v3, v3, v5
  v_mul_u32_u24 v1, 1152, v1
  v_lshl_add_u32 v5, v3, 4, v1
  v_add_u32 v3, 64, v2
  v_mul_u32_u24 v1, 5462, v3
  v_lshrrev_b32 v1, 16, v1
  v_mul_u32_u24 v6, 12, v1
  v_sub_u32 v3, v3, v6
  v_mul_u32_u24 v1, 1152, v1
  v_lshl_add_u32 v6, v3, 4, v1
  v_subrev_u32 v6, 1024, v6
  v_add_u32 v3, 128, v2
  v_mul_u32_u24 v1, 5462, v3
  v_lshrrev_b32 v1, 16, v1
  v_mul_u32_u24 v7, 12, v1
  v_sub_u32 v3, v3, v7
  v_mul_u32_u24 v1, 1152, v1
  v_lshl_add_u32 v7, v3, 4, v1
  v_subrev_u32 v7, 2048, v7
  s_mul_i32 s37, s34, 165888
  s_mul_i32 s5, s33, 192
  s_add_u32 s37, s37, s5
  s_mul_i32 s38, s34, 9216
  s_mov_b32 s16, s48
  s_and_b32 s17, s49, 0xffff
  s_mov_b32 s19, 0x20000
  s_lshr_b32 s5, s2, 6
  s_cmp_eq_u32 s5, 1
  s_cselect_b32 s18, 0, 663552
  s_add_u32 s3, s2, 40
  s_mul_i32 s54, s3, 9216
  s_cmp_lg_u32 s34, 0
  s_cselect_b32 s54, 1073741824, s54
  buffer_load_dwordx4 v[104:107], v9, s[16:19], s54 offen
  buffer_load_dwordx4 v[108:111], v9, s[16:19], s54 offen offset:128
  buffer_load_dwordx4 v[112:115], v9, s[16:19], s54 offen offset:256
  buffer_load_dwordx4 v[116:119], v9, s[16:19], s54 offen offset:384
  buffer_load_dwordx4 v[120:123], v9, s[16:19], s54 offen offset:512
  buffer_load_dwordx4 v[124:127], v9, s[16:19], s54 offen offset:640
  buffer_load_dwordx4 v[128:131], v9, s[16:19], s54 offen offset:768
  buffer_load_dwordx4 v[132:135], v9, s[16:19], s54 offen offset:896
  buffer_load_dwordx4 v[136:139], v9, s[16:19], s54 offen offset:1024
  v_cmp_gt_u32 vcc, 95, v0
  v_lshlrev_b32 v28, 3, v0
  v_mov_b32 v30, 0
  v_mov_b32 v31, 0
  v_cndmask_b32 v29, v8, v28, vcc
  s_mul_i32 s5, s2, 760
  s_lshl_b32 s4, s2, 11
  s_add_u32 s4, s4, 2752512
  buffer_store_dwordx2 v[30:31], v29, s[8:11], s5 offen sc0 sc1
  buffer_store_dwordx2 v[30:31], v28, s[8:11], s4 offen sc0 sc1
  v_lshrrev_b32 v3, 3, v2
  v_lshlrev_b32 v3, 2, v3
  v_cndmask_b32 v3, v8, v3, s[52:53]
  s_lshl_b32 s6, s6, 5
  v_mov_b32 v12, 0
  v_mov_b32 v13, 0
  s_waitcnt vmcnt(28)
  v_dot2c_f32_bf16 v12, v32, v10
  v_dot2c_f32_bf16 v13, v32, v32
  v_dot2c_f32_bf16 v12, v33, v10
  v_dot2c_f32_bf16 v13, v33, v33
  v_dot2c_f32_bf16 v12, v34, v10
  v_dot2c_f32_bf16 v13, v34, v34
  v_dot2c_f32_bf16 v12, v35, v10
  v_dot2c_f32_bf16 v13, v35, v35
  s_waitcnt vmcnt(27)
  v_dot2c_f32_bf16 v12, v36, v10
  v_dot2c_f32_bf16 v13, v36, v36
  v_dot2c_f32_bf16 v12, v37, v10
  v_dot2c_f32_bf16 v13, v37, v37
  v_dot2c_f32_bf16 v12, v38, v10
  v_dot2c_f32_bf16 v13, v38, v38
  v_dot2c_f32_bf16 v12, v39, v10
  v_dot2c_f32_bf16 v13, v39, v39
  s_waitcnt vmcnt(26)
  v_dot2c_f32_bf16 v12, v40, v10
  v_dot2c_f32_bf16 v13, v40, v40
  v_dot2c_f32_bf16 v12, v41, v10
  v_dot2c_f32_bf16 v13, v41, v41
  v_dot2c_f32_bf16 v12, v42, v10
  v_dot2c_f32_bf16 v13, v42, v42
  v_dot2c_f32_bf16 v12, v43, v10
  v_dot2c_f32_bf16 v13, v43, v43
  s_waitcnt vmcnt(25)
  v_dot2c_f32_bf16 v12, v44, v10
  v_dot2c_f32_bf16 v13, v44, v44
  v_dot2c_f32_bf16 v12, v45, v10
  v_dot2c_f32_bf16 v13, v45, v45
  v_dot2c_f32_bf16 v12, v46, v10
  v_dot2c_f32_bf16 v13, v46, v46
  v_dot2c_f32_bf16 v12, v47, v10
  v_dot2c_f32_bf16 v13, v47, v47
  s_waitcnt vmcnt(24)
  v_dot2c_f32_bf16 v12, v48, v10
  v_dot2c_f32_bf16 v13, v48, v48
  v_dot2c_f32_bf16 v12, v49, v10
  v_dot2c_f32_bf16 v13, v49, v49
  v_dot2c_f32_bf16 v12, v50, v10
  v_dot2c_f32_bf16 v13, v50, v50
  v_dot2c_f32_bf16 v12, v51, v10
  v_dot2c_f32_bf16 v13, v51, v51
  s_waitcnt vmcnt(23)
  v_dot2c_f32_bf16 v12, v52, v10
  v_dot2c_f32_bf16 v13, v52, v52
  v_dot2c_f32_bf16 v12, v53, v10
  v_dot2c_f32_bf16 v13, v53, v53
  v_dot2c_f32_bf16 v12, v54, v10
  v_dot2c_f32_bf16 v13, v54, v54
  v_dot2c_f32_bf16 v12, v55, v10
  v_dot2c_f32_bf16 v13, v55, v55
  s_waitcnt vmcnt(22)
  v_dot2c_f32_bf16 v12, v56, v10
  v_dot2c_f32_bf16 v13, v56, v56
  v_dot2c_f32_bf16 v12, v57, v10
  v_dot2c_f32_bf16 v13, v57, v57
  v_dot2c_f32_bf16 v12, v58, v10
  v_dot2c_f32_bf16 v13, v58, v58
  v_dot2c_f32_bf16 v12, v59, v10
  v_dot2c_f32_bf16 v13, v59, v59
  s_waitcnt vmcnt(21)
  v_dot2c_f32_bf16 v12, v60, v10
  v_dot2c_f32_bf16 v13, v60, v60
  v_dot2c_f32_bf16 v12, v61, v10
  v_dot2c_f32_bf16 v13, v61, v61
  v_dot2c_f32_bf16 v12, v62, v10
  v_dot2c_f32_bf16 v13, v62, v62
  v_dot2c_f32_bf16 v12, v63, v10
  v_dot2c_f32_bf16 v13, v63, v63
  s_waitcnt vmcnt(20)
  v_dot2c_f32_bf16 v12, v64, v10
  v_dot2c_f32_bf16 v13, v64, v64
  v_dot2c_f32_bf16 v12, v65, v10
  v_dot2c_f32_bf16 v13, v65, v65
  v_dot2c_f32_bf16 v12, v66, v10
  v_dot2c_f32_bf16 v13, v66, v66
  v_dot2c_f32_bf16 v12, v67, v10
  v_dot2c_f32_bf16 v13, v67, v67
  s_nop 2
  v_add_f32_dpp v12, v12, v12 quad_perm:[1,0,3,2] row_mask:0xf bank_mask:0xf
  v_add_f32_dpp v13, v13, v13 quad_perm:[1,0,3,2] row_mask:0xf bank_mask:0xf
  s_nop 0
  v_add_f32_dpp v12, v12, v12 quad_perm:[2,3,0,1] row_mask:0xf bank_mask:0xf
  v_add_f32_dpp v13, v13, v13 quad_perm:[2,3,0,1] row_mask:0xf bank_mask:0xf
  s_nop 0
  v_add_f32_dpp v12, v12, v12 row_half_mirror row_mask:0xf bank_mask:0xf
  v_add_f32_dpp v13, v13, v13 row_half_mirror row_mask:0xf bank_mask:0xf
  s_nop 0
  v_mul_f32 v15, 0x3ae38e39, v12
  v_mul_f32 v12, 0x3ae38e39, v12
  v_mul_f32 v13, 0x3ae38e39, v13
  v_fma_f32 v13, -v12, v12, v13
  v_max_f32 v13, 0, v13
  v_cvt_pk_bf16_f32 v14, v12, v13
  v_lshlrev_b32 v12, 16, v14
  v_and_b32 v13, 0xffff0000, v14
  v_add_f32 v13, 0x3727c5ac, v13
  v_cvt_pk_bf16_f32 v13, v13, v13
  v_and_b32 v13, 0xffff0000, v13
  v_sqrt_f32 v13, v13
  s_nop 0
  v_cvt_pk_bf16_f32 v13, v13, v13
  v_and_b32 v13, 0xffff0000, v13
  v_rcp_f32 v16, v13
  s_nop 0
  v_mul_f32_e64 v17, -v12, v16
  v_mul_f32 v18, 0x3fb8aa3b, v16
  v_mul_f32 v19, 0x3fb8aa3b, v17
  s_add_u32 s5, s6, 2719744
  buffer_store_dword v16, v3, s[8:11], s5 offen sc0 sc1
  s_add_u32 s5, s6, 2727936
  buffer_store_dword v17, v3, s[8:11], s5 offen sc0 sc1
  s_add_u32 s5, s6, 2736128
  buffer_store_dword v18, v3, s[8:11], s5 offen sc0 sc1
  s_add_u32 s5, s6, 2744320
  buffer_store_dword v19, v3, s[8:11], s5 offen sc0 sc1
  s_add_u32 s5, s6, 2686976
  buffer_store_dword v15, v3, s[8:11], s5 offen sc0 sc1
  v_mov_b32 v12, 0
  v_mov_b32 v13, 0
  s_waitcnt vmcnt(24)
  v_dot2c_f32_bf16 v12, v68, v10
  v_dot2c_f32_bf16 v13, v68, v68
  v_dot2c_f32_bf16 v12, v69, v10
  v_dot2c_f32_bf16 v13, v69, v69
  v_dot2c_f32_bf16 v12, v70, v10
  v_dot2c_f32_bf16 v13, v70, v70
  v_dot2c_f32_bf16 v12, v71, v10
  v_dot2c_f32_bf16 v13, v71, v71
  s_waitcnt vmcnt(23)
  v_dot2c_f32_bf16 v12, v72, v10
  v_dot2c_f32_bf16 v13, v72, v72
  v_dot2c_f32_bf16 v12, v73, v10
  v_dot2c_f32_bf16 v13, v73, v73
  v_dot2c_f32_bf16 v12, v74, v10
  v_dot2c_f32_bf16 v13, v74, v74
  v_dot2c_f32_bf16 v12, v75, v10
  v_dot2c_f32_bf16 v13, v75, v75
  s_waitcnt vmcnt(22)
  v_dot2c_f32_bf16 v12, v76, v10
  v_dot2c_f32_bf16 v13, v76, v76
  v_dot2c_f32_bf16 v12, v77, v10
  v_dot2c_f32_bf16 v13, v77, v77
  v_dot2c_f32_bf16 v12, v78, v10
  v_dot2c_f32_bf16 v13, v78, v78
  v_dot2c_f32_bf16 v12, v79, v10
  v_dot2c_f32_bf16 v13, v79, v79
  s_waitcnt vmcnt(21)
  v_dot2c_f32_bf16 v12, v80, v10
  v_dot2c_f32_bf16 v13, v80, v80
  v_dot2c_f32_bf16 v12, v81, v10
  v_dot2c_f32_bf16 v13, v81, v81
  v_dot2c_f32_bf16 v12, v82, v10
  v_dot2c_f32_bf16 v13, v82, v82
  v_dot2c_f32_bf16 v12, v83, v10
  v_dot2c_f32_bf16 v13, v83, v83
  s_waitcnt vmcnt(20)
  v_dot2c_f32_bf16 v12, v84, v10
  v_dot2c_f32_bf16 v13, v84, v84
  v_dot2c_f32_bf16 v12, v85, v10
  v_dot2c_f32_bf16 v13, v85, v85
  v_dot2c_f32_bf16 v12, v86, v10
  v_dot2c_f32_bf16 v13, v86, v86
  v_dot2c_f32_bf16 v12, v87, v10
  v_dot2c_f32_bf16 v13, v87, v87
  s_waitcnt vmcnt(19)
  v_dot2c_f32_bf16 v12, v88, v10
  v_dot2c_f32_bf16 v13, v88, v88
  v_dot2c_f32_bf16 v12, v89, v10
  v_dot2c_f32_bf16 v13, v89, v89
  v_dot2c_f32_bf16 v12, v90, v10
  v_dot2c_f32_bf16 v13, v90, v90
  v_dot2c_f32_bf16 v12, v91, v10
  v_dot2c_f32_bf16 v13, v91, v91
  s_waitcnt vmcnt(18)
  v_dot2c_f32_bf16 v12, v92, v10
  v_dot2c_f32_bf16 v13, v92, v92
  v_dot2c_f32_bf16 v12, v93, v10
  v_dot2c_f32_bf16 v13, v93, v93
  v_dot2c_f32_bf16 v12, v94, v10
  v_dot2c_f32_bf16 v13, v94, v94
  v_dot2c_f32_bf16 v12, v95, v10
  v_dot2c_f32_bf16 v13, v95, v95
  s_waitcnt vmcnt(17)
  v_dot2c_f32_bf16 v12, v96, v10
  v_dot2c_f32_bf16 v13, v96, v96
  v_dot2c_f32_bf16 v12, v97, v10
  v_dot2c_f32_bf16 v13, v97, v97
  v_dot2c_f32_bf16 v12, v98, v10
  v_dot2c_f32_bf16 v13, v98, v98
  v_dot2c_f32_bf16 v12, v99, v10
  v_dot2c_f32_bf16 v13, v99, v99
  s_waitcnt vmcnt(16)
  v_dot2c_f32_bf16 v12, v100, v10
  v_dot2c_f32_bf16 v13, v100, v100
  v_dot2c_f32_bf16 v12, v101, v10
  v_dot2c_f32_bf16 v13, v101, v101
  v_dot2c_f32_bf16 v12, v102, v10
  v_dot2c_f32_bf16 v13, v102, v102
  v_dot2c_f32_bf16 v12, v103, v10
  v_dot2c_f32_bf16 v13, v103, v103
  s_nop 2
  v_add_f32_dpp v12, v12, v12 quad_perm:[1,0,3,2] row_mask:0xf bank_mask:0xf
  v_add_f32_dpp v13, v13, v13 quad_perm:[1,0,3,2] row_mask:0xf bank_mask:0xf
  s_nop 0
  v_add_f32_dpp v12, v12, v12 quad_perm:[2,3,0,1] row_mask:0xf bank_mask:0xf
  v_add_f32_dpp v13, v13, v13 quad_perm:[2,3,0,1] row_mask:0xf bank_mask:0xf
  s_nop 0
  v_add_f32_dpp v12, v12, v12 row_half_mirror row_mask:0xf bank_mask:0xf
  v_add_f32_dpp v13, v13, v13 row_half_mirror row_mask:0xf bank_mask:0xf
  s_nop 0
  v_mul_f32 v15, 0x3ae38e39, v12
  v_mul_f32 v12, 0x3ae38e39, v12
  v_mul_f32 v13, 0x3ae38e39, v13
  v_fma_f32 v13, -v12, v12, v13
  v_max_f32 v13, 0, v13
  v_cvt_pk_bf16_f32 v14, v12, v13
  v_lshlrev_b32 v12, 16, v14
  v_and_b32 v13, 0xffff0000, v14
  v_add_f32 v13, 0x3727c5ac, v13
  v_cvt_pk_bf16_f32 v13, v13, v13
  v_and_b32 v13, 0xffff0000, v13
  v_sqrt_f32 v13, v13
  s_nop 0
  v_cvt_pk_bf16_f32 v13, v13, v13
  v_and_b32 v13, 0xffff0000, v13
  v_rcp_f32 v16, v13
  s_nop 0
  v_mul_f32_e64 v17, -v12, v16
  v_mul_f32 v18, 0x3fb8aa3b, v16
  v_mul_f32 v19, 0x3fb8aa3b, v17
  s_add_u32 s5, s6, 2719776
  buffer_store_dword v16, v3, s[8:11], s5 offen sc0 sc1
  s_add_u32 s5, s6, 2727968
  buffer_store_dword v17, v3, s[8:11], s5 offen sc0 sc1
  s_add_u32 s5, s6, 2736160
  buffer_store_dword v18, v3, s[8:11], s5 offen sc0 sc1
  s_add_u32 s5, s6, 2744352
  buffer_store_dword v19, v3, s[8:11], s5 offen sc0 sc1
  s_add_u32 s5, s6, 2687008
  buffer_store_dword v15, v3, s[8:11], s5 offen sc0 sc1
  s_cmp_lg_u32 s34, 0
  s_cbranch_scc1 F_sj
  s_mul_i32 s7, s3, 57
  s_lshr_b32 s7, s7, 10
  s_mul_i32 s5, s7, 18
  s_sub_u32 s4, s3, s5
  s_mul_i32 s7, s7, 320
  s_lshr_b32 s5, s4, 1
  s_lshl_b32 s5, s5, 3
  s_add_u32 s7, s7, s5
  s_and_b32 s5, s4, 1
  s_mul_i32 s5, s5, 160
  s_add_u32 s7, s7, s5
  s_add_u32 s7, s7, 2703360
  v_lshrrev_b32 v14, 5, v2
  v_mul_u32_u24 v14, 80, v14
  v_bfe_u32 v15, v2, 3, 2
  v_lshl_add_u32 v14, v15, 1, v14
  v_cndmask_b32 v14, v8, v14, s[52:53]
  v_mov_b32 v12, 0
  v_mov_b32 v13, 0
  s_waitcnt vmcnt(20)
  v_dot2c_f32_bf16 v12, v104, v10
  v_dot2c_f32_bf16 v12, v105, v10
  v_dot2c_f32_bf16 v12, v106, v10
  v_dot2c_f32_bf16 v12, v107, v10
  s_waitcnt vmcnt(19)
  v_dot2c_f32_bf16 v12, v108, v10
  v_dot2c_f32_bf16 v12, v109, v10
  v_dot2c_f32_bf16 v12, v110, v10
  v_dot2c_f32_bf16 v12, v111, v10
  s_waitcnt vmcnt(18)
  v_dot2c_f32_bf16 v12, v112, v10
  v_dot2c_f32_bf16 v12, v113, v10
  v_dot2c_f32_bf16 v12, v114, v10
  v_dot2c_f32_bf16 v12, v115, v10
  s_waitcnt vmcnt(17)
  v_dot2c_f32_bf16 v12, v116, v10
  v_dot2c_f32_bf16 v12, v117, v10
  v_dot2c_f32_bf16 v12, v118, v10
  v_dot2c_f32_bf16 v12, v119, v10
  s_waitcnt vmcnt(16)
  v_dot2c_f32_bf16 v12, v120, v10
  v_dot2c_f32_bf16 v12, v121, v10
  v_dot2c_f32_bf16 v12, v122, v10
  v_dot2c_f32_bf16 v12, v123, v10
  s_waitcnt vmcnt(15)
  v_dot2c_f32_bf16 v12, v124, v10
  v_dot2c_f32_bf16 v12, v125, v10
  v_dot2c_f32_bf16 v12, v126, v10
  v_dot2c_f32_bf16 v12, v127, v10
  s_waitcnt vmcnt(14)
  v_dot2c_f32_bf16 v12, v128, v10
  v_dot2c_f32_bf16 v12, v129, v10
  v_dot2c_f32_bf16 v12, v130, v10
  v_dot2c_f32_bf16 v12, v131, v10
  s_waitcnt vmcnt(13)
  v_dot2c_f32_bf16 v12, v132, v10
  v_dot2c_f32_bf16 v12, v133, v10
  v_dot2c_f32_bf16 v12, v134, v10
  v_dot2c_f32_bf16 v12, v135, v10
  s_waitcnt vmcnt(12)
  v_dot2c_f32_bf16 v12, v136, v10
  v_dot2c_f32_bf16 v12, v137, v10
  v_dot2c_f32_bf16 v12, v138, v10
  v_dot2c_f32_bf16 v12, v139, v10
  s_nop 2
  v_add_f32_dpp v12, v12, v12 quad_perm:[1,0,3,2] row_mask:0xf bank_mask:0xf
  v_add_f32_dpp v13, v13, v13 quad_perm:[1,0,3,2] row_mask:0xf bank_mask:0xf
  s_nop 0
  v_add_f32_dpp v12, v12, v12 quad_perm:[2,3,0,1] row_mask:0xf bank_mask:0xf
  v_add_f32_dpp v13, v13, v13 quad_perm:[2,3,0,1] row_mask:0xf bank_mask:0xf
  s_nop 0
  v_add_f32_dpp v12, v12, v12 row_half_mirror row_mask:0xf bank_mask:0xf
  v_add_f32_dpp v13, v13, v13 row_half_mirror row_mask:0xf bank_mask:0xf
  s_nop 0
  v_mul_f32 v12, 0x3ae38e39, v12
  v_cvt_pk_bf16_f32 v12, v12, v12
  buffer_store_short v12, v14, s[8:11], s7 offen sc0 sc1
  s_branch F_sj
F_wb2:
  s_lshr_b32 s4, s2, 3
  s_sub_u32 s5, s4, 8
  s_cmp_lt_u32 s4, 8
  s_cselect_b32 s5, s4, s5
  s_lshr_b32 s33, s5, 2
  s_and_b32 s5, s5, 3
  s_and_b32 s4, s2, 7
  s_lshl_b32 s4, s4, 2
  s_add_u32 s32, s4, s5
  v_add_u32 v3, 0, v2
  v_mul_u32_u24 v1, 5462, v3
  v_lshrrev_b32 v1, 16, v1
  v_mul_u32_u24 v5, 12, v1
  v_sub_u32 v3, v3, v5
  v_mul_u32_u24 v1, 1152, v1
  v_lshl_add_u32 v5, v3, 4, v1
  v_add_u32 v3, 64, v2
  v_mul_u32_u24 v1, 5462, v3
  v_lshrrev_b32 v1, 16, v1
  v_mul_u32_u24 v6, 12, v1
  v_sub_u32 v3, v3, v6
  v_mul_u32_u24 v1, 1152, v1
  v_lshl_add_u32 v6, v3, 4, v1
  v_subrev_u32 v6, 1024, v6
  v_add_u32 v3, 128, v2
  v_mul_u32_u24 v1, 5462, v3
  v_lshrrev_b32 v1, 16, v1
  v_mul_u32_u24 v7, 12, v1
  v_sub_u32 v3, v3, v7
  v_mul_u32_u24 v1, 1152, v1
  v_lshl_add_u32 v7, v3, 4, v1
  v_subrev_u32 v7, 2048, v7
  s_mul_i32 s37, s34, 165888
  s_mul_i32 s5, s33, 192
  s_add_u32 s37, s37, s5
  s_mul_i32 s38, s34, 9216
  s_mov_b32 s16, s48
  s_and_b32 s17, s49, 0xffff
  s_mov_b32 s19, 0x20000
  s_lshr_b32 s5, s2, 6
  s_cmp_eq_u32 s5, 1
  s_cselect_b32 s18, 0, 663552
  s_sub_u32 s6, s2, 32
  s_lshl_b32 s6, s6, 2
  s_add_u32 s6, s6, s34
  s_lshl_b32 s6, s6, 1
  s_mul_i32 s54, s6, 9216
  s_add_u32 s55, s54, 9216
  buffer_load_dwordx4 v[32:35], v9, s[16:19], s54 offen
  buffer_load_dwordx4 v[36:39], v9, s[16:19], s54 offen offset:128
  buffer_load_dwordx4 v[40:43], v9, s[16:19], s54 offen offset:256
  buffer_load_dwordx4 v[44:47], v9, s[16:19], s54 offen offset:384
  buffer_load_dwordx4 v[48:51], v9, s[16:19], s54 offen offset:512
  buffer_load_dwordx4 v[52:55], v9, s[16:19], s54 offen offset:640
  buffer_load_dwordx4 v[56:59], v9, s[16:19], s54 offen offset:768
  buffer_load_dwordx4 v[60:63], v9, s[16:19], s54 offen offset:896
  buffer_load_dwordx4 v[64:67], v9, s[16:19], s54 offen offset:1024
  buffer_load_dwordx4 v[68:71], v9, s[16:19], s55 offen
  buffer_load_dwordx4 v[72:75], v9, s[16:19], s55 offen offset:128
  buffer_load_dwordx4 v[76:79], v9, s[16:19], s55 offen offset:256
  buffer_load_dwordx4 v[80:83], v9, s[16:19], s55 offen offset:384
  buffer_load_dwordx4 v[84:87], v9, s[16:19], s55 offen offset:512
  buffer_load_dwordx4 v[88:91], v9, s[16:19], s55 offen offset:640
  buffer_load_dwordx4 v[92:95], v9, s[16:19], s55 offen offset:768
  buffer_load_dwordx4 v[96:99], v9, s[16:19], s55 offen offset:896
  buffer_load_dwordx4 v[100:103], v9, s[16:19], s55 offen offset:1024
  v_cmp_gt_u32 vcc, 95, v0
  v_lshlrev_b32 v28, 3, v0
  v_mov_b32 v30, 0
  v_mov_b32 v31, 0
  v_cndmask_b32 v29, v8, v28, vcc
  s_mul_i32 s5, s2, 760
  s_lshl_b32 s4, s2, 11
  s_add_u32 s4, s4, 2752512
  buffer_store_dwordx2 v[30:31], v29, s[8:11], s5 offen sc0 sc1
  buffer_store_dwordx2 v[30:31], v28, s[8:11], s4 offen sc0 sc1
  s_add_u32 s3, s6, 1
  s_mul_i32 s7, s6, 57
  s_lshr_b32 s7, s7, 10
  s_mul_i32 s5, s7, 18
  s_sub_u32 s4, s6, s5
  s_mul_i32 s7, s7, 320
  s_lshr_b32 s5, s4, 1
  s_lshl_b32 s5, s5, 3
  s_add_u32 s7, s7, s5
  s_and_b32 s5, s4, 1
  s_mul_i32 s5, s5, 160
  s_add_u32 s7, s7, s5
  s_add_u32 s7, s7, 2703360
  v_lshrrev_b32 v14, 5, v2
  v_mul_u32_u24 v14, 80, v14
  v_bfe_u32 v15, v2, 3, 2
  v_lshl_add_u32 v14, v15, 1, v14
  v_cndmask_b32 v14, v8, v14, s[52:53]
  v_mov_b32 v12, 0
  v_mov_b32 v13, 0
  s_waitcnt vmcnt(19)
  v_dot2c_f32_bf16 v12, v32, v10
  v_dot2c_f32_bf16 v12, v33, v10
  v_dot2c_f32_bf16 v12, v34, v10
  v_dot2c_f32_bf16 v12, v35, v10
  s_waitcnt vmcnt(18)
  v_dot2c_f32_bf16 v12, v36, v10
  v_dot2c_f32_bf16 v12, v37, v10
  v_dot2c_f32_bf16 v12, v38, v10
  v_dot2c_f32_bf16 v12, v39, v10
  s_waitcnt vmcnt(17)
  v_dot2c_f32_bf16 v12, v40, v10
  v_dot2c_f32_bf16 v12, v41, v10
  v_dot2c_f32_bf16 v12, v42, v10
  v_dot2c_f32_bf16 v12, v43, v10
  s_waitcnt vmcnt(16)
  v_dot2c_f32_bf16 v12, v44, v10
  v_dot2c_f32_bf16 v12, v45, v10
  v_dot2c_f32_bf16 v12, v46, v10
  v_dot2c_f32_bf16 v12, v47, v10
  s_waitcnt vmcnt(15)
  v_dot2c_f32_bf16 v12, v48, v10
  v_dot2c_f32_bf16 v12, v49, v10
  v_dot2c_f32_bf16 v12, v50, v10
  v_dot2c_f32_bf16 v12, v51, v10
  s_waitcnt vmcnt(14)
  v_dot2c_f32_bf16 v12, v52, v10
  v_dot2c_f32_bf16 v12, v53, v10
  v_dot2c_f32_bf16 v12, v54, v10
  v_dot2c_f32_bf16 v12, v55, v10
  s_waitcnt vmcnt(13)
  v_dot2c_f32_bf16 v12, v56, v10
  v_dot2c_f32_bf16 v12, v57, v10
  v_dot2c_f32_bf16 v12, v58, v10
  v_dot2c_f32_bf16 v12, v59, v10
  s_waitcnt vmcnt(12)
  v_dot2c_f32_bf16 v12, v60, v10
  v_dot2c_f32_bf16 v12, v61, v10
  v_dot2c_f32_bf16 v12, v62, v10
  v_dot2c_f32_bf16 v12, v63, v10
  s_waitcnt vmcnt(11)
  v_dot2c_f32_bf16 v12, v64, v10
  v_dot2c_f32_bf16 v12, v65, v10
  v_dot2c_f32_bf16 v12, v66, v10
  v_dot2c_f32_bf16 v12, v67, v10
  s_nop 2
  v_add_f32_dpp v12, v12, v12 quad_perm:[1,0,3,2] row_mask:0xf bank_mask:0xf
  v_add_f32_dpp v13, v13, v13 quad_perm:[1,0,3,2] row_mask:0xf bank_mask:0xf
  s_nop 0
  v_add_f32_dpp v12, v12, v12 quad_perm:[2,3,0,1] row_mask:0xf bank_mask:0xf
  v_add_f32_dpp v13, v13, v13 quad_perm:[2,3,0,1] row_mask:0xf bank_mask:0xf
  s_nop 0
  v_add_f32_dpp v12, v12, v12 row_half_mirror row_mask:0xf bank_mask:0xf
  v_add_f32_dpp v13, v13, v13 row_half_mirror row_mask:0xf bank_mask:0xf
  s_nop 0
  v_mul_f32 v12, 0x3ae38e39, v12
  v_cvt_pk_bf16_f32 v12, v12, v12
  buffer_store_short v12, v14, s[8:11], s7 offen sc0 sc1
  s_mul_i32 s7, s3, 57
  s_lshr_b32 s7, s7, 10
  s_mul_i32 s5, s7, 18
  s_sub_u32 s4, s3, s5
  s_mul_i32 s7, s7, 320
  s_lshr_b32 s5, s4, 1
  s_lshl_b32 s5, s5, 3
  s_add_u32 s7, s7, s5
  s_and_b32 s5, s4, 1
  s_mul_i32 s5, s5, 160
  s_add_u32 s7, s7, s5
  s_add_u32 s7, s7, 2703360
  v_lshrrev_b32 v14, 5, v2
  v_mul_u32_u24 v14, 80, v14
  v_bfe_u32 v15, v2, 3, 2
  v_lshl_add_u32 v14, v15, 1, v14
  v_cndmask_b32 v14, v8, v14, s[52:53]
  v_mov_b32 v12, 0
  v_mov_b32 v13, 0
  s_waitcnt vmcnt(11)
  v_dot2c_f32_bf16 v12, v68, v10
  v_dot2c_f32_bf16 v12, v69, v10
  v_dot2c_f32_bf16 v12, v70, v10
  v_dot2c_f32_bf16 v12, v71, v10
  s_waitcnt vmcnt(10)
  v_dot2c_f32_bf16 v12, v72, v10
  v_dot2c_f32_bf16 v12, v73, v10
  v_dot2c_f32_bf16 v12, v74, v10
  v_dot2c_f32_bf16 v12, v75, v10
  s_waitcnt vmcnt(9)
  v_dot2c_f32_bf16 v12, v76, v10
  v_dot2c_f32_bf16 v12, v77, v10
  v_dot2c_f32_bf16 v12, v78, v10
  v_dot2c_f32_bf16 v12, v79, v10
  s_waitcnt vmcnt(8)
  v_dot2c_f32_bf16 v12, v80, v10
  v_dot2c_f32_bf16 v12, v81, v10
  v_dot2c_f32_bf16 v12, v82, v10
  v_dot2c_f32_bf16 v12, v83, v10
  s_waitcnt vmcnt(7)
  v_dot2c_f32_bf16 v12, v84, v10
  v_dot2c_f32_bf16 v12, v85, v10
  v_dot2c_f32_bf16 v12, v86, v10
  v_dot2c_f32_bf16 v12, v87, v10
  s_waitcnt vmcnt(6)
  v_dot2c_f32_bf16 v12, v88, v10
  v_dot2c_f32_bf16 v12, v89, v10
  v_dot2c_f32_bf16 v12, v90, v10
  v_dot2c_f32_bf16 v12, v91, v10
  s_waitcnt vmcnt(5)
  v_dot2c_f32_bf16 v12, v92, v10
  v_dot2c_f32_bf16 v12, v93, v10
  v_dot2c_f32_bf16 v12, v94, v10
  v_dot2c_f32_bf16 v12, v95, v10
  s_waitcnt vmcnt(4)
  v_dot2c_f32_bf16 v12, v96, v10
  v_dot2c_f32_bf16 v12, v97, v10
  v_dot2c_f32_bf16 v12, v98, v10
  v_dot2c_f32_bf16 v12, v99, v10
  s_waitcnt vmcnt(3)
  v_dot2c_f32_bf16 v12, v100, v10
  v_dot2c_f32_bf16 v12, v101, v10
  v_dot2c_f32_bf16 v12, v102, v10
  v_dot2c_f32_bf16 v12, v103, v10
  s_nop 2
  v_add_f32_dpp v12, v12, v12 quad_perm:[1,0,3,2] row_mask:0xf bank_mask:0xf
  v_add_f32_dpp v13, v13, v13 quad_perm:[1,0,3,2] row_mask:0xf bank_mask:0xf
  s_nop 0
  v_add_f32_dpp v12, v12, v12 quad_perm:[2,3,0,1] row_mask:0xf bank_mask:0xf
  v_add_f32_dpp v13, v13, v13 quad_perm:[2,3,0,1] row_mask:0xf bank_mask:0xf
  s_nop 0
  v_add_f32_dpp v12, v12, v12 row_half_mirror row_mask:0xf bank_mask:0xf
  v_add_f32_dpp v13, v13, v13 row_half_mirror row_mask:0xf bank_mask:0xf
  s_nop 0
  v_mul_f32 v12, 0x3ae38e39, v12
  v_cvt_pk_bf16_f32 v12, v12, v12
  buffer_store_short v12, v14, s[8:11], s7 offen sc0 sc1
  s_branch F_sj
F_cs:
  v_mul_u32_u24 v9, 3456, v3
  v_add_u32 v9, v9, v20
  s_sub_u32 s6, s2, 37
  s_mul_i32 s54, s34, 497664
  s_lshl_b32 s5, s6, 7
  s_add_u32 s54, s54, s5
  buffer_load_dwordx4 v[32:35], v9, s[12:15], s54 offen
  s_add_u32 s54, s54, 27648
  buffer_load_dwordx4 v[36:39], v9, s[12:15], s54 offen
  s_add_u32 s54, s54, 27648
  buffer_load_dwordx4 v[40:43], v9, s[12:15], s54 offen
  s_add_u32 s54, s54, 27648
  buffer_load_dwordx4 v[44:47], v9, s[12:15], s54 offen
  s_add_u32 s54, s54, 27648
  buffer_load_dwordx4 v[48:51], v9, s[12:15], s54 offen
  s_add_u32 s54, s54, 27648
  buffer_load_dwordx4 v[52:55], v9, s[12:15], s54 offen
  s_add_u32 s54, s54, 27648
  buffer_load_dwordx4 v[56:59], v9, s[12:15], s54 offen
  s_add_u32 s54, s54, 27648
  buffer_load_dwordx4 v[60:63], v9, s[12:15], s54 offen
  s_add_u32 s54, s54, 27648
  buffer_load_dwordx4 v[64:67], v9, s[12:15], s54 offen
  s_add_u32 s54, s54, 27648
  buffer_load_dwordx4 v[68:71], v9, s[12:15], s54 offen
  s_add_u32 s54, s54, 27648
  buffer_load_dwordx4 v[72:75], v9, s[12:15], s54 offen
  s_add_u32 s54, s54, 27648
  buffer_load_dwordx4 v[76:79], v9, s[12:15], s54 offen
  s_add_u32 s54, s54, 27648
  buffer_load_dwordx4 v[80:83], v9, s[12:15], s54 offen
  s_add_u32 s54, s54, 27648
  buffer_load_dwordx4 v[84:87], v9, s[12:15], s54 offen
  s_add_u32 s54, s54, 27648
  buffer_load_dwordx4 v[88:91], v9, s[12:15], s54 offen
  s_add_u32 s54, s54, 27648
  buffer_load_dwordx4 v[92:95], v9, s[12:15], s54 offen
  s_add_u32 s54, s54, 27648
  buffer_load_dwordx4 v[96:99], v9, s[12:15], s54 offen
  s_add_u32 s54, s54, 27648
  buffer_load_dwordx4 v[100:103], v9, s[12:15], s54 offen
  v_cmp_gt_u32 vcc, 95, v0
  v_lshlrev_b32 v28, 3, v0
  v_mov_b32 v30, 0
  v_mov_b32 v31, 0
  v_cndmask_b32 v29, v8, v28, vcc
  s_mul_i32 s5, s2, 760
  s_lshl_b32 s4, s2, 11
  s_add_u32 s4, s4, 2752512
  buffer_store_dwordx2 v[30:31], v29, s[8:11], s5 offen sc0 sc1
  buffer_store_dwordx2 v[30:31], v28, s[8:11], s4 offen sc0 sc1
  s_lshr_b32 s4, s2, 3
  s_sub_u32 s5, s4, 8
  s_cmp_lt_u32 s4, 8
  s_cselect_b32 s5, s4, s5
  s_lshr_b32 s33, s5, 2
  s_and_b32 s5, s5, 3
  s_and_b32 s4, s2, 7
  s_lshl_b32 s4, s4, 2
  s_add_u32 s32, s4, s5
  v_add_u32 v3, 0, v2
  v_mul_u32_u24 v1, 5462, v3
  v_lshrrev_b32 v1, 16, v1
  v_mul_u32_u24 v5, 12, v1
  v_sub_u32 v3, v3, v5
  v_mul_u32_u24 v1, 1152, v1
  v_lshl_add_u32 v5, v3, 4, v1
  v_add_u32 v3, 64, v2
  v_mul_u32_u24 v1, 5462, v3
  v_lshrrev_b32 v1, 16, v1
  v_mul_u32_u24 v6, 12, v1
  v_sub_u32 v3, v3, v6
  v_mul_u32_u24 v1, 1152, v1
  v_lshl_add_u32 v6, v3, 4, v1
  v_subrev_u32 v6, 1024, v6
  v_add_u32 v3, 128, v2
  v_mul_u32_u24 v1, 5462, v3
  v_lshrrev_b32 v1, 16, v1
  v_mul_u32_u24 v7, 12, v1
  v_sub_u32 v3, v3, v7
  v_mul_u32_u24 v1, 1152, v1
  v_lshl_add_u32 v7, v3, 4, v1
  v_subrev_u32 v7, 2048, v7
  s_mul_i32 s37, s34, 165888
  s_mul_i32 s5, s33, 192
  s_add_u32 s37, s37, s5
  s_mul_i32 s38, s34, 9216
  s_mov_b32 s16, s48
  s_and_b32 s17, s49, 0xffff
  s_mov_b32 s19, 0x20000
  s_lshr_b32 s5, s2, 6
  s_cmp_eq_u32 s5, 1
  s_cselect_b32 s18, 0, 663552
  v_mov_b32 v10, 0x3f80
  v_mov_b32 v11, 0x3f800000
  v_mov_b32 v12, 0
  v_mov_b32 v13, 0
  v_mov_b32 v14, 0
  v_mov_b32 v15, 0
  v_mov_b32 v16, 0
  v_mov_b32 v17, 0
  v_mov_b32 v18, 0
  v_mov_b32 v19, 0
  v_lshlrev_b32 v3, 5, v0
  v_add_u32 v3, 110592, v3
  v_lshlrev_b32 v9, 2, v2
  v_add_u32 v20, 110592, v9
  s_lshl_b32 s6, s6, 8
  s_add_u32 s6, s6, 2621440
  s_waitcnt vmcnt(19)
  v_dot2c_f32_bf16 v12, v32, v10
  v_dot2c_f32_bf16 v13, v32, v11
  v_dot2c_f32_bf16 v14, v33, v10
  v_dot2c_f32_bf16 v15, v33, v11
  v_dot2c_f32_bf16 v16, v34, v10
  v_dot2c_f32_bf16 v17, v34, v11
  v_dot2c_f32_bf16 v18, v35, v10
  v_dot2c_f32_bf16 v19, v35, v11
  s_waitcnt vmcnt(18)
  v_dot2c_f32_bf16 v12, v36, v10
  v_dot2c_f32_bf16 v13, v36, v11
  v_dot2c_f32_bf16 v14, v37, v10
  v_dot2c_f32_bf16 v15, v37, v11
  v_dot2c_f32_bf16 v16, v38, v10
  v_dot2c_f32_bf16 v17, v38, v11
  v_dot2c_f32_bf16 v18, v39, v10
  v_dot2c_f32_bf16 v19, v39, v11
  s_waitcnt vmcnt(17)
  v_dot2c_f32_bf16 v12, v40, v10
  v_dot2c_f32_bf16 v13, v40, v11
  v_dot2c_f32_bf16 v14, v41, v10
  v_dot2c_f32_bf16 v15, v41, v11
  v_dot2c_f32_bf16 v16, v42, v10
  v_dot2c_f32_bf16 v17, v42, v11
  v_dot2c_f32_bf16 v18, v43, v10
  v_dot2c_f32_bf16 v19, v43, v11
  s_waitcnt vmcnt(16)
  v_dot2c_f32_bf16 v12, v44, v10
  v_dot2c_f32_bf16 v13, v44, v11
  v_dot2c_f32_bf16 v14, v45, v10
  v_dot2c_f32_bf16 v15, v45, v11
  v_dot2c_f32_bf16 v16, v46, v10
  v_dot2c_f32_bf16 v17, v46, v11
  v_dot2c_f32_bf16 v18, v47, v10
  v_dot2c_f32_bf16 v19, v47, v11
  s_waitcnt vmcnt(15)
  v_dot2c_f32_bf16 v12, v48, v10
  v_dot2c_f32_bf16 v13, v48, v11
  v_dot2c_f32_bf16 v14, v49, v10
  v_dot2c_f32_bf16 v15, v49, v11
  v_dot2c_f32_bf16 v16, v50, v10
  v_dot2c_f32_bf16 v17, v50, v11
  v_dot2c_f32_bf16 v18, v51, v10
  v_dot2c_f32_bf16 v19, v51, v11
  s_waitcnt vmcnt(14)
  v_dot2c_f32_bf16 v12, v52, v10
  v_dot2c_f32_bf16 v13, v52, v11
  v_dot2c_f32_bf16 v14, v53, v10
  v_dot2c_f32_bf16 v15, v53, v11
  v_dot2c_f32_bf16 v16, v54, v10
  v_dot2c_f32_bf16 v17, v54, v11
  v_dot2c_f32_bf16 v18, v55, v10
  v_dot2c_f32_bf16 v19, v55, v11
  s_waitcnt vmcnt(13)
  v_dot2c_f32_bf16 v12, v56, v10
  v_dot2c_f32_bf16 v13, v56, v11
  v_dot2c_f32_bf16 v14, v57, v10
  v_dot2c_f32_bf16 v15, v57, v11
  v_dot2c_f32_bf16 v16, v58, v10
  v_dot2c_f32_bf16 v17, v58, v11
  v_dot2c_f32_bf16 v18, v59, v10
  v_dot2c_f32_bf16 v19, v59, v11
  s_waitcnt vmcnt(12)
  v_dot2c_f32_bf16 v12, v60, v10
  v_dot2c_f32_bf16 v13, v60, v11
  v_dot2c_f32_bf16 v14, v61, v10
  v_dot2c_f32_bf16 v15, v61, v11
  v_dot2c_f32_bf16 v16, v62, v10
  v_dot2c_f32_bf16 v17, v62, v11
  v_dot2c_f32_bf16 v18, v63, v10
  v_dot2c_f32_bf16 v19, v63, v11
  s_waitcnt vmcnt(11)
  v_dot2c_f32_bf16 v12, v64, v10
  v_dot2c_f32_bf16 v13, v64, v11
  v_dot2c_f32_bf16 v14, v65, v10
  v_dot2c_f32_bf16 v15, v65, v11
  v_dot2c_f32_bf16 v16, v66, v10
  v_dot2c_f32_bf16 v17, v66, v11
  v_dot2c_f32_bf16 v18, v67, v10
  v_dot2c_f32_bf16 v19, v67, v11
  s_waitcnt vmcnt(10)
  v_dot2c_f32_bf16 v12, v68, v10
  v_dot2c_f32_bf16 v13, v68, v11
  v_dot2c_f32_bf16 v14, v69, v10
  v_dot2c_f32_bf16 v15, v69, v11
  v_dot2c_f32_bf16 v16, v70, v10
  v_dot2c_f32_bf16 v17, v70, v11
  v_dot2c_f32_bf16 v18, v71, v10
  v_dot2c_f32_bf16 v19, v71, v11
  s_waitcnt vmcnt(9)
  v_dot2c_f32_bf16 v12, v72, v10
  v_dot2c_f32_bf16 v13, v72, v11
  v_dot2c_f32_bf16 v14, v73, v10
  v_dot2c_f32_bf16 v15, v73, v11
  v_dot2c_f32_bf16 v16, v74, v10
  v_dot2c_f32_bf16 v17, v74, v11
  v_dot2c_f32_bf16 v18, v75, v10
  v_dot2c_f32_bf16 v19, v75, v11
  s_waitcnt vmcnt(8)
  v_dot2c_f32_bf16 v12, v76, v10
  v_dot2c_f32_bf16 v13, v76, v11
  v_dot2c_f32_bf16 v14, v77, v10
  v_dot2c_f32_bf16 v15, v77, v11
  v_dot2c_f32_bf16 v16, v78, v10
  v_dot2c_f32_bf16 v17, v78, v11
  v_dot2c_f32_bf16 v18, v79, v10
  v_dot2c_f32_bf16 v19, v79, v11
  s_waitcnt vmcnt(7)
  v_dot2c_f32_bf16 v12, v80, v10
  v_dot2c_f32_bf16 v13, v80, v11
  v_dot2c_f32_bf16 v14, v81, v10
  v_dot2c_f32_bf16 v15, v81, v11
  v_dot2c_f32_bf16 v16, v82, v10
  v_dot2c_f32_bf16 v17, v82, v11
  v_dot2c_f32_bf16 v18, v83, v10
  v_dot2c_f32_bf16 v19, v83, v11
  s_waitcnt vmcnt(6)
  v_dot2c_f32_bf16 v12, v84, v10
  v_dot2c_f32_bf16 v13, v84, v11
  v_dot2c_f32_bf16 v14, v85, v10
  v_dot2c_f32_bf16 v15, v85, v11
  v_dot2c_f32_bf16 v16, v86, v10
  v_dot2c_f32_bf16 v17, v86, v11
  v_dot2c_f32_bf16 v18, v87, v10
  v_dot2c_f32_bf16 v19, v87, v11
  s_waitcnt vmcnt(5)
  v_dot2c_f32_bf16 v12, v88, v10
  v_dot2c_f32_bf16 v13, v88, v11
  v_dot2c_f32_bf16 v14, v89, v10
  v_dot2c_f32_bf16 v15, v89, v11
  v_dot2c_f32_bf16 v16, v90, v10
  v_dot2c_f32_bf16 v17, v90, v11
  v_dot2c_f32_bf16 v18, v91, v10
  v_dot2c_f32_bf16 v19, v91, v11
  s_waitcnt vmcnt(4)
  v_dot2c_f32_bf16 v12, v92, v10
  v_dot2c_f32_bf16 v13, v92, v11
  v_dot2c_f32_bf16 v14, v93, v10
  v_dot2c_f32_bf16 v15, v93, v11
  v_dot2c_f32_bf16 v16, v94, v10
  v_dot2c_f32_bf16 v17, v94, v11
  v_dot2c_f32_bf16 v18, v95, v10
  v_dot2c_f32_bf16 v19, v95, v11
  s_waitcnt vmcnt(3)
  v_dot2c_f32_bf16 v12, v96, v10
  v_dot2c_f32_bf16 v13, v96, v11
  v_dot2c_f32_bf16 v14, v97, v10
  v_dot2c_f32_bf16 v15, v97, v11
  v_dot2c_f32_bf16 v16, v98, v10
  v_dot2c_f32_bf16 v17, v98, v11
  v_dot2c_f32_bf16 v18, v99, v10
  v_dot2c_f32_bf16 v19, v99, v11
  s_waitcnt vmcnt(2)
  v_dot2c_f32_bf16 v12, v100, v10
  v_dot2c_f32_bf16 v13, v100, v11
  v_dot2c_f32_bf16 v14, v101, v10
  v_dot2c_f32_bf16 v15, v101, v11
  v_dot2c_f32_bf16 v16, v102, v10
  v_dot2c_f32_bf16 v17, v102, v11
  v_dot2c_f32_bf16 v18, v103, v10
  v_dot2c_f32_bf16 v19, v103, v11
  s_nop 2
  ds_write_b128 v3, v[12:15]
  ds_write_b128 v3, v[16:19] offset:16
  s_waitcnt lgkmcnt(0)
  s_barrier
  s_cmp_lg_u32 s34, 0
  s_cbranch_scc1 F_sj
  ds_read2st64_b32 v[32:33], v20 offset0:0 offset1:1
  ds_read2st64_b32 v[34:35], v20 offset0:2 offset1:3
  ds_read2st64_b32 v[36:37], v20 offset0:4 offset1:5
  ds_read2st64_b32 v[38:39], v20 offset0:6 offset1:7
  ds_read2st64_b32 v[40:41], v20 offset0:8 offset1:9
  ds_read2st64_b32 v[42:43], v20 offset0:10 offset1:11
  ds_read2st64_b32 v[44:45], v20 offset0:12 offset1:13
  ds_read2st64_b32 v[46:47], v20 offset0:14 offset1:15
  ds_read2st64_b32 v[48:49], v20 offset0:16 offset1:17
  ds_read2st64_b32 v[50:51], v20 offset0:18 offset1:19
  ds_read2st64_b32 v[52:53], v20 offset0:20 offset1:21
  ds_read2st64_b32 v[54:55], v20 offset0:22 offset1:23
  ds_read2st64_b32 v[56:57], v20 offset0:24 offset1:25
  ds_read2st64_b32 v[58:59], v20 offset0:26 offset1:27
  ds_read2st64_b32 v[60:61], v20 offset0:28 offset1:29
  ds_read2st64_b32 v[62:63], v20 offset0:30 offset1:31
  s_waitcnt lgkmcnt(0)
  v_pk_add_f32 v[32:33], v[32:33], v[48:49]
  v_pk_add_f32 v[34:35], v[34:35], v[50:51]
  v_pk_add_f32 v[36:37], v[36:37], v[52:53]
  v_pk_add_f32 v[38:39], v[38:39], v[54:55]
  v_pk_add_f32 v[40:41], v[40:41], v[56:57]
  v_pk_add_f32 v[42:43], v[42:43], v[58:59]
  v_pk_add_f32 v[44:45], v[44:45], v[60:61]
  v_pk_add_f32 v[46:47], v[46:47], v[62:63]
  v_pk_add_f32 v[32:33], v[32:33], v[40:41]
  v_pk_add_f32 v[34:35], v[34:35], v[42:43]
  v_pk_add_f32 v[36:37], v[36:37], v[44:45]
  v_pk_add_f32 v[38:39], v[38:39], v[46:47]
  v_pk_add_f32 v[32:33], v[32:33], v[36:37]
  v_pk_add_f32 v[34:35], v[34:35], v[38:39]
  v_pk_add_f32 v[32:33], v[32:33], v[34:35]
  v_add_f32 v32, v32, v33
  buffer_store_dword v32, v9, s[8:11], s6 offen sc0 sc1
F_sj:
  s_load_dwordx4 s[40:43], s[0:1], 32
  s_mov_b32 s24, s44
  s_and_b32 s25, s45, 0xffff
  s_mov_b32 s26, 256
  s_mov_b32 s27, 0x20000
  s_and_b32 s3, s2, 7
  s_lshr_b32 s4, s2, 3
  s_and_b32 s5, s3, 1
  s_lshl_b32 s50, s5, 9
  s_mul_i32 s5, s4, 27648
  s_add_u32 s50, s50, s5
  s_xor_b32 s3, s3, 1
  s_lshl_b32 s3, s3, 3
  s_add_u32 s3, s3, s4
  s_mul_i32 s51, s3, 36864
  v_and_b32 v21, 15, v0
  v_mul_u32_u24 v22, 52, v21
  v_lshrrev_b32 v22, 8, v22
  v_lshl_add_u32 v22, v22, 2, v21
  v_lshlrev_b32 v22, 7, v22
  v_bfe_u32 v23, v0, 4, 3
  v_lshrrev_b32 v1, 7, v0
  v_lshl_add_u32 v23, v1, 6, v23
  v_mul_u32_u24 v23, 3456, v23
  v_cmp_gt_u32 vcc, 15, v21
  v_add_u32 v22, v22, v23
  v_and_b32 v21, 31, v0
  v_cndmask_b32 v22, v8, v22, vcc
  v_mul_u32_u24 v21, 1152, v21
  v_lshrrev_b32 v23, 5, v0
  v_cmp_gt_u32 vcc, 4, v23
  v_lshl_add_u32 v21, v23, 7, v21
  s_add_u32 s51, s51, 640
  v_cndmask_b32 v21, v8, v21, vcc
  v_cmp_eq_u32 vcc, 0, v2
  v_mov_b32 v4, 1
  v_mov_b32 v11, 0
  v_cndmask_b32_e64 v3, v8, 0, vcc
  s_waitcnt vmcnt(0) lgkmcnt(0)
  s_barrier
  s_cmp_lg_u32 s34, 3
  s_cbranch_scc1 F_nsg
  buffer_atomic_add v4, v3, s[24:27], 0 offen sc0 sc1
F_nsg:
  s_add_u32 s5, s50, 1105920
  buffer_load_dword v246, v22, s[12:15], s5 offen
  buffer_load_dword v247, v21, s[20:23], s51 offen
  s_add_u32 s5, s50, 1548288
  buffer_load_dword v246, v22, s[12:15], s5 offen
  s_cmp_lg_u32 s34, 3
  s_cbranch_scc1 F_nsg2
  s_waitcnt vmcnt(3)
  v_readfirstlane_b32 s5, v4
  s_nop 1
  s_cmp_lg_u32 s5, 63
  s_cbranch_scc1 F_nsg2
  buffer_store_dword v4, v3, s[24:27], 0 offen offset:128 sc0 sc1
F_nsg2:
  s_lshr_b32 s6, s2, 3
  s_lshl_b32 s6, s6, 13
  s_cmp_lg_u32 s34, 3
  s_cbranch_scc1 F_ncp
  s_getpc_b64 s[4:5]
F_pc2:
  s_add_u32 s4, s4, F_k2-F_pc2
  s_addc_u32 s5, s5, 0
  v_lshlrev_b32 v248, 7, v2
  v_add_u32 v248, s6, v248
  v_min_u32 v248, KB_last-F_k2, v248
  v_mov_b32 v249, 0
  v_lshl_add_u64 v[248:249], v[248:249], 0, s[4:5]
  global_load_dword v250, v[248:249], off
F_ncp:
  s_mov_b32 s52, s40
  s_and_b32 s53, s41, 0xffff
  s_mov_b32 s54, 5308416
  s_mov_b32 s55, 0x20000
  s_mov_b32 s56, s42
  s_and_b32 s57, s43, 0xffff
  s_mov_b32 s58, 5308416
  s_mov_b32 s59, 0x20000
  s_and_b32 s5, s2, 7
  s_lshr_b32 s6, s5, 2
  s_and_b32 s5, s5, 3
  s_lshl_b32 s5, s5, 1
  s_add_u32 s5, s5, s6
  s_mul_i32 s5, s5, 1152
  s_bfe_u32 s6, s2, 0x30003
  s_mul_i32 s6, s6, 663552
  s_add_u32 s5, s5, s6
  v_mul_u32_u24 v4, 911, v0
  v_lshrrev_b32 v4, 16, v4
  v_mul_u32_u24 v3, 72, v4
  v_sub_u32 v3, v0, v3
  v_mul_u32_u24 v3, 9216, v3
  v_mov_b32 v12, 1073741824
  v_cmp_eq_u32 vcc, 0, v4
  v_add_u32 v13, 0, v3
  s_nop 0
  v_cndmask_b32 v12, v12, v13, vcc
  v_cmp_eq_u32 vcc, 1, v4
  v_add_u32 v13, 640, v3
  s_nop 0
  v_cndmask_b32 v12, v12, v13, vcc
  v_cmp_eq_u32 vcc, 2, v4
  v_add_u32 v13, 512, v3
  s_nop 0
  v_cndmask_b32 v12, v12, v13, vcc
  buffer_load_dword v244, v12, s[52:55], s5 offen
  buffer_load_dword v245, v12, s[56:59], s5 offen
  s_add_u32 m0, s38, 36864
  s_add_u32 s54, s37, 0
  buffer_load_dwordx4 v5, s[16:19], s54 offen lds
  buffer_load_dwordx4 v6, s[16:19], s54 offen offset:1024 lds
  buffer_load_dwordx4 v7, s[16:19], s54 offen offset:2048 lds
  s_add_u32 m0, s38, 39936
  s_add_u32 s54, s37, 18432
  buffer_load_dwordx4 v5, s[16:19], s54 offen lds
  buffer_load_dwordx4 v6, s[16:19], s54 offen offset:1024 lds
  buffer_load_dwordx4 v7, s[16:19], s54 offen offset:2048 lds
  s_add_u32 m0, s38, 43008
  s_add_u32 s54, s37, 36864
  buffer_load_dwordx4 v5, s[16:19], s54 offen lds
  buffer_load_dwordx4 v6, s[16:19], s54 offen offset:1024 lds
  buffer_load_dwordx4 v7, s[16:19], s54 offen offset:2048 lds
  s_add_u32 m0, s38, 73728
  s_add_u32 s54, s37, 55296
  buffer_load_dwordx4 v5, s[16:19], s54 offen lds
  buffer_load_dwordx4 v6, s[16:19], s54 offen offset:1024 lds
  buffer_load_dwordx4 v7, s[16:19], s54 offen offset:2048 lds
  s_add_u32 m0, s38, 76800
  s_add_u32 s54, s37, 73728
  buffer_load_dwordx4 v5, s[16:19], s54 offen lds
  buffer_load_dwordx4 v6, s[16:19], s54 offen offset:1024 lds
  buffer_load_dwordx4 v7, s[16:19], s54 offen offset:2048 lds
  s_add_u32 m0, s38, 79872
  s_add_u32 s54, s37, 92160
  buffer_load_dwordx4 v5, s[16:19], s54 offen lds
  buffer_load_dwordx4 v6, s[16:19], s54 offen offset:1024 lds
  buffer_load_dwordx4 v7, s[16:19], s54 offen offset:2048 lds
  s_add_u32 m0, s38, 0
  s_add_u32 s54, s37, 110592
  buffer_load_dwordx4 v5, s[16:19], s54 offen lds
  buffer_load_dwordx4 v6, s[16:19], s54 offen offset:1024 lds
  buffer_load_dwordx4 v7, s[16:19], s54 offen offset:2048 lds
  s_add_u32 m0, s38, 3072
  s_add_u32 s54, s37, 129024
  buffer_load_dwordx4 v5, s[16:19], s54 offen lds
  buffer_load_dwordx4 v6, s[16:19], s54 offen offset:1024 lds
  buffer_load_dwordx4 v7, s[16:19], s54 offen offset:2048 lds
F_gate:
  buffer_load_dword v10, v11, s[24:27], 0 offen offset:128 sc0 sc1
  s_waitcnt vmcnt(0)
  v_readfirstlane_b32 s5, v10
  s_nop 1
  s_cmp_eq_u32 s5, 63
  s_cbranch_scc1 F_gated
  s_sleep 4
  s_branch F_gate
F_gated:
  v_and_b32 v215, 15, v2
  v_lshrrev_b32 v213, 5, v2
  v_lshl_add_u32 v215, v213, 4, v215
  v_mul_u32_u24 v213, 1152, v215
  v_bfe_u32 v214, v2, 4, 1
  v_lshl_add_u32 v213, v214, 4, v213
  v_lshlrev_b32 v215, 2, v215
  v_lshrrev_b32 v214, 4, v2
  v_mul_u32_u24 v214, 80, v214
  s_lshr_b32 s5, s34, 1
  s_lshl_b32 s101, s32, 1
  s_add_u32 s101, s101, s5
  s_mul_i32 s99, s101, 36864
  s_lshl_b32 s101, s101, 7
  s_add_u32 s101, s101, 2686976
  s_mul_i32 s5, s33, 192
  s_add_u32 s99, s99, s5
  s_and_b32 s5, s34, 1
  s_mul_i32 s5, s5, 96
  s_add_u32 s99, s99, s5
  s_mul_i32 s100, s34, 320
  s_add_u32 s100, s100, 2703360
  v_mov_b32 v23, 1073741824
  s_mov_b32 s39, 0
F_k2:
  s_load_dwordx4 s[12:15], s[0:1], 32
  s_load_dwordx4 s[40:43], s[0:1], 48
  s_mul_i32 s35, s34, 12288
  s_add_u32 s35, s35, 110592
  s_mul_i32 s24, s34, 12160
  v_lshlrev_b32 v4, 4, v2
  s_lshr_b32 s5, s34, 1
  s_lshl_b32 s6, s32, 1
  s_add_u32 s36, s6, s5
  s_lshl_b32 s5, s36, 2
  s_add_u32 s5, s5, s34
  s_xor_b32 s6, s5, 4
  s_mul_i32 s25, s5, 9216
  s_mul_i32 s26, s6, 9216
  s_lshl_b32 s45, s34, 5
  s_add_u32 s45, s45, s32
  s_lshl_b32 s45, s45, 7
  s_add_u32 s45, s45, 2867200
  v_cmp_eq_u32 vcc, 0, v2
  v_mov_b32 v1, 1073741824
  s_nop 0
  v_cndmask_b32_e64 v21, v1, 0, vcc
  v_and_b32 v13, 15, v2
  v_lshrrev_b32 v14, 4, v2
  v_mul_u32_u24 v3, 80, v13
  v_lshl_add_u32 v3, v14, 4, v3
  v_add_u32 v3, s35, v3
  v_mov_b32 v16, 196608
  v_and_b32 v1, 3, v13
  v_mul_u32_u24 v17, 9, v1
  v_lshrrev_b32 v17, 1, v17
  v_sub_u32 v17, v14, v17
  v_lshlrev_b32 v17, 4, v17
  v_mul_u32_u24 v1, 1520, v1
  v_add3_u32 v17, v17, v1, s35
  s_and_b32 s5, s34, 1
  s_mul_i32 s59, s5, 96
  v_lshrrev_b32 v1, 5, v2
  v_lshl_add_u32 v1, v1, 4, v13
  v_and_b32 v244, 1, v14
  v_lshlrev_b32 v11, 4, v1
  v_lshl_add_u32 v11, v244, 9, v11
  v_cmp_eq_u32 s[48:49], 0, v244
  v_lshlrev_b32 v12, 3, v1
  v_lshlrev_b32 v15, 2, v1
  v_mov_b32 v1, 1073741824
  v_cndmask_b32 v12, v1, v12, s[48:49]
  s_mul_i32 s51, s36, 36864
  v_lshrrev_b32 v245, 2, v2
  v_mul_u32_u24 v245, 192, v245
  v_and_b32 v8, 3, v2
  v_lshl_add_u32 v245, v8, 3, v245
  s_add_u32 s7, s38, s59
  v_add_u32 v8, s7, v245
  s_add_u32 s7, s38, 96
  s_sub_u32 s7, s7, s59
  v_add_u32 v9, s7, v245
  v_add_u32 v18, 73728, v8
  v_add_u32 v19, 73728, v9
  v_add_u32 v249, 0, v2
  v_mul_u32_u24 v250, 10923, v249
  v_lshrrev_b32 v250, 16, v250
  v_lshlrev_b32 v249, 4, v249
  v_mul_u32_u24 v250, 1056, v250
  v_add_u32 v246, v249, v250
  v_add_u32 v249, 64, v2
  v_mul_u32_u24 v250, 10923, v249
  v_lshrrev_b32 v250, 16, v250
  v_lshlrev_b32 v249, 4, v249
  v_mul_u32_u24 v250, 1056, v250
  v_add_u32 v247, v249, v250
  v_subrev_u32 v247, 1024, v247
  v_add_u32 v249, 128, v2
  v_mul_u32_u24 v250, 10923, v249
  v_lshrrev_b32 v250, 16, v250
  v_lshlrev_b32 v249, 4, v249
  v_mul_u32_u24 v250, 1056, v250
  v_add_u32 v248, v249, v250
  v_subrev_u32 v248, 2048, v248
  v_mul_u32_u24 v249, 96, v13
  v_lshl_add_u32 v249, v14, 3, v249
  v_add_u32 v249, s35, v249
  v_cmp_lt_u32 vcc, 19, v2
  v_add_u32 v251, s100, v4
  s_sub_u32 s5, s101, 320
  v_add_u32 v250, s5, v4
  v_cndmask_b32 v251, v251, v250, vcc
  v_cmp_lt_u32 vcc, 27, v2
  v_mov_b32 v250, 1073741824
  v_mul_u32_u24 v252, 80, v14
  v_cndmask_b32 v251, v251, v250, vcc
  v_add_u32 v252, s35, v252
  v_add_u32 v253, s35, v15
  s_mov_b32 s48, 0x11111111
  s_mov_b32 s49, 0x11111111
  v_cndmask_b32 v112, v16, v17, s[48:49]
  s_mov_b32 s48, 0x22223333
  s_mov_b32 s49, 0x22222222
  v_cndmask_b32 v113, v16, v17, s[48:49]
  s_mov_b32 s48, 0x44442222
  s_mov_b32 s49, 0x44444444
  v_cndmask_b32 v114, v16, v17, s[48:49]
  s_mov_b32 s48, 0xcccc4444
  s_mov_b32 s49, 0x88888888
  v_cndmask_b32 v115, v16, v17, s[48:49]
  s_mov_b32 s48, 0x88888888
  s_mov_b32 s49, 0x0
  v_cndmask_b32 v116, v16, v17, s[48:49]
  s_mov_b32 s48, 0x0
  s_mov_b32 s49, 0x11111111
  v_cndmask_b32 v117, v16, v17, s[48:49]
  s_mov_b32 s48, 0x11111111
  s_mov_b32 s49, 0x22223333
  v_cndmask_b32 v118, v16, v17, s[48:49]
  s_mov_b32 s48, 0x22222222
  s_mov_b32 s49, 0x44442222
  v_cndmask_b32 v119, v16, v17, s[48:49]
  s_mov_b32 s48, 0x44444444
  s_mov_b32 s49, 0xcccc4444
  v_cndmask_b32 v120, v16, v17, s[48:49]
  s_mov_b32 s48, 0x88888888
  s_mov_b32 s49, 0x88888888
  v_cndmask_b32 v121, v16, v17, s[48:49]
  s_mov_b32 s48, 0xffffffff
  s_mov_b32 s49, 0xffffffff
  v_cndmask_b32 v122, v16, v3, s[48:49]
  s_mov_b32 s48, 0xffff
  s_mov_b32 s49, 0x0
  v_cndmask_b32 v123, v16, v3, s[48:49]
  s_mov_b32 s48, 0x30003
  s_mov_b32 s49, 0x30003
  v_cndmask_b32 v124, v16, v3, s[48:49]
  s_mov_b32 s48, 0x3
  s_mov_b32 s49, 0x0
  v_cndmask_b32 v125, v16, v3, s[48:49]
  s_mov_b32 s48, 0xfffcfffc
  s_mov_b32 s49, 0xfffcfffc
  v_cndmask_b32 v126, v16, v3, s[48:49]
  s_mov_b32 s48, 0xfffc
  s_mov_b32 s49, 0x0
  v_cndmask_b32 v127, v16, v3, s[48:49]
  s_mov_b32 s48, 0xf000f
  s_mov_b32 s49, 0xf000f
  v_cndmask_b32 v128, v16, v3, s[48:49]
  s_mov_b32 s48, 0xf
  s_mov_b32 s49, 0x0
  v_cndmask_b32 v129, v16, v3, s[48:49]
  s_mov_b32 s48, 0xfff00000
  s_mov_b32 s49, 0xfff0fff0
  v_cndmask_b32 v130, v16, v3, s[48:49]
  s_mov_b32 s48, 0xfff0fff0
  s_mov_b32 s49, 0x0
  v_cndmask_b32 v131, v16, v3, s[48:49]
  s_mov_b32 s48, 0x3f0000
  s_mov_b32 s49, 0x3f003f
  v_cndmask_b32 v132, v16, v3, s[48:49]
  s_mov_b32 s48, 0x3f003f
  s_mov_b32 s49, 0x0
  v_cndmask_b32 v133, v16, v3, s[48:49]
  s_mov_b32 s48, 0xffc00000
  s_mov_b32 s49, 0xffc0ffc0
  v_cndmask_b32 v134, v16, v3, s[48:49]
  s_mov_b32 s48, 0xffc0ffc0
  s_mov_b32 s49, 0x0
  v_cndmask_b32 v135, v16, v3, s[48:49]
  s_mov_b32 s48, 0xff0000
  s_mov_b32 s49, 0xff00ff
  v_cndmask_b32 v136, v16, v3, s[48:49]
  s_mov_b32 s48, 0xff00ff
  s_mov_b32 s49, 0x0
  v_cndmask_b32 v137, v16, v3, s[48:49]
  s_mov_b32 s48, 0x0
  s_mov_b32 s49, 0xff00ff00
  v_cndmask_b32 v138, v16, v3, s[48:49]
  s_mov_b32 s48, 0xff00ff00
  s_mov_b32 s49, 0xff00
  v_cndmask_b32 v139, v16, v3, s[48:49]
  s_mov_b32 s48, 0x0
  s_mov_b32 s49, 0x3ff03ff
  v_cndmask_b32 v140, v16, v3, s[48:49]
  s_mov_b32 s48, 0x3ff03ff
  s_mov_b32 s49, 0x3ff
  v_cndmask_b32 v141, v16, v3, s[48:49]
  s_mov_b32 s48, 0x0
  s_mov_b32 s49, 0xfc00fc00
  v_cndmask_b32 v142, v16, v3, s[48:49]
  s_mov_b32 s48, 0xfc00fc00
  s_mov_b32 s49, 0xfc00
  v_cndmask_b32 v143, v16, v3, s[48:49]
  s_mov_b32 s48, 0x0
  s_mov_b32 s49, 0xfff0fff
  v_cndmask_b32 v144, v16, v3, s[48:49]
  s_mov_b32 s48, 0xfff0fff
  s_mov_b32 s49, 0xfff
  v_cndmask_b32 v145, v16, v3, s[48:49]
  s_mov_b32 s48, 0x0
  s_mov_b32 s49, 0xf0000000
  v_cndmask_b32 v146, v16, v3, s[48:49]
  s_mov_b32 s48, 0xf000f000
  s_mov_b32 s49, 0xf000f000
  v_cndmask_b32 v147, v16, v3, s[48:49]
  s_mov_b32 s48, 0x0
  s_mov_b32 s49, 0x3fff0000
  v_cndmask_b32 v148, v16, v3, s[48:49]
  s_mov_b32 s48, 0x3fff3fff
  s_mov_b32 s49, 0x3fff3fff
  v_cndmask_b32 v149, v16, v3, s[48:49]
  s_mov_b32 s48, 0x0
  s_mov_b32 s49, 0xc0000000
  v_cndmask_b32 v150, v16, v3, s[48:49]
  s_mov_b32 s48, 0xc000c000
  s_mov_b32 s49, 0xc000c000
  v_cndmask_b32 v151, v16, v3, s[48:49]
  s_mov_b32 s48, 0x0
  s_mov_b32 s49, 0xffff0000
  v_cndmask_b32 v152, v16, v3, s[48:49]
  s_mov_b32 s48, 0xffffffff
  s_mov_b32 s49, 0xffffffff
  v_cndmask_b32 v153, v16, v3, s[48:49]
  s_waitcnt vmcnt(0)
  s_barrier
  buffer_atomic_add v22, v23, s[8:11], s39 offen sc1
  s_lshr_b32 s5, s2, 6
  s_cmp_eq_u32 s5, 1
  s_cbranch_scc1 F2_idle
  s_add_u32 m0, s38, 6144
  s_add_u32 s54, s37, 147456
  buffer_load_dwordx4 v5, s[16:19], s54 offen lds
  buffer_load_dwordx4 v6, s[16:19], s54 offen offset:1024 lds
  buffer_load_dwordx4 v7, s[16:19], s54 offen offset:2048 lds
  s_add_u32 m0, s35, 8192
  s_nop 0
  buffer_load_dwordx4 v251, s[8:11], 0 offen sc0 sc1 lds
  s_add_u32 m0, s35, 9216
  s_nop 0
  buffer_load_dwordx4 v246, s[20:23], s99 offen lds
  buffer_load_dwordx4 v247, s[20:23], s99 offen offset:1024 lds
  buffer_load_dwordx4 v248, s[20:23], s99 offen offset:2048 lds
  ds_read_b64_tr_b16 a[72:73], v8 offset:36864
  ds_read_b64_tr_b16 a[74:75], v8 offset:39936
  ds_read_b64_tr_b16 a[76:77], v8 offset:36896
  ds_read_b64_tr_b16 a[78:79], v8 offset:39968
  ds_read_b64_tr_b16 a[80:81], v8 offset:36928
  ds_read_b64_tr_b16 a[82:83], v8 offset:40000
  ds_read_b64_tr_b16 a[84:85], v9 offset:36864
  ds_read_b64_tr_b16 a[86:87], v9 offset:39936
  ds_read_b64_tr_b16 a[88:89], v9 offset:36896
  ds_read_b64_tr_b16 a[90:91], v9 offset:39968
  ds_read_b64_tr_b16 a[92:93], v9 offset:36928
  ds_read_b64_tr_b16 a[94:95], v9 offset:40000
  ds_read_b64_tr_b16 a[96:97], v8 offset:43008
  ds_read_b64_tr_b16 a[98:99], v18 offset:0
  ds_read_b64_tr_b16 a[100:101], v8 offset:43040
  ds_read_b64_tr_b16 a[102:103], v18 offset:32
  ds_read_b64_tr_b16 a[104:105], v8 offset:43072
  ds_read_b64_tr_b16 a[106:107], v18 offset:64
  ds_read_b64_tr_b16 a[108:109], v9 offset:43008
  ds_read_b64_tr_b16 a[110:111], v19 offset:0
  ds_read_b64_tr_b16 a[112:113], v9 offset:43040
  ds_read_b64_tr_b16 a[114:115], v19 offset:32
  ds_read_b64_tr_b16 a[116:117], v9 offset:43072
  ds_read_b64_tr_b16 a[118:119], v19 offset:64
  ds_read_b64_tr_b16 a[120:121], v18 offset:3072
  ds_read_b64_tr_b16 a[122:123], v18 offset:6144
  ds_read_b64_tr_b16 a[124:125], v18 offset:3104
  ds_read_b64_tr_b16 a[126:127], v18 offset:6176
  ds_read_b64_tr_b16 a[128:129], v18 offset:3136
  ds_read_b64_tr_b16 a[130:131], v18 offset:6208
  ds_read_b64_tr_b16 a[132:133], v19 offset:3072
  ds_read_b64_tr_b16 a[134:135], v19 offset:6144
  ds_read_b64_tr_b16 a[136:137], v19 offset:3104
  ds_read_b64_tr_b16 a[138:139], v19 offset:6176
  ds_read_b64_tr_b16 a[140:141], v19 offset:3136
  ds_read_b64_tr_b16 a[142:143], v19 offset:6208
  ds_read_b64_tr_b16 a[144:145], v8 offset:0
  ds_read_b64_tr_b16 a[146:147], v8 offset:3072
  ds_read_b64_tr_b16 a[148:149], v8 offset:32
  ds_read_b64_tr_b16 a[150:151], v8 offset:3104
  ds_read_b64_tr_b16 a[152:153], v8 offset:64
  ds_read_b64_tr_b16 a[154:155], v8 offset:3136
  ds_read_b64_tr_b16 a[156:157], v9 offset:0
  ds_read_b64_tr_b16 a[158:159], v9 offset:3072
  ds_read_b64_tr_b16 a[160:161], v9 offset:32
  ds_read_b64_tr_b16 a[162:163], v9 offset:3104
  ds_read_b64_tr_b16 a[164:165], v9 offset:64
  ds_read_b64_tr_b16 a[166:167], v9 offset:3136
  v_mov_b32 v22, 0
  buffer_atomic_add v22, v21, s[8:11], s45 offen sc0 sc1
  s_waitcnt lgkmcnt(0)
  s_cmp_lt_u32 s34, 2
  s_cselect_b32 s12, s12, s14
  s_cselect_b32 s13, s13, s15
  s_and_b32 s13, s13, 0xffff
  s_mov_b32 s14, 5308416
  s_mov_b32 s15, 0x20000
  s_mov_b64 exec, 0
  s_cmp_eq_u32 s34, 0
  s_cbranch_scc1 HP_k2_p0
  s_cmp_eq_u32 s34, 1
  s_cbranch_scc1 HP_k2_p1
  s_cmp_eq_u32 s34, 2
  s_cbranch_scc1 HP_k2_p2
  s_cmp_eq_u32 s34, 3
  s_cbranch_scc1 HP_k2_p3
HP_k2_ret:
  s_mov_b64 exec, -1
  s_waitcnt vmcnt(0)
  v_readfirstlane_b32 s5, v22
  s_nop 1
  s_cmp_ge_u32 s5, 0x220
  s_cbranch_scc1 F2_go
F2_pl:
  v_mov_b32 v22, 0
  buffer_atomic_add v22, v21, s[8:11], s45 offen sc0 sc1
  s_waitcnt vmcnt(0)
  v_readfirstlane_b32 s5, v22
  s_nop 1
  s_cmp_ge_u32 s5, 0x220
  s_cbranch_scc1 F2_go
  s_and_b32 s6, s5, 0xff
  s_cmp_ge_u32 s6, 4
  s_cbranch_scc1 F2_pl
  s_sleep 4
  s_branch F2_pl
F2_go:
  s_add_u32 m0, s35, 0
  s_add_u32 s6, s24, 0
  buffer_load_dwordx4 v4, s[8:11], s6 offen sc0 sc1 lds
  buffer_load_dwordx4 v4, s[8:11], s6 offen offset:1024 sc0 sc1 lds
  buffer_load_dwordx4 v4, s[8:11], s6 offen offset:2048 sc0 sc1 lds
  buffer_load_dwordx4 v4, s[8:11], s6 offen offset:3072 sc0 sc1 lds
  ds_read_b64 a[200:201], v249 offset:9216
  ds_read_b64 a[202:203], v249 offset:10752
  ds_read_b64 a[204:205], v249 offset:9248
  ds_read_b64 a[206:207], v249 offset:10784
  ds_read_b64 a[208:209], v249 offset:9280
  ds_read_b64 a[210:211], v249 offset:10816
  ds_read_b128 a[180:183], v252 offset:8192
  ds_read_b128 a[184:187], v252 offset:8208
  ds_read_b128 a[188:191], v252 offset:8224
  ds_read_b128 a[192:195], v252 offset:8240
  ds_read_b128 a[196:199], v252 offset:8256
  ds_read_b32 v1, v253 offset:8512
  s_add_u32 m0, s35, 4096
  s_add_u32 s6, s24, 4096
  buffer_load_dwordx4 v4, s[8:11], s6 offen sc0 sc1 lds
  buffer_load_dwordx4 v4, s[8:11], s6 offen offset:1024 sc0 sc1 lds
  buffer_load_dwordx4 v4, s[8:11], s6 offen offset:2048 sc0 sc1 lds
  buffer_load_dwordx4 v4, s[8:11], s6 offen offset:3072 sc0 sc1 lds
  s_waitcnt lgkmcnt(0)
  s_add_u32 m0, s35, 8192
  s_add_u32 s6, s24, 8192
  buffer_load_dwordx4 v4, s[8:11], s6 offen sc0 sc1 lds
  buffer_load_dwordx4 v4, s[8:11], s6 offen offset:1024 sc0 sc1 lds
  buffer_load_dwordx4 v4, s[8:11], s6 offen offset:2048 sc0 sc1 lds
  buffer_load_dwordx4 v4, s[8:11], s6 offen offset:3072 sc0 sc1 lds
  ds_read_b64_tr_b16 a[168:169], v8 offset:6144
  ds_read_b64_tr_b16 a[170:171], v8 offset:6176
  ds_read_b64_tr_b16 a[172:173], v8 offset:6208
  ds_read_b64_tr_b16 a[174:175], v9 offset:6144
  ds_read_b64_tr_b16 a[176:177], v9 offset:6176
  ds_read_b64_tr_b16 a[178:179], v9 offset:6208
HP_k2_p0:
  s_cbranch_execz HP_k2_p4
  s_and_b32 s3, s2, 3
  s_lshl_b32 s3, s3, 2
  s_bfe_u32 s44, s2, 0x20003
  s_add_u32 s3, s3, s44
  s_mul_i32 s30, s3, 576
  s_and_b32 s3, s3, 1
  s_xor_b32 s39, s3, 1
  s_lshl_b32 s39, s39, 9
  s_add_u32 s39, s39, s30
  s_lshl_b32 s3, s3, 6
  s_add_u32 s30, s30, s3
  s_and_b32 s3, s34, 1
  s_mul_i32 s3, s3, 663552
  s_add_u32 s30, s30, s3
  s_add_u32 s39, s39, s3
  s_add_u32 s39, s39, s3
  v_lshrrev_b32 v16, 2, v2
  v_mul_u32_u24 v16, 9216, v16
  v_and_b32 v17, 3, v2
  v_lshl_add_u32 v16, v17, 4, v16
  v_add_u32 v17, 146432, v16
  v_add_u32 v23, 292864, v16
  s_mul_i32 s31, s34, 9216
  v_bfe_u32 v18, v2, 2, 3
  v_mul_u32_u24 v18, 9216, v18
  v_and_b32 v19, 3, v2
  v_lshl_add_u32 v18, v19, 4, v18
  v_lshrrev_b32 v19, 5, v2
  v_lshl_add_u32 v18, v19, 6, v18
  v_add_u32 v19, 72704, v18
  v_add_u32 v20, 145408, v18
  s_mov_b32 s52, 0xffff
  s_mov_b32 s53, 0x0
  s_mov_b32 s54, 0xffffffff
  s_mov_b32 s55, 0x0
  s_mov_b32 s56, 0xffffffff
  s_mov_b32 s57, 0xffff
  s_movk_i32 s58, 0x3f80
  v_and_b32 v5, 1, v13
  v_lshlrev_b32 v5, 4, v5
  v_lshlrev_b32_e64 v5, v5, s58
  s_mov_b32 s48, 0x300003
  s_mov_b32 s49, 0x30000300
  v_cndmask_b32 v6, 0, v5, s[48:49]
  s_mov_b32 s48, 0xc0000c
  s_mov_b32 s49, 0xc0000c00
  v_cndmask_b32 v7, 0, v5, s[48:49]
  v_lshlrev_b32 v5, 3, v2
  v_add_u32 v3, s35, v5
  s_and_b32 s5, s34, 2
  v_xor_b32 v14, s5, v14
  v_lshl_add_u32 v13, v14, 4, v13
  s_lshl_b32 s5, s34, 8
  s_add_u32 s5, s5, 159744
  v_lshl_add_u32 v13, v13, 2, s5
  s_lshl_b32 s5, s34, 6
  s_and_b32 s5, s5, 128
  s_add_u32 s5, s5, 159744
  v_add_u32 v15, s5, v15
  s_mul_i32 s5, s33, 6144
  s_lshl_b32 s6, s59, 5
  s_add_u32 s5, s5, s6
  s_add_u32 s5, s5, s51
  s_add_u32 s4, s5, 6291456
  s_add_u32 s3, s5, 3145728
  s_lshl_b32 s6, s33, 1
  s_and_b32 s7, s34, 1
  s_add_u32 s6, s6, s7
  s_lshl_b32 s6, s6, 14
  s_lshl_b32 s7, s36, 8
  s_add_u32 s6, s6, s7
  s_add_u32 s7, s6, 65536
  s_add_u32 s29, s26, 262144
  buffer_load_dwordx4 a[36:39], v4, s[8:11], s29 offen sc0 sc1
  buffer_load_dwordx4 a[40:43], v4, s[8:11], s29 offen offset:1024 sc0 sc1
  buffer_load_dwordx4 a[44:47], v4, s[8:11], s29 offen offset:2048 sc0 sc1
  buffer_load_dwordx4 a[48:51], v4, s[8:11], s29 offen offset:3072 sc0 sc1
  s_add_u32 s29, s26, 266240
  buffer_load_dwordx4 a[52:55], v4, s[8:11], s29 offen sc0 sc1
  s_waitcnt lgkmcnt(0)
  s_xor_b32 s5, s34, 1
  s_mul_i32 s5, s5, 12288
  s_add_u32 s5, s5, 110592
  v_add_u32 v8, s5, v5
  s_xor_b32 s5, s34, 2
  s_mul_i32 s5, s5, 12288
  s_add_u32 s5, s5, 110592
  v_add_u32 v9, s5, v5
  s_xor_b32 s5, s34, 3
  s_mul_i32 s5, s5, 12288
  s_add_u32 s5, s5, 110592
  v_add_u32 v10, s5, v5
  s_waitcnt vmcnt(15)
  ds_read_b128 v[184:187], v122 offset:0
  ds_read_b128 v[188:191], v123 offset:64
  ds_read_b128 v[192:195], v124 offset:1280
  ds_read_b128 v[196:199], v125 offset:1344
  s_waitcnt vmcnt(14)
  ds_read_b128 v[200:203], v126 offset:1360
  ds_read_b128 v[204:207], v127 offset:1424
  ds_read_b128 v[208:211], v128 offset:2640
  ds_read_b128 v[212:215], v129 offset:2704
  s_waitcnt vmcnt(12)
  ds_read_b128 v[216:219], v130 offset:2704
  ds_read_b128 v[220:223], v131 offset:2768
  buffer_load_dwordx4 a[56:59], v4, s[8:11], s29 offen offset:1024 sc0 sc1
  s_waitcnt lgkmcnt(8)
  v_cvt_pk_bf16_f32 v48, v184, v185
  v_cvt_pk_bf16_f32 v49, v186, v187
  v_cvt_pk_bf16_f32 v50, v188, v189
  v_cvt_pk_bf16_f32 v51, v190, v191
  ds_read_b128 v[224:227], v132 offset:3984
  ds_read_b128 v[228:231], v133 offset:4048
  s_waitcnt lgkmcnt(8)
  v_cvt_pk_bf16_f32 v52, v192, v193
  v_cvt_pk_bf16_f32 v53, v194, v195
  v_cvt_pk_bf16_f32 v54, v196, v197
  v_cvt_pk_bf16_f32 v55, v198, v199
  s_waitcnt vmcnt(12)
  ds_read_b128 v[184:187], v134 offset:4064
  ds_read_b128 v[188:191], v135 offset:4128
  buffer_load_dwordx4 a[60:63], v4, s[8:11], s29 offen offset:2048 sc0 sc1
  s_waitcnt lgkmcnt(8)
  v_cvt_pk_bf16_f32 v56, v200, v201
  v_cvt_pk_bf16_f32 v57, v202, v203
  v_cvt_pk_bf16_f32 v58, v204, v205
  v_cvt_pk_bf16_f32 v59, v206, v207
  ds_read_b128 v[192:195], v136 offset:5344
  ds_read_b128 v[196:199], v137 offset:5408
  s_waitcnt lgkmcnt(8)
  v_cvt_pk_bf16_f32 v60, v208, v209
  v_cvt_pk_bf16_f32 v61, v210, v211
  v_cvt_pk_bf16_f32 v62, v212, v213
  v_cvt_pk_bf16_f32 v63, v214, v215
  s_waitcnt vmcnt(11)
  ds_read_b128 v[200:203], v138 offset:5408
  ds_read_b128 v[204:207], v139 offset:5472
  buffer_load_dwordx4 a[64:67], v4, s[8:11], s29 offen offset:3072 sc0 sc1
  s_waitcnt lgkmcnt(8)
  v_cvt_pk_bf16_f32 v64, v216, v217
  v_cvt_pk_bf16_f32 v65, v218, v219
  v_cvt_pk_bf16_f32 v66, v220, v221
  v_cvt_pk_bf16_f32 v67, v222, v223
  ds_read_b128 v[208:211], v140 offset:6688
  ds_read_b128 v[212:215], v141 offset:6752
  s_waitcnt lgkmcnt(8)
  v_cvt_pk_bf16_f32 v68, v224, v225
  v_cvt_pk_bf16_f32 v69, v226, v227
  v_cvt_pk_bf16_f32 v70, v228, v229
  v_cvt_pk_bf16_f32 v71, v230, v231
  s_waitcnt vmcnt(11)
  ds_read_b128 v[216:219], v142 offset:6768
  ds_read_b128 v[220:223], v143 offset:6832
  s_add_u32 s29, s26, 270336
  buffer_load_dwordx4 a[68:71], v4, s[8:11], s29 offen sc0 sc1
  s_waitcnt lgkmcnt(8)
  v_cvt_pk_bf16_f32 v72, v184, v185
  v_cvt_pk_bf16_f32 v73, v186, v187
  v_cvt_pk_bf16_f32 v74, v188, v189
  v_cvt_pk_bf16_f32 v75, v190, v191
  ds_read_b128 v[224:227], v144 offset:8048
  ds_read_b128 v[228:231], v145 offset:8112
  s_waitcnt lgkmcnt(8)
  v_cvt_pk_bf16_f32 v76, v192, v193
  v_cvt_pk_bf16_f32 v77, v194, v195
  v_cvt_pk_bf16_f32 v78, v196, v197
  v_cvt_pk_bf16_f32 v79, v198, v199
  s_waitcnt vmcnt(10)
  ds_read_b128 v[184:187], v146 offset:8112
  ds_read_b128 v[188:191], v147 offset:8176
  s_add_u32 s29, s25, 262144
  buffer_load_dwordx4 a[0:3], v4, s[8:11], s29 offen sc0 sc1
  s_waitcnt lgkmcnt(8)
  v_cvt_pk_bf16_f32 v80, v200, v201
  v_cvt_pk_bf16_f32 v81, v202, v203
  v_cvt_pk_bf16_f32 v82, v204, v205
  v_cvt_pk_bf16_f32 v83, v206, v207
  ds_read_b128 v[192:195], v148 offset:9392
  ds_read_b128 v[196:199], v149 offset:9456
  s_waitcnt lgkmcnt(8)
  v_cvt_pk_bf16_f32 v84, v208, v209
  v_cvt_pk_bf16_f32 v85, v210, v211
  v_cvt_pk_bf16_f32 v86, v212, v213
  v_cvt_pk_bf16_f32 v87, v214, v215
  s_waitcnt vmcnt(10)
  ds_read_b128 v[200:203], v150 offset:9472
  ds_read_b128 v[204:207], v151 offset:9536
  buffer_load_dwordx4 a[4:7], v4, s[8:11], s29 offen offset:1024 sc0 sc1
  s_waitcnt lgkmcnt(8)
  v_cvt_pk_bf16_f32 v88, v216, v217
  v_cvt_pk_bf16_f32 v89, v218, v219
  v_cvt_pk_bf16_f32 v90, v220, v221
  v_cvt_pk_bf16_f32 v91, v222, v223
  ds_read_b128 v[208:211], v152 offset:10752
  ds_read_b128 v[212:215], v153 offset:10816
  s_waitcnt lgkmcnt(8)
  v_cvt_pk_bf16_f32 v92, v224, v225
  v_cvt_pk_bf16_f32 v93, v226, v227
  v_cvt_pk_bf16_f32 v94, v228, v229
  v_cvt_pk_bf16_f32 v95, v230, v231
  ds_read_b128 v[216:219], v112 offset:1440
  ds_read_b128 v[220:223], v113 offset:1504
  buffer_load_dwordx4 a[8:11], v4, s[8:11], s29 offen offset:2048 sc0 sc1
  s_waitcnt lgkmcnt(8)
  v_cvt_pk_bf16_f32 v96, v184, v185
  v_cvt_pk_bf16_f32 v97, v186, v187
  v_cvt_pk_bf16_f32 v98, v188, v189
  v_cvt_pk_bf16_f32 v99, v190, v191
  ds_read_b128 v[224:227], v114 offset:1568
  ds_read_b128 v[228:231], v115 offset:1632
  s_waitcnt lgkmcnt(8)
  v_cvt_pk_bf16_f32 v100, v192, v193
  v_cvt_pk_bf16_f32 v101, v194, v195
  v_cvt_pk_bf16_f32 v102, v196, v197
  v_cvt_pk_bf16_f32 v103, v198, v199
  ds_read_b128 v[184:187], v116 offset:1696
  buffer_load_dwordx4 a[12:15], v4, s[8:11], s29 offen offset:3072 sc0 sc1
  s_waitcnt lgkmcnt(7)
  v_cvt_pk_bf16_f32 v104, v200, v201
  v_cvt_pk_bf16_f32 v105, v202, v203
  v_cvt_pk_bf16_f32 v106, v204, v205
  v_cvt_pk_bf16_f32 v107, v206, v207
  ds_read_b128 v[192:195], v117 offset:7488
  ds_read_b128 v[196:199], v118 offset:7552
  s_waitcnt lgkmcnt(7)
  v_cvt_pk_bf16_f32 v108, v208, v209
  v_cvt_pk_bf16_f32 v109, v210, v211
  v_cvt_pk_bf16_f32 v110, v212, v213
  v_cvt_pk_bf16_f32 v111, v214, v215
  ds_read_b128 v[200:203], v119 offset:7616
  ds_read_b128 v[204:207], v120 offset:7680
  s_add_u32 s29, s25, 266240
  buffer_load_dwordx4 a[16:19], v4, s[8:11], s29 offen sc0 sc1
  s_waitcnt lgkmcnt(7)
  v_cvt_pk_bf16_f32 v24, v216, v217
  v_cvt_pk_bf16_f32 v25, v218, v219
  v_cvt_pk_bf16_f32 v26, v220, v221
  v_cvt_pk_bf16_f32 v27, v222, v223
  ds_read_b128 v[212:215], v121 offset:7744
  s_waitcnt lgkmcnt(6)
  v_cvt_pk_bf16_f32 v28, v224, v225
  v_cvt_pk_bf16_f32 v29, v226, v227
  v_cvt_pk_bf16_f32 v30, v228, v229
  v_cvt_pk_bf16_f32 v31, v230, v231
  buffer_load_dwordx4 a[20:23], v4, s[8:11], s29 offen offset:1024 sc0 sc1
  s_waitcnt lgkmcnt(5)
  v_cvt_pk_bf16_f32 v32, v184, v185
  v_cvt_pk_bf16_f32 v33, v186, v187
  v_mov_b32 v34, 0
  v_mov_b32 v35, 0
  s_waitcnt lgkmcnt(3)
  v_cvt_pk_bf16_f32 v36, v192, v193
  v_cvt_pk_bf16_f32 v37, v194, v195
  v_cvt_pk_bf16_f32 v38, v196, v197
  v_cvt_pk_bf16_f32 v39, v198, v199
  s_waitcnt lgkmcnt(1)
  v_cvt_pk_bf16_f32 v40, v200, v201
  v_cvt_pk_bf16_f32 v41, v202, v203
  v_cvt_pk_bf16_f32 v42, v204, v205
  v_cvt_pk_bf16_f32 v43, v206, v207
  buffer_load_dwordx4 a[24:27], v4, s[8:11], s29 offen offset:2048 sc0 sc1
  s_waitcnt lgkmcnt(0)
  v_mov_b32 v44, 0
  v_mov_b32 v45, 0
  v_cvt_pk_bf16_f32 v46, v212, v213
  v_cvt_pk_bf16_f32 v47, v214, v215
  s_nop 1
  s_waitcnt vmcnt(11)
  v_mfma_f32_16x16x32_bf16 v[148:151], v[24:27], a[36:39], 0
  v_mfma_f32_16x16x32_bf16 v[148:151], v[28:31], a[40:43], v[148:151]
  v_mfma_f32_16x16x32_bf16 v[148:151], v[32:35], a[44:47], v[148:151]
  buffer_load_dwordx4 a[28:31], v4, s[8:11], s29 offen offset:3072 sc0 sc1
  v_mfma_f32_16x16x32_bf16 v[152:155], v[36:39], a[44:47], 0
  v_mfma_f32_16x16x32_bf16 v[152:155], v[40:43], a[48:51], v[152:155]
  v_mfma_f32_16x16x32_bf16 v[152:155], v[44:47], a[50:53], v[152:155]
  v_mfma_f32_16x16x32_bf16 v[168:171], v[48:51], a[36:39], 0
  v_mfma_f32_16x16x32_bf16 v[172:175], v[52:55], a[36:39], 0
  v_mfma_f32_16x16x32_bf16 v[172:175], v[56:59], a[38:41], v[172:175]
  v_mfma_f32_16x16x32_bf16 v[176:179], v[60:63], a[38:41], 0
  v_mfma_f32_16x16x32_bf16 v[176:179], v[64:67], a[40:43], v[176:179]
  v_add_f32 v148, 0x358637bd, v148
  v_rcp_f32 v148, v148
  v_add_f32 v149, 0x358637bd, v149
  v_mfma_f32_16x16x32_bf16 v[164:167], v[68:71], a[40:43], 0
  s_add_u32 s29, s25, 270336
  buffer_load_dwordx4 a[32:35], v4, s[8:11], s29 offen sc0 sc1
  v_rcp_f32 v149, v149
  v_add_f32 v150, 0x358637bd, v150
  v_add_f32 v151, 0x358637bd, v151
  v_mfma_f32_16x16x32_bf16 v[164:167], v[72:75], a[42:45], v[164:167]
  v_rcp_f32 v150, v150
  v_rcp_f32 v151, v151
  v_add_f32 v152, 0x358637bd, v152
  v_rcp_f32 v152, v152
  v_add_f32 v153, 0x358637bd, v153
  v_rcp_f32 v153, v153
  v_add_f32 v154, 0x358637bd, v154
  v_rcp_f32 v154, v154
  v_add_f32 v155, 0x358637bd, v155
  v_rcp_f32 v155, v155
  v_mul_f32 v168, v168, v148
  v_mul_f32 v169, v169, v148
HP_k2_p1:
  s_cbranch_execz HP_k2_ret
  v_mul_f32 v170, v170, v148
  v_mul_f32 v171, v171, v148
  v_cvt_pk_bf16_f32 v112, v168, v169
  v_cvt_pk_bf16_f32 v113, v170, v171
  v_mfma_f32_16x16x32_bf16 v[168:171], v[76:79], a[42:45], 0
  s_barrier
  s_add_u32 m0, s31, 0
  s_add_u32 s44, s30, 0
  buffer_load_dwordx4 v18, s[12:15], s44 offen lds
  v_cndmask_b32 v180, v149, v148, s[52:53]
  v_mul_f32 v172, v172, v180
  v_mul_f32 v173, v173, v180
  v_mul_f32 v174, v174, v149
  v_mfma_f32_16x16x32_bf16 v[168:171], v[80:83], a[44:47], v[168:171]
  v_mul_f32 v175, v175, v149
  v_cvt_pk_bf16_f32 v114, v172, v173
  v_cvt_pk_bf16_f32 v115, v174, v175
  v_cndmask_b32 v181, v150, v149, s[52:53]
  s_waitcnt vmcnt(10)
  v_mfma_f32_16x16x32_bf16 v[156:159], v[24:27], a[54:57], 0
  buffer_load_dwordx4 v19, s[12:15], s44 offen offset:1024 lds
  v_mul_f32 v176, v176, v181
  v_mul_f32 v177, v177, v181
  v_mul_f32 v178, v178, v181
  v_mul_f32 v179, v179, v181
  v_mfma_f32_16x16x32_bf16 v[156:159], v[28:31], a[58:61], v[156:159]
  v_cvt_pk_bf16_f32 v116, v176, v177
  v_cvt_pk_bf16_f32 v117, v178, v179
  v_cndmask_b32 v182, v151, v150, s[54:55]
  v_mul_f32 v164, v164, v182
  v_mfma_f32_16x16x32_bf16 v[156:159], v[32:35], a[62:65], v[156:159]
  v_mul_f32 v165, v165, v182
  v_cndmask_b32 v183, v151, v150, s[52:53]
  v_mul_f32 v166, v166, v183
  v_mul_f32 v167, v167, v183
  v_mfma_f32_16x16x32_bf16 v[160:163], v[36:39], a[62:65], 0
  buffer_load_dwordx4 v20, s[12:15], s44 offen offset:2048 lds
  v_cvt_pk_bf16_f32 v118, v164, v165
  v_cvt_pk_bf16_f32 v119, v166, v167
  v_cndmask_b32 v180, v152, v151, s[54:55]
  v_mul_f32 v168, v168, v180
  v_mfma_f32_16x16x32_bf16 v[160:163], v[40:43], a[66:69], v[160:163]
  v_mul_f32 v169, v169, v180
  v_mul_f32 v170, v170, v180
  v_mul_f32 v171, v171, v180
  v_cvt_pk_bf16_f32 v120, v168, v169
  v_mfma_f32_16x16x32_bf16 v[160:163], v[44:47], a[68:71], v[160:163]
  v_cvt_pk_bf16_f32 v121, v170, v171
  v_add_f32 v156, 0x358637bd, v156
  v_rcp_f32 v156, v156
  v_mfma_f32_16x16x32_bf16 v[172:175], v[84:87], a[44:47], 0
  s_add_u32 m0, s31, 3072
  s_add_u32 s44, s30, 221184
  buffer_load_dwordx4 v18, s[12:15], s44 offen lds
  v_add_f32 v157, 0x358637bd, v157
  v_rcp_f32 v157, v157
  v_add_f32 v158, 0x358637bd, v158
  v_mfma_f32_16x16x32_bf16 v[172:175], v[88:91], a[46:49], v[172:175]
  v_rcp_f32 v158, v158
  v_add_f32 v159, 0x358637bd, v159
  v_add_f32 v160, 0x358637bd, v160
  v_mfma_f32_16x16x32_bf16 v[176:179], v[92:95], a[46:49], 0
  v_rcp_f32 v159, v159
  v_rcp_f32 v160, v160
  v_mfma_f32_16x16x32_bf16 v[176:179], v[96:99], a[48:51], v[176:179]
  buffer_load_dwordx4 v19, s[12:15], s44 offen offset:1024 lds
  v_add_f32 v161, 0x358637bd, v161
  v_rcp_f32 v161, v161
  v_add_f32 v162, 0x358637bd, v162
  v_mfma_f32_16x16x32_bf16 v[164:167], v[100:103], a[48:51], 0
  v_rcp_f32 v162, v162
  v_add_f32 v163, 0x358637bd, v163
  v_cndmask_b32 v181, v153, v152, s[56:57]
  v_mfma_f32_16x16x32_bf16 v[164:167], v[104:107], a[50:53], v[164:167]
  v_rcp_f32 v163, v163
  v_mul_f32 v172, v172, v181
  v_mul_f32 v173, v173, v181
  v_mfma_f32_16x16x32_bf16 v[168:171], v[108:111], a[50:53], 0
  buffer_load_dwordx4 v20, s[12:15], s44 offen offset:2048 lds
  v_cndmask_b32 v182, v153, v152, s[54:55]
  v_mul_f32 v174, v174, v182
  v_mul_f32 v175, v175, v182
  v_cvt_pk_bf16_f32 v122, v172, v173
  v_cvt_pk_bf16_f32 v123, v174, v175
  v_mfma_f32_16x16x32_bf16 v[172:175], v[48:51], a[54:57], 0
  v_cndmask_b32 v183, v154, v153, s[56:57]
  v_mul_f32 v176, v176, v183
  v_mfma_f32_16x16x32_bf16 v[184:187], a[72:75], v[112:115], 0
  v_mul_f32 v177, v177, v183
  v_mul_f32 v178, v178, v183
  v_mfma_f32_16x16x32_bf16 v[188:191], a[76:79], v[112:115], 0
  s_add_u32 m0, s31, 6144
  s_add_u32 s44, s30, 442368
  buffer_load_dwordx4 v18, s[12:15], s44 offen lds
  v_mul_f32 v179, v179, v183
  v_cvt_pk_bf16_f32 v124, v176, v177
  v_cvt_pk_bf16_f32 v125, v178, v179
  v_mfma_f32_16x16x32_bf16 v[176:179], v[52:55], a[54:57], 0
  v_mul_f32 v164, v164, v154
  v_mul_f32 v165, v165, v154
  v_mfma_f32_16x16x32_bf16 v[192:195], a[80:83], v[112:115], 0
  v_cndmask_b32 v180, v155, v154, s[56:57]
  v_mul_f32 v166, v166, v180
  v_mfma_f32_16x16x32_bf16 v[176:179], v[56:59], a[56:59], v[176:179]
  v_mul_f32 v167, v167, v180
  v_cvt_pk_bf16_f32 v126, v164, v165
  v_mfma_f32_16x16x32_bf16 v[196:199], a[84:87], v[112:115], 0
  buffer_load_dwordx4 v19, s[12:15], s44 offen offset:1024 lds
  v_cvt_pk_bf16_f32 v127, v166, v167
  v_mul_f32 v168, v168, v155
  v_mfma_f32_16x16x32_bf16 v[164:167], v[60:63], a[56:59], 0
  v_mul_f32 v169, v169, v155
  v_mul_f32 v170, v170, v155
  v_mfma_f32_16x16x32_bf16 v[200:203], a[88:91], v[112:115], 0
  v_mul_f32 v171, v171, v155
  v_cvt_pk_bf16_f32 v128, v168, v169
  v_mfma_f32_16x16x32_bf16 v[204:207], a[92:95], v[112:115], 0
  v_cvt_pk_bf16_f32 v129, v170, v171
  v_mul_f32 v172, v172, v156
  v_mfma_f32_16x16x32_bf16 v[164:167], v[64:67], a[58:61], v[164:167]
  buffer_load_dwordx4 v20, s[12:15], s44 offen offset:2048 lds
  v_mul_f32 v173, v173, v156
  v_mul_f32 v174, v174, v156
  v_mfma_f32_16x16x32_bf16 a[220:223], a[180:183], v[112:115], 0
  v_mul_f32 v175, v175, v156
  v_cvt_pk_bf16_f32 v130, v172, v173
  v_mfma_f32_16x16x32_bf16 v[168:171], v[68:71], a[58:61], 0
  v_cvt_pk_bf16_f32 v131, v174, v175
  v_cndmask_b32 v181, v157, v156, s[52:53]
  v_mfma_f32_16x16x32_bf16 v[184:187], a[96:99], v[116:119], v[184:187]
  v_mul_f32 v176, v176, v181
  v_mul_f32 v177, v177, v181
  s_waitcnt vmcnt(13)
  v_mfma_f32_16x16x32_bf16 v[148:151], v[24:27], a[0:3], 0
  v_mul_f32 v178, v178, v157
  v_mul_f32 v179, v179, v157
  v_mfma_f32_16x16x32_bf16 v[188:191], a[100:103], v[116:119], v[188:191]
  v_cvt_pk_bf16_f32 v132, v176, v177
  v_cvt_pk_bf16_f32 v133, v178, v179
  v_mfma_f32_16x16x32_bf16 v[148:151], v[28:31], a[4:7], v[148:151]
  v_cndmask_b32 v182, v158, v157, s[52:53]
  v_mul_f32 v164, v164, v182
  v_mfma_f32_16x16x32_bf16 v[192:195], a[104:107], v[116:119], v[192:195]
  s_add_u32 m0, s31, 36864
  s_add_u32 s44, s39, 0
  buffer_load_dwordx4 v16, s[12:15], s44 offen lds
  v_mul_f32 v165, v165, v182
  v_mul_f32 v166, v166, v182
  v_mfma_f32_16x16x32_bf16 v[196:199], a[108:111], v[116:119], v[196:199]
  v_mul_f32 v167, v167, v182
  v_cvt_pk_bf16_f32 v134, v164, v165
  v_mfma_f32_16x16x32_bf16 v[148:151], v[32:35], a[8:11], v[148:151]
  v_cvt_pk_bf16_f32 v135, v166, v167
  v_mfma_f32_16x16x32_bf16 v[200:203], a[112:115], v[116:119], v[200:203]
  v_mfma_f32_16x16x32_bf16 v[152:155], v[36:39], a[8:11], 0
  v_mfma_f32_16x16x32_bf16 v[204:207], a[116:119], v[116:119], v[204:207]
  v_mfma_f32_16x16x32_bf16 v[152:155], v[40:43], a[12:15], v[152:155]
  v_mfma_f32_16x16x32_bf16 a[220:223], a[184:187], v[116:119], a[220:223]
  v_mfma_f32_16x16x32_bf16 v[152:155], v[44:47], a[14:17], v[152:155]
  v_mfma_f32_16x16x32_bf16 v[184:187], a[120:123], v[120:123], v[184:187]
  v_mfma_f32_16x16x32_bf16 v[188:191], a[124:127], v[120:123], v[188:191]
  v_add_f32 v148, 0x358637bd, v148
  v_add_f32 v149, 0x358637bd, v149
  v_mfma_f32_16x16x32_bf16 v[168:171], v[72:75], a[60:63], v[168:171]
  v_rcp_f32 v148, v148
  v_mfma_f32_16x16x32_bf16 v[192:195], a[128:131], v[120:123], v[192:195]
  v_rcp_f32 v149, v149
  v_mfma_f32_16x16x32_bf16 v[172:175], v[76:79], a[60:63], 0
  buffer_load_dwordx4 v17, s[12:15], s44 offen offset:1024 lds
  v_add_f32 v150, 0x358637bd, v150
  v_add_f32 v151, 0x358637bd, v151
  v_mfma_f32_16x16x32_bf16 v[196:199], a[132:135], v[120:123], v[196:199]
  v_rcp_f32 v150, v150
  v_mfma_f32_16x16x32_bf16 v[172:175], v[80:83], a[62:65], v[172:175]
  v_rcp_f32 v151, v151
  v_mfma_f32_16x16x32_bf16 v[200:203], a[136:139], v[120:123], v[200:203]
  v_add_f32 v152, 0x358637bd, v152
  v_add_f32 v153, 0x358637bd, v153
  v_mfma_f32_16x16x32_bf16 v[204:207], a[140:143], v[120:123], v[204:207]
  v_rcp_f32 v152, v152
  v_mfma_f32_16x16x32_bf16 v[176:179], v[84:87], a[62:65], 0
  v_rcp_f32 v153, v153
  v_mfma_f32_16x16x32_bf16 a[220:223], a[188:191], v[120:123], a[220:223]
  v_add_f32 v154, 0x358637bd, v154
  v_add_f32 v155, 0x358637bd, v155
  v_mfma_f32_16x16x32_bf16 v[176:179], v[88:91], a[64:67], v[176:179]
  v_rcp_f32 v154, v154
  v_mfma_f32_16x16x32_bf16 v[184:187], a[144:147], v[124:127], v[184:187]
  v_rcp_f32 v155, v155
  v_mfma_f32_16x16x32_bf16 v[164:167], v[92:95], a[64:67], 0
  v_cndmask_b32 v183, v159, v158, s[54:55]
  v_mul_f32 v168, v168, v183
  v_mfma_f32_16x16x32_bf16 v[188:191], a[148:151], v[124:127], v[188:191]
  buffer_load_dwordx4 v23, s[12:15], s44 offen offset:2048 lds
  v_mul_f32 v169, v169, v183
  v_cndmask_b32 v180, v159, v158, s[52:53]
  v_mfma_f32_16x16x32_bf16 v[164:167], v[96:99], a[66:69], v[164:167]
  v_mul_f32 v170, v170, v180
  v_mul_f32 v171, v171, v180
  v_mfma_f32_16x16x32_bf16 v[192:195], a[152:155], v[124:127], v[192:195]
  v_cvt_pk_bf16_f32 v136, v168, v169
  v_cvt_pk_bf16_f32 v137, v170, v171
  v_mfma_f32_16x16x32_bf16 v[196:199], a[156:159], v[124:127], v[196:199]
  v_cndmask_b32 v181, v160, v159, s[54:55]
  v_mul_f32 v172, v172, v181
  v_mfma_f32_16x16x32_bf16 v[168:171], v[100:103], a[66:69], 0
  v_mul_f32 v173, v173, v181
  v_mul_f32 v174, v174, v181
  v_mfma_f32_16x16x32_bf16 v[200:203], a[160:163], v[124:127], v[200:203]
  v_mul_f32 v175, v175, v181
  v_cvt_pk_bf16_f32 v138, v172, v173
  v_mfma_f32_16x16x32_bf16 v[168:171], v[104:107], a[68:71], v[168:171]
  v_cvt_pk_bf16_f32 v139, v174, v175
  v_cndmask_b32 v182, v161, v160, s[56:57]
  v_mfma_f32_16x16x32_bf16 v[204:207], a[164:167], v[124:127], v[204:207]
  v_mul_f32 v176, v176, v182
  v_mul_f32 v177, v177, v182
  v_mfma_f32_16x16x32_bf16 v[172:175], v[108:111], a[68:71], 0
  s_add_u32 m0, s31, 39936
  s_add_u32 s44, s39, 442368
  buffer_load_dwordx4 v16, s[12:15], s44 offen lds
  v_cndmask_b32 v183, v161, v160, s[54:55]
  v_mul_f32 v178, v178, v183
  v_mfma_f32_16x16x32_bf16 a[220:223], a[192:195], v[124:127], a[220:223]
  v_mul_f32 v179, v179, v183
  v_cvt_pk_bf16_f32 v140, v176, v177
  v_mfma_f32_16x16x16_bf16 v[184:187], a[168:169], v[128:129], v[184:187]
  v_cvt_pk_bf16_f32 v141, v178, v179
  v_cndmask_b32 v180, v162, v161, s[56:57]
  v_mfma_f32_16x16x16_bf16 v[188:191], a[170:171], v[128:129], v[188:191]
  v_mul_f32 v164, v164, v180
  v_mul_f32 v165, v165, v180
  v_mfma_f32_16x16x16_bf16 v[192:195], a[172:173], v[128:129], v[192:195]
  v_mul_f32 v166, v166, v180
  v_mul_f32 v167, v167, v180
  v_mfma_f32_16x16x16_bf16 v[196:199], a[174:175], v[128:129], v[196:199]
  v_cvt_pk_bf16_f32 v142, v164, v165
  v_cvt_pk_bf16_f32 v143, v166, v167
  v_mfma_f32_16x16x16_bf16 v[200:203], a[176:177], v[128:129], v[200:203]
  v_mul_f32 v168, v168, v162
  v_mul_f32 v169, v169, v162
  v_mfma_f32_16x16x16_bf16 v[204:207], a[178:179], v[128:129], v[204:207]
  v_cndmask_b32 v181, v163, v162, s[56:57]
  v_mul_f32 v170, v170, v181
  v_mfma_f32_16x16x16_bf16 a[220:223], a[196:197], v[128:129], a[220:223]
  buffer_load_dwordx4 v17, s[12:15], s44 offen offset:1024 lds
  v_mul_f32 v171, v171, v181
  v_cvt_pk_bf16_f32 v144, v168, v169
  v_mfma_f32_16x16x32_bf16 v[176:179], v[48:51], a[0:3], 0
  v_cvt_pk_bf16_f32 v145, v170, v171
  v_mul_f32 v172, v172, v163
  v_mfma_f32_16x16x32_bf16 v[208:211], a[72:75], v[130:133], 0
  v_mul_f32 v173, v173, v163
  v_mul_f32 v174, v174, v163
  v_mfma_f32_16x16x32_bf16 v[212:215], a[76:79], v[130:133], 0
  v_mul_f32 v175, v175, v163
  v_cvt_pk_bf16_f32 v146, v172, v173
  v_mfma_f32_16x16x32_bf16 v[164:167], v[52:55], a[0:3], 0
  v_cvt_pk_bf16_f32 v147, v174, v175
  v_cvt_pk_bf16_f32 v184, v184, v185
  v_mfma_f32_16x16x32_bf16 v[216:219], a[80:83], v[130:133], 0
  v_cvt_pk_bf16_f32 v185, v186, v187
  ds_write_b64 v3, v[184:185] offset:6144
  v_mfma_f32_16x16x32_bf16 v[164:167], v[56:59], a[2:5], v[164:167]
  v_cvt_pk_bf16_f32 v188, v188, v189
  v_cvt_pk_bf16_f32 v189, v190, v191
  v_mfma_f32_16x16x32_bf16 v[220:223], a[84:87], v[130:133], 0
  ds_write_b64 v3, v[188:189] offset:6656
  v_cvt_pk_bf16_f32 v192, v192, v193
  v_mfma_f32_16x16x32_bf16 v[168:171], v[60:63], a[2:5], 0
  buffer_load_dwordx4 v23, s[12:15], s44 offen offset:2048 lds
  v_cvt_pk_bf16_f32 v193, v194, v195
  ds_write_b64 v3, v[192:193] offset:7168
  v_mfma_f32_16x16x32_bf16 v[224:227], a[88:91], v[130:133], 0
  v_cvt_pk_bf16_f32 v196, v196, v197
  v_cvt_pk_bf16_f32 v197, v198, v199
  v_mfma_f32_16x16x32_bf16 v[228:231], a[92:95], v[130:133], 0
  ds_write_b64 v3, v[196:197] offset:9216
  v_cvt_pk_bf16_f32 v200, v200, v201
  v_mfma_f32_16x16x32_bf16 v[168:171], v[64:67], a[4:7], v[168:171]
  v_cvt_pk_bf16_f32 v201, v202, v203
  ds_write_b64 v3, v[200:201] offset:9728
  v_mfma_f32_16x16x32_bf16 a[224:227], a[180:183], v[130:133], 0
  v_cvt_pk_bf16_f32 v204, v204, v205
  v_cvt_pk_bf16_f32 v205, v206, v207
  v_mfma_f32_16x16x32_bf16 v[172:175], v[68:71], a[4:7], 0
  ds_write_b64 v3, v[204:205] offset:10240
  v_mul_f32 v176, v176, v148
  v_mfma_f32_16x16x32_bf16 v[208:211], a[96:99], v[134:137], v[208:211]
  v_mul_f32 v177, v177, v148
  v_mul_f32 v178, v178, v148
  s_waitcnt vmcnt(15)
  v_mfma_f32_16x16x32_bf16 v[156:159], v[24:27], a[18:21], 0
  s_add_u32 m0, s31, 43008
  s_add_u32 s44, s39, 884736
  buffer_load_dwordx4 v16, s[12:15], s44 offen lds
  v_mul_f32 v179, v179, v148
  v_cvt_pk_bf16_f32 v112, v176, v177
  v_mfma_f32_16x16x32_bf16 v[212:215], a[100:103], v[134:137], v[212:215]
  v_cvt_pk_bf16_f32 v113, v178, v179
  v_cndmask_b32 v182, v149, v148, s[52:53]
  v_mfma_f32_16x16x32_bf16 v[156:159], v[28:31], a[22:25], v[156:159]
  v_mul_f32 v164, v164, v182
  v_mul_f32 v165, v165, v182
  v_mfma_f32_16x16x32_bf16 v[216:219], a[104:107], v[134:137], v[216:219]
HP_k2_p2:
  s_cbranch_execz HP_k2_ret
  v_mul_f32 v166, v166, v149
  v_mul_f32 v167, v167, v149
  v_mfma_f32_16x16x32_bf16 v[220:223], a[108:111], v[134:137], v[220:223]
  v_cvt_pk_bf16_f32 v114, v164, v165
  v_cvt_pk_bf16_f32 v115, v166, v167
  v_mfma_f32_16x16x32_bf16 v[156:159], v[32:35], a[26:29], v[156:159]
  v_cndmask_b32 v183, v150, v149, s[52:53]
  v_mul_f32 v168, v168, v183
  v_mfma_f32_16x16x32_bf16 v[224:227], a[112:115], v[134:137], v[224:227]
  v_mul_f32 v169, v169, v183
  v_mul_f32 v170, v170, v183
  v_mfma_f32_16x16x32_bf16 v[160:163], v[36:39], a[26:29], 0
  v_mul_f32 v171, v171, v183
  v_cvt_pk_bf16_f32 v116, v168, v169
  v_mfma_f32_16x16x32_bf16 v[228:231], a[116:119], v[134:137], v[228:231]
  buffer_load_dwordx4 v17, s[12:15], s44 offen offset:1024 lds
  v_cvt_pk_bf16_f32 v117, v170, v171
  v_add_f32 v156, 0x358637bd, v156
  v_mfma_f32_16x16x32_bf16 v[160:163], v[40:43], a[30:33], v[160:163]
  v_rcp_f32 v156, v156
  v_mfma_f32_16x16x32_bf16 a[224:227], a[184:187], v[134:137], a[224:227]
  v_add_f32 v157, 0x358637bd, v157
  v_add_f32 v158, 0x358637bd, v158
  v_mfma_f32_16x16x32_bf16 v[160:163], v[44:47], a[32:35], v[160:163]
  v_rcp_f32 v157, v157
  v_mfma_f32_16x16x32_bf16 v[208:211], a[120:123], v[138:141], v[208:211]
  v_rcp_f32 v158, v158
  v_mfma_f32_16x16x32_bf16 v[212:215], a[124:127], v[138:141], v[212:215]
  v_add_f32 v159, 0x358637bd, v159
  v_mfma_f32_16x16x32_bf16 v[172:175], v[72:75], a[6:9], v[172:175]
  v_rcp_f32 v159, v159
  v_mfma_f32_16x16x32_bf16 v[216:219], a[128:131], v[138:141], v[216:219]
  v_cndmask_b32 v180, v151, v150, s[54:55]
  v_add_f32 v160, 0x358637bd, v160
  v_mfma_f32_16x16x32_bf16 v[176:179], v[76:79], a[6:9], 0
  v_rcp_f32 v160, v160
  v_mfma_f32_16x16x32_bf16 v[220:223], a[132:135], v[138:141], v[220:223]
  v_add_f32 v161, 0x358637bd, v161
  v_add_f32 v162, 0x358637bd, v162
  v_mfma_f32_16x16x32_bf16 v[176:179], v[80:83], a[8:11], v[176:179]
  buffer_load_dwordx4 v23, s[12:15], s44 offen offset:2048 lds
  v_rcp_f32 v161, v161
  v_mfma_f32_16x16x32_bf16 v[224:227], a[136:139], v[138:141], v[224:227]
  v_rcp_f32 v162, v162
  v_mfma_f32_16x16x32_bf16 v[228:231], a[140:143], v[138:141], v[228:231]
  v_add_f32 v163, 0x358637bd, v163
  v_mul_f32 v172, v172, v180
  v_mfma_f32_16x16x32_bf16 v[164:167], v[84:87], a[8:11], 0
  v_rcp_f32 v163, v163
  v_mfma_f32_16x16x32_bf16 a[224:227], a[188:191], v[138:141], a[224:227]
  v_mul_f32 v173, v173, v180
  v_cndmask_b32 v181, v151, v150, s[52:53]
  v_mfma_f32_16x16x32_bf16 v[164:167], v[88:91], a[10:13], v[164:167]
  v_mul_f32 v174, v174, v181
  v_mul_f32 v175, v175, v181
  v_mfma_f32_16x16x32_bf16 v[208:211], a[144:147], v[142:145], v[208:211]
  v_cvt_pk_bf16_f32 v118, v172, v173
  v_cvt_pk_bf16_f32 v119, v174, v175
  v_mfma_f32_16x16x32_bf16 v[168:171], v[92:95], a[10:13], 0
  v_cndmask_b32 v182, v152, v151, s[54:55]
  v_mul_f32 v176, v176, v182
  v_mfma_f32_16x16x32_bf16 v[212:215], a[148:151], v[142:145], v[212:215]
  v_mul_f32 v177, v177, v182
  v_mul_f32 v178, v178, v182
  v_mfma_f32_16x16x32_bf16 v[168:171], v[96:99], a[12:15], v[168:171]
  s_add_u32 m0, s31, 73728
  s_add_u32 s44, s39, 2654208
  buffer_load_dwordx4 v16, s[12:15], s44 offen lds
  v_mul_f32 v179, v179, v182
  v_cvt_pk_bf16_f32 v120, v176, v177
  v_mfma_f32_16x16x32_bf16 v[216:219], a[152:155], v[142:145], v[216:219]
  v_cvt_pk_bf16_f32 v121, v178, v179
  v_cndmask_b32 v183, v153, v152, s[56:57]
  v_mfma_f32_16x16x32_bf16 v[220:223], a[156:159], v[142:145], v[220:223]
  v_mul_f32 v164, v164, v183
  v_mul_f32 v165, v165, v183
  v_mfma_f32_16x16x32_bf16 v[172:175], v[100:103], a[12:15], 0
  v_cndmask_b32 v180, v153, v152, s[54:55]
  v_mul_f32 v166, v166, v180
  v_mfma_f32_16x16x32_bf16 v[224:227], a[160:163], v[142:145], v[224:227]
  v_mul_f32 v167, v167, v180
  v_cvt_pk_bf16_f32 v122, v164, v165
  v_mfma_f32_16x16x32_bf16 v[172:175], v[104:107], a[14:17], v[172:175]
  v_cvt_pk_bf16_f32 v123, v166, v167
  v_cndmask_b32 v181, v154, v153, s[56:57]
  v_mfma_f32_16x16x32_bf16 v[228:231], a[164:167], v[142:145], v[228:231]
  v_mul_f32 v168, v168, v181
  v_mul_f32 v169, v169, v181
  v_mfma_f32_16x16x32_bf16 v[176:179], v[108:111], a[14:17], 0
  v_mul_f32 v170, v170, v181
  v_mul_f32 v171, v171, v181
  v_mfma_f32_16x16x32_bf16 a[224:227], a[192:195], v[142:145], a[224:227]
  buffer_load_dwordx4 v17, s[12:15], s44 offen offset:1024 lds
  v_cvt_pk_bf16_f32 v124, v168, v169
  v_cvt_pk_bf16_f32 v125, v170, v171
  v_mfma_f32_16x16x16_bf16 v[208:211], a[168:169], v[146:147], v[208:211]
  v_mul_f32 v172, v172, v154
  v_mul_f32 v173, v173, v154
  v_mfma_f32_16x16x16_bf16 v[212:215], a[170:171], v[146:147], v[212:215]
  v_cndmask_b32 v182, v155, v154, s[56:57]
  v_mul_f32 v174, v174, v182
  v_mfma_f32_16x16x16_bf16 v[216:219], a[172:173], v[146:147], v[216:219]
  v_mul_f32 v175, v175, v182
  v_cvt_pk_bf16_f32 v126, v172, v173
  v_mfma_f32_16x16x16_bf16 v[220:223], a[174:175], v[146:147], v[220:223]
  v_cvt_pk_bf16_f32 v127, v174, v175
  v_mul_f32 v176, v176, v155
  v_mfma_f32_16x16x16_bf16 v[224:227], a[176:177], v[146:147], v[224:227]
  v_mul_f32 v177, v177, v155
  v_mul_f32 v178, v178, v155
  v_mfma_f32_16x16x16_bf16 v[228:231], a[178:179], v[146:147], v[228:231]
  v_mul_f32 v179, v179, v155
  v_cvt_pk_bf16_f32 v128, v176, v177
  v_mfma_f32_16x16x16_bf16 a[224:227], a[196:197], v[146:147], a[224:227]
  v_cvt_pk_bf16_f32 v129, v178, v179
  v_cvt_pk_bf16_f32 v208, v208, v209
  v_mfma_f32_16x16x32_bf16 v[164:167], v[48:51], a[18:21], 0
  buffer_load_dwordx4 v23, s[12:15], s44 offen offset:2048 lds
  v_cvt_pk_bf16_f32 v209, v210, v211
  ds_write_b64 v3, v[208:209] offset:7680
  v_mfma_f32_16x16x32_bf16 v[232:235], a[72:75], v[112:115], 0
  v_cvt_pk_bf16_f32 v212, v212, v213
  v_cvt_pk_bf16_f32 v213, v214, v215
  v_mfma_f32_16x16x32_bf16 v[236:239], a[76:79], v[112:115], 0
  ds_write_b64 v3, v[212:213] offset:8192
  v_cvt_pk_bf16_f32 v216, v216, v217
  v_mfma_f32_16x16x32_bf16 v[168:171], v[52:55], a[18:21], 0
  v_cvt_pk_bf16_f32 v217, v218, v219
  ds_write_b64 v3, v[216:217] offset:8704
  v_mfma_f32_16x16x32_bf16 v[240:243], a[80:83], v[112:115], 0
  v_cvt_pk_bf16_f32 v220, v220, v221
  v_cvt_pk_bf16_f32 v221, v222, v223
  v_mfma_f32_16x16x32_bf16 v[196:199], a[84:87], v[112:115], 0
  ds_write_b64 v3, v[220:221] offset:10752
  v_cvt_pk_bf16_f32 v224, v224, v225
  v_mfma_f32_16x16x32_bf16 v[168:171], v[56:59], a[20:23], v[168:171]
  v_cvt_pk_bf16_f32 v225, v226, v227
  ds_write_b64 v3, v[224:225] offset:11264
  v_mfma_f32_16x16x32_bf16 v[200:203], a[88:91], v[112:115], 0
  v_cvt_pk_bf16_f32 v228, v228, v229
  v_cvt_pk_bf16_f32 v229, v230, v231
  v_mfma_f32_16x16x32_bf16 v[204:207], a[92:95], v[112:115], 0
  s_add_u32 m0, s31, 76800
  s_add_u32 s44, s39, 3096576
  buffer_load_dwordx4 v16, s[12:15], s44 offen lds
  ds_write_b64 v3, v[228:229] offset:11776
  v_mul_f32 v164, v164, v156
  v_mfma_f32_16x16x32_bf16 v[172:175], v[60:63], a[20:23], 0
  v_mul_f32 v165, v165, v156
  v_mul_f32 v166, v166, v156
  v_mfma_f32_16x16x32_bf16 a[212:215], a[180:183], v[112:115], 0
  v_mul_f32 v167, v167, v156
  v_cvt_pk_bf16_f32 v130, v164, v165
  v_mfma_f32_16x16x32_bf16 v[172:175], v[64:67], a[22:25], v[172:175]
  v_cvt_pk_bf16_f32 v131, v166, v167
  v_cndmask_b32 v183, v157, v156, s[52:53]
  v_mfma_f32_16x16x32_bf16 v[232:235], a[96:99], v[116:119], v[232:235]
  v_mul_f32 v168, v168, v183
  v_mul_f32 v169, v169, v183
  v_mfma_f32_16x16x32_bf16 v[236:239], a[100:103], v[116:119], v[236:239]
  v_mul_f32 v170, v170, v157
  v_mul_f32 v171, v171, v157
  v_mfma_f32_16x16x32_bf16 v[176:179], v[68:71], a[22:25], 0
  v_cvt_pk_bf16_f32 v132, v168, v169
  v_cvt_pk_bf16_f32 v133, v170, v171
  v_mfma_f32_16x16x32_bf16 v[240:243], a[104:107], v[116:119], v[240:243]
  v_cndmask_b32 v180, v158, v157, s[52:53]
  v_mul_f32 v172, v172, v180
  v_mfma_f32_16x16x32_bf16 v[196:199], a[108:111], v[116:119], v[196:199]
  buffer_load_dwordx4 v17, s[12:15], s44 offen offset:1024 lds
  v_mul_f32 v173, v173, v180
  v_mul_f32 v174, v174, v180
  v_mfma_f32_16x16x32_bf16 v[176:179], v[72:75], a[24:27], v[176:179]
  v_mul_f32 v175, v175, v180
  v_cvt_pk_bf16_f32 v134, v172, v173
  v_mfma_f32_16x16x32_bf16 v[200:203], a[112:115], v[116:119], v[200:203]
  v_cvt_pk_bf16_f32 v135, v174, v175
  v_cndmask_b32 v181, v159, v158, s[54:55]
  v_mfma_f32_16x16x32_bf16 v[204:207], a[116:119], v[116:119], v[204:207]
  v_cndmask_b32 v182, v159, v158, s[52:53]
  v_mfma_f32_16x16x32_bf16 v[164:167], v[76:79], a[24:27], 0
  v_mfma_f32_16x16x32_bf16 a[212:215], a[184:187], v[116:119], a[212:215]
  v_mul_f32 v176, v176, v181
  v_mul_f32 v177, v177, v181
  v_mfma_f32_16x16x32_bf16 v[164:167], v[80:83], a[26:29], v[164:167]
  v_mul_f32 v178, v178, v182
  v_mul_f32 v179, v179, v182
  v_mfma_f32_16x16x32_bf16 v[232:235], a[120:123], v[120:123], v[232:235]
  v_cvt_pk_bf16_f32 v136, v176, v177
  v_cvt_pk_bf16_f32 v137, v178, v179
  v_mfma_f32_16x16x32_bf16 v[236:239], a[124:127], v[120:123], v[236:239]
  v_cndmask_b32 v183, v160, v159, s[54:55]
  v_mfma_f32_16x16x32_bf16 v[168:171], v[84:87], a[26:29], 0
  buffer_load_dwordx4 v23, s[12:15], s44 offen offset:2048 lds
  v_mul_f32 v164, v164, v183
  v_mul_f32 v165, v165, v183
  v_mfma_f32_16x16x32_bf16 v[240:243], a[128:131], v[120:123], v[240:243]
  v_mul_f32 v166, v166, v183
  v_mul_f32 v167, v167, v183
  v_mfma_f32_16x16x32_bf16 v[196:199], a[132:135], v[120:123], v[196:199]
  v_cvt_pk_bf16_f32 v138, v164, v165
  v_cvt_pk_bf16_f32 v139, v166, v167
  v_mfma_f32_16x16x32_bf16 v[168:171], v[88:91], a[28:31], v[168:171]
  v_cndmask_b32 v180, v161, v160, s[56:57]
  v_cndmask_b32 v181, v161, v160, s[54:55]
  v_mfma_f32_16x16x32_bf16 v[200:203], a[136:139], v[120:123], v[200:203]
  v_mfma_f32_16x16x32_bf16 v[204:207], a[140:143], v[120:123], v[204:207]
  v_mfma_f32_16x16x32_bf16 v[172:175], v[92:95], a[28:31], 0
  v_mfma_f32_16x16x32_bf16 a[212:215], a[188:191], v[120:123], a[212:215]
  v_mfma_f32_16x16x32_bf16 v[172:175], v[96:99], a[30:33], v[172:175]
  v_cndmask_b32 v182, v162, v161, s[56:57]
  v_mfma_f32_16x16x32_bf16 v[232:235], a[144:147], v[124:127], v[232:235]
  v_mul_f32 v168, v168, v180
  v_mul_f32 v169, v169, v180
  v_mfma_f32_16x16x32_bf16 v[236:239], a[148:151], v[124:127], v[236:239]
  v_mul_f32 v170, v170, v181
  v_mul_f32 v171, v171, v181
  v_mfma_f32_16x16x32_bf16 v[176:179], v[100:103], a[30:33], 0
  s_add_u32 m0, s31, 79872
  s_add_u32 s44, s39, 3538944
  buffer_load_dwordx4 v16, s[12:15], s44 offen lds
  v_cvt_pk_bf16_f32 v140, v168, v169
  v_cvt_pk_bf16_f32 v141, v170, v171
  v_mfma_f32_16x16x32_bf16 v[240:243], a[152:155], v[124:127], v[240:243]
  v_mul_f32 v172, v172, v182
  v_mul_f32 v173, v173, v182
  v_mfma_f32_16x16x32_bf16 v[196:199], a[156:159], v[124:127], v[196:199]
  v_mul_f32 v174, v174, v182
  v_mul_f32 v175, v175, v182
  v_mfma_f32_16x16x32_bf16 v[176:179], v[104:107], a[32:35], v[176:179]
  v_cvt_pk_bf16_f32 v142, v172, v173
  v_cvt_pk_bf16_f32 v143, v174, v175
  v_mfma_f32_16x16x32_bf16 v[200:203], a[160:163], v[124:127], v[200:203]
  v_cndmask_b32 v183, v163, v162, s[56:57]
  v_mfma_f32_16x16x32_bf16 v[204:207], a[164:167], v[124:127], v[204:207]
  v_mfma_f32_16x16x32_bf16 v[164:167], v[108:111], a[32:35], 0
  v_mfma_f32_16x16x32_bf16 a[212:215], a[192:195], v[124:127], a[212:215]
  v_mfma_f32_16x16x16_bf16 v[232:235], a[168:169], v[128:129], v[232:235]
  v_mfma_f32_16x16x16_bf16 v[232:235], v[6:7], a[200:201], v[232:235]
  v_mul_f32 v176, v176, v162
  v_mul_f32 v177, v177, v162
  v_mfma_f32_16x16x16_bf16 v[236:239], a[170:171], v[128:129], v[236:239]
  v_mul_f32 v178, v178, v183
  v_mul_f32 v179, v179, v183
  v_mfma_f32_16x16x16_bf16 v[236:239], v[6:7], a[204:205], v[236:239]
  buffer_load_dwordx4 v17, s[12:15], s44 offen offset:1024 lds
  v_cvt_pk_bf16_f32 v144, v176, v177
  v_cvt_pk_bf16_f32 v145, v178, v179
  v_mfma_f32_16x16x16_bf16 v[240:243], a[172:173], v[128:129], v[240:243]
  v_mul_f32 v164, v164, v163
  v_mul_f32 v165, v165, v163
  v_mfma_f32_16x16x16_bf16 v[240:243], v[6:7], a[208:209], v[240:243]
  v_mul_f32 v166, v166, v163
  v_mul_f32 v167, v167, v163
  v_mfma_f32_16x16x16_bf16 v[196:199], a[174:175], v[128:129], v[196:199]
  v_cvt_pk_bf16_f32 v146, v164, v165
  v_cvt_pk_bf16_f32 v147, v166, v167
  v_mfma_f32_16x16x16_bf16 v[200:203], a[176:177], v[128:129], v[200:203]
  v_mfma_f32_16x16x16_bf16 v[204:207], a[178:179], v[128:129], v[204:207]
  v_mfma_f32_16x16x16_bf16 a[212:215], a[196:197], v[128:129], a[212:215]
  v_mfma_f32_16x16x32_bf16 a[216:219], a[180:183], v[130:133], 0
  v_mfma_f32_16x16x32_bf16 v[220:223], a[84:87], v[130:133], 0
  v_mfma_f32_16x16x32_bf16 v[224:227], a[88:91], v[130:133], 0
  v_mfma_f32_16x16x32_bf16 v[228:231], a[92:95], v[130:133], 0
  v_cvt_pk_bf16_f32 v196, v196, v197
  v_cvt_pk_bf16_f32 v197, v198, v199
  v_mfma_f32_16x16x32_bf16 a[216:219], a[184:187], v[134:137], a[216:219]
  ds_write_b64 v3, v[196:197] offset:3072
  v_cvt_pk_bf16_f32 v200, v200, v201
  v_mfma_f32_16x16x32_bf16 v[220:223], a[108:111], v[134:137], v[220:223]
  buffer_load_dwordx4 v23, s[12:15], s44 offen offset:2048 lds
  v_cvt_pk_bf16_f32 v201, v202, v203
  ds_write_b64 v3, v[200:201] offset:3584
  v_mfma_f32_16x16x32_bf16 v[224:227], a[112:115], v[134:137], v[224:227]
  v_cvt_pk_bf16_f32 v204, v204, v205
  v_cvt_pk_bf16_f32 v205, v206, v207
  v_mfma_f32_16x16x32_bf16 v[228:231], a[116:119], v[134:137], v[228:231]
  ds_write_b64 v3, v[204:205] offset:4096
  v_mfma_f32_16x16x32_bf16 a[216:219], a[188:191], v[138:141], a[216:219]
  v_mfma_f32_16x16x32_bf16 v[220:223], a[132:135], v[138:141], v[220:223]
  v_mfma_f32_16x16x32_bf16 v[224:227], a[136:139], v[138:141], v[224:227]
  v_mfma_f32_16x16x32_bf16 v[228:231], a[140:143], v[138:141], v[228:231]
  v_mfma_f32_16x16x32_bf16 a[216:219], a[192:195], v[142:145], a[216:219]
  v_mfma_f32_16x16x32_bf16 v[220:223], a[156:159], v[142:145], v[220:223]
  v_mfma_f32_16x16x32_bf16 v[224:227], a[160:163], v[142:145], v[224:227]
  v_mfma_f32_16x16x32_bf16 v[228:231], a[164:167], v[142:145], v[228:231]
  s_nop 2
  v_mfma_f32_16x16x16_bf16 a[216:219], a[196:197], v[146:147], a[216:219]
  v_mfma_f32_16x16x16_bf16 v[220:223], a[174:175], v[146:147], v[220:223]
  v_mfma_f32_16x16x16_bf16 v[224:227], a[176:177], v[146:147], v[224:227]
  v_mfma_f32_16x16x16_bf16 v[228:231], a[178:179], v[146:147], v[228:231]
  v_mfma_f32_16x16x32_bf16 v[244:247], a[72:75], v[130:133], 0
  v_accvgpr_read_b32 v16, a224
HP_k2_p3:
  s_cbranch_execz HP_k2_ret
  v_accvgpr_read_b32 v17, a220
  v_mfma_f32_16x16x32_bf16 v[248:251], a[76:79], v[130:133], 0
  v_cndmask_b32 v16, v16, v17, s[56:57]
  v_mfma_f32_16x16x32_bf16 v[252:255], a[80:83], v[130:133], 0
  v_accvgpr_read_b32 v17, a216
  v_cvt_pk_bf16_f32 v220, v220, v221
  v_mfma_f32_16x16x32_bf16 v[244:247], a[96:99], v[134:137], v[244:247]
  v_cvt_pk_bf16_f32 v221, v222, v223
  ds_write_b64 v3, v[220:221] offset:4608
  v_mfma_f32_16x16x32_bf16 v[248:251], a[100:103], v[134:137], v[248:251]
  v_cvt_pk_bf16_f32 v224, v224, v225
  v_cvt_pk_bf16_f32 v225, v226, v227
  v_mfma_f32_16x16x32_bf16 v[252:255], a[104:107], v[134:137], v[252:255]
  ds_write_b64 v3, v[224:225] offset:5120
  v_cvt_pk_bf16_f32 v228, v228, v229
  v_mfma_f32_16x16x32_bf16 v[244:247], a[120:123], v[138:141], v[244:247]
  v_cvt_pk_bf16_f32 v229, v230, v231
  ds_write_b64 v3, v[228:229] offset:5632
  v_mfma_f32_16x16x32_bf16 v[248:251], a[124:127], v[138:141], v[248:251]
  v_cndmask_b32 v16, v16, v17, s[54:55]
  v_accvgpr_read_b32 v17, a212
  v_mfma_f32_16x16x32_bf16 v[252:255], a[128:131], v[138:141], v[252:255]
  v_cndmask_b32 v16, v16, v17, s[52:53]
  ds_write_b32 v13, v16
  s_waitcnt lgkmcnt(0)
  s_barrier
  v_mfma_f32_16x16x32_bf16 v[244:247], a[144:147], v[142:145], v[244:247]
  ds_read2st64_b64 v[40:43], v8 offset0:6 offset1:7
  ds_read2st64_b64 v[44:47], v8 offset0:8 offset1:9
  v_mfma_f32_16x16x32_bf16 v[248:251], a[148:151], v[142:145], v[248:251]
  ds_read2st64_b64 v[48:51], v8 offset0:10 offset1:11
  ds_read2st64_b64 v[52:55], v9 offset0:12 offset1:13
  v_mfma_f32_16x16x32_bf16 v[252:255], a[152:155], v[142:145], v[252:255]
  ds_read2st64_b64 v[56:59], v9 offset0:14 offset1:15
  ds_read2st64_b64 v[60:63], v9 offset0:16 offset1:17
  v_mfma_f32_16x16x16_bf16 v[244:247], a[168:169], v[146:147], v[244:247]
  ds_read2st64_b64 v[64:67], v10 offset0:18 offset1:19
  ds_read2st64_b64 v[68:71], v10 offset0:20 offset1:21
  v_mfma_f32_16x16x16_bf16 v[244:247], v[6:7], a[202:203], v[244:247]
  ds_read2st64_b64 v[72:75], v10 offset0:22 offset1:23
  ds_read2st64_b32 v[104:105], v15 offset0:0 offset1:1
  v_mfma_f32_16x16x16_bf16 v[248:251], a[170:171], v[146:147], v[248:251]
  ds_read2st64_b32 v[106:107], v15 offset0:2 offset1:3
  v_mfma_f32_16x16x16_bf16 v[248:251], v[6:7], a[206:207], v[248:251]
  v_mfma_f32_16x16x16_bf16 v[252:255], a[172:173], v[146:147], v[252:255]
  v_mfma_f32_16x16x16_bf16 v[252:255], v[6:7], a[210:211], v[252:255]
  v_mov_b32 v13, 0x3f80
  v_mov_b32 v14, 0x3f800000
  v_mov_b32 v15, 0x3f803f80
  v_mov_b32 v8, 0
  v_mov_b32 v9, 0
  s_nop 2
  s_waitcnt lgkmcnt(0)
  v_dot2c_f32_bf16 v232, v40, v13
  v_dot2c_f32_bf16 v233, v40, v14
  v_dot2c_f32_bf16 v234, v41, v13
  v_dot2c_f32_bf16 v235, v41, v14
  v_dot2c_f32_bf16 v236, v42, v13
  v_dot2c_f32_bf16 v237, v42, v14
  v_dot2c_f32_bf16 v238, v43, v13
  v_dot2c_f32_bf16 v239, v43, v14
  v_dot2c_f32_bf16 v240, v44, v13
  v_dot2c_f32_bf16 v241, v44, v14
  v_dot2c_f32_bf16 v242, v45, v13
  v_dot2c_f32_bf16 v243, v45, v14
  v_dot2c_f32_bf16 v244, v46, v13
  v_dot2c_f32_bf16 v245, v46, v14
  v_dot2c_f32_bf16 v246, v47, v13
  v_dot2c_f32_bf16 v247, v47, v14
  v_dot2c_f32_bf16 v248, v48, v13
  v_dot2c_f32_bf16 v249, v48, v14
  v_dot2c_f32_bf16 v250, v49, v13
  v_dot2c_f32_bf16 v251, v49, v14
  v_dot2c_f32_bf16 v252, v50, v13
  v_dot2c_f32_bf16 v253, v50, v14
  v_dot2c_f32_bf16 v254, v51, v13
  v_dot2c_f32_bf16 v255, v51, v14
  v_dot2c_f32_bf16 v232, v52, v13
  v_dot2c_f32_bf16 v233, v52, v14
  v_dot2c_f32_bf16 v234, v53, v13
  v_dot2c_f32_bf16 v235, v53, v14
  v_dot2c_f32_bf16 v236, v54, v13
  v_dot2c_f32_bf16 v237, v54, v14
  v_dot2c_f32_bf16 v238, v55, v13
  v_dot2c_f32_bf16 v239, v55, v14
  v_dot2c_f32_bf16 v240, v56, v13
  v_dot2c_f32_bf16 v241, v56, v14
  v_dot2c_f32_bf16 v242, v57, v13
  v_dot2c_f32_bf16 v243, v57, v14
  v_dot2c_f32_bf16 v244, v58, v13
  v_dot2c_f32_bf16 v245, v58, v14
  v_dot2c_f32_bf16 v246, v59, v13
  v_dot2c_f32_bf16 v247, v59, v14
  v_dot2c_f32_bf16 v248, v60, v13
  v_dot2c_f32_bf16 v249, v60, v14
  v_dot2c_f32_bf16 v250, v61, v13
  v_dot2c_f32_bf16 v251, v61, v14
  v_dot2c_f32_bf16 v252, v62, v13
  v_dot2c_f32_bf16 v253, v62, v14
  v_dot2c_f32_bf16 v254, v63, v13
  v_dot2c_f32_bf16 v255, v63, v14
  v_dot2c_f32_bf16 v232, v64, v13
  v_dot2c_f32_bf16 v233, v64, v14
  v_dot2c_f32_bf16 v234, v65, v13
  v_dot2c_f32_bf16 v235, v65, v14
  v_dot2c_f32_bf16 v236, v66, v13
  v_dot2c_f32_bf16 v237, v66, v14
  v_dot2c_f32_bf16 v238, v67, v13
  v_dot2c_f32_bf16 v239, v67, v14
  v_dot2c_f32_bf16 v240, v68, v13
  v_dot2c_f32_bf16 v241, v68, v14
  v_dot2c_f32_bf16 v242, v69, v13
  v_dot2c_f32_bf16 v243, v69, v14
  v_dot2c_f32_bf16 v244, v70, v13
  v_dot2c_f32_bf16 v245, v70, v14
  v_dot2c_f32_bf16 v246, v71, v13
  v_dot2c_f32_bf16 v247, v71, v14
  v_dot2c_f32_bf16 v248, v72, v13
  v_dot2c_f32_bf16 v249, v72, v14
  v_dot2c_f32_bf16 v250, v73, v13
  v_dot2c_f32_bf16 v251, v73, v14
  v_dot2c_f32_bf16 v252, v74, v13
  v_dot2c_f32_bf16 v253, v74, v14
  v_dot2c_f32_bf16 v254, v75, v13
  v_dot2c_f32_bf16 v255, v75, v14
  v_pk_add_f32 v[104:105], v[104:105], v[106:107]
  v_add_f32 v1, v1, v104
  v_add_f32 v1, v1, v105
  v_cvt_pk_bf16_f32 v1, v1, v1
  v_and_b32 v1, 0xffff0000, v1
  v_xor_b32 v1, 0x80000000, v1
  v_cvt_pk_bf16_f32 v80, v232, v233
  v_cvt_pk_bf16_f32 v81, v234, v235
  v_cvt_pk_bf16_f32 v82, v244, v245
  v_cvt_pk_bf16_f32 v83, v246, v247
  v_cvt_pk_bf16_f32 v84, v236, v237
  v_cvt_pk_bf16_f32 v85, v238, v239
  v_cvt_pk_bf16_f32 v86, v248, v249
  v_cvt_pk_bf16_f32 v87, v250, v251
  v_cvt_pk_bf16_f32 v88, v240, v241
  v_cvt_pk_bf16_f32 v89, v242, v243
  v_cvt_pk_bf16_f32 v90, v252, v253
  v_cvt_pk_bf16_f32 v91, v254, v255
  v_permlane32_swap_b32 v80, v82
  v_permlane32_swap_b32 v81, v83
  v_permlane32_swap_b32 v84, v86
  v_permlane32_swap_b32 v85, v87
  v_permlane32_swap_b32 v88, v90
  v_permlane32_swap_b32 v89, v91
  buffer_store_dwordx4 v[80:83], v11, s[8:11], s3 offen sc0 sc1
  v_dot2c_f32_bf16 v8, v80, v15
  v_dot2c_f32_bf16 v9, v80, v80
  v_dot2c_f32_bf16 v8, v81, v15
  v_dot2c_f32_bf16 v9, v81, v81
  v_dot2c_f32_bf16 v8, v82, v15
  v_dot2c_f32_bf16 v9, v82, v82
  v_dot2c_f32_bf16 v8, v83, v15
  v_dot2c_f32_bf16 v9, v83, v83
  buffer_store_dwordx4 v[84:87], v11, s[8:11], s3 offen offset:1024 sc0 sc1
  v_dot2c_f32_bf16 v8, v84, v15
  v_dot2c_f32_bf16 v9, v84, v84
  v_dot2c_f32_bf16 v8, v85, v15
  v_dot2c_f32_bf16 v9, v85, v85
  v_dot2c_f32_bf16 v8, v86, v15
  v_dot2c_f32_bf16 v9, v86, v86
  v_dot2c_f32_bf16 v8, v87, v15
  v_dot2c_f32_bf16 v9, v87, v87
  buffer_store_dwordx4 v[88:91], v11, s[8:11], s3 offen offset:2048 sc0 sc1
  v_dot2c_f32_bf16 v8, v88, v15
  v_dot2c_f32_bf16 v9, v88, v88
  v_dot2c_f32_bf16 v8, v89, v15
  v_dot2c_f32_bf16 v9, v89, v89
  v_dot2c_f32_bf16 v8, v90, v15
  v_dot2c_f32_bf16 v9, v90, v90
  v_dot2c_f32_bf16 v8, v91, v15
  v_dot2c_f32_bf16 v9, v91, v91
  v_dot2_f32_bf16 v40, v80, v13, v1
  v_dot2_f32_bf16 v41, v80, v14, v1
  v_dot2_f32_bf16 v42, v81, v13, v1
  v_dot2_f32_bf16 v43, v81, v14, v1
  v_dot2_f32_bf16 v44, v82, v13, v1
  v_dot2_f32_bf16 v45, v82, v14, v1
  v_dot2_f32_bf16 v46, v83, v13, v1
  v_dot2_f32_bf16 v47, v83, v14, v1
  v_mov_b32 v6, v8
  v_mov_b32 v7, v9
  v_dot2_f32_bf16 v48, v84, v13, v1
  v_dot2_f32_bf16 v49, v84, v14, v1
  v_dot2_f32_bf16 v50, v85, v13, v1
  v_dot2_f32_bf16 v51, v85, v14, v1
  v_dot2_f32_bf16 v52, v86, v13, v1
  v_dot2_f32_bf16 v53, v86, v14, v1
  v_dot2_f32_bf16 v54, v87, v13, v1
  v_dot2_f32_bf16 v55, v87, v14, v1
  v_permlane16_swap_b32 v6, v8
  v_permlane16_swap_b32 v7, v9
  v_dot2_f32_bf16 v56, v88, v13, v1
  v_dot2_f32_bf16 v57, v88, v14, v1
  v_dot2_f32_bf16 v58, v89, v13, v1
  v_dot2_f32_bf16 v59, v89, v14, v1
  v_dot2_f32_bf16 v60, v90, v13, v1
  v_dot2_f32_bf16 v61, v90, v14, v1
  v_dot2_f32_bf16 v62, v91, v13, v1
  v_dot2_f32_bf16 v63, v91, v14, v1
  v_pk_add_f32 v[6:7], v[6:7], v[8:9]
  buffer_store_dwordx2 v[6:7], v12, s[8:11], s7 offen sc0 sc1
  v_cvt_pk_bf16_f32 v92, v40, v41
  v_cvt_pk_bf16_f32 v93, v42, v43
  v_cvt_pk_bf16_f32 v94, v44, v45
  v_cvt_pk_bf16_f32 v95, v46, v47
  buffer_store_dwordx4 v[92:95], v11, s[8:11], s4 offen sc0 sc1
  v_cvt_pk_bf16_f32 v96, v48, v49
  v_cvt_pk_bf16_f32 v97, v50, v51
  v_cvt_pk_bf16_f32 v98, v52, v53
  v_cvt_pk_bf16_f32 v99, v54, v55
  buffer_store_dwordx4 v[96:99], v11, s[8:11], s4 offen offset:1024 sc0 sc1
  v_cvt_pk_bf16_f32 v100, v56, v57
  v_cvt_pk_bf16_f32 v101, v58, v59
  v_cvt_pk_bf16_f32 v102, v60, v61
  v_cvt_pk_bf16_f32 v103, v62, v63
  buffer_store_dwordx4 v[100:103], v11, s[8:11], s4 offen offset:2048 sc0 sc1
  s_lshl_b32 s59, s36, 8
  s_add_u32 s59, s59, 2818048
  s_branch K2_done
F2_idle:
  s_waitcnt vmcnt(0) lgkmcnt(0)
  s_barrier
  s_and_b32 s3, s2, 3
  s_lshl_b32 s3, s3, 2
  s_bfe_u32 s44, s2, 0x20003
  s_add_u32 s3, s3, s44
  s_mul_i32 s30, s3, 576
  s_and_b32 s3, s3, 1
  s_xor_b32 s39, s3, 1
  s_lshl_b32 s39, s39, 9
  s_add_u32 s39, s39, s30
  s_lshl_b32 s3, s3, 6
  s_add_u32 s30, s30, s3
  s_and_b32 s3, s34, 1
  s_mul_i32 s3, s3, 663552
  s_add_u32 s30, s30, s3
  s_add_u32 s39, s39, s3
  s_add_u32 s39, s39, s3
  v_lshrrev_b32 v16, 2, v2
  v_mul_u32_u24 v16, 9216, v16
  v_and_b32 v17, 3, v2
  v_lshl_add_u32 v16, v17, 4, v16
  v_add_u32 v17, 146432, v16
  v_add_u32 v23, 292864, v16
  s_mul_i32 s31, s34, 9216
  v_bfe_u32 v18, v2, 2, 3
  v_mul_u32_u24 v18, 9216, v18
  v_and_b32 v19, 3, v2
  v_lshl_add_u32 v18, v19, 4, v18
  v_lshrrev_b32 v19, 5, v2
  v_lshl_add_u32 v18, v19, 6, v18
  v_add_u32 v19, 72704, v18
  v_add_u32 v20, 145408, v18
  s_mov_b32 s52, s12
  s_and_b32 s53, s13, 0xffff
  s_mov_b32 s54, 5308416
  s_mov_b32 s55, 0x20000
  s_mov_b32 s56, s14
  s_and_b32 s57, s15, 0xffff
  s_mov_b32 s58, 5308416
  s_mov_b32 s59, 0x20000
  s_and_b32 s5, s2, 7
  s_lshr_b32 s6, s5, 2
  s_and_b32 s5, s5, 3
  s_lshl_b32 s5, s5, 1
  s_add_u32 s5, s5, s6
  s_mul_i32 s5, s5, 1152
  s_bfe_u32 s6, s2, 0x30003
  s_mul_i32 s6, s6, 663552
  s_add_u32 s5, s5, s6
  v_mul_u32_u24 v4, 911, v0
  v_lshrrev_b32 v4, 16, v4
  v_mul_u32_u24 v3, 72, v4
  v_sub_u32 v3, v0, v3
  v_mul_u32_u24 v3, 9216, v3
  v_mov_b32 v12, 1073741824
  v_cmp_eq_u32 vcc, 0, v4
  v_add_u32 v13, 128, v3
  s_nop 0
  v_cndmask_b32 v12, v12, v13, vcc
  v_cmp_eq_u32 vcc, 1, v4
  v_add_u32 v13, 768, v3
  s_nop 0
  v_cndmask_b32 v12, v12, v13, vcc
  v_cmp_eq_u32 vcc, 2, v4
  v_add_u32 v13, 256, v3
  s_nop 0
  v_cndmask_b32 v12, v12, v13, vcc
  buffer_load_dword v244, v12, s[52:55], s5 offen
  buffer_load_dword v245, v12, s[56:59], s5 offen
  v_mov_b32 v12, 1073741824
  v_cmp_eq_u32 vcc, 0, v4
  v_add_u32 v13, 896, v3
  s_nop 0
  v_cndmask_b32 v12, v12, v13, vcc
  v_cmp_eq_u32 vcc, 1, v4
  v_add_u32 v13, 384, v3
  s_nop 0
  v_cndmask_b32 v12, v12, v13, vcc
  v_cmp_eq_u32 vcc, 2, v4
  v_add_u32 v13, 1024, v3
  s_nop 0
  v_cndmask_b32 v12, v12, v13, vcc
  buffer_load_dword v244, v12, s[52:55], s5 offen
  buffer_load_dword v245, v12, s[56:59], s5 offen
  s_cmp_lt_u32 s34, 2
  s_cselect_b32 s12, s12, s14
  s_cselect_b32 s13, s13, s15
  s_and_b32 s13, s13, 0xffff
  s_mov_b32 s14, 5308416
  s_mov_b32 s15, 0x20000
  s_add_u32 m0, s31, 0
  s_add_u32 s44, s30, 0
  buffer_load_dwordx4 v18, s[12:15], s44 offen lds
  buffer_load_dwordx4 v19, s[12:15], s44 offen offset:1024 lds
  buffer_load_dwordx4 v20, s[12:15], s44 offen offset:2048 lds
  s_add_u32 m0, s31, 3072
  s_add_u32 s44, s30, 221184
  buffer_load_dwordx4 v18, s[12:15], s44 offen lds
  buffer_load_dwordx4 v19, s[12:15], s44 offen offset:1024 lds
  buffer_load_dwordx4 v20, s[12:15], s44 offen offset:2048 lds
  s_add_u32 m0, s31, 6144
  s_add_u32 s44, s30, 442368
  buffer_load_dwordx4 v18, s[12:15], s44 offen lds
  buffer_load_dwordx4 v19, s[12:15], s44 offen offset:1024 lds
  buffer_load_dwordx4 v20, s[12:15], s44 offen offset:2048 lds
  s_add_u32 m0, s31, 36864
  s_add_u32 s44, s39, 0
  buffer_load_dwordx4 v16, s[12:15], s44 offen lds
  buffer_load_dwordx4 v17, s[12:15], s44 offen offset:1024 lds
  buffer_load_dwordx4 v23, s[12:15], s44 offen offset:2048 lds
  s_add_u32 m0, s31, 39936
  s_add_u32 s44, s39, 442368
  buffer_load_dwordx4 v16, s[12:15], s44 offen lds
  buffer_load_dwordx4 v17, s[12:15], s44 offen offset:1024 lds
  buffer_load_dwordx4 v23, s[12:15], s44 offen offset:2048 lds
  s_add_u32 m0, s31, 43008
  s_add_u32 s44, s39, 884736
HP_k2_p4:
  s_cbranch_execz HP_k2_ret
  buffer_load_dwordx4 v16, s[12:15], s44 offen lds
  buffer_load_dwordx4 v17, s[12:15], s44 offen offset:1024 lds
  buffer_load_dwordx4 v23, s[12:15], s44 offen offset:2048 lds
  s_add_u32 m0, s31, 73728
  s_add_u32 s44, s39, 2654208
  buffer_load_dwordx4 v16, s[12:15], s44 offen lds
  buffer_load_dwordx4 v17, s[12:15], s44 offen offset:1024 lds
  buffer_load_dwordx4 v23, s[12:15], s44 offen offset:2048 lds
  s_add_u32 m0, s31, 76800
  s_add_u32 s44, s39, 3096576
  buffer_load_dwordx4 v16, s[12:15], s44 offen lds
  buffer_load_dwordx4 v17, s[12:15], s44 offen offset:1024 lds
  buffer_load_dwordx4 v23, s[12:15], s44 offen offset:2048 lds
  s_add_u32 m0, s31, 79872
  s_add_u32 s44, s39, 3538944
  buffer_load_dwordx4 v16, s[12:15], s44 offen lds
  buffer_load_dwordx4 v17, s[12:15], s44 offen offset:1024 lds
  buffer_load_dwordx4 v23, s[12:15], s44 offen offset:2048 lds
  s_mov_b32 s59, -1
K2_done:
  s_mov_b32 s23, s59
  s_mov_b64 s[26:27], s[42:43]
  s_mov_b64 s[44:45], s[40:41]
  s_mov_b64 s[40:41], s[12:13]
  v_lshrrev_b32 v1, 6, v0
  v_and_b32 v2, 63, v0
  s_bfe_u32 s29, s2, 0x10002
  s_lshl_b32 s29, s29, 3
  s_lshr_b32 s5, s2, 5
  s_add_u32 s29, s29, s5
  s_and_b32 s28, s2, 3
  s_lshl_b32 s28, s28, 2
  s_bfe_u32 s5, s2, 0x20003
  s_add_u32 s28, s28, s5
  v_readfirstlane_b32 s30, v1
  v_lshlrev_b32 v37, 4, v2
  v_bfe_u32 v3, v2, 2, 3
  v_and_b32 v208, 3, v2
  v_lshlrev_b32 v208, 4, v208
  v_lshrrev_b32 v209, 5, v2
  v_lshl_add_u32 v209, v209, 6, v208
  s_mul_i32 s31, s30, 9216
  s_and_b32 s3, s28, 1
  s_mul_i32 s6, s28, 576
  s_lshl_b32 s7, s3, 6
  s_add_u32 s32, s6, s7
  s_and_b32 s4, s30, 1
  s_mul_i32 s5, s4, 663552
  s_add_u32 s32, s32, s5
  v_mul_u32_u24 v1, 9216, v3
  v_add_u32 v8, v1, v209
  v_add_u32 v9, 72704, v8
  v_add_u32 v10, 145408, v8
  v_add_u32 v11, 221184, v8
  v_add_u32 v12, 293888, v8
  v_add_u32 v13, 366592, v8
  v_add_u32 v14, 442368, v8
  v_add_u32 v15, 515072, v8
  v_add_u32 v16, 587776, v8
  s_lshl_b32 s5, s29, 2
  s_add_u32 s5, s5, s30
  s_mul_i32 s35, s5, 36864
  s_add_u32 s20, s35, 6291456
  v_lshrrev_b32 v1, 5, v2
  v_lshlrev_b32 v1, 8, v1
  v_bfe_u32 v44, v2, 2, 2
  v_lshl_add_u32 v1, v44, 6, v1
  v_bfe_u32 v44, v2, 4, 1
  v_lshl_add_u32 v1, v44, 5, v1
  v_and_b32 v44, 3, v2
  v_lshl_add_u32 v4, v44, 3, v1
  v_add_u32 v5, 36864, v4
  v_add_u32 v6, 73728, v4
  v_add_u32 v7, 110592, v4
  s_mov_b32 s8, s40
  s_and_b32 s9, s41, 0xffff
  s_mov_b32 s10, 5308416
  s_mov_b32 s11, 0x20000
  s_mov_b32 s16, s46
  s_and_b32 s17, s47, 0xffff
  s_mov_b32 s18, 268435456
  s_mov_b32 s19, 0x20000
  s_lshl_b32 s52, s5, 8
  v_and_b32 v39, 31, v2
  v_lshlrev_b32 v39, 3, v39
  v_lshrrev_b32 v1, 5, v2
  v_mul_u32_u24 v1, 98304, v1
  v_add_u32 v39, v39, v1
  s_sub_u32 s12, s44, 4096
  s_subb_u32 s13, s45, 0
  s_and_b32 s13, s13, 0xffff
  s_mov_b32 s14, 5312512
  s_mov_b32 s15, 0x20000
  s_xor_b32 s7, s3, 1
  s_lshl_b32 s7, s7, 9
  s_add_u32 s33, s6, s7
  s_mul_i32 s4, s4, 1327104
  s_add_u32 s33, s33, s4
  v_lshrrev_b32 v1, 2, v2
  v_mul_u32_u24 v44, 9216, v1
  v_add_u32 v17, v44, v208
  v_add_u32 v18, 146432, v17
  v_add_u32 v19, 292864, v17
  v_add_u32 v20, 442368, v17
  v_add_u32 v21, 588800, v17
  v_add_u32 v22, 735232, v17
  v_add_u32 v23, 884736, v17
  v_add_u32 v24, 1031168, v17
  v_add_u32 v25, 1177600, v17
  s_mov_b64 s[44:45], s[8:9]
  s_mov_b32 s46, s10
  s_mov_b32 s47, 0x20000
  s_mul_i32 s5, s30, 18432
  s_add_u32 s5, s5, 4096
  v_mul_u32_u24 v44, 1152, v3
  v_add3_u32 v26, v44, v209, s5
  v_subrev_u32 v27, 896, v26
  v_add_u32 v29, 8192, v26
  s_lshr_b32 s5, s28, 2
  s_mul_i32 s5, s5, 1327104
  s_and_b32 s4, s28, 3
  s_lshl_b32 s6, s4, 8
  s_add_u32 s6, s6, s5
  s_xor_b32 s7, s4, 0
  s_mul_i32 s56, s7, 331776
  s_and_b32 s7, s7, 1
  s_mul_i32 s7, s7, 36864
  s_add_u32 s56, s56, s7
  s_add_u32 s56, s56, s6
  s_xor_b32 s7, s4, 1
  s_mul_i32 s57, s7, 331776
  s_and_b32 s7, s7, 1
  s_mul_i32 s7, s7, 36864
  s_add_u32 s57, s57, s7
  s_add_u32 s57, s57, s6
  s_xor_b32 s7, s4, 2
  s_mul_i32 s54, s7, 331776
  s_and_b32 s7, s7, 1
  s_mul_i32 s7, s7, 36864
  s_add_u32 s54, s54, s7
  s_add_u32 s54, s54, s6
  s_xor_b32 s7, s4, 3
  s_mul_i32 s55, s7, 331776
  s_and_b32 s7, s7, 1
  s_mul_i32 s7, s7, 36864
  s_add_u32 s55, s55, s7
  s_add_u32 s55, s55, s6
  s_sub_u32 s101, s56, s6
  s_add_u32 s101, s101, s5
  s_add_u32 s101, s101, 1024
  s_lshr_b32 s4, s4, 1
  s_mul_i32 s4, s4, 663552
  s_lshl_b32 s7, s3, 2
  s_sub_u32 s7, s7, s30
  s_add_u32 s7, s7, 32
  s_mul_i32 s7, s7, 9216
  s_add_u32 s37, s5, s4
  s_add_u32 s37, s37, s7
  s_add_u32 s37, s37, 1024
  s_lshl_b32 s7, s3, 1
  s_xor_b32 s7, s7, s30
  s_sub_u32 s7, s7, s30
  s_add_u32 s7, s7, 16
  s_mul_i32 s7, s7, 18432
  s_add_u32 s7, s7, s6
  s_add_u32 s58, s7, s4
  s_add_u32 s100, s7, 663552
  s_sub_u32 s100, s100, s4
  s_lshl_b32 s5, s29, 4
  s_add_u32 s5, s5, s28
  s_lshl_b32 s5, s5, 2
  s_add_u32 s5, s5, s30
  s_lshl_b32 s42, s5, 6
  s_add_u32 s42, s42, 2752512
  v_add_u32 v1, 1, v2
  v_lshlrev_b32 v1, 2, v1
  v_xor_b32 v1, s5, v1
  v_cmp_gt_u32 vcc, 3, v2
  v_lshlrev_b32 v1, 6, v1
  v_add_u32 v1, 2752512, v1
  v_mov_b32 v30, 0x40000000
  v_cndmask_b32 v30, v30, v1, vcc
  s_xor_b32 s6, s5, 0
  s_mul_i32 s40, s6, 18432
  s_add_u32 s40, s40, 9437184
  s_xor_b32 s6, s5, 4
  s_mul_i32 s41, s6, 18432
  s_add_u32 s41, s41, 9437184
  s_xor_b32 s6, s5, 8
  s_mul_i32 s43, s6, 18432
  s_add_u32 s43, s43, 9437184
  s_xor_b32 s6, s5, 12
  s_mul_i32 s99, s6, 18432
  s_add_u32 s99, s99, 9437184
  s_mov_b32 s50, s40
  s_add_u32 s21, s32, 2654336
  s_add_u32 s22, s32, 3981440
  s_add_u32 s38, s32, 256
  s_add_u32 s39, s32, 1327360
  s_mov_b32 s49, 0
  s_mul_i32 s5, s30, 42
  v_add_u32 v1, s5, v2
  v_lshlrev_b32 v1, 7, v1
  v_cmp_gt_u32 vcc, 14, v2
  v_mov_b32 v38, 0x40000000
  s_mul_i32 s5, s29, 18
  s_mul_i32 s6, s28, 288
  s_add_u32 s5, s5, s6
  s_mul_i32 s53, s5, 1152
  s_add_u32 s53, s53, 4096
  v_cndmask_b32 v38, v38, v1, vcc
  s_lshl_b32 s5, s29, 2
  s_add_u32 s5, s5, s30
  s_lshl_b32 s24, s5, 8
  s_add_u32 s24, s24, 2818048
  v_cmp_eq_u32 vcc, 0, v2
  v_mov_b32 v42, 1
  v_mov_b32 v1, 0x40000000
  v_cndmask_b32_e64 v49, v1, 0, vcc
  s_waitcnt vmcnt(0)
  s_cmp_lt_i32 s23, 0
  s_cbranch_scc1 K3_ns
  buffer_atomic_add v42, v49, s[16:19], s23 offen sc1
K3_ns:
  s_barrier
  s_add_u32 s34, s32, 1327104
  s_add_u32 m0, s31, 110592
  s_nop 0
  buffer_load_dwordx4 v8, s[8:11], s34 offen lds
  buffer_load_dwordx4 v9, s[8:11], s34 offen offset:1024 lds
  buffer_load_dwordx4 v10, s[8:11], s34 offen offset:2048 lds
  ds_read_b64_tr_b16 a[144:145], v4 offset:0
  ds_read_b64_tr_b16 a[146:147], v4 offset:1024
  ds_read_b64_tr_b16 a[148:149], v4 offset:18432
  ds_read_b64_tr_b16 a[150:151], v4 offset:19456
  ds_read_b64_tr_b16 a[152:153], v4 offset:512
  ds_read_b64_tr_b16 a[154:155], v4 offset:1536
  ds_read_b64_tr_b16 a[156:157], v4 offset:18944
  ds_read_b64_tr_b16 a[158:159], v4 offset:19968
  ds_read_b64_tr_b16 a[160:161], v4 offset:2048
  ds_read_b64_tr_b16 a[162:163], v4 offset:3072
  ds_read_b64_tr_b16 a[164:165], v4 offset:20480
  ds_read_b64_tr_b16 a[166:167], v4 offset:21504
  ds_read_b64_tr_b16 a[168:169], v4 offset:2560
  ds_read_b64_tr_b16 a[170:171], v4 offset:3584
  ds_read_b64_tr_b16 a[172:173], v4 offset:20992
  ds_read_b64_tr_b16 a[174:175], v4 offset:22016
  s_and_b32 s4, s28, 3
  s_lshr_b32 s23, s28, 2
  s_lshl_b32 s25, s5, 2
  s_add_u32 s25, s25, s4
  s_lshl_b32 s48, s25, 13
  s_add_u32 s48, s48, 29360128
  s_lshl_b32 s6, s23, 21
  s_add_u32 s36, s48, s6
  s_lshl_b32 s25, s25, 7
  s_add_u32 s25, s25, 2834432
  s_lshl_b32 s7, s30, 11
  s_add_u32 s7, s7, 147456
  v_bfe_u32 v44, v2, 3, 2
  v_cmp_eq_u32 vcc, s23, v44
  v_lshrrev_b32 v45, 5, v2
  v_and_b32 v46, 7, v2
  v_lshlrev_b32 v46, 4, v46
  v_lshl_add_u32 v45, v45, 7, v46
  v_lshl_add_u32 v33, v44, 10, v45
  v_add_u32 v45, s7, v45
  v_mov_b32 v46, 0x30000
  v_cndmask_b32_e64 v48, v33, v1, vcc
  v_cndmask_b32_e64 v41, v46, v45, vcc
  v_lshrrev_b32 v44, 3, v2
  v_bfe_u32 v45, v2, 1, 2
  v_and_b32 v46, 1, v2
  v_lshlrev_b32 v3, 4, v44
  v_lshl_add_u32 v3, v46, 7, v3
  v_lshl_add_u32 v3, v45, 8, v3
  v_add_u32 v43, s7, v3
  s_lshl_b32 s6, s23, 10
  v_add_u32 v3, s6, v3
  s_lshl_b32 s7, s23, 3
  v_add_u32 v44, s7, v44
  v_lshl_add_u32 v45, s4, 3, v45
  v_mul_u32_u24 v52, 1152, v44
  v_lshl_add_u32 v52, v46, 4, v52
  v_lshl_add_u32 v52, v45, 5, v52
  v_lshl_add_u32 v44, v46, 5, v44
  v_lshlrev_b32 v54, 4, v44
  v_lshl_add_u32 v54, v45, 10, v54
  v_bfe_u32 v44, v2, 1, 3
  v_lshlrev_b32 v51, 4, v44
  v_lshl_add_u32 v51, v46, 7, v51
  v_lshrrev_b32 v45, 4, v2
  v_lshl_add_u32 v51, v45, 18, v51
  s_lshl_b32 s6, s28, 8
  v_add_u32 v51, s6, v51
  v_cmp_gt_u32 vcc, 16, v2
  v_add_u32 v44, s7, v44
  s_add_u32 s4, s4, 32
  v_mul_u32_u24 v53, 1152, v44
  v_lshl_add_u32 v53, v46, 4, v53
  v_lshl_add_u32 v53, s4, 5, v53
  v_lshl_add_u32 v44, v46, 5, v44
  v_lshlrev_b32 v55, 4, v44
  v_lshl_add_u32 v55, s4, 10, v55
  v_cndmask_b32_e64 v53, v1, v53, vcc
  v_cndmask_b32_e64 v55, v1, v55, vcc
  v_mov_b32 v40, 0
  buffer_atomic_add v40, v49, s[16:19], s24 offen sc0 sc1
  s_add_u32 m0, s31, 113664
  s_nop 0
  buffer_load_dwordx4 v11, s[8:11], s34 offen lds
  buffer_load_dwordx4 v12, s[8:11], s34 offen offset:1024 lds
  buffer_load_dwordx4 v13, s[8:11], s34 offen offset:2048 lds
  s_add_u32 m0, s31, 116736
  s_nop 0
  buffer_load_dwordx4 v14, s[8:11], s34 offen lds
  buffer_load_dwordx4 v15, s[8:11], s34 offen offset:1024 lds
  buffer_load_dwordx4 v16, s[8:11], s34 offen offset:2048 lds
  s_mov_b64 exec, 0
  s_cmp_eq_u32 s30, 0
  s_cbranch_scc1 HP_k3_p0
  s_cmp_eq_u32 s30, 1
  s_cbranch_scc1 HP_k3_p1
  s_cmp_eq_u32 s30, 2
  s_cbranch_scc1 HP_k3_p2
  s_cmp_eq_u32 s30, 3
  s_cbranch_scc1 HP_k3_p3
HP_k3_ret:
  s_mov_b64 exec, -1
  s_waitcnt vmcnt(6)
  v_readfirstlane_b32 s5, v40
  s_nop 1
  s_cmp_ge_u32 s5, 12
  s_cbranch_scc1 K3_pdA
K3_plA:
  v_mov_b32 v40, 0
  buffer_atomic_add v40, v49, s[16:19], s24 offen sc0 sc1
  s_waitcnt vmcnt(0)
  v_readfirstlane_b32 s5, v40
  s_nop 1
  s_cmp_ge_u32 s5, 12
  s_cbranch_scc1 K3_pdA
  s_cmp_lg_u32 s5, 0
  s_cbranch_scc1 K3_plA
  s_sleep 8
  s_branch K3_plA
K3_pdA:
  s_add_u32 s51, s20, 0
  buffer_load_dwordx4 a[0:3], v37, s[16:19], s51 offen sc0 sc1
HP_k3_p0:
  s_cbranch_execz HP_k3_p4
  buffer_load_dwordx4 a[4:7], v37, s[16:19], s51 offen offset:1024 sc0 sc1
  buffer_load_dwordx4 a[8:11], v37, s[16:19], s51 offen offset:2048 sc0 sc1
  buffer_load_dwordx4 a[12:15], v37, s[16:19], s51 offen offset:3072 sc0 sc1
  s_add_u32 s51, s20, 4096
  buffer_load_dwordx4 a[16:19], v37, s[16:19], s51 offen sc0 sc1
  buffer_load_dwordx4 a[20:23], v37, s[16:19], s51 offen offset:1024 sc0 sc1
  buffer_load_dwordx4 a[24:27], v37, s[16:19], s51 offen offset:2048 sc0 sc1
  buffer_load_dwordx4 a[28:31], v37, s[16:19], s51 offen offset:3072 sc0 sc1
  s_waitcnt lgkmcnt(8)
  s_waitcnt vmcnt(7)
  v_mfma_f32_32x32x16_bf16 v[56:71], a[144:147], a[0:3], 0
  ds_read_b64_tr_b16 a[176:177], v4 offset:4096
  ds_read_b64_tr_b16 a[178:179], v4 offset:5120
  s_add_u32 s51, s20, 8192
  buffer_load_dwordx4 a[32:35], v37, s[16:19], s51 offen sc0 sc1
  v_mfma_f32_32x32x16_bf16 v[72:87], a[148:151], a[0:3], 0
  ds_read_b64_tr_b16 a[180:181], v4 offset:22528
  ds_read_b64_tr_b16 a[182:183], v4 offset:23552
  buffer_load_dwordx4 a[36:39], v37, s[16:19], s51 offen offset:1024 sc0 sc1
  v_mfma_f32_32x32x16_bf16 v[88:103], a[152:155], a[0:3], 0
  ds_read_b64_tr_b16 a[184:185], v4 offset:4608
  ds_read_b64_tr_b16 a[186:187], v4 offset:5632
  buffer_load_dwordx4 a[40:43], v37, s[16:19], s51 offen offset:2048 sc0 sc1
  v_mfma_f32_32x32x16_bf16 v[104:119], a[156:159], a[0:3], 0
  ds_read_b64_tr_b16 a[188:189], v4 offset:23040
  ds_read_b64_tr_b16 a[190:191], v4 offset:24064
  buffer_load_dwordx4 a[44:47], v37, s[16:19], s51 offen offset:3072 sc0 sc1
  s_waitcnt lgkmcnt(8)
  s_waitcnt vmcnt(10)
  v_mfma_f32_32x32x16_bf16 v[56:71], a[160:163], a[4:7], v[56:71]
  ds_read_b64_tr_b16 a[144:145], v4 offset:6144
  ds_read_b64_tr_b16 a[146:147], v4 offset:7168
  s_add_u32 s51, s20, 12288
  buffer_load_dwordx4 a[48:51], v37, s[16:19], s51 offen sc0 sc1
  v_mfma_f32_32x32x16_bf16 v[72:87], a[164:167], a[4:7], v[72:87]
  ds_read_b64_tr_b16 a[148:149], v4 offset:24576
  ds_read_b64_tr_b16 a[150:151], v4 offset:25600
  v_mfma_f32_32x32x16_bf16 v[88:103], a[168:171], a[4:7], v[88:103]
  ds_read_b64_tr_b16 a[152:153], v4 offset:6656
  ds_read_b64_tr_b16 a[154:155], v4 offset:7680
  v_mfma_f32_32x32x16_bf16 v[104:119], a[172:175], a[4:7], v[104:119]
  ds_read_b64_tr_b16 a[156:157], v4 offset:25088
  ds_read_b64_tr_b16 a[158:159], v4 offset:26112
  buffer_load_dwordx4 a[52:55], v37, s[16:19], s51 offen offset:1024 sc0 sc1
  s_waitcnt lgkmcnt(8)
  s_waitcnt vmcnt(11)
  v_mfma_f32_32x32x16_bf16 v[56:71], a[176:179], a[8:11], v[56:71]
  ds_read_b64_tr_b16 a[160:161], v4 offset:8192
  ds_read_b64_tr_b16 a[162:163], v4 offset:9216
  v_mfma_f32_32x32x16_bf16 v[72:87], a[180:183], a[8:11], v[72:87]
  ds_read_b64_tr_b16 a[164:165], v4 offset:26624
  ds_read_b64_tr_b16 a[166:167], v4 offset:27648
  v_mfma_f32_32x32x16_bf16 v[88:103], a[184:187], a[8:11], v[88:103]
  ds_read_b64_tr_b16 a[168:169], v4 offset:8704
  ds_read_b64_tr_b16 a[170:171], v4 offset:9728
  v_mfma_f32_32x32x16_bf16 v[104:119], a[188:191], a[8:11], v[104:119]
  ds_read_b64_tr_b16 a[172:173], v4 offset:27136
  ds_read_b64_tr_b16 a[174:175], v4 offset:28160
  buffer_load_dwordx4 a[56:59], v37, s[16:19], s51 offen offset:2048 sc0 sc1
  s_waitcnt lgkmcnt(8)
  s_waitcnt vmcnt(11)
  v_mfma_f32_32x32x16_bf16 v[56:71], a[144:147], a[12:15], v[56:71]
  ds_read_b64_tr_b16 a[176:177], v4 offset:10240
  ds_read_b64_tr_b16 a[178:179], v4 offset:11264
  v_mfma_f32_32x32x16_bf16 v[72:87], a[148:151], a[12:15], v[72:87]
  ds_read_b64_tr_b16 a[180:181], v4 offset:28672
  ds_read_b64_tr_b16 a[182:183], v4 offset:29696
  v_mfma_f32_32x32x16_bf16 v[88:103], a[152:155], a[12:15], v[88:103]
  ds_read_b64_tr_b16 a[184:185], v4 offset:10752
  ds_read_b64_tr_b16 a[186:187], v4 offset:11776
  v_mfma_f32_32x32x16_bf16 v[104:119], a[156:159], a[12:15], v[104:119]
  ds_read_b64_tr_b16 a[188:189], v4 offset:29184
  ds_read_b64_tr_b16 a[190:191], v4 offset:30208
  buffer_load_dwordx4 a[60:63], v37, s[16:19], s51 offen offset:3072 sc0 sc1
  s_waitcnt lgkmcnt(8)
  s_waitcnt vmcnt(11)
  v_mfma_f32_32x32x16_bf16 v[56:71], a[160:163], a[16:19], v[56:71]
  ds_read_b64_tr_b16 a[144:145], v4 offset:12288
  ds_read_b64_tr_b16 a[146:147], v4 offset:13312
  v_mfma_f32_32x32x16_bf16 v[72:87], a[164:167], a[16:19], v[72:87]
  ds_read_b64_tr_b16 a[148:149], v4 offset:30720
  ds_read_b64_tr_b16 a[150:151], v4 offset:31744
  v_mfma_f32_32x32x16_bf16 v[88:103], a[168:171], a[16:19], v[88:103]
  ds_read_b64_tr_b16 a[152:153], v4 offset:12800
  ds_read_b64_tr_b16 a[154:155], v4 offset:13824
  v_mfma_f32_32x32x16_bf16 v[104:119], a[172:175], a[16:19], v[104:119]
  ds_read_b64_tr_b16 a[156:157], v4 offset:31232
  ds_read_b64_tr_b16 a[158:159], v4 offset:32256
  s_add_u32 s51, s20, 16384
  buffer_load_dwordx4 a[64:67], v37, s[16:19], s51 offen sc0 sc1
  s_waitcnt lgkmcnt(8)
  s_waitcnt vmcnt(11)
  v_mfma_f32_32x32x16_bf16 v[56:71], a[176:179], a[20:23], v[56:71]
  ds_read_b64_tr_b16 a[160:161], v4 offset:14336
  ds_read_b64_tr_b16 a[162:163], v4 offset:15360
  v_mfma_f32_32x32x16_bf16 v[72:87], a[180:183], a[20:23], v[72:87]
  ds_read_b64_tr_b16 a[164:165], v4 offset:32768
  ds_read_b64_tr_b16 a[166:167], v4 offset:33792
  v_mfma_f32_32x32x16_bf16 v[88:103], a[184:187], a[20:23], v[88:103]
  ds_read_b64_tr_b16 a[168:169], v4 offset:14848
  ds_read_b64_tr_b16 a[170:171], v4 offset:15872
  v_mfma_f32_32x32x16_bf16 v[104:119], a[188:191], a[20:23], v[104:119]
  ds_read_b64_tr_b16 a[172:173], v4 offset:33280
  ds_read_b64_tr_b16 a[174:175], v4 offset:34304
  buffer_load_dwordx4 a[68:71], v37, s[16:19], s51 offen offset:1024 sc0 sc1
  s_waitcnt lgkmcnt(8)
  s_waitcnt vmcnt(11)
  v_mfma_f32_32x32x16_bf16 v[56:71], a[144:147], a[24:27], v[56:71]
  ds_read_b64_tr_b16 a[176:177], v4 offset:16384
  ds_read_b64_tr_b16 a[178:179], v4 offset:17408
  v_mfma_f32_32x32x16_bf16 v[72:87], a[148:151], a[24:27], v[72:87]
  ds_read_b64_tr_b16 a[180:181], v4 offset:34816
  ds_read_b64_tr_b16 a[182:183], v4 offset:35840
  v_mfma_f32_32x32x16_bf16 v[88:103], a[152:155], a[24:27], v[88:103]
  ds_read_b64_tr_b16 a[184:185], v4 offset:16896
  ds_read_b64_tr_b16 a[186:187], v4 offset:17920
  v_mfma_f32_32x32x16_bf16 v[104:119], a[156:159], a[24:27], v[104:119]
  ds_read_b64_tr_b16 a[188:189], v4 offset:35328
  ds_read_b64_tr_b16 a[190:191], v4 offset:36352
  buffer_load_dwordx4 a[72:75], v37, s[16:19], s51 offen offset:2048 sc0 sc1
  s_waitcnt lgkmcnt(8)
  s_waitcnt vmcnt(11)
  v_mfma_f32_32x32x16_bf16 v[56:71], a[160:163], a[28:31], v[56:71]
  s_barrier
  ds_read_b64_tr_b16 a[144:145], v5 offset:0
  ds_read_b64_tr_b16 a[146:147], v5 offset:512
  v_mfma_f32_32x32x16_bf16 v[72:87], a[164:167], a[28:31], v[72:87]
  ds_read_b64_tr_b16 a[148:149], v5 offset:18432
  ds_read_b64_tr_b16 a[150:151], v5 offset:18944
  v_mfma_f32_32x32x16_bf16 v[88:103], a[168:171], a[28:31], v[88:103]
  ds_read_b64_tr_b16 a[152:153], v5 offset:1024
  ds_read_b64_tr_b16 a[154:155], v5 offset:1536
  v_mfma_f32_32x32x16_bf16 v[104:119], a[172:175], a[28:31], v[104:119]
  ds_read_b64_tr_b16 a[156:157], v5 offset:19456
  ds_read_b64_tr_b16 a[158:159], v5 offset:19968
  buffer_load_dwordx4 a[76:79], v37, s[16:19], s51 offen offset:3072 sc0 sc1
HP_k3_p1:
  s_cbranch_execz HP_k3_p5
  s_waitcnt lgkmcnt(8)
  s_waitcnt vmcnt(11)
  v_mfma_f32_32x32x16_bf16 v[56:71], a[176:179], a[32:35], v[56:71]
  ds_read_b64_tr_b16 a[160:161], v5 offset:2048
  ds_read_b64_tr_b16 a[162:163], v5 offset:2560
  v_mfma_f32_32x32x16_bf16 v[72:87], a[180:183], a[32:35], v[72:87]
  ds_read_b64_tr_b16 a[164:165], v5 offset:20480
  ds_read_b64_tr_b16 a[166:167], v5 offset:20992
  v_mfma_f32_32x32x16_bf16 v[88:103], a[184:187], a[32:35], v[88:103]
  ds_read_b64_tr_b16 a[168:169], v5 offset:3072
  ds_read_b64_tr_b16 a[170:171], v5 offset:3584
  v_mfma_f32_32x32x16_bf16 v[104:119], a[188:191], a[32:35], v[104:119]
  ds_read_b64_tr_b16 a[172:173], v5 offset:21504
  ds_read_b64_tr_b16 a[174:175], v5 offset:22016
  s_add_u32 s51, s20, 20480
  buffer_load_dwordx4 a[80:83], v37, s[16:19], s51 offen sc0 sc1
  s_waitcnt lgkmcnt(8)
  v_mfma_f32_32x32x16_bf16 v[224:239], a[144:147], a[0:3], 0
  ds_read_b64_tr_b16 a[176:177], v5 offset:4096
  ds_read_b64_tr_b16 a[178:179], v5 offset:4608
  v_mfma_f32_32x32x16_bf16 v[240:255], a[148:151], a[0:3], 0
  ds_read_b64_tr_b16 a[180:181], v5 offset:22528
  ds_read_b64_tr_b16 a[182:183], v5 offset:23040
  v_mfma_f32_32x32x16_bf16 v[224:239], a[152:155], a[4:7], v[224:239]
  ds_read_b64_tr_b16 a[184:185], v5 offset:5120
  ds_read_b64_tr_b16 a[186:187], v5 offset:5632
  v_mfma_f32_32x32x16_bf16 v[240:255], a[156:159], a[4:7], v[240:255]
  ds_read_b64_tr_b16 a[188:189], v5 offset:23552
  ds_read_b64_tr_b16 a[190:191], v5 offset:24064
  buffer_load_dwordx4 a[84:87], v37, s[16:19], s51 offen offset:1024 sc0 sc1
  s_waitcnt lgkmcnt(8)
  v_mfma_f32_32x32x16_bf16 v[224:239], a[160:163], a[8:11], v[224:239]
  ds_read_b64_tr_b16 a[144:145], v5 offset:6144
  ds_read_b64_tr_b16 a[146:147], v5 offset:6656
  v_mfma_f32_32x32x16_bf16 v[240:255], a[164:167], a[8:11], v[240:255]
  ds_read_b64_tr_b16 a[148:149], v5 offset:24576
  ds_read_b64_tr_b16 a[150:151], v5 offset:25088
  v_mfma_f32_32x32x16_bf16 v[224:239], a[168:171], a[12:15], v[224:239]
  ds_read_b64_tr_b16 a[152:153], v5 offset:7168
  ds_read_b64_tr_b16 a[154:155], v5 offset:7680
  v_mfma_f32_32x32x16_bf16 v[240:255], a[172:175], a[12:15], v[240:255]
  ds_read_b64_tr_b16 a[156:157], v5 offset:25600
  ds_read_b64_tr_b16 a[158:159], v5 offset:26112
  buffer_load_dwordx4 a[88:91], v37, s[16:19], s51 offen offset:2048 sc0 sc1
  s_waitcnt lgkmcnt(8)
  v_mfma_f32_32x32x16_bf16 v[224:239], a[176:179], a[16:19], v[224:239]
  ds_read_b64_tr_b16 a[160:161], v5 offset:8192
  ds_read_b64_tr_b16 a[162:163], v5 offset:8704
  v_mfma_f32_32x32x16_bf16 v[240:255], a[180:183], a[16:19], v[240:255]
  ds_read_b64_tr_b16 a[164:165], v5 offset:26624
  ds_read_b64_tr_b16 a[166:167], v5 offset:27136
  v_mfma_f32_32x32x16_bf16 v[224:239], a[184:187], a[20:23], v[224:239]
  ds_read_b64_tr_b16 a[168:169], v5 offset:9216
  ds_read_b64_tr_b16 a[170:171], v5 offset:9728
  v_mfma_f32_32x32x16_bf16 v[240:255], a[188:191], a[20:23], v[240:255]
  ds_read_b64_tr_b16 a[172:173], v5 offset:27648
  ds_read_b64_tr_b16 a[174:175], v5 offset:28160
  buffer_load_dwordx4 a[92:95], v37, s[16:19], s51 offen offset:3072 sc0 sc1
  s_waitcnt lgkmcnt(8)
  v_mfma_f32_32x32x16_bf16 v[224:239], a[144:147], a[24:27], v[224:239]
  ds_read_b64_tr_b16 a[176:177], v5 offset:10240
  ds_read_b64_tr_b16 a[178:179], v5 offset:10752
  v_mfma_f32_32x32x16_bf16 v[240:255], a[148:151], a[24:27], v[240:255]
  ds_read_b64_tr_b16 a[180:181], v5 offset:28672
  ds_read_b64_tr_b16 a[182:183], v5 offset:29184
  v_mfma_f32_32x32x16_bf16 v[224:239], a[152:155], a[28:31], v[224:239]
  ds_read_b64_tr_b16 a[184:185], v5 offset:11264
  ds_read_b64_tr_b16 a[186:187], v5 offset:11776
  v_mfma_f32_32x32x16_bf16 v[240:255], a[156:159], a[28:31], v[240:255]
  ds_read_b64_tr_b16 a[188:189], v5 offset:29696
  ds_read_b64_tr_b16 a[190:191], v5 offset:30208
  s_add_u32 s51, s20, 24576
  buffer_load_dwordx4 a[96:99], v37, s[16:19], s51 offen sc0 sc1
  s_waitcnt lgkmcnt(8)
  v_mfma_f32_32x32x16_bf16 v[224:239], a[160:163], a[32:35], v[224:239]
  ds_read_b64_tr_b16 a[144:145], v5 offset:12288
  ds_read_b64_tr_b16 a[146:147], v5 offset:12800
  v_mfma_f32_32x32x16_bf16 v[240:255], a[164:167], a[32:35], v[240:255]
  ds_read_b64_tr_b16 a[148:149], v5 offset:30720
  ds_read_b64_tr_b16 a[150:151], v5 offset:31232
  s_waitcnt vmcnt(15)
  v_mfma_f32_32x32x16_bf16 v[224:239], a[168:171], a[36:39], v[224:239]
  ds_read_b64_tr_b16 a[152:153], v5 offset:13312
  ds_read_b64_tr_b16 a[154:155], v5 offset:13824
  v_mfma_f32_32x32x16_bf16 v[240:255], a[172:175], a[36:39], v[240:255]
  ds_read_b64_tr_b16 a[156:157], v5 offset:31744
  ds_read_b64_tr_b16 a[158:159], v5 offset:32256
  buffer_load_dwordx4 a[100:103], v37, s[16:19], s51 offen offset:1024 sc0 sc1
  s_waitcnt lgkmcnt(8)
  s_waitcnt vmcnt(15)
  v_mfma_f32_32x32x16_bf16 v[224:239], a[176:179], a[40:43], v[224:239]
  ds_read_b64_tr_b16 a[160:161], v5 offset:14336
  ds_read_b64_tr_b16 a[162:163], v5 offset:14848
  s_add_u32 s59, s52, 65536
  buffer_load_dwordx2 v[210:211], v39, s[16:19], s59 offen sc0 sc1
  v_mfma_f32_32x32x16_bf16 v[240:255], a[180:183], a[40:43], v[240:255]
  ds_read_b64_tr_b16 a[164:165], v5 offset:32768
  ds_read_b64_tr_b16 a[166:167], v5 offset:33280
  s_add_u32 s59, s52, 81920
  buffer_load_dwordx2 v[212:213], v39, s[16:19], s59 offen sc0 sc1
  s_waitcnt vmcnt(16)
  v_mfma_f32_32x32x16_bf16 v[224:239], a[184:187], a[44:47], v[224:239]
  ds_read_b64_tr_b16 a[168:169], v5 offset:15360
  ds_read_b64_tr_b16 a[170:171], v5 offset:15872
  s_add_u32 s59, s52, 98304
  buffer_load_dwordx2 v[214:215], v39, s[16:19], s59 offen sc0 sc1
  v_mfma_f32_32x32x16_bf16 v[240:255], a[188:191], a[44:47], v[240:255]
  ds_read_b64_tr_b16 a[172:173], v5 offset:33792
  ds_read_b64_tr_b16 a[174:175], v5 offset:34304
  s_add_u32 s59, s52, 114688
  buffer_load_dwordx2 v[216:217], v39, s[16:19], s59 offen sc0 sc1
  s_waitcnt lgkmcnt(8)
  s_waitcnt vmcnt(17)
  v_mfma_f32_32x32x16_bf16 v[224:239], a[144:147], a[48:51], v[224:239]
  ds_read_b64_tr_b16 a[176:177], v5 offset:16384
  ds_read_b64_tr_b16 a[178:179], v5 offset:16896
  buffer_load_dwordx4 a[104:107], v37, s[16:19], s51 offen offset:2048 sc0 sc1
  v_mfma_f32_32x32x16_bf16 v[240:255], a[148:151], a[48:51], v[240:255]
  ds_read_b64_tr_b16 a[180:181], v5 offset:34816
  ds_read_b64_tr_b16 a[182:183], v5 offset:35328
  s_add_u32 s59, s52, 131072
  buffer_load_dwordx2 v[218:219], v39, s[16:19], s59 offen sc0 sc1
  s_waitcnt vmcnt(18)
  v_mfma_f32_32x32x16_bf16 v[224:239], a[152:155], a[52:55], v[224:239]
  ds_read_b64_tr_b16 a[184:185], v5 offset:17408
  ds_read_b64_tr_b16 a[186:187], v5 offset:17920
  s_add_u32 s59, s52, 147456
  buffer_load_dwordx2 v[220:221], v39, s[16:19], s59 offen sc0 sc1
  v_mfma_f32_32x32x16_bf16 v[240:255], a[156:159], a[52:55], v[240:255]
  ds_read_b64_tr_b16 a[188:189], v5 offset:35840
  ds_read_b64_tr_b16 a[190:191], v5 offset:36352
  buffer_load_dwordx4 a[108:111], v37, s[16:19], s51 offen offset:3072 sc0 sc1
  s_waitcnt lgkmcnt(8)
  s_waitcnt vmcnt(19)
  v_mfma_f32_32x32x16_bf16 v[224:239], a[160:163], a[56:59], v[224:239]
HP_k3_p2:
  s_cbranch_execz HP_k3_p6
  s_barrier
  ds_read_b64_tr_b16 a[144:145], v7 offset:0
  ds_read_b64_tr_b16 a[146:147], v7 offset:1024
  v_mfma_f32_32x32x16_bf16 v[240:255], a[164:167], a[56:59], v[240:255]
  ds_read_b64_tr_b16 a[148:149], v7 offset:18432
  ds_read_b64_tr_b16 a[150:151], v7 offset:19456
  s_add_u32 s34, s32, 2654208
  s_waitcnt vmcnt(18)
  v_mfma_f32_32x32x16_bf16 v[224:239], a[168:171], a[60:63], v[224:239]
  ds_read_b64_tr_b16 a[152:153], v7 offset:512
  ds_read_b64_tr_b16 a[154:155], v7 offset:1536
  v_mov_b32 v17, v8
  v_mov_b32 v18, v9
  v_mov_b32 v19, v10
  v_mfma_f32_32x32x16_bf16 v[240:255], a[172:175], a[60:63], v[240:255]
  ds_read_b64_tr_b16 a[156:157], v7 offset:18944
  ds_read_b64_tr_b16 a[158:159], v7 offset:19968
  s_add_u32 s51, s20, 28672
  buffer_load_dwordx4 a[112:115], v37, s[16:19], s51 offen sc0 sc1
  s_waitcnt lgkmcnt(8)
  s_waitcnt vmcnt(18)
  v_mfma_f32_32x32x16_bf16 v[224:239], a[176:179], a[64:67], v[224:239]
  ds_read_b64_tr_b16 a[160:161], v7 offset:2048
  ds_read_b64_tr_b16 a[162:163], v7 offset:3072
  s_add_u32 m0, s31, 0
  v_mov_b32 v20, v11
  v_mov_b32 v21, v12
  v_mfma_f32_32x32x16_bf16 v[240:255], a[180:183], a[64:67], v[240:255]
  ds_read_b64_tr_b16 a[164:165], v7 offset:20480
  ds_read_b64_tr_b16 a[166:167], v7 offset:21504
  buffer_load_dwordx4 v8, s[8:11], s34 offen lds
  v_mov_b32 v22, v13
  v_mov_b32 v23, v14
  s_waitcnt vmcnt(18)
  v_mfma_f32_32x32x16_bf16 v[224:239], a[184:187], a[68:71], v[224:239]
  ds_read_b64_tr_b16 a[168:169], v7 offset:2560
  ds_read_b64_tr_b16 a[170:171], v7 offset:3584
  buffer_load_dwordx4 v9, s[8:11], s34 offen offset:1024 lds
  v_mov_b32 v24, v15
  v_mov_b32 v25, v16
  v_mfma_f32_32x32x16_bf16 v[240:255], a[188:191], a[68:71], v[240:255]
  ds_read_b64_tr_b16 a[172:173], v7 offset:20992
  ds_read_b64_tr_b16 a[174:175], v7 offset:22016
  buffer_load_dwordx4 a[116:119], v37, s[16:19], s51 offen offset:1024 sc0 sc1
  s_waitcnt lgkmcnt(8)
  v_mfma_f32_32x32x16_bf16 v[56:71], a[144:147], a[36:39], v[56:71]
  ds_read_b64_tr_b16 a[176:177], v7 offset:4096
  ds_read_b64_tr_b16 a[178:179], v7 offset:5120
  v_mfma_f32_32x32x16_bf16 v[72:87], a[148:151], a[36:39], v[72:87]
  ds_read_b64_tr_b16 a[180:181], v7 offset:22528
  ds_read_b64_tr_b16 a[182:183], v7 offset:23552
  v_mfma_f32_32x32x16_bf16 v[88:103], a[152:155], a[36:39], v[88:103]
  ds_read_b64_tr_b16 a[184:185], v7 offset:4608
  ds_read_b64_tr_b16 a[186:187], v7 offset:5632
  buffer_load_dwordx4 v10, s[8:11], s34 offen offset:2048 lds
  v_mfma_f32_32x32x16_bf16 v[104:119], a[156:159], a[36:39], v[104:119]
  ds_read_b64_tr_b16 a[188:189], v7 offset:23040
  ds_read_b64_tr_b16 a[190:191], v7 offset:24064
  buffer_load_dwordx4 a[120:123], v37, s[16:19], s51 offen offset:2048 sc0 sc1
  s_waitcnt lgkmcnt(8)
  v_mfma_f32_32x32x16_bf16 v[56:71], a[160:163], a[40:43], v[56:71]
  ds_read_b64_tr_b16 a[144:145], v7 offset:6144
  ds_read_b64_tr_b16 a[146:147], v7 offset:7168
  s_add_u32 m0, s31, 3072
  v_mfma_f32_32x32x16_bf16 v[72:87], a[164:167], a[40:43], v[72:87]
  ds_read_b64_tr_b16 a[148:149], v7 offset:24576
  ds_read_b64_tr_b16 a[150:151], v7 offset:25600
  v_mfma_f32_32x32x16_bf16 v[88:103], a[168:171], a[40:43], v[88:103]
  ds_read_b64_tr_b16 a[152:153], v7 offset:6656
  ds_read_b64_tr_b16 a[154:155], v7 offset:7680
  buffer_load_dwordx4 v11, s[8:11], s34 offen lds
  v_mfma_f32_32x32x16_bf16 v[104:119], a[172:175], a[40:43], v[104:119]
  ds_read_b64_tr_b16 a[156:157], v7 offset:25088
  ds_read_b64_tr_b16 a[158:159], v7 offset:26112
  buffer_load_dwordx4 a[124:127], v37, s[16:19], s51 offen offset:3072 sc0 sc1
  s_waitcnt lgkmcnt(8)
  v_mfma_f32_32x32x16_bf16 v[56:71], a[176:179], a[44:47], v[56:71]
  ds_read_b64_tr_b16 a[160:161], v7 offset:8192
  ds_read_b64_tr_b16 a[162:163], v7 offset:9216
  v_mfma_f32_32x32x16_bf16 v[72:87], a[180:183], a[44:47], v[72:87]
  ds_read_b64_tr_b16 a[164:165], v7 offset:26624
  ds_read_b64_tr_b16 a[166:167], v7 offset:27648
  v_mfma_f32_32x32x16_bf16 v[88:103], a[184:187], a[44:47], v[88:103]
  ds_read_b64_tr_b16 a[168:169], v7 offset:8704
  ds_read_b64_tr_b16 a[170:171], v7 offset:9728
  buffer_load_dwordx4 v12, s[8:11], s34 offen offset:1024 lds
  v_mfma_f32_32x32x16_bf16 v[104:119], a[188:191], a[44:47], v[104:119]
  ds_read_b64_tr_b16 a[172:173], v7 offset:27136
  ds_read_b64_tr_b16 a[174:175], v7 offset:28160
  s_add_u32 s51, s20, 32768
  buffer_load_dwordx4 a[128:131], v37, s[16:19], s51 offen sc0 sc1
  s_waitcnt lgkmcnt(8)
  v_mfma_f32_32x32x16_bf16 v[56:71], a[144:147], a[48:51], v[56:71]
  ds_read_b64_tr_b16 a[176:177], v7 offset:10240
  ds_read_b64_tr_b16 a[178:179], v7 offset:11264
  v_mfma_f32_32x32x16_bf16 v[72:87], a[148:151], a[48:51], v[72:87]
  ds_read_b64_tr_b16 a[180:181], v7 offset:28672
  ds_read_b64_tr_b16 a[182:183], v7 offset:29696
  v_mfma_f32_32x32x16_bf16 v[88:103], a[152:155], a[48:51], v[88:103]
  ds_read_b64_tr_b16 a[184:185], v7 offset:10752
  ds_read_b64_tr_b16 a[186:187], v7 offset:11776
  buffer_load_dwordx4 v13, s[8:11], s34 offen offset:2048 lds
  v_mfma_f32_32x32x16_bf16 v[104:119], a[156:159], a[48:51], v[104:119]
  ds_read_b64_tr_b16 a[188:189], v7 offset:29184
  ds_read_b64_tr_b16 a[190:191], v7 offset:30208
  buffer_load_dwordx4 a[132:135], v37, s[16:19], s51 offen offset:1024 sc0 sc1
  s_waitcnt lgkmcnt(8)
  v_mfma_f32_32x32x16_bf16 v[56:71], a[160:163], a[52:55], v[56:71]
  ds_read_b64_tr_b16 a[144:145], v7 offset:12288
  ds_read_b64_tr_b16 a[146:147], v7 offset:13312
  s_add_u32 m0, s31, 6144
  v_mfma_f32_32x32x16_bf16 v[72:87], a[164:167], a[52:55], v[72:87]
  ds_read_b64_tr_b16 a[148:149], v7 offset:30720
  ds_read_b64_tr_b16 a[150:151], v7 offset:31744
  v_mfma_f32_32x32x16_bf16 v[88:103], a[168:171], a[52:55], v[88:103]
  ds_read_b64_tr_b16 a[152:153], v7 offset:12800
  ds_read_b64_tr_b16 a[154:155], v7 offset:13824
  buffer_load_dwordx4 v14, s[8:11], s34 offen lds
  v_mfma_f32_32x32x16_bf16 v[104:119], a[172:175], a[52:55], v[104:119]
  ds_read_b64_tr_b16 a[156:157], v7 offset:31232
  ds_read_b64_tr_b16 a[158:159], v7 offset:32256
  buffer_load_dwordx4 a[136:139], v37, s[16:19], s51 offen offset:2048 sc0 sc1
  s_waitcnt lgkmcnt(8)
  v_mfma_f32_32x32x16_bf16 v[56:71], a[176:179], a[56:59], v[56:71]
  ds_read_b64_tr_b16 a[160:161], v7 offset:14336
  ds_read_b64_tr_b16 a[162:163], v7 offset:15360
  v_mfma_f32_32x32x16_bf16 v[72:87], a[180:183], a[56:59], v[72:87]
  ds_read_b64_tr_b16 a[164:165], v7 offset:32768
  ds_read_b64_tr_b16 a[166:167], v7 offset:33792
  v_mfma_f32_32x32x16_bf16 v[88:103], a[184:187], a[56:59], v[88:103]
  ds_read_b64_tr_b16 a[168:169], v7 offset:14848
  ds_read_b64_tr_b16 a[170:171], v7 offset:15872
  buffer_load_dwordx4 v15, s[8:11], s34 offen offset:1024 lds
  v_mfma_f32_32x32x16_bf16 v[104:119], a[188:191], a[56:59], v[104:119]
  ds_read_b64_tr_b16 a[172:173], v7 offset:33280
  ds_read_b64_tr_b16 a[174:175], v7 offset:34304
  buffer_load_dwordx4 a[140:143], v37, s[16:19], s51 offen offset:3072 sc0 sc1
  s_waitcnt lgkmcnt(8)
  v_mfma_f32_32x32x16_bf16 v[56:71], a[144:147], a[60:63], v[56:71]
HP_k3_p3:
  s_cbranch_execz HP_k3_p7
  ds_read_b64_tr_b16 a[176:177], v7 offset:16384
  ds_read_b64_tr_b16 a[178:179], v7 offset:17408
  v_mfma_f32_32x32x16_bf16 v[72:87], a[148:151], a[60:63], v[72:87]
  ds_read_b64_tr_b16 a[180:181], v7 offset:34816
  ds_read_b64_tr_b16 a[182:183], v7 offset:35840
  v_mfma_f32_32x32x16_bf16 v[88:103], a[152:155], a[60:63], v[88:103]
  ds_read_b64_tr_b16 a[184:185], v7 offset:16896
  ds_read_b64_tr_b16 a[186:187], v7 offset:17920
  buffer_load_dwordx4 v16, s[8:11], s34 offen offset:2048 lds
  v_mfma_f32_32x32x16_bf16 v[104:119], a[156:159], a[60:63], v[104:119]
  ds_read_b64_tr_b16 a[188:189], v7 offset:35328
  ds_read_b64_tr_b16 a[190:191], v7 offset:36352
  s_waitcnt lgkmcnt(8)
  v_mfma_f32_32x32x16_bf16 v[56:71], a[160:163], a[64:67], v[56:71]
  s_barrier
  ds_read_b64_tr_b16 a[144:145], v6 offset:0
  ds_read_b64_tr_b16 a[146:147], v6 offset:512
  s_waitcnt vmcnt(18)
  v_mfma_f32_32x32x16_bf16 v[72:87], a[164:167], a[64:67], v[72:87]
  ds_read_b64_tr_b16 a[148:149], v6 offset:18432
  ds_read_b64_tr_b16 a[150:151], v6 offset:18944
  s_add_u32 s34, s32, 3981312
  v_add_f32 v210, v210, v212
  v_add_f32 v211, v211, v213
  v_mfma_f32_32x32x16_bf16 v[88:103], a[168:171], a[64:67], v[88:103]
  ds_read_b64_tr_b16 a[152:153], v6 offset:1024
  ds_read_b64_tr_b16 a[154:155], v6 offset:1536
  s_add_u32 m0, s31, 36864
  v_add_f32 v214, v214, v216
  v_add_f32 v215, v215, v217
  v_mfma_f32_32x32x16_bf16 v[104:119], a[172:175], a[64:67], v[104:119]
  ds_read_b64_tr_b16 a[156:157], v6 offset:19456
  ds_read_b64_tr_b16 a[158:159], v6 offset:19968
  buffer_load_dwordx4 v8, s[8:11], s34 offen lds
  v_add_f32 v218, v218, v220
  s_waitcnt lgkmcnt(8)
  v_mfma_f32_32x32x16_bf16 v[56:71], a[176:179], a[68:71], v[56:71]
  ds_read_b64_tr_b16 a[160:161], v6 offset:2048
  ds_read_b64_tr_b16 a[162:163], v6 offset:2560
  v_add_f32 v219, v219, v221
  v_add_f32 v210, v210, v214
  v_add_f32 v211, v211, v215
  v_mfma_f32_32x32x16_bf16 v[72:87], a[180:183], a[68:71], v[72:87]
  ds_read_b64_tr_b16 a[164:165], v6 offset:20480
  ds_read_b64_tr_b16 a[166:167], v6 offset:20992
  v_add_f32 v210, v210, v218
  v_add_f32 v211, v211, v219
  v_mov_b32 v212, v210
  v_mfma_f32_32x32x16_bf16 v[88:103], a[184:187], a[68:71], v[88:103]
  ds_read_b64_tr_b16 a[168:169], v6 offset:3072
  ds_read_b64_tr_b16 a[170:171], v6 offset:3584
  buffer_load_dwordx4 v9, s[8:11], s34 offen offset:1024 lds
  v_mov_b32 v213, v211
  v_mov_b32 v42, 1
  v_mfma_f32_32x32x16_bf16 v[104:119], a[188:191], a[68:71], v[104:119]
  ds_read_b64_tr_b16 a[172:173], v6 offset:21504
  ds_read_b64_tr_b16 a[174:175], v6 offset:22016
  s_nop 0
  s_waitcnt lgkmcnt(8)
  v_mfma_f32_32x32x16_bf16 v[224:239], a[144:147], a[72:75], v[224:239]
  ds_read_b64_tr_b16 a[176:177], v6 offset:4096
  ds_read_b64_tr_b16 a[178:179], v6 offset:4608
  v_permlane32_swap_b32 v210, v212
  v_mfma_f32_32x32x16_bf16 v[240:255], a[148:151], a[72:75], v[240:255]
  ds_read_b64_tr_b16 a[180:181], v6 offset:22528
  ds_read_b64_tr_b16 a[182:183], v6 offset:23040
  v_permlane32_swap_b32 v211, v213
  s_nop 0
  v_mfma_f32_32x32x16_bf16 v[224:239], a[152:155], a[76:79], v[224:239]
  ds_read_b64_tr_b16 a[184:185], v6 offset:5120
  ds_read_b64_tr_b16 a[186:187], v6 offset:5632
  buffer_load_dwordx4 v10, s[8:11], s34 offen offset:2048 lds
  v_add_f32 v210, v210, v212
  v_add_f32 v211, v211, v213
  v_mfma_f32_32x32x16_bf16 v[240:255], a[156:159], a[76:79], v[240:255]
  ds_read_b64_tr_b16 a[188:189], v6 offset:23552
  ds_read_b64_tr_b16 a[190:191], v6 offset:24064
  v_mul_f32 v210, 0x3ae38e39, v210
  v_mul_f32 v211, 0x3ae38e39, v211
  s_waitcnt lgkmcnt(8)
  v_mfma_f32_32x32x16_bf16 v[224:239], a[160:163], a[80:83], v[224:239]
  ds_read_b64_tr_b16 a[144:145], v6 offset:6144
  ds_read_b64_tr_b16 a[146:147], v6 offset:6656
  s_add_u32 m0, s31, 39936
  v_fma_f32 v211, -v210, v210, v211
  v_max_f32 v211, 0, v211
  v_mfma_f32_32x32x16_bf16 v[240:255], a[164:167], a[80:83], v[240:255]
  ds_read_b64_tr_b16 a[148:149], v6 offset:24576
  ds_read_b64_tr_b16 a[150:151], v6 offset:25088
  v_cvt_pk_bf16_f32 v211, v211, v211
  v_and_b32 v211, 0xffff0000, v211
  v_add_f32 v211, 0x3727c5ac, v211
  v_mfma_f32_32x32x16_bf16 v[224:239], a[168:171], a[84:87], v[224:239]
  ds_read_b64_tr_b16 a[152:153], v6 offset:7168
  ds_read_b64_tr_b16 a[154:155], v6 offset:7680
  buffer_load_dwordx4 v11, s[8:11], s34 offen lds
  v_cvt_pk_bf16_f32 v211, v211, v211
  v_and_b32 v211, 0xffff0000, v211
  v_mfma_f32_32x32x16_bf16 v[240:255], a[172:175], a[84:87], v[240:255]
  ds_read_b64_tr_b16 a[156:157], v6 offset:25600
  ds_read_b64_tr_b16 a[158:159], v6 offset:26112
  v_sqrt_f32 v211, v211
  s_waitcnt lgkmcnt(8)
  v_mfma_f32_32x32x16_bf16 v[224:239], a[176:179], a[88:91], v[224:239]
  ds_read_b64_tr_b16 a[160:161], v6 offset:8192
  ds_read_b64_tr_b16 a[162:163], v6 offset:8704
  s_nop 0
  v_cvt_pk_bf16_f32 v211, v211, v211
  v_and_b32 v211, 0xffff0000, v211
  v_mfma_f32_32x32x16_bf16 v[240:255], a[180:183], a[88:91], v[240:255]
  ds_read_b64_tr_b16 a[164:165], v6 offset:26624
  ds_read_b64_tr_b16 a[166:167], v6 offset:27136
  v_rcp_f32 v210, v211
  v_mul_f32 v36, v211, v211
  v_mfma_f32_32x32x16_bf16 v[224:239], a[184:187], a[92:95], v[224:239]
  ds_read_b64_tr_b16 a[168:169], v6 offset:9216
  ds_read_b64_tr_b16 a[170:171], v6 offset:9728
  buffer_load_dwordx4 v12, s[8:11], s34 offen offset:1024 lds
  v_mul_f32 v34, 0xc0135761, v210
  v_mul_f32 v211, v210, v210
  v_mfma_f32_32x32x16_bf16 v[240:255], a[188:191], a[92:95], v[240:255]
  ds_read_b64_tr_b16 a[172:173], v6 offset:27648
  ds_read_b64_tr_b16 a[174:175], v6 offset:28160
  v_mul_f32 v210, 0xbdd2d3e8, v210
  v_mul_f32 v35, v210, v211
  s_waitcnt lgkmcnt(8)
  v_mfma_f32_32x32x16_bf16 v[224:239], a[144:147], a[96:99], v[224:239]
  ds_read_b64_tr_b16 a[176:177], v6 offset:10240
  ds_read_b64_tr_b16 a[178:179], v6 offset:10752
  v_mfma_f32_32x32x16_bf16 v[240:255], a[148:151], a[96:99], v[240:255]
  ds_read_b64_tr_b16 a[180:181], v6 offset:28672
  ds_read_b64_tr_b16 a[182:183], v6 offset:29184
  v_mfma_f32_32x32x16_bf16 v[224:239], a[152:155], a[100:103], v[224:239]
  ds_read_b64_tr_b16 a[184:185], v6 offset:11264
  ds_read_b64_tr_b16 a[186:187], v6 offset:11776
  buffer_load_dwordx4 v13, s[8:11], s34 offen offset:2048 lds
  v_mfma_f32_32x32x16_bf16 v[240:255], a[156:159], a[100:103], v[240:255]
  ds_read_b64_tr_b16 a[188:189], v6 offset:29696
  ds_read_b64_tr_b16 a[190:191], v6 offset:30208
  s_waitcnt lgkmcnt(8)
  v_mfma_f32_32x32x16_bf16 v[224:239], a[160:163], a[104:107], v[224:239]
  ds_read_b64_tr_b16 a[144:145], v6 offset:12288
  ds_read_b64_tr_b16 a[146:147], v6 offset:12800
  s_add_u32 m0, s31, 43008
  v_mfma_f32_32x32x16_bf16 v[240:255], a[164:167], a[104:107], v[240:255]
HP_k3_p4:
  s_cbranch_execz HP_k3_p8
  ds_read_b64_tr_b16 a[148:149], v6 offset:30720
  ds_read_b64_tr_b16 a[150:151], v6 offset:31232
  s_waitcnt vmcnt(23)
  v_mfma_f32_32x32x16_bf16 v[224:239], a[168:171], a[108:111], v[224:239]
  ds_read_b64_tr_b16 a[152:153], v6 offset:13312
  ds_read_b64_tr_b16 a[154:155], v6 offset:13824
  buffer_load_dwordx4 v14, s[8:11], s34 offen lds
  v_mfma_f32_32x32x16_bf16 v[240:255], a[172:175], a[108:111], v[240:255]
  ds_read_b64_tr_b16 a[156:157], v6 offset:31744
  ds_read_b64_tr_b16 a[158:159], v6 offset:32256
  s_waitcnt lgkmcnt(8)
  s_waitcnt vmcnt(23)
  v_mfma_f32_32x32x16_bf16 v[224:239], a[176:179], a[112:115], v[224:239]
  ds_read_b64_tr_b16 a[160:161], v6 offset:14336
  ds_read_b64_tr_b16 a[162:163], v6 offset:14848
  v_mfma_f32_32x32x16_bf16 v[240:255], a[180:183], a[112:115], v[240:255]
  ds_read_b64_tr_b16 a[164:165], v6 offset:32768
  ds_read_b64_tr_b16 a[166:167], v6 offset:33280
  s_waitcnt vmcnt(20)
  v_mfma_f32_32x32x16_bf16 v[224:239], a[184:187], a[116:119], v[224:239]
  ds_read_b64_tr_b16 a[168:169], v6 offset:15360
  ds_read_b64_tr_b16 a[170:171], v6 offset:15872
  buffer_load_dwordx4 v15, s[8:11], s34 offen offset:1024 lds
  v_mfma_f32_32x32x16_bf16 v[240:255], a[188:191], a[116:119], v[240:255]
  ds_read_b64_tr_b16 a[172:173], v6 offset:33792
  ds_read_b64_tr_b16 a[174:175], v6 offset:34304
  s_waitcnt lgkmcnt(8)
  s_waitcnt vmcnt(19)
  v_mfma_f32_32x32x16_bf16 v[224:239], a[144:147], a[120:123], v[224:239]
  ds_read_b64_tr_b16 a[176:177], v6 offset:16384
  ds_read_b64_tr_b16 a[178:179], v6 offset:16896
  v_mfma_f32_32x32x16_bf16 v[240:255], a[148:151], a[120:123], v[240:255]
  ds_read_b64_tr_b16 a[180:181], v6 offset:34816
  ds_read_b64_tr_b16 a[182:183], v6 offset:35328
  s_waitcnt vmcnt(17)
  v_mfma_f32_32x32x16_bf16 v[224:239], a[152:155], a[124:127], v[224:239]
  ds_read_b64_tr_b16 a[184:185], v6 offset:17408
  ds_read_b64_tr_b16 a[186:187], v6 offset:17920
  buffer_load_dwordx4 v16, s[8:11], s34 offen offset:2048 lds
  v_mfma_f32_32x32x16_bf16 v[240:255], a[156:159], a[124:127], v[240:255]
  ds_read_b64_tr_b16 a[188:189], v6 offset:35840
  ds_read_b64_tr_b16 a[190:191], v6 offset:36352
  s_waitcnt lgkmcnt(8)
  s_waitcnt vmcnt(16)
  v_mfma_f32_32x32x16_bf16 v[224:239], a[160:163], a[128:131], v[224:239]
  s_waitcnt vmcnt(9)
  s_barrier
  ds_read_b64_tr_b16 a[144:145], v4 offset:0
  ds_read_b64_tr_b16 a[146:147], v4 offset:1024
  v_mfma_f32_32x32x16_bf16 v[240:255], a[164:167], a[128:131], v[240:255]
  ds_read_b64_tr_b16 a[148:149], v4 offset:18432
  ds_read_b64_tr_b16 a[150:151], v4 offset:19456
  s_add_u32 s34, s32, 128
  v_mfma_f32_32x32x16_bf16 v[224:239], a[168:171], a[132:135], v[224:239]
  ds_read_b64_tr_b16 a[152:153], v4 offset:512
  ds_read_b64_tr_b16 a[154:155], v4 offset:1536
  s_add_u32 m0, s31, 110592
  v_mfma_f32_32x32x16_bf16 v[240:255], a[172:175], a[132:135], v[240:255]
  ds_read_b64_tr_b16 a[156:157], v4 offset:18944
  ds_read_b64_tr_b16 a[158:159], v4 offset:19968
  buffer_load_dwordx4 v8, s[8:11], s34 offen lds
  s_waitcnt lgkmcnt(8)
  v_mfma_f32_32x32x16_bf16 v[224:239], a[176:179], a[136:139], v[224:239]
  ds_read_b64_tr_b16 a[160:161], v4 offset:2048
  ds_read_b64_tr_b16 a[162:163], v4 offset:3072
  v_mfma_f32_32x32x16_bf16 v[240:255], a[180:183], a[136:139], v[240:255]
  ds_read_b64_tr_b16 a[164:165], v4 offset:20480
  ds_read_b64_tr_b16 a[166:167], v4 offset:21504
  v_mfma_f32_32x32x16_bf16 v[224:239], a[184:187], a[140:143], v[224:239]
  ds_read_b64_tr_b16 a[168:169], v4 offset:2560
  ds_read_b64_tr_b16 a[170:171], v4 offset:3584
  buffer_load_dwordx4 v9, s[8:11], s34 offen offset:1024 lds
  v_mfma_f32_32x32x16_bf16 v[240:255], a[188:191], a[140:143], v[240:255]
  ds_read_b64_tr_b16 a[172:173], v4 offset:20992
  ds_read_b64_tr_b16 a[174:175], v4 offset:22016
  s_waitcnt lgkmcnt(8)
  v_mfma_f32_32x32x16_bf16 v[56:71], a[144:147], a[72:75], v[56:71]
  ds_read_b64_tr_b16 a[176:177], v4 offset:4096
  ds_read_b64_tr_b16 a[178:179], v4 offset:5120
  v_mfma_f32_32x32x16_bf16 v[72:87], a[148:151], a[72:75], v[72:87]
  ds_read_b64_tr_b16 a[180:181], v4 offset:22528
  ds_read_b64_tr_b16 a[182:183], v4 offset:23552
  v_mul_f32 v44, v224, v224
  v_mul_f32 v45, v225, v225
  v_fma_f32 v44, v44, v35, v34
  v_mfma_f32_32x32x16_bf16 v[88:103], a[152:155], a[72:75], v[88:103]
  ds_read_b64_tr_b16 a[184:185], v4 offset:4608
  ds_read_b64_tr_b16 a[186:187], v4 offset:5632
  buffer_load_dwordx4 v10, s[8:11], s34 offen offset:2048 lds
  v_fma_f32 v45, v45, v35, v34
  v_mul_f32 v44, v224, v44
  v_mfma_f32_32x32x16_bf16 v[104:119], a[156:159], a[72:75], v[104:119]
  ds_read_b64_tr_b16 a[188:189], v4 offset:23040
  ds_read_b64_tr_b16 a[190:191], v4 offset:24064
  v_mul_f32 v45, v225, v45
  v_mul_f32 v240, v224, v240
  s_waitcnt lgkmcnt(8)
  v_mfma_f32_32x32x16_bf16 v[56:71], a[160:163], a[76:79], v[56:71]
  ds_read_b64_tr_b16 a[144:145], v4 offset:6144
  ds_read_b64_tr_b16 a[146:147], v4 offset:7168
  s_add_u32 m0, s31, 113664
  v_exp_f32 v44, v44
  v_mfma_f32_32x32x16_bf16 v[72:87], a[164:167], a[76:79], v[72:87]
  ds_read_b64_tr_b16 a[148:149], v4 offset:24576
  ds_read_b64_tr_b16 a[150:151], v4 offset:25600
  v_exp_f32 v45, v45
  v_mul_f32 v241, v225, v241
  v_mfma_f32_32x32x16_bf16 v[88:103], a[168:171], a[76:79], v[88:103]
  ds_read_b64_tr_b16 a[152:153], v4 offset:6656
  ds_read_b64_tr_b16 a[154:155], v4 offset:7680
  buffer_load_dwordx4 v11, s[8:11], s34 offen lds
  v_fma_f32 v44, v44, v36, v36
  v_fma_f32 v45, v45, v36, v36
  v_mfma_f32_32x32x16_bf16 v[104:119], a[172:175], a[76:79], v[104:119]
  ds_read_b64_tr_b16 a[156:157], v4 offset:25088
  ds_read_b64_tr_b16 a[158:159], v4 offset:26112
  v_rcp_f32 v44, v44
  s_waitcnt lgkmcnt(8)
  v_mfma_f32_32x32x16_bf16 v[56:71], a[176:179], a[80:83], v[56:71]
  ds_read_b64_tr_b16 a[160:161], v4 offset:8192
  ds_read_b64_tr_b16 a[162:163], v4 offset:9216
  v_rcp_f32 v45, v45
  v_mul_f32 v44, v240, v44
  v_mfma_f32_32x32x16_bf16 v[72:87], a[180:183], a[80:83], v[72:87]
  ds_read_b64_tr_b16 a[164:165], v4 offset:26624
  ds_read_b64_tr_b16 a[166:167], v4 offset:27648
  v_mul_f32 v45, v241, v45
  v_cvt_pk_bf16_f32 v200, v44, v45
  v_mul_f32 v46, v226, v226
  v_mfma_f32_32x32x16_bf16 v[88:103], a[184:187], a[80:83], v[88:103]
  ds_read_b64_tr_b16 a[168:169], v4 offset:8704
  ds_read_b64_tr_b16 a[170:171], v4 offset:9728
  buffer_load_dwordx4 v12, s[8:11], s34 offen offset:1024 lds
  v_mul_f32 v47, v227, v227
  v_fma_f32 v46, v46, v35, v34
  v_mfma_f32_32x32x16_bf16 v[104:119], a[188:191], a[80:83], v[104:119]
  ds_read_b64_tr_b16 a[172:173], v4 offset:27136
  ds_read_b64_tr_b16 a[174:175], v4 offset:28160
  v_fma_f32 v47, v47, v35, v34
  v_mul_f32 v46, v226, v46
  s_waitcnt lgkmcnt(8)
  v_mfma_f32_32x32x16_bf16 v[56:71], a[144:147], a[84:87], v[56:71]
  ds_read_b64_tr_b16 a[176:177], v4 offset:10240
HP_k3_p5:
  s_cbranch_execz HP_k3_p9
  ds_read_b64_tr_b16 a[178:179], v4 offset:11264
  v_mul_f32 v47, v227, v47
  v_exp_f32 v46, v46
  v_mfma_f32_32x32x16_bf16 v[72:87], a[148:151], a[84:87], v[72:87]
  ds_read_b64_tr_b16 a[180:181], v4 offset:28672
  ds_read_b64_tr_b16 a[182:183], v4 offset:29696
  v_mul_f32 v242, v226, v242
  v_exp_f32 v47, v47
  v_mfma_f32_32x32x16_bf16 v[88:103], a[152:155], a[84:87], v[88:103]
  ds_read_b64_tr_b16 a[184:185], v4 offset:10752
  ds_read_b64_tr_b16 a[186:187], v4 offset:11776
  buffer_load_dwordx4 v13, s[8:11], s34 offen offset:2048 lds
  v_mul_f32 v243, v227, v243
  v_fma_f32 v46, v46, v36, v36
  v_mfma_f32_32x32x16_bf16 v[104:119], a[156:159], a[84:87], v[104:119]
  ds_read_b64_tr_b16 a[188:189], v4 offset:29184
  ds_read_b64_tr_b16 a[190:191], v4 offset:30208
  v_fma_f32 v47, v47, v36, v36
  v_mul_f32 v44, v228, v228
  s_waitcnt lgkmcnt(8)
  v_mfma_f32_32x32x16_bf16 v[56:71], a[160:163], a[88:91], v[56:71]
  ds_read_b64_tr_b16 a[144:145], v4 offset:12288
  ds_read_b64_tr_b16 a[146:147], v4 offset:13312
  s_add_u32 m0, s31, 116736
  v_rcp_f32 v46, v46
  v_mfma_f32_32x32x16_bf16 v[72:87], a[164:167], a[88:91], v[72:87]
  ds_read_b64_tr_b16 a[148:149], v4 offset:30720
  ds_read_b64_tr_b16 a[150:151], v4 offset:31744
  v_rcp_f32 v47, v47
  v_mul_f32 v46, v242, v46
  v_mfma_f32_32x32x16_bf16 v[88:103], a[168:171], a[88:91], v[88:103]
  ds_read_b64_tr_b16 a[152:153], v4 offset:12800
  ds_read_b64_tr_b16 a[154:155], v4 offset:13824
  buffer_load_dwordx4 v14, s[8:11], s34 offen lds
  v_mul_f32 v47, v243, v47
  v_cvt_pk_bf16_f32 v201, v46, v47
  v_mfma_f32_32x32x16_bf16 v[104:119], a[172:175], a[88:91], v[104:119]
  ds_read_b64_tr_b16 a[156:157], v4 offset:31232
  ds_read_b64_tr_b16 a[158:159], v4 offset:32256
  v_mul_f32 v45, v229, v229
  v_fma_f32 v44, v44, v35, v34
  s_waitcnt lgkmcnt(8)
  v_mfma_f32_32x32x16_bf16 v[56:71], a[176:179], a[92:95], v[56:71]
  ds_read_b64_tr_b16 a[160:161], v4 offset:14336
  ds_read_b64_tr_b16 a[162:163], v4 offset:15360
  v_fma_f32 v45, v45, v35, v34
  v_mul_f32 v44, v228, v44
  v_mul_f32 v45, v229, v45
  v_mfma_f32_32x32x16_bf16 v[72:87], a[180:183], a[92:95], v[72:87]
  ds_read_b64_tr_b16 a[164:165], v4 offset:32768
  ds_read_b64_tr_b16 a[166:167], v4 offset:33792
  v_exp_f32 v44, v44
  v_mul_f32 v244, v228, v244
  v_mfma_f32_32x32x16_bf16 v[88:103], a[184:187], a[92:95], v[88:103]
  ds_read_b64_tr_b16 a[168:169], v4 offset:14848
  ds_read_b64_tr_b16 a[170:171], v4 offset:15872
  s_add_u32 s51, s35, 3145728
  buffer_load_dwordx4 a[240:243], v54, s[16:19], s51 offen sc0 sc1
  v_mfma_f32_32x32x16_bf16 v[104:119], a[188:191], a[92:95], v[104:119]
  ds_read_b64_tr_b16 a[172:173], v4 offset:33280
  ds_read_b64_tr_b16 a[174:175], v4 offset:34304
  buffer_load_dwordx4 v15, s[8:11], s34 offen offset:1024 lds
  v_mul_f32 v245, v229, v245
  s_waitcnt lgkmcnt(8)
  v_mfma_f32_32x32x16_bf16 v[56:71], a[144:147], a[96:99], v[56:71]
  ds_read_b64_tr_b16 a[176:177], v4 offset:16384
  ds_read_b64_tr_b16 a[178:179], v4 offset:17408
  s_add_u32 s51, s35, 3149824
  buffer_load_dwordx4 a[244:247], v54, s[16:19], s51 offen sc0 sc1
  v_mfma_f32_32x32x16_bf16 v[72:87], a[148:151], a[96:99], v[72:87]
  ds_read_b64_tr_b16 a[180:181], v4 offset:34816
  ds_read_b64_tr_b16 a[182:183], v4 offset:35840
  v_exp_f32 v45, v45
  v_fma_f32 v44, v44, v36, v36
  v_mfma_f32_32x32x16_bf16 v[88:103], a[152:155], a[96:99], v[88:103]
  ds_read_b64_tr_b16 a[184:185], v4 offset:16896
  ds_read_b64_tr_b16 a[186:187], v4 offset:17920
  buffer_load_dwordx4 v16, s[8:11], s34 offen offset:2048 lds
  s_add_u32 s51, s35, 3145728
  buffer_load_dwordx4 a[248:251], v55, s[16:19], s51 offen sc0 sc1
  v_mfma_f32_32x32x16_bf16 v[104:119], a[156:159], a[96:99], v[104:119]
  ds_read_b64_tr_b16 a[188:189], v4 offset:35328
  ds_read_b64_tr_b16 a[190:191], v4 offset:36352
  v_fma_f32 v45, v45, v36, v36
  v_mul_f32 v46, v230, v230
  s_waitcnt lgkmcnt(8)
  v_mfma_f32_32x32x16_bf16 v[56:71], a[160:163], a[100:103], v[56:71]
  s_waitcnt vmcnt(12)
  s_barrier
  ds_read_b64_tr_b16 a[144:145], v5 offset:0
  ds_read_b64_tr_b16 a[146:147], v5 offset:1024
  v_mfma_f32_32x32x16_bf16 v[72:87], a[164:167], a[100:103], v[72:87]
  ds_read_b64_tr_b16 a[148:149], v5 offset:18432
  ds_read_b64_tr_b16 a[150:151], v5 offset:19456
  s_add_u32 s34, s32, 1327232
  v_rcp_f32 v44, v44
  v_mfma_f32_32x32x16_bf16 v[88:103], a[168:171], a[100:103], v[88:103]
  ds_read_b64_tr_b16 a[152:153], v5 offset:512
  ds_read_b64_tr_b16 a[154:155], v5 offset:1536
  s_add_u32 m0, s31, 73728
  v_rcp_f32 v45, v45
  v_mfma_f32_32x32x16_bf16 v[104:119], a[172:175], a[100:103], v[104:119]
  ds_read_b64_tr_b16 a[156:157], v5 offset:18944
  ds_read_b64_tr_b16 a[158:159], v5 offset:19968
  buffer_load_dwordx4 v8, s[8:11], s34 offen lds
  v_mul_f32 v44, v244, v44
  s_waitcnt lgkmcnt(8)
  v_mfma_f32_32x32x16_bf16 v[56:71], a[176:179], a[104:107], v[56:71]
  ds_read_b64_tr_b16 a[160:161], v5 offset:2048
  ds_read_b64_tr_b16 a[162:163], v5 offset:3072
  v_mul_f32 v45, v245, v45
  v_cvt_pk_bf16_f32 v202, v44, v45
  v_mul_f32 v47, v231, v231
  v_mfma_f32_32x32x16_bf16 v[72:87], a[180:183], a[104:107], v[72:87]
  ds_read_b64_tr_b16 a[164:165], v5 offset:20480
  ds_read_b64_tr_b16 a[166:167], v5 offset:21504
  v_fma_f32 v46, v46, v35, v34
  v_fma_f32 v47, v47, v35, v34
  v_mul_f32 v46, v230, v46
  v_mfma_f32_32x32x16_bf16 v[88:103], a[184:187], a[104:107], v[88:103]
  ds_read_b64_tr_b16 a[168:169], v5 offset:2560
  ds_read_b64_tr_b16 a[170:171], v5 offset:3584
  buffer_load_dwordx4 v9, s[8:11], s34 offen offset:1024 lds
  v_mul_f32 v47, v231, v47
  v_mul_f32 v246, v230, v246
  v_mfma_f32_32x32x16_bf16 v[104:119], a[188:191], a[104:107], v[104:119]
  ds_read_b64_tr_b16 a[172:173], v5 offset:20992
  ds_read_b64_tr_b16 a[174:175], v5 offset:22016
  v_exp_f32 v46, v46
  s_waitcnt lgkmcnt(8)
  v_mfma_f32_32x32x16_bf16 v[56:71], a[144:147], a[108:111], v[56:71]
  ds_read_b64_tr_b16 a[176:177], v5 offset:4096
  ds_read_b64_tr_b16 a[178:179], v5 offset:5120
  v_exp_f32 v47, v47
  v_mul_f32 v247, v231, v247
  v_mfma_f32_32x32x16_bf16 v[72:87], a[148:151], a[108:111], v[72:87]
  ds_read_b64_tr_b16 a[180:181], v5 offset:22528
  ds_read_b64_tr_b16 a[182:183], v5 offset:23552
  v_fma_f32 v46, v46, v36, v36
  v_fma_f32 v47, v47, v36, v36
  v_mul_f32 v44, v232, v232
  v_mfma_f32_32x32x16_bf16 v[88:103], a[152:155], a[108:111], v[88:103]
  ds_read_b64_tr_b16 a[184:185], v5 offset:4608
  ds_read_b64_tr_b16 a[186:187], v5 offset:5632
  buffer_load_dwordx4 v10, s[8:11], s34 offen offset:2048 lds
  v_rcp_f32 v46, v46
  v_mfma_f32_32x32x16_bf16 v[104:119], a[156:159], a[108:111], v[104:119]
HP_k3_p6:
  s_cbranch_execz HP_k3_p10
  ds_read_b64_tr_b16 a[188:189], v5 offset:23040
  ds_read_b64_tr_b16 a[190:191], v5 offset:24064
  v_rcp_f32 v47, v47
  s_waitcnt lgkmcnt(8)
  v_mfma_f32_32x32x16_bf16 v[56:71], a[160:163], a[112:115], v[56:71]
  ds_read_b64_tr_b16 a[144:145], v5 offset:6144
  ds_read_b64_tr_b16 a[146:147], v5 offset:7168
  s_add_u32 m0, s31, 76800
  v_mul_f32 v46, v246, v46
  v_mul_f32 v47, v247, v47
  v_mfma_f32_32x32x16_bf16 v[72:87], a[164:167], a[112:115], v[72:87]
  ds_read_b64_tr_b16 a[148:149], v5 offset:24576
  ds_read_b64_tr_b16 a[150:151], v5 offset:25600
  v_cvt_pk_bf16_f32 v203, v46, v47
  v_mul_f32 v45, v233, v233
  v_fma_f32 v44, v44, v35, v34
  v_mfma_f32_32x32x16_bf16 v[88:103], a[168:171], a[112:115], v[88:103]
  ds_read_b64_tr_b16 a[152:153], v5 offset:6656
  ds_read_b64_tr_b16 a[154:155], v5 offset:7680
  buffer_load_dwordx4 v11, s[8:11], s34 offen lds
  v_fma_f32 v45, v45, v35, v34
  v_mul_f32 v44, v232, v44
  v_mfma_f32_32x32x16_bf16 v[104:119], a[172:175], a[112:115], v[104:119]
  ds_read_b64_tr_b16 a[156:157], v5 offset:25088
  ds_read_b64_tr_b16 a[158:159], v5 offset:26112
  s_add_u32 s59, s40, 16384
  buffer_store_dwordx4 v[200:203], v37, s[16:19], s59 offen sc0 sc1
  s_waitcnt lgkmcnt(8)
  v_mfma_f32_32x32x16_bf16 v[56:71], a[176:179], a[116:119], v[56:71]
  ds_read_b64_tr_b16 a[160:161], v5 offset:8192
  ds_read_b64_tr_b16 a[162:163], v5 offset:9216
  v_mul_f32 v45, v233, v45
  v_exp_f32 v44, v44
  v_mfma_f32_32x32x16_bf16 v[72:87], a[180:183], a[116:119], v[72:87]
  ds_read_b64_tr_b16 a[164:165], v5 offset:26624
  ds_read_b64_tr_b16 a[166:167], v5 offset:27648
  v_mul_f32 v248, v232, v248
  v_exp_f32 v45, v45
  v_mfma_f32_32x32x16_bf16 v[88:103], a[184:187], a[116:119], v[88:103]
  ds_read_b64_tr_b16 a[168:169], v5 offset:8704
  ds_read_b64_tr_b16 a[170:171], v5 offset:9728
  buffer_load_dwordx4 v12, s[8:11], s34 offen offset:1024 lds
  v_mul_f32 v249, v233, v249
  v_fma_f32 v44, v44, v36, v36
  v_mfma_f32_32x32x16_bf16 v[104:119], a[188:191], a[116:119], v[104:119]
  ds_read_b64_tr_b16 a[172:173], v5 offset:27136
  ds_read_b64_tr_b16 a[174:175], v5 offset:28160
  v_fma_f32 v45, v45, v36, v36
  v_mul_f32 v46, v234, v234
  s_waitcnt lgkmcnt(8)
  v_mfma_f32_32x32x16_bf16 v[56:71], a[144:147], a[120:123], v[56:71]
  ds_read_b64_tr_b16 a[176:177], v5 offset:10240
  ds_read_b64_tr_b16 a[178:179], v5 offset:11264
  v_rcp_f32 v44, v44
  v_mul_f32 v47, v235, v235
  v_mfma_f32_32x32x16_bf16 v[72:87], a[148:151], a[120:123], v[72:87]
  ds_read_b64_tr_b16 a[180:181], v5 offset:28672
  ds_read_b64_tr_b16 a[182:183], v5 offset:29696
  v_rcp_f32 v45, v45
  v_mul_f32 v44, v248, v44
  v_mfma_f32_32x32x16_bf16 v[88:103], a[152:155], a[120:123], v[88:103]
  ds_read_b64_tr_b16 a[184:185], v5 offset:10752
  ds_read_b64_tr_b16 a[186:187], v5 offset:11776
  buffer_load_dwordx4 v13, s[8:11], s34 offen offset:2048 lds
  v_mul_f32 v45, v249, v45
  v_cvt_pk_bf16_f32 v204, v44, v45
  v_mfma_f32_32x32x16_bf16 v[104:119], a[156:159], a[120:123], v[104:119]
  ds_read_b64_tr_b16 a[188:189], v5 offset:29184
  ds_read_b64_tr_b16 a[190:191], v5 offset:30208
  v_fma_f32 v46, v46, v35, v34
  v_fma_f32 v47, v47, v35, v34
  s_waitcnt lgkmcnt(8)
  v_mfma_f32_32x32x16_bf16 v[56:71], a[160:163], a[124:127], v[56:71]
  ds_read_b64_tr_b16 a[144:145], v5 offset:12288
  ds_read_b64_tr_b16 a[146:147], v5 offset:13312
  s_add_u32 m0, s31, 79872
  v_mul_f32 v46, v234, v46
  v_mul_f32 v47, v235, v47
  v_mfma_f32_32x32x16_bf16 v[72:87], a[164:167], a[124:127], v[72:87]
  ds_read_b64_tr_b16 a[148:149], v5 offset:30720
  ds_read_b64_tr_b16 a[150:151], v5 offset:31744
  v_exp_f32 v46, v46
  v_mul_f32 v250, v234, v250
  v_mfma_f32_32x32x16_bf16 v[88:103], a[168:171], a[124:127], v[88:103]
  ds_read_b64_tr_b16 a[152:153], v5 offset:12800
  ds_read_b64_tr_b16 a[154:155], v5 offset:13824
  buffer_load_dwordx4 v14, s[8:11], s34 offen lds
  v_exp_f32 v47, v47
  v_mfma_f32_32x32x16_bf16 v[104:119], a[172:175], a[124:127], v[104:119]
  ds_read_b64_tr_b16 a[156:157], v5 offset:31232
  ds_read_b64_tr_b16 a[158:159], v5 offset:32256
  v_mul_f32 v251, v235, v251
  v_fma_f32 v46, v46, v36, v36
  s_waitcnt lgkmcnt(8)
  v_mfma_f32_32x32x16_bf16 v[56:71], a[176:179], a[128:131], v[56:71]
  ds_read_b64_tr_b16 a[160:161], v5 offset:14336
  ds_read_b64_tr_b16 a[162:163], v5 offset:15360
  v_fma_f32 v47, v47, v36, v36
  v_rcp_f32 v46, v46
  v_mfma_f32_32x32x16_bf16 v[72:87], a[180:183], a[128:131], v[72:87]
  ds_read_b64_tr_b16 a[164:165], v5 offset:32768
  ds_read_b64_tr_b16 a[166:167], v5 offset:33792
  v_rcp_f32 v47, v47
  v_mul_f32 v46, v250, v46
  v_mfma_f32_32x32x16_bf16 v[88:103], a[184:187], a[128:131], v[88:103]
  ds_read_b64_tr_b16 a[168:169], v5 offset:16384
  ds_read_b64_tr_b16 a[170:171], v5 offset:17408
  buffer_load_dwordx4 v15, s[8:11], s34 offen offset:1024 lds
  v_mul_f32 v47, v251, v47
  v_cvt_pk_bf16_f32 v205, v46, v47
  v_mfma_f32_32x32x16_bf16 v[104:119], a[188:191], a[128:131], v[104:119]
  ds_read_b64_tr_b16 a[172:173], v5 offset:34816
  ds_read_b64_tr_b16 a[174:175], v5 offset:35840
  v_mul_f32 v44, v236, v236
  v_mul_f32 v45, v237, v237
  s_waitcnt lgkmcnt(8)
  v_mfma_f32_32x32x16_bf16 v[56:71], a[144:147], a[132:135], v[56:71]
  ds_read_b64_tr_b16 a[176:177], v5 offset:14848
  ds_read_b64_tr_b16 a[178:179], v5 offset:15872
  v_fma_f32 v44, v44, v35, v34
  v_fma_f32 v45, v45, v35, v34
  v_mul_f32 v44, v236, v44
  v_mfma_f32_32x32x16_bf16 v[72:87], a[148:151], a[132:135], v[72:87]
  ds_read_b64_tr_b16 a[180:181], v5 offset:33280
  ds_read_b64_tr_b16 a[182:183], v5 offset:34304
  v_mul_f32 v45, v237, v45
  v_exp_f32 v44, v44
  v_mfma_f32_32x32x16_bf16 v[88:103], a[152:155], a[132:135], v[88:103]
  ds_read_b64_tr_b16 a[184:185], v5 offset:16896
  ds_read_b64_tr_b16 a[186:187], v5 offset:17920
  buffer_load_dwordx4 v16, s[8:11], s34 offen offset:2048 lds
  v_mul_f32 v252, v236, v252
  v_mul_f32 v253, v237, v253
  v_mfma_f32_32x32x16_bf16 v[104:119], a[156:159], a[132:135], v[104:119]
  ds_read_b64_tr_b16 a[188:189], v5 offset:35328
  ds_read_b64_tr_b16 a[190:191], v5 offset:36352
  v_exp_f32 v45, v45
  s_waitcnt lgkmcnt(8)
  v_mfma_f32_32x32x16_bf16 v[56:71], a[160:163], a[136:139], v[56:71]
  s_waitcnt vmcnt(9)
  s_barrier
  ds_read_b64_tr_b16 a[144:145], v7 offset:0
  ds_read_b64_tr_b16 a[146:147], v7 offset:1024
  v_fma_f32 v44, v44, v36, v36
  v_mfma_f32_32x32x16_bf16 v[72:87], a[164:167], a[136:139], v[72:87]
  ds_read_b64_tr_b16 a[148:149], v7 offset:18432
  ds_read_b64_tr_b16 a[150:151], v7 offset:19456
  v_fma_f32 v45, v45, v36, v36
  v_rcp_f32 v44, v44
HP_k3_p7:
  s_cbranch_execz HP_k3_p11
  v_mul_f32 v46, v238, v238
  v_mfma_f32_32x32x16_bf16 v[120:135], a[168:171], a[140:143], v[56:71]
  ds_read_b64_tr_b16 a[152:153], v7 offset:512
  ds_read_b64_tr_b16 a[154:155], v7 offset:1536
  v_rcp_f32 v45, v45
  v_mul_f32 v44, v252, v44
  v_mul_f32 v45, v253, v45
  v_mfma_f32_32x32x16_bf16 v[136:151], a[172:175], a[140:143], v[72:87]
  ds_read_b64_tr_b16 a[156:157], v7 offset:18944
  ds_read_b64_tr_b16 a[158:159], v7 offset:19968
  v_cvt_pk_bf16_f32 v206, v44, v45
  v_mul_f32 v47, v239, v239
  v_fma_f32 v46, v46, v35, v34
  s_waitcnt lgkmcnt(8)
  v_mfma_f32_32x32x16_bf16 v[88:103], a[176:179], a[136:139], v[88:103]
  ds_read_b64_tr_b16 a[160:161], v7 offset:2048
  ds_read_b64_tr_b16 a[162:163], v7 offset:3072
  v_fma_f32 v47, v47, v35, v34
  v_mul_f32 v46, v238, v46
  v_mul_f32 v47, v239, v47
  v_mul_f32 v254, v238, v254
  v_mfma_f32_32x32x16_bf16 v[104:119], a[180:183], a[136:139], v[104:119]
  ds_read_b64_tr_b16 a[164:165], v7 offset:20480
  ds_read_b64_tr_b16 a[166:167], v7 offset:21504
  v_exp_f32 v46, v46
  v_exp_f32 v47, v47
  v_mfma_f32_32x32x16_bf16 v[152:167], a[184:187], a[140:143], v[88:103]
  ds_read_b64_tr_b16 a[168:169], v7 offset:2560
  ds_read_b64_tr_b16 a[170:171], v7 offset:3584
  v_mul_f32 v255, v239, v255
  v_fma_f32 v46, v46, v36, v36
  v_fma_f32 v47, v47, v36, v36
  v_rcp_f32 v46, v46
  v_rcp_f32 v47, v47
  v_mul_f32 v46, v254, v46
  v_mul_f32 v47, v255, v47
  v_cvt_pk_bf16_f32 v207, v46, v47
  buffer_store_dwordx4 v[204:207], v37, s[16:19], s59 offen offset:1024 sc0 sc1
.p2align 3
K3_body:
  v_mfma_f32_32x32x16_bf16 v[168:183], a[188:191], a[140:143], v[104:119]
  ds_read_b64_tr_b16 a[172:173], v7 offset:20992
  ds_read_b64_tr_b16 a[174:175], v7 offset:22016
  s_add_u32 m0, s31, 0
  v_mul_f32 v44, v120, v120
  v_mul_f32 v45, v121, v121
  s_waitcnt lgkmcnt(8)
  v_mfma_f32_32x32x16_bf16 v[56:71], a[144:147], a[0:3], 0
  ds_read_b64_tr_b16 a[176:177], v7 offset:4096
  ds_read_b64_tr_b16 a[178:179], v7 offset:5120
  buffer_load_dwordx4 v8, s[8:11], s21 offen lds
  v_fma_f32 v44, v44, v35, v34
  v_fma_f32 v45, v45, v35, v34
  v_mul_f32 v44, v120, v44
  v_mfma_f32_32x32x16_bf16 v[72:87], a[148:151], a[0:3], 0
  ds_read_b64_tr_b16 a[180:181], v7 offset:22528
  ds_read_b64_tr_b16 a[182:183], v7 offset:23552
  buffer_load_dwordx4 v9, s[8:11], s21 offen offset:1024 lds
  v_mul_f32 v45, v121, v45
  v_exp_f32 v44, v44
  v_mfma_f32_32x32x16_bf16 v[88:103], a[152:155], a[0:3], 0
  ds_read_b64_tr_b16 a[184:185], v7 offset:4608
  ds_read_b64_tr_b16 a[186:187], v7 offset:5632
  buffer_load_dwordx4 v10, s[8:11], s21 offen offset:2048 lds
  v_mul_f32 v136, v120, v136
  v_exp_f32 v45, v45
  v_mfma_f32_32x32x16_bf16 v[104:119], a[156:159], a[0:3], 0
  ds_read_b64_tr_b16 a[188:189], v7 offset:23040
  ds_read_b64_tr_b16 a[190:191], v7 offset:24064
  v_mul_f32 v137, v121, v137
  v_fma_f32 v44, v44, v36, v36
  v_fma_f32 v45, v45, v36, v36
  s_waitcnt lgkmcnt(8)
  v_mfma_f32_32x32x16_bf16 v[56:71], a[160:163], a[4:7], v[56:71]
  ds_read_b64_tr_b16 a[144:145], v7 offset:6144
  ds_read_b64_tr_b16 a[146:147], v7 offset:7168
  s_add_u32 m0, s31, 3072
  v_rcp_f32 v44, v44
  v_mul_f32 v46, v122, v122
  v_mfma_f32_32x32x16_bf16 v[72:87], a[164:167], a[4:7], v[72:87]
  ds_read_b64_tr_b16 a[148:149], v7 offset:24576
  ds_read_b64_tr_b16 a[150:151], v7 offset:25600
  v_rcp_f32 v45, v45
  v_mul_f32 v44, v136, v44
  v_mul_f32 v45, v137, v45
  v_mfma_f32_32x32x16_bf16 v[88:103], a[168:171], a[4:7], v[88:103]
  ds_read_b64_tr_b16 a[152:153], v7 offset:6656
  ds_read_b64_tr_b16 a[154:155], v7 offset:7680
  buffer_load_dwordx4 v11, s[8:11], s21 offen lds
  v_cvt_pk_bf16_f32 v184, v44, v45
  v_mul_f32 v47, v123, v123
  v_fma_f32 v46, v46, v35, v34
  v_mfma_f32_32x32x16_bf16 v[104:119], a[172:175], a[4:7], v[104:119]
  ds_read_b64_tr_b16 a[156:157], v7 offset:25088
  ds_read_b64_tr_b16 a[158:159], v7 offset:26112
  v_fma_f32 v47, v47, v35, v34
  v_mul_f32 v46, v122, v46
  v_mul_f32 v47, v123, v47
  s_waitcnt lgkmcnt(8)
  v_mfma_f32_32x32x16_bf16 v[56:71], a[176:179], a[8:11], v[56:71]
  ds_read_b64_tr_b16 a[160:161], v7 offset:8192
  ds_read_b64_tr_b16 a[162:163], v7 offset:9216
  v_exp_f32 v46, v46
  v_mul_f32 v138, v122, v138
  v_mul_f32 v139, v123, v139
  v_mfma_f32_32x32x16_bf16 v[72:87], a[180:183], a[8:11], v[72:87]
  ds_read_b64_tr_b16 a[164:165], v7 offset:26624
  ds_read_b64_tr_b16 a[166:167], v7 offset:27648
  v_exp_f32 v47, v47
  v_fma_f32 v46, v46, v36, v36
  v_fma_f32 v47, v47, v36, v36
  v_mfma_f32_32x32x16_bf16 v[88:103], a[184:187], a[8:11], v[88:103]
  ds_read_b64_tr_b16 a[168:169], v7 offset:8704
  ds_read_b64_tr_b16 a[170:171], v7 offset:9728
  buffer_load_dwordx4 v12, s[8:11], s21 offen offset:1024 lds
  v_rcp_f32 v46, v46
  v_mul_f32 v44, v124, v124
  v_mfma_f32_32x32x16_bf16 v[104:119], a[188:191], a[8:11], v[104:119]
  ds_read_b64_tr_b16 a[172:173], v7 offset:27136
  ds_read_b64_tr_b16 a[174:175], v7 offset:28160
  v_rcp_f32 v47, v47
  v_mul_f32 v46, v138, v46
  s_waitcnt lgkmcnt(8)
  v_mfma_f32_32x32x16_bf16 v[56:71], a[144:147], a[12:15], v[56:71]
  ds_read_b64_tr_b16 a[176:177], v7 offset:10240
  ds_read_b64_tr_b16 a[178:179], v7 offset:11264
  v_mul_f32 v47, v139, v47
  v_cvt_pk_bf16_f32 v185, v46, v47
  v_mul_f32 v45, v125, v125
  v_fma_f32 v44, v44, v35, v34
  v_mfma_f32_32x32x16_bf16 v[72:87], a[148:151], a[12:15], v[72:87]
  ds_read_b64_tr_b16 a[180:181], v7 offset:28672
  ds_read_b64_tr_b16 a[182:183], v7 offset:29696
  v_fma_f32 v45, v45, v35, v34
  v_mul_f32 v44, v124, v44
  v_mul_f32 v45, v125, v45
  v_mul_f32 v140, v124, v140
  v_mfma_f32_32x32x16_bf16 v[88:103], a[152:155], a[12:15], v[88:103]
  ds_read_b64_tr_b16 a[184:185], v7 offset:10752
  ds_read_b64_tr_b16 a[186:187], v7 offset:11776
  buffer_load_dwordx4 v13, s[8:11], s21 offen offset:2048 lds
  v_exp_f32 v44, v44
  v_mul_f32 v141, v125, v141
  v_mfma_f32_32x32x16_bf16 v[104:119], a[156:159], a[12:15], v[104:119]
  ds_read_b64_tr_b16 a[188:189], v7 offset:29184
  ds_read_b64_tr_b16 a[190:191], v7 offset:30208
  v_exp_f32 v45, v45
  v_fma_f32 v44, v44, v36, v36
  s_waitcnt lgkmcnt(8)
  v_mfma_f32_32x32x16_bf16 v[56:71], a[160:163], a[16:19], v[56:71]
  ds_read_b64_tr_b16 a[144:145], v7 offset:12288
  ds_read_b64_tr_b16 a[146:147], v7 offset:13312
  s_add_u32 m0, s31, 6144
  v_fma_f32 v45, v45, v36, v36
  v_rcp_f32 v44, v44
  v_mfma_f32_32x32x16_bf16 v[72:87], a[164:167], a[16:19], v[72:87]
  ds_read_b64_tr_b16 a[148:149], v7 offset:30720
HP_k3_p8:
  s_cbranch_execz HP_k3_p12
  ds_read_b64_tr_b16 a[150:151], v7 offset:31744
  v_rcp_f32 v45, v45
  v_mul_f32 v44, v140, v44
  v_mul_f32 v45, v141, v45
  v_mfma_f32_32x32x16_bf16 v[88:103], a[168:171], a[16:19], v[88:103]
  ds_read_b64_tr_b16 a[152:153], v7 offset:12800
  ds_read_b64_tr_b16 a[154:155], v7 offset:13824
  buffer_load_dwordx4 v14, s[8:11], s21 offen lds
  v_cvt_pk_bf16_f32 v186, v44, v45
  v_mul_f32 v46, v126, v126
  v_mul_f32 v47, v127, v127
  v_mfma_f32_32x32x16_bf16 v[104:119], a[172:175], a[16:19], v[104:119]
  ds_read_b64_tr_b16 a[156:157], v7 offset:31232
  ds_read_b64_tr_b16 a[158:159], v7 offset:32256
  v_fma_f32 v46, v46, v35, v34
  v_fma_f32 v47, v47, v35, v34
  v_mul_f32 v46, v126, v46
  s_waitcnt lgkmcnt(8)
  v_mfma_f32_32x32x16_bf16 v[56:71], a[176:179], a[20:23], v[56:71]
  ds_read_b64_tr_b16 a[160:161], v7 offset:14336
  ds_read_b64_tr_b16 a[162:163], v7 offset:15360
  v_mul_f32 v47, v127, v47
  v_exp_f32 v46, v46
  v_mul_f32 v142, v126, v142
  v_mfma_f32_32x32x16_bf16 v[72:87], a[180:183], a[20:23], v[72:87]
  ds_read_b64_tr_b16 a[164:165], v7 offset:32768
  ds_read_b64_tr_b16 a[166:167], v7 offset:33792
  v_exp_f32 v47, v47
  v_mul_f32 v143, v127, v143
  v_fma_f32 v46, v46, v36, v36
  v_mfma_f32_32x32x16_bf16 v[88:103], a[184:187], a[20:23], v[88:103]
  ds_read_b64_tr_b16 a[168:169], v7 offset:14848
  ds_read_b64_tr_b16 a[170:171], v7 offset:15872
  buffer_load_dwordx4 v15, s[8:11], s21 offen offset:1024 lds
  v_fma_f32 v47, v47, v36, v36
  v_rcp_f32 v46, v46
  v_mfma_f32_32x32x16_bf16 v[104:119], a[188:191], a[20:23], v[104:119]
  ds_read_b64_tr_b16 a[172:173], v7 offset:33280
  ds_read_b64_tr_b16 a[174:175], v7 offset:34304
  v_rcp_f32 v47, v47
  v_mul_f32 v46, v142, v46
  s_waitcnt lgkmcnt(8)
  v_mfma_f32_32x32x16_bf16 v[56:71], a[144:147], a[24:27], v[56:71]
  ds_read_b64_tr_b16 a[176:177], v7 offset:16384
  ds_read_b64_tr_b16 a[178:179], v7 offset:17408
  v_mul_f32 v47, v143, v47
  v_cvt_pk_bf16_f32 v187, v46, v47
  v_mul_f32 v44, v128, v128
  v_mul_f32 v45, v129, v129
  v_mfma_f32_32x32x16_bf16 v[72:87], a[148:151], a[24:27], v[72:87]
  ds_read_b64_tr_b16 a[180:181], v7 offset:34816
  ds_read_b64_tr_b16 a[182:183], v7 offset:35840
  buffer_load_dwordx4 v16, s[8:11], s21 offen offset:2048 lds
  v_fma_f32 v44, v44, v35, v34
  v_fma_f32 v45, v45, v35, v34
  v_mul_f32 v44, v128, v44
  v_mfma_f32_32x32x16_bf16 v[88:103], a[152:155], a[24:27], v[88:103]
  ds_read_b64_tr_b16 a[184:185], v7 offset:16896
  ds_read_b64_tr_b16 a[186:187], v7 offset:17920
  s_add_u32 s21, s21, 128
  v_mul_f32 v45, v129, v45
  v_mul_f32 v144, v128, v144
  v_mfma_f32_32x32x16_bf16 v[104:119], a[156:159], a[24:27], v[104:119]
  ds_read_b64_tr_b16 a[188:189], v7 offset:35328
  ds_read_b64_tr_b16 a[190:191], v7 offset:36352
  buffer_store_dwordx4 v[184:187], v37, s[16:19], s50 offen sc0 sc1
  v_mul_f32 v145, v129, v145
  s_waitcnt lgkmcnt(8)
  v_mfma_f32_32x32x16_bf16 v[56:71], a[160:163], a[28:31], v[56:71]
  s_waitcnt vmcnt(10)
  s_barrier
  ds_read_b64_tr_b16 a[144:145], v6 offset:0
  ds_read_b64_tr_b16 a[146:147], v6 offset:1024
  v_mul_f32 v46, v130, v130
  v_mfma_f32_32x32x16_bf16 v[72:87], a[164:167], a[28:31], v[72:87]
  ds_read_b64_tr_b16 a[148:149], v6 offset:18432
  ds_read_b64_tr_b16 a[150:151], v6 offset:19456
  s_add_u32 m0, s31, 36864
  v_exp_f32 v44, v44
  v_mul_f32 v47, v131, v131
  v_mfma_f32_32x32x16_bf16 v[88:103], a[168:171], a[28:31], v[88:103]
  ds_read_b64_tr_b16 a[152:153], v6 offset:512
  ds_read_b64_tr_b16 a[154:155], v6 offset:1536
  buffer_load_dwordx4 v8, s[8:11], s22 offen lds
  v_exp_f32 v45, v45
  v_fma_f32 v44, v44, v36, v36
  v_mfma_f32_32x32x16_bf16 v[104:119], a[172:175], a[28:31], v[104:119]
  ds_read_b64_tr_b16 a[156:157], v6 offset:18944
  ds_read_b64_tr_b16 a[158:159], v6 offset:19968
  v_fma_f32 v45, v45, v36, v36
  v_rcp_f32 v44, v44
  s_waitcnt lgkmcnt(8)
  v_mfma_f32_32x32x16_bf16 v[56:71], a[176:179], a[32:35], v[56:71]
  ds_read_b64_tr_b16 a[160:161], v6 offset:2048
  ds_read_b64_tr_b16 a[162:163], v6 offset:3072
  s_add_u32 s49, s49, 1
  v_rcp_f32 v45, v45
  v_mfma_f32_32x32x16_bf16 v[72:87], a[180:183], a[32:35], v[72:87]
  ds_read_b64_tr_b16 a[164:165], v6 offset:20480
  ds_read_b64_tr_b16 a[166:167], v6 offset:21504
  v_mul_f32 v44, v144, v44
  v_mul_f32 v45, v145, v45
  v_cvt_pk_bf16_f32 v188, v44, v45
  v_fma_f32 v46, v46, v35, v34
  v_mfma_f32_32x32x16_bf16 v[88:103], a[184:187], a[32:35], v[88:103]
  ds_read_b64_tr_b16 a[168:169], v6 offset:2560
  ds_read_b64_tr_b16 a[170:171], v6 offset:3584
  buffer_load_dwordx4 v9, s[8:11], s22 offen offset:1024 lds
  v_fma_f32 v47, v47, v35, v34
  v_mul_f32 v46, v130, v46
  v_mfma_f32_32x32x16_bf16 v[104:119], a[188:191], a[32:35], v[104:119]
  ds_read_b64_tr_b16 a[172:173], v6 offset:20992
  ds_read_b64_tr_b16 a[174:175], v6 offset:22016
  v_mul_f32 v47, v131, v47
  v_mul_f32 v146, v130, v146
  s_waitcnt lgkmcnt(8)
  v_mfma_f32_32x32x16_bf16 v[56:71], a[144:147], a[36:39], v[56:71]
  ds_read_b64_tr_b16 a[176:177], v6 offset:4096
  ds_read_b64_tr_b16 a[178:179], v6 offset:5120
  buffer_atomic_add v42, v49, s[16:19], s42 offen sc1
  v_mul_f32 v147, v131, v147
  v_mfma_f32_32x32x16_bf16 v[72:87], a[148:151], a[36:39], v[72:87]
  ds_read_b64_tr_b16 a[180:181], v6 offset:22528
  ds_read_b64_tr_b16 a[182:183], v6 offset:23552
  v_exp_f32 v46, v46
  v_exp_f32 v47, v47
  v_mfma_f32_32x32x16_bf16 v[88:103], a[152:155], a[36:39], v[88:103]
  ds_read_b64_tr_b16 a[184:185], v6 offset:4608
  ds_read_b64_tr_b16 a[186:187], v6 offset:5632
  buffer_load_dwordx4 v10, s[8:11], s22 offen offset:2048 lds
  v_fma_f32 v46, v46, v36, v36
  v_fma_f32 v47, v47, v36, v36
  v_mfma_f32_32x32x16_bf16 v[104:119], a[156:159], a[36:39], v[104:119]
  ds_read_b64_tr_b16 a[188:189], v6 offset:23040
  ds_read_b64_tr_b16 a[190:191], v6 offset:24064
  v_rcp_f32 v46, v46
  s_waitcnt lgkmcnt(8)
  v_mfma_f32_32x32x16_bf16 v[56:71], a[160:163], a[40:43], v[56:71]
  ds_read_b64_tr_b16 a[144:145], v6 offset:6144
  ds_read_b64_tr_b16 a[146:147], v6 offset:7168
  s_add_u32 m0, s31, 39936
  v_rcp_f32 v47, v47
  v_mfma_f32_32x32x16_bf16 v[72:87], a[164:167], a[40:43], v[72:87]
  ds_read_b64_tr_b16 a[148:149], v6 offset:24576
  ds_read_b64_tr_b16 a[150:151], v6 offset:25600
  v_mul_f32 v46, v146, v46
  v_mul_f32 v47, v147, v47
  v_cvt_pk_bf16_f32 v189, v46, v47
  v_mfma_f32_32x32x16_bf16 v[88:103], a[168:171], a[40:43], v[88:103]
  ds_read_b64_tr_b16 a[152:153], v6 offset:6656
  ds_read_b64_tr_b16 a[154:155], v6 offset:7680
HP_k3_p9:
  s_cbranch_execz HP_k3_p13
  buffer_load_dwordx4 v11, s[8:11], s22 offen lds
  v_mul_f32 v44, v132, v132
  v_mul_f32 v45, v133, v133
  v_mfma_f32_32x32x16_bf16 v[104:119], a[172:175], a[40:43], v[104:119]
  ds_read_b64_tr_b16 a[156:157], v6 offset:25088
  ds_read_b64_tr_b16 a[158:159], v6 offset:26112
  v_fma_f32 v44, v44, v35, v34
  v_fma_f32 v45, v45, v35, v34
  s_waitcnt lgkmcnt(8)
  v_mfma_f32_32x32x16_bf16 v[56:71], a[176:179], a[44:47], v[56:71]
  ds_read_b64_tr_b16 a[160:161], v6 offset:8192
  ds_read_b64_tr_b16 a[162:163], v6 offset:9216
  v_mul_f32 v44, v132, v44
  v_mul_f32 v45, v133, v45
  v_mul_f32 v148, v132, v148
  v_mfma_f32_32x32x16_bf16 v[72:87], a[180:183], a[44:47], v[72:87]
  ds_read_b64_tr_b16 a[164:165], v6 offset:26624
  ds_read_b64_tr_b16 a[166:167], v6 offset:27648
  v_exp_f32 v44, v44
  v_mul_f32 v149, v133, v149
  v_mfma_f32_32x32x16_bf16 v[88:103], a[184:187], a[44:47], v[88:103]
  ds_read_b64_tr_b16 a[168:169], v6 offset:8704
  ds_read_b64_tr_b16 a[170:171], v6 offset:9728
  buffer_load_dwordx4 v12, s[8:11], s22 offen offset:1024 lds
  v_exp_f32 v45, v45
  v_mfma_f32_32x32x16_bf16 v[104:119], a[188:191], a[44:47], v[104:119]
  ds_read_b64_tr_b16 a[172:173], v6 offset:27136
  ds_read_b64_tr_b16 a[174:175], v6 offset:28160
  v_fma_f32 v44, v44, v36, v36
  v_fma_f32 v45, v45, v36, v36
  s_waitcnt lgkmcnt(8)
  v_mfma_f32_32x32x16_bf16 v[56:71], a[144:147], a[48:51], v[56:71]
  ds_read_b64_tr_b16 a[176:177], v6 offset:10240
  ds_read_b64_tr_b16 a[178:179], v6 offset:11264
  v_rcp_f32 v44, v44
  v_mul_f32 v46, v134, v134
  v_mfma_f32_32x32x16_bf16 v[72:87], a[148:151], a[48:51], v[72:87]
  ds_read_b64_tr_b16 a[180:181], v6 offset:28672
  ds_read_b64_tr_b16 a[182:183], v6 offset:29696
  v_rcp_f32 v45, v45
  v_mul_f32 v44, v148, v44
  v_mfma_f32_32x32x16_bf16 v[88:103], a[152:155], a[48:51], v[88:103]
  ds_read_b64_tr_b16 a[184:185], v6 offset:10752
  ds_read_b64_tr_b16 a[186:187], v6 offset:11776
  buffer_load_dwordx4 v13, s[8:11], s22 offen offset:2048 lds
  v_mul_f32 v45, v149, v45
  v_cvt_pk_bf16_f32 v190, v44, v45
  v_mfma_f32_32x32x16_bf16 v[104:119], a[156:159], a[48:51], v[104:119]
  ds_read_b64_tr_b16 a[188:189], v6 offset:29184
  ds_read_b64_tr_b16 a[190:191], v6 offset:30208
  v_mul_f32 v47, v135, v135
  v_fma_f32 v46, v46, v35, v34
  s_waitcnt lgkmcnt(8)
  v_mfma_f32_32x32x16_bf16 v[56:71], a[160:163], a[52:55], v[56:71]
  ds_read_b64_tr_b16 a[144:145], v6 offset:12288
  ds_read_b64_tr_b16 a[146:147], v6 offset:13312
  s_add_u32 m0, s31, 43008
  v_fma_f32 v47, v47, v35, v34
  v_mul_f32 v46, v134, v46
  v_mfma_f32_32x32x16_bf16 v[72:87], a[164:167], a[52:55], v[72:87]
  ds_read_b64_tr_b16 a[148:149], v6 offset:30720
  ds_read_b64_tr_b16 a[150:151], v6 offset:31744
  v_mul_f32 v47, v135, v47
  v_exp_f32 v46, v46
  v_mfma_f32_32x32x16_bf16 v[88:103], a[168:171], a[52:55], v[88:103]
  ds_read_b64_tr_b16 a[152:153], v6 offset:12800
  ds_read_b64_tr_b16 a[154:155], v6 offset:13824
  buffer_load_dwordx4 v14, s[8:11], s22 offen lds
  v_mul_f32 v150, v134, v150
  v_mul_f32 v151, v135, v151
  v_mfma_f32_32x32x16_bf16 v[104:119], a[172:175], a[52:55], v[104:119]
  ds_read_b64_tr_b16 a[156:157], v6 offset:31232
  ds_read_b64_tr_b16 a[158:159], v6 offset:32256
  v_exp_f32 v47, v47
  s_waitcnt lgkmcnt(8)
  v_mfma_f32_32x32x16_bf16 v[56:71], a[176:179], a[56:59], v[56:71]
  ds_read_b64_tr_b16 a[160:161], v6 offset:14336
  ds_read_b64_tr_b16 a[162:163], v6 offset:15360
  v_fma_f32 v46, v46, v36, v36
  v_fma_f32 v47, v47, v36, v36
  v_mul_f32 v44, v152, v152
  v_mfma_f32_32x32x16_bf16 v[72:87], a[180:183], a[56:59], v[72:87]
  ds_read_b64_tr_b16 a[164:165], v6 offset:32768
  ds_read_b64_tr_b16 a[166:167], v6 offset:33792
  v_rcp_f32 v46, v46
  v_mul_f32 v45, v153, v153
  v_mfma_f32_32x32x16_bf16 v[88:103], a[184:187], a[56:59], v[88:103]
  ds_read_b64_tr_b16 a[168:169], v6 offset:14848
  ds_read_b64_tr_b16 a[170:171], v6 offset:15872
  buffer_load_dwordx4 v15, s[8:11], s22 offen offset:1024 lds
  v_rcp_f32 v47, v47
  v_mfma_f32_32x32x16_bf16 v[104:119], a[188:191], a[56:59], v[104:119]
  ds_read_b64_tr_b16 a[172:173], v6 offset:33280
  ds_read_b64_tr_b16 a[174:175], v6 offset:34304
  v_mul_f32 v46, v150, v46
  v_mul_f32 v47, v151, v47
  s_waitcnt lgkmcnt(8)
  v_mfma_f32_32x32x16_bf16 v[56:71], a[144:147], a[60:63], v[56:71]
  ds_read_b64_tr_b16 a[176:177], v6 offset:16384
  ds_read_b64_tr_b16 a[178:179], v6 offset:17408
  buffer_load_dword v1, v38, s[12:15], s53 offen
  s_add_u32 s53, s53, 1792
  v_cvt_pk_bf16_f32 v191, v46, v47
  v_mfma_f32_32x32x16_bf16 v[72:87], a[148:151], a[60:63], v[72:87]
  ds_read_b64_tr_b16 a[180:181], v6 offset:34816
  ds_read_b64_tr_b16 a[182:183], v6 offset:35840
  buffer_load_dwordx4 v16, s[8:11], s22 offen offset:2048 lds
  v_fma_f32 v44, v44, v35, v34
  v_fma_f32 v45, v45, v35, v34
  v_mfma_f32_32x32x16_bf16 v[88:103], a[152:155], a[60:63], v[88:103]
  ds_read_b64_tr_b16 a[184:185], v6 offset:16896
  ds_read_b64_tr_b16 a[186:187], v6 offset:17920
  s_add_u32 s22, s22, 128
  v_mul_f32 v44, v152, v44
  v_mul_f32 v45, v153, v45
  v_mfma_f32_32x32x16_bf16 v[104:119], a[156:159], a[60:63], v[104:119]
  ds_read_b64_tr_b16 a[188:189], v6 offset:35328
  ds_read_b64_tr_b16 a[190:191], v6 offset:36352
  buffer_store_dwordx4 v[188:191], v37, s[16:19], s50 offen offset:1024 sc0 sc1
  v_mul_f32 v168, v152, v168
  s_waitcnt lgkmcnt(8)
  v_mfma_f32_32x32x16_bf16 v[56:71], a[160:163], a[64:67], v[56:71]
  s_waitcnt vmcnt(13)
  s_barrier
  ds_read_b64_tr_b16 a[144:145], v4 offset:0
  ds_read_b64_tr_b16 a[146:147], v4 offset:1024
  v_mfma_f32_32x32x16_bf16 v[72:87], a[164:167], a[64:67], v[72:87]
  ds_read_b64_tr_b16 a[148:149], v4 offset:18432
  ds_read_b64_tr_b16 a[150:151], v4 offset:19456
  s_add_u32 m0, s31, 110592
  v_exp_f32 v44, v44
  v_mul_f32 v169, v153, v169
  v_mfma_f32_32x32x16_bf16 v[88:103], a[168:171], a[64:67], v[88:103]
  ds_read_b64_tr_b16 a[152:153], v4 offset:512
  ds_read_b64_tr_b16 a[154:155], v4 offset:1536
  buffer_load_dwordx4 v17, s[44:47], s38 offen lds
  v_exp_f32 v45, v45
  v_fma_f32 v44, v44, v36, v36
  v_mfma_f32_32x32x16_bf16 v[104:119], a[172:175], a[64:67], v[104:119]
  ds_read_b64_tr_b16 a[156:157], v4 offset:18944
  ds_read_b64_tr_b16 a[158:159], v4 offset:19968
  v_fma_f32 v45, v45, v36, v36
  v_mul_f32 v46, v154, v154
  s_waitcnt lgkmcnt(8)
  v_mfma_f32_32x32x16_bf16 v[56:71], a[176:179], a[68:71], v[56:71]
  ds_read_b64_tr_b16 a[160:161], v4 offset:2048
  ds_read_b64_tr_b16 a[162:163], v4 offset:3072
  v_rcp_f32 v44, v44
  v_mul_f32 v47, v155, v155
  v_mfma_f32_32x32x16_bf16 v[72:87], a[180:183], a[68:71], v[72:87]
HP_k3_p10:
  s_cbranch_execz HP_k3_p14
  ds_read_b64_tr_b16 a[164:165], v4 offset:20480
  ds_read_b64_tr_b16 a[166:167], v4 offset:21504
  v_rcp_f32 v45, v45
  v_mul_f32 v44, v168, v44
  v_mfma_f32_32x32x16_bf16 v[88:103], a[184:187], a[68:71], v[88:103]
  ds_read_b64_tr_b16 a[168:169], v4 offset:2560
  ds_read_b64_tr_b16 a[170:171], v4 offset:3584
  buffer_load_dwordx4 v18, s[44:47], s38 offen offset:1024 lds
  v_mul_f32 v45, v169, v45
  v_cvt_pk_bf16_f32 v192, v44, v45
  v_mfma_f32_32x32x16_bf16 v[104:119], a[188:191], a[68:71], v[104:119]
  ds_read_b64_tr_b16 a[172:173], v4 offset:20992
  ds_read_b64_tr_b16 a[174:175], v4 offset:22016
  v_fma_f32 v46, v46, v35, v34
  v_fma_f32 v47, v47, v35, v34
  s_waitcnt lgkmcnt(8)
  v_mfma_f32_32x32x16_bf16 v[56:71], a[144:147], a[72:75], v[56:71]
  ds_read_b64_tr_b16 a[176:177], v4 offset:4096
  ds_read_b64_tr_b16 a[178:179], v4 offset:5120
  v_mul_f32 v46, v154, v46
  v_mul_f32 v47, v155, v47
  v_mul_f32 v170, v154, v170
  v_mfma_f32_32x32x16_bf16 v[72:87], a[148:151], a[72:75], v[72:87]
  ds_read_b64_tr_b16 a[180:181], v4 offset:22528
  ds_read_b64_tr_b16 a[182:183], v4 offset:23552
  v_exp_f32 v46, v46
  v_mul_f32 v171, v155, v171
  v_mfma_f32_32x32x16_bf16 v[88:103], a[152:155], a[72:75], v[88:103]
  ds_read_b64_tr_b16 a[184:185], v4 offset:4608
  ds_read_b64_tr_b16 a[186:187], v4 offset:5632
  buffer_load_dwordx4 v19, s[44:47], s38 offen offset:2048 lds
  v_exp_f32 v47, v47
  v_mfma_f32_32x32x16_bf16 v[104:119], a[156:159], a[72:75], v[104:119]
  ds_read_b64_tr_b16 a[188:189], v4 offset:23040
  ds_read_b64_tr_b16 a[190:191], v4 offset:24064
  v_fma_f32 v46, v46, v36, v36
  v_fma_f32 v47, v47, v36, v36
  s_waitcnt lgkmcnt(8)
  v_mfma_f32_32x32x16_bf16 v[56:71], a[160:163], a[76:79], v[56:71]
  ds_read_b64_tr_b16 a[144:145], v4 offset:6144
  ds_read_b64_tr_b16 a[146:147], v4 offset:7168
  s_add_u32 m0, s31, 113664
  v_rcp_f32 v46, v46
  v_mfma_f32_32x32x16_bf16 v[72:87], a[164:167], a[76:79], v[72:87]
  ds_read_b64_tr_b16 a[148:149], v4 offset:24576
  ds_read_b64_tr_b16 a[150:151], v4 offset:25600
  v_rcp_f32 v47, v47
  v_mul_f32 v46, v170, v46
  v_mfma_f32_32x32x16_bf16 v[88:103], a[168:171], a[76:79], v[88:103]
  ds_read_b64_tr_b16 a[152:153], v4 offset:6656
  ds_read_b64_tr_b16 a[154:155], v4 offset:7680
  buffer_load_dwordx4 v20, s[44:47], s38 offen lds
  v_mul_f32 v47, v171, v47
  v_cvt_pk_bf16_f32 v193, v46, v47
  v_mfma_f32_32x32x16_bf16 v[104:119], a[172:175], a[76:79], v[104:119]
  ds_read_b64_tr_b16 a[156:157], v4 offset:25088
  ds_read_b64_tr_b16 a[158:159], v4 offset:26112
  v_mul_f32 v44, v156, v156
  v_mul_f32 v45, v157, v157
  s_waitcnt lgkmcnt(8)
  v_mfma_f32_32x32x16_bf16 v[56:71], a[176:179], a[80:83], v[56:71]
  ds_read_b64_tr_b16 a[160:161], v4 offset:8192
  ds_read_b64_tr_b16 a[162:163], v4 offset:9216
  v_fma_f32 v44, v44, v35, v34
  v_fma_f32 v45, v45, v35, v34
  v_mul_f32 v44, v156, v44
  v_mfma_f32_32x32x16_bf16 v[72:87], a[180:183], a[80:83], v[72:87]
  ds_read_b64_tr_b16 a[164:165], v4 offset:26624
  ds_read_b64_tr_b16 a[166:167], v4 offset:27648
  v_mul_f32 v45, v157, v45
  v_exp_f32 v44, v44
  v_mfma_f32_32x32x16_bf16 v[88:103], a[184:187], a[80:83], v[88:103]
  ds_read_b64_tr_b16 a[168:169], v4 offset:8704
  ds_read_b64_tr_b16 a[170:171], v4 offset:9728
  buffer_load_dwordx4 v21, s[44:47], s38 offen offset:1024 lds
  v_mul_f32 v172, v156, v172
  v_mul_f32 v173, v157, v173
  v_mfma_f32_32x32x16_bf16 v[104:119], a[188:191], a[80:83], v[104:119]
  ds_read_b64_tr_b16 a[172:173], v4 offset:27136
  ds_read_b64_tr_b16 a[174:175], v4 offset:28160
  v_exp_f32 v45, v45
  s_waitcnt lgkmcnt(8)
  v_mfma_f32_32x32x16_bf16 v[56:71], a[144:147], a[84:87], v[56:71]
  ds_read_b64_tr_b16 a[176:177], v4 offset:10240
  ds_read_b64_tr_b16 a[178:179], v4 offset:11264
  v_fma_f32 v44, v44, v36, v36
  v_fma_f32 v45, v45, v36, v36
  v_mul_f32 v46, v158, v158
  v_mfma_f32_32x32x16_bf16 v[72:87], a[148:151], a[84:87], v[72:87]
  ds_read_b64_tr_b16 a[180:181], v4 offset:28672
  ds_read_b64_tr_b16 a[182:183], v4 offset:29696
  v_rcp_f32 v44, v44
  v_mul_f32 v47, v159, v159
  v_mfma_f32_32x32x16_bf16 v[88:103], a[152:155], a[84:87], v[88:103]
  ds_read_b64_tr_b16 a[184:185], v4 offset:10752
  ds_read_b64_tr_b16 a[186:187], v4 offset:11776
  buffer_load_dwordx4 v22, s[44:47], s38 offen offset:2048 lds
  v_rcp_f32 v45, v45
  v_mfma_f32_32x32x16_bf16 v[104:119], a[156:159], a[84:87], v[104:119]
  ds_read_b64_tr_b16 a[188:189], v4 offset:29184
  ds_read_b64_tr_b16 a[190:191], v4 offset:30208
  v_mul_f32 v44, v172, v44
  v_mul_f32 v45, v173, v45
  s_waitcnt lgkmcnt(8)
  v_mfma_f32_32x32x16_bf16 v[56:71], a[160:163], a[88:91], v[56:71]
  ds_read_b64_tr_b16 a[144:145], v4 offset:12288
  ds_read_b64_tr_b16 a[146:147], v4 offset:13312
  s_add_u32 m0, s31, 116736
  v_cvt_pk_bf16_f32 v194, v44, v45
  v_fma_f32 v46, v46, v35, v34
  v_mfma_f32_32x32x16_bf16 v[72:87], a[164:167], a[88:91], v[72:87]
  ds_read_b64_tr_b16 a[148:149], v4 offset:30720
  ds_read_b64_tr_b16 a[150:151], v4 offset:31744
  v_fma_f32 v47, v47, v35, v34
  v_mul_f32 v46, v158, v46
  v_mul_f32 v47, v159, v47
  v_mfma_f32_32x32x16_bf16 v[88:103], a[168:171], a[88:91], v[88:103]
  ds_read_b64_tr_b16 a[152:153], v4 offset:12800
  ds_read_b64_tr_b16 a[154:155], v4 offset:13824
  buffer_load_dwordx4 v23, s[44:47], s38 offen lds
  v_exp_f32 v46, v46
  v_mfma_f32_32x32x16_bf16 v[104:119], a[172:175], a[88:91], v[104:119]
  ds_read_b64_tr_b16 a[156:157], v4 offset:31232
  ds_read_b64_tr_b16 a[158:159], v4 offset:32256
  v_mul_f32 v174, v158, v174
  v_mul_f32 v175, v159, v175
  s_waitcnt lgkmcnt(8)
  v_mfma_f32_32x32x16_bf16 v[56:71], a[176:179], a[92:95], v[56:71]
  ds_read_b64_tr_b16 a[160:161], v4 offset:14336
  ds_read_b64_tr_b16 a[162:163], v4 offset:15360
  v_mov_b32 v40, 0
  buffer_atomic_add v40, v30, s[16:19], 0 offen sc0 sc1
  v_mfma_f32_32x32x16_bf16 v[72:87], a[180:183], a[92:95], v[72:87]
  ds_read_b64_tr_b16 a[164:165], v4 offset:32768
  ds_read_b64_tr_b16 a[166:167], v4 offset:33792
  v_exp_f32 v47, v47
  v_fma_f32 v46, v46, v36, v36
  v_mfma_f32_32x32x16_bf16 v[88:103], a[184:187], a[92:95], v[88:103]
  ds_read_b64_tr_b16 a[168:169], v4 offset:14848
  ds_read_b64_tr_b16 a[170:171], v4 offset:15872
  buffer_load_dwordx4 v24, s[44:47], s38 offen offset:1024 lds
  v_fma_f32 v47, v47, v36, v36
  v_mul_f32 v44, v160, v160
  v_mfma_f32_32x32x16_bf16 v[104:119], a[188:191], a[92:95], v[104:119]
  ds_read_b64_tr_b16 a[172:173], v4 offset:33280
  ds_read_b64_tr_b16 a[174:175], v4 offset:34304
  v_rcp_f32 v46, v46
  s_waitcnt lgkmcnt(8)
  v_mfma_f32_32x32x16_bf16 v[56:71], a[144:147], a[96:99], v[56:71]
HP_k3_p11:
  s_cbranch_execz HP_k3_p15
  ds_read_b64_tr_b16 a[176:177], v4 offset:16384
  ds_read_b64_tr_b16 a[178:179], v4 offset:17408
  v_rcp_f32 v47, v47
  v_mul_f32 v46, v174, v46
  v_mfma_f32_32x32x16_bf16 v[72:87], a[148:151], a[96:99], v[72:87]
  ds_read_b64_tr_b16 a[180:181], v4 offset:34816
  ds_read_b64_tr_b16 a[182:183], v4 offset:35840
  buffer_load_dwordx4 v25, s[44:47], s38 offen offset:2048 lds
  v_mul_f32 v47, v175, v47
  v_cvt_pk_bf16_f32 v195, v46, v47
  v_mfma_f32_32x32x16_bf16 v[88:103], a[152:155], a[96:99], v[88:103]
  ds_read_b64_tr_b16 a[184:185], v4 offset:16896
  ds_read_b64_tr_b16 a[186:187], v4 offset:17920
  s_add_u32 s38, s38, 128
  v_mul_f32 v45, v161, v161
  v_fma_f32 v44, v44, v35, v34
  v_mfma_f32_32x32x16_bf16 v[104:119], a[156:159], a[96:99], v[104:119]
  ds_read_b64_tr_b16 a[188:189], v4 offset:35328
  ds_read_b64_tr_b16 a[190:191], v4 offset:36352
  buffer_store_dwordx4 v[192:195], v37, s[16:19], s50 offen offset:2048 sc0 sc1
  v_fma_f32 v45, v45, v35, v34
  s_waitcnt lgkmcnt(8)
  v_mfma_f32_32x32x16_bf16 v[56:71], a[160:163], a[100:103], v[56:71]
  s_waitcnt vmcnt(12)
  s_barrier
  ds_read_b64_tr_b16 a[144:145], v5 offset:0
  ds_read_b64_tr_b16 a[146:147], v5 offset:1024
  v_mfma_f32_32x32x16_bf16 v[72:87], a[164:167], a[100:103], v[72:87]
  ds_read_b64_tr_b16 a[148:149], v5 offset:18432
  ds_read_b64_tr_b16 a[150:151], v5 offset:19456
  s_add_u32 m0, s31, 73728
  v_mul_f32 v44, v160, v44
  v_mul_f32 v45, v161, v45
  v_mul_f32 v176, v160, v176
  v_mfma_f32_32x32x16_bf16 v[88:103], a[168:171], a[100:103], v[88:103]
  ds_read_b64_tr_b16 a[152:153], v5 offset:512
  ds_read_b64_tr_b16 a[154:155], v5 offset:1536
  buffer_load_dwordx4 v17, s[44:47], s39 offen lds
  v_exp_f32 v44, v44
  v_mul_f32 v177, v161, v177
  v_mfma_f32_32x32x16_bf16 v[104:119], a[172:175], a[100:103], v[104:119]
  ds_read_b64_tr_b16 a[156:157], v5 offset:18944
  ds_read_b64_tr_b16 a[158:159], v5 offset:19968
  v_exp_f32 v45, v45
  s_waitcnt lgkmcnt(8)
  v_mfma_f32_32x32x16_bf16 v[56:71], a[176:179], a[104:107], v[56:71]
  ds_read_b64_tr_b16 a[160:161], v5 offset:2048
  ds_read_b64_tr_b16 a[162:163], v5 offset:3072
  v_fma_f32 v44, v44, v36, v36
  v_fma_f32 v45, v45, v36, v36
  v_mul_f32 v46, v162, v162
  v_mfma_f32_32x32x16_bf16 v[72:87], a[180:183], a[104:107], v[72:87]
  ds_read_b64_tr_b16 a[164:165], v5 offset:20480
  ds_read_b64_tr_b16 a[166:167], v5 offset:21504
  v_rcp_f32 v44, v44
  v_mul_f32 v47, v163, v163
  v_mfma_f32_32x32x16_bf16 v[88:103], a[184:187], a[104:107], v[88:103]
  ds_read_b64_tr_b16 a[168:169], v5 offset:2560
  ds_read_b64_tr_b16 a[170:171], v5 offset:3584
  buffer_load_dwordx4 v18, s[44:47], s39 offen offset:1024 lds
  v_rcp_f32 v45, v45
  v_mfma_f32_32x32x16_bf16 v[104:119], a[188:191], a[104:107], v[104:119]
  ds_read_b64_tr_b16 a[172:173], v5 offset:20992
  ds_read_b64_tr_b16 a[174:175], v5 offset:22016
  v_mul_f32 v44, v176, v44
  v_mul_f32 v45, v177, v45
  s_waitcnt lgkmcnt(8)
  v_mfma_f32_32x32x16_bf16 v[56:71], a[144:147], a[108:111], v[56:71]
  ds_read_b64_tr_b16 a[176:177], v5 offset:4096
  ds_read_b64_tr_b16 a[178:179], v5 offset:5120
  v_cvt_pk_bf16_f32 v196, v44, v45
  v_fma_f32 v46, v46, v35, v34
  v_fma_f32 v47, v47, v35, v34
  v_mfma_f32_32x32x16_bf16 v[72:87], a[148:151], a[108:111], v[72:87]
  ds_read_b64_tr_b16 a[180:181], v5 offset:22528
  ds_read_b64_tr_b16 a[182:183], v5 offset:23552
  v_mul_f32 v46, v162, v46
  v_mul_f32 v47, v163, v47
  v_mul_f32 v178, v162, v178
  v_mfma_f32_32x32x16_bf16 v[88:103], a[152:155], a[108:111], v[88:103]
  ds_read_b64_tr_b16 a[184:185], v5 offset:4608
  ds_read_b64_tr_b16 a[186:187], v5 offset:5632
  buffer_load_dwordx4 v19, s[44:47], s39 offen offset:2048 lds
  v_exp_f32 v46, v46
  v_mfma_f32_32x32x16_bf16 v[104:119], a[156:159], a[108:111], v[104:119]
  ds_read_b64_tr_b16 a[188:189], v5 offset:23040
  ds_read_b64_tr_b16 a[190:191], v5 offset:24064
  v_exp_f32 v47, v47
  s_waitcnt lgkmcnt(8)
  v_mfma_f32_32x32x16_bf16 v[56:71], a[160:163], a[112:115], v[56:71]
  ds_read_b64_tr_b16 a[144:145], v5 offset:6144
  ds_read_b64_tr_b16 a[146:147], v5 offset:7168
  s_add_u32 m0, s31, 76800
  v_mul_f32 v179, v163, v179
  v_fma_f32 v46, v46, v36, v36
  v_mfma_f32_32x32x16_bf16 v[72:87], a[164:167], a[112:115], v[72:87]
  ds_read_b64_tr_b16 a[148:149], v5 offset:24576
  ds_read_b64_tr_b16 a[150:151], v5 offset:25600
  v_fma_f32 v47, v47, v36, v36
  v_rcp_f32 v46, v46
  v_mfma_f32_32x32x16_bf16 v[88:103], a[168:171], a[112:115], v[88:103]
  ds_read_b64_tr_b16 a[152:153], v5 offset:6656
  ds_read_b64_tr_b16 a[154:155], v5 offset:7680
  buffer_load_dwordx4 v20, s[44:47], s39 offen lds
  v_rcp_f32 v47, v47
  v_mfma_f32_32x32x16_bf16 v[104:119], a[172:175], a[112:115], v[104:119]
  ds_read_b64_tr_b16 a[156:157], v5 offset:25088
  ds_read_b64_tr_b16 a[158:159], v5 offset:26112
  v_mul_f32 v46, v178, v46
  v_mul_f32 v47, v179, v47
  s_waitcnt lgkmcnt(8)
  v_mfma_f32_32x32x16_bf16 v[56:71], a[176:179], a[116:119], v[56:71]
  ds_read_b64_tr_b16 a[160:161], v5 offset:8192
  ds_read_b64_tr_b16 a[162:163], v5 offset:9216
  v_cvt_pk_bf16_f32 v197, v46, v47
  v_mul_f32 v44, v164, v164
  v_mul_f32 v45, v165, v165
  v_mfma_f32_32x32x16_bf16 v[72:87], a[180:183], a[116:119], v[72:87]
  ds_read_b64_tr_b16 a[164:165], v5 offset:26624
  ds_read_b64_tr_b16 a[166:167], v5 offset:27648
  v_fma_f32 v44, v44, v35, v34
  v_fma_f32 v45, v45, v35, v34
  v_mul_f32 v44, v164, v44
  v_mfma_f32_32x32x16_bf16 v[88:103], a[184:187], a[116:119], v[88:103]
  ds_read_b64_tr_b16 a[168:169], v5 offset:8704
  ds_read_b64_tr_b16 a[170:171], v5 offset:9728
  buffer_load_dwordx4 v21, s[44:47], s39 offen offset:1024 lds
  v_mul_f32 v45, v165, v45
  v_mul_f32 v180, v164, v180
  v_mfma_f32_32x32x16_bf16 v[104:119], a[188:191], a[116:119], v[104:119]
  ds_read_b64_tr_b16 a[172:173], v5 offset:27136
  ds_read_b64_tr_b16 a[174:175], v5 offset:28160
  v_exp_f32 v44, v44
  s_waitcnt lgkmcnt(8)
  v_mfma_f32_32x32x16_bf16 v[56:71], a[144:147], a[120:123], v[56:71]
  ds_read_b64_tr_b16 a[176:177], v5 offset:10240
  ds_read_b64_tr_b16 a[178:179], v5 offset:11264
  v_exp_f32 v45, v45
  v_mul_f32 v181, v165, v181
  v_mfma_f32_32x32x16_bf16 v[72:87], a[148:151], a[120:123], v[72:87]
  ds_read_b64_tr_b16 a[180:181], v5 offset:28672
  ds_read_b64_tr_b16 a[182:183], v5 offset:29696
  v_fma_f32 v44, v44, v36, v36
  v_fma_f32 v45, v45, v36, v36
  v_mul_f32 v46, v166, v166
  v_mfma_f32_32x32x16_bf16 v[88:103], a[152:155], a[120:123], v[88:103]
  ds_read_b64_tr_b16 a[184:185], v5 offset:10752
  ds_read_b64_tr_b16 a[186:187], v5 offset:11776
  buffer_load_dwordx4 v22, s[44:47], s39 offen offset:2048 lds
HP_k3_p12:
  s_cbranch_execz HP_k3_p16
  v_rcp_f32 v44, v44
  v_mfma_f32_32x32x16_bf16 v[104:119], a[156:159], a[120:123], v[104:119]
  ds_read_b64_tr_b16 a[188:189], v5 offset:29184
  ds_read_b64_tr_b16 a[190:191], v5 offset:30208
  v_rcp_f32 v45, v45
  s_waitcnt lgkmcnt(8)
  v_mfma_f32_32x32x16_bf16 v[56:71], a[160:163], a[124:127], v[56:71]
  ds_read_b64_tr_b16 a[144:145], v5 offset:12288
  ds_read_b64_tr_b16 a[146:147], v5 offset:13312
  s_add_u32 m0, s31, 79872
  v_mul_f32 v44, v180, v44
  v_mul_f32 v45, v181, v45
  v_mfma_f32_32x32x16_bf16 v[72:87], a[164:167], a[124:127], v[72:87]
  ds_read_b64_tr_b16 a[148:149], v5 offset:30720
  ds_read_b64_tr_b16 a[150:151], v5 offset:31744
  v_cvt_pk_bf16_f32 v198, v44, v45
  v_mul_f32 v47, v167, v167
  v_fma_f32 v46, v46, v35, v34
  v_mfma_f32_32x32x16_bf16 v[88:103], a[168:171], a[124:127], v[88:103]
  ds_read_b64_tr_b16 a[152:153], v5 offset:12800
  ds_read_b64_tr_b16 a[154:155], v5 offset:13824
  buffer_load_dwordx4 v23, s[44:47], s39 offen lds
  v_fma_f32 v47, v47, v35, v34
  v_mul_f32 v46, v166, v46
  v_mfma_f32_32x32x16_bf16 v[104:119], a[172:175], a[124:127], v[104:119]
  ds_read_b64_tr_b16 a[156:157], v5 offset:31232
  ds_read_b64_tr_b16 a[158:159], v5 offset:32256
  v_mul_f32 v47, v167, v47
  v_mul_f32 v182, v166, v182
  s_waitcnt lgkmcnt(8)
  v_mfma_f32_32x32x16_bf16 v[56:71], a[176:179], a[128:131], v[56:71]
  ds_read_b64_tr_b16 a[160:161], v5 offset:14336
  ds_read_b64_tr_b16 a[162:163], v5 offset:15360
  v_exp_f32 v46, v46
  v_mul_f32 v183, v167, v183
  v_mfma_f32_32x32x16_bf16 v[72:87], a[180:183], a[128:131], v[72:87]
  ds_read_b64_tr_b16 a[164:165], v5 offset:32768
  ds_read_b64_tr_b16 a[166:167], v5 offset:33792
  v_exp_f32 v47, v47
  v_fma_f32 v46, v46, v36, v36
  v_mfma_f32_32x32x16_bf16 v[88:103], a[184:187], a[128:131], v[88:103]
  ds_read_b64_tr_b16 a[168:169], v5 offset:16384
  ds_read_b64_tr_b16 a[170:171], v5 offset:17408
  buffer_load_dwordx4 v24, s[44:47], s39 offen offset:1024 lds
  v_fma_f32 v47, v47, v36, v36
  v_mfma_f32_32x32x16_bf16 v[104:119], a[188:191], a[128:131], v[104:119]
  ds_read_b64_tr_b16 a[172:173], v5 offset:34816
  ds_read_b64_tr_b16 a[174:175], v5 offset:35840
  v_rcp_f32 v46, v46
  s_waitcnt lgkmcnt(8)
  v_mfma_f32_32x32x16_bf16 v[56:71], a[144:147], a[132:135], v[56:71]
  ds_read_b64_tr_b16 a[176:177], v5 offset:14848
  ds_read_b64_tr_b16 a[178:179], v5 offset:15872
  v_rcp_f32 v47, v47
  v_mul_f32 v46, v182, v46
  v_mfma_f32_32x32x16_bf16 v[72:87], a[148:151], a[132:135], v[72:87]
  ds_read_b64_tr_b16 a[180:181], v5 offset:33280
  ds_read_b64_tr_b16 a[182:183], v5 offset:34304
  buffer_load_dwordx4 v25, s[44:47], s39 offen offset:2048 lds
  v_mul_f32 v47, v183, v47
  v_cvt_pk_bf16_f32 v199, v46, v47
  v_mfma_f32_32x32x16_bf16 v[88:103], a[152:155], a[132:135], v[88:103]
  ds_read_b64_tr_b16 a[184:185], v5 offset:16896
  ds_read_b64_tr_b16 a[186:187], v5 offset:17920
  s_add_u32 s39, s39, 128
  v_mfma_f32_32x32x16_bf16 v[104:119], a[156:159], a[132:135], v[104:119]
  ds_read_b64_tr_b16 a[188:189], v5 offset:35328
  ds_read_b64_tr_b16 a[190:191], v5 offset:36352
  buffer_store_dwordx4 v[196:199], v37, s[16:19], s50 offen offset:3072 sc0 sc1
  s_waitcnt lgkmcnt(8)
  s_cmp_eq_u32 s49, 1
  s_cbranch_scc1 K3_head0
  s_cmp_eq_u32 s49, 2
  s_cbranch_scc1 K3_head1
  v_add_u32 v8, 7168, v26
  v_add_u32 v9, 7168, v27
  v_mfma_f32_32x32x16_bf16 v[56:71], a[160:163], a[136:139], v[56:71]
  s_waitcnt vmcnt(11)
  s_barrier
  ds_read_b64_tr_b16 a[144:145], v7 offset:0
  ds_read_b64_tr_b16 a[146:147], v7 offset:2048
  s_add_u32 s50, s50, 4096
  v_mfma_f32_32x32x16_bf16 v[72:87], a[164:167], a[136:139], v[72:87]
  ds_read_b64_tr_b16 a[148:149], v7 offset:512
  ds_read_b64_tr_b16 a[150:151], v7 offset:2560
  v_cmp_le_u32 vcc, 3, v40
  s_nop 1
  s_cmp_eq_u32 vcc_lo, 7
  s_cbranch_scc0 K3_spinZ
K3_retZ:
  v_mfma_f32_32x32x16_bf16 v[120:135], a[168:171], a[140:143], v[56:71]
  ds_read_b64_tr_b16 a[152:153], v7 offset:1024
  ds_read_b64_tr_b16 a[154:155], v7 offset:3072
  s_add_u32 s34, s54, 0
  v_accvgpr_write_b32 a224, v184
  v_accvgpr_write_b32 a225, v185
  v_accvgpr_write_b32 a226, v186
  v_mfma_f32_32x32x16_bf16 v[136:151], a[172:175], a[140:143], v[72:87]
  ds_read_b64_tr_b16 a[156:157], v7 offset:1536
  ds_read_b64_tr_b16 a[158:159], v7 offset:3584
  s_add_u32 s51, s41, 4096
  buffer_load_dwordx4 v[224:227], v37, s[16:19], s51 offen sc0 sc1
  v_accvgpr_write_b32 a227, v187
  s_waitcnt lgkmcnt(8)
  v_mfma_f32_32x32x16_bf16 v[88:103], a[176:179], a[136:139], v[88:103]
  ds_read_b64_tr_b16 a[160:161], v7 offset:9216
  ds_read_b64_tr_b16 a[162:163], v7 offset:11264
  s_add_u32 m0, s31, 0
  v_accvgpr_write_b32 a228, v188
  v_accvgpr_write_b32 a229, v189
  v_accvgpr_write_b32 a230, v190
  v_mfma_f32_32x32x16_bf16 v[104:119], a[180:183], a[136:139], v[104:119]
  ds_read_b64_tr_b16 a[164:165], v7 offset:9728
  ds_read_b64_tr_b16 a[166:167], v7 offset:11776
  v_accvgpr_write_b32 a231, v191
  v_accvgpr_write_b32 a232, v192
  v_accvgpr_write_b32 a233, v193
  v_accvgpr_write_b32 a234, v194
  v_mfma_f32_32x32x16_bf16 v[152:167], a[184:187], a[140:143], v[88:103]
  ds_read_b64_tr_b16 a[168:169], v7 offset:10240
  ds_read_b64_tr_b16 a[170:171], v7 offset:12288
  buffer_load_dwordx4 v26, s[12:15], s34 offen lds
  v_accvgpr_write_b32 a235, v195
  v_accvgpr_write_b32 a236, v196
  v_accvgpr_write_b32 a237, v197
  v_mfma_f32_32x32x16_bf16 v[168:183], a[188:191], a[140:143], v[104:119]
  ds_read_b64_tr_b16 a[172:173], v7 offset:10752
  ds_read_b64_tr_b16 a[174:175], v7 offset:12800
  buffer_load_dwordx4 v[228:231], v37, s[16:19], s51 offen offset:1024 sc0 sc1
  v_accvgpr_write_b32 a238, v198
  v_accvgpr_write_b32 a239, v199
  s_waitcnt lgkmcnt(8)
  v_mfma_f32_32x32x16_bf16 v[56:71], a[144:147], a[192:195], 0
  ds_read_b64_tr_b16 a[176:177], v7 offset:18432
  ds_read_b64_tr_b16 a[178:179], v7 offset:20480
  v_mul_f32 v44, v120, v120
  v_mul_f32 v45, v121, v121
  v_fma_f32 v44, v44, v35, v34
  v_fma_f32 v45, v45, v35, v34
  v_mfma_f32_32x32x16_bf16 v[72:87], a[148:151], a[192:195], 0
  ds_read_b64_tr_b16 a[180:181], v7 offset:18944
  ds_read_b64_tr_b16 a[182:183], v7 offset:20992
  buffer_load_dwordx4 v27, s[12:15], s34 offen offset:1024 lds
  v_mul_f32 v44, v120, v44
  v_mul_f32 v45, v121, v45
  v_mul_f32 v136, v120, v136
  v_mfma_f32_32x32x16_bf16 v[88:103], a[152:155], a[192:195], 0
HP_k3_p13:
  s_cbranch_execz HP_k3_p17
  ds_read_b64_tr_b16 a[184:185], v7 offset:19456
  ds_read_b64_tr_b16 a[186:187], v7 offset:21504
  v_exp_f32 v44, v44
  v_exp_f32 v45, v45
  v_mfma_f32_32x32x16_bf16 v[104:119], a[156:159], a[192:195], 0
  ds_read_b64_tr_b16 a[188:189], v7 offset:19968
  ds_read_b64_tr_b16 a[190:191], v7 offset:22016
  buffer_load_dwordx4 v[232:235], v37, s[16:19], s51 offen offset:2048 sc0 sc1
  v_mul_f32 v137, v121, v137
  v_fma_f32 v44, v44, v36, v36
  s_waitcnt lgkmcnt(8)
  v_mfma_f32_32x32x16_bf16 v[56:71], a[160:163], a[196:199], v[56:71]
  ds_read_b64_tr_b16 a[144:145], v7 offset:27648
  ds_read_b64_tr_b16 a[146:147], v7 offset:29696
  v_fma_f32 v45, v45, v36, v36
  v_rcp_f32 v44, v44
  v_mul_f32 v46, v122, v122
  v_mfma_f32_32x32x16_bf16 v[72:87], a[164:167], a[196:199], v[72:87]
  ds_read_b64_tr_b16 a[148:149], v7 offset:28160
  ds_read_b64_tr_b16 a[150:151], v7 offset:30208
  buffer_load_dwordx4 v8, s[12:15], s34 offen offset:2048 lds
  v_rcp_f32 v45, v45
  v_mul_f32 v44, v136, v44
  v_mfma_f32_32x32x16_bf16 v[88:103], a[168:171], a[196:199], v[88:103]
  ds_read_b64_tr_b16 a[152:153], v7 offset:28672
  ds_read_b64_tr_b16 a[154:155], v7 offset:30720
  v_mul_f32 v45, v137, v45
  v_cvt_pk_bf16_f32 v184, v44, v45
  v_mul_f32 v47, v123, v123
  v_fma_f32 v46, v46, v35, v34
  v_mfma_f32_32x32x16_bf16 v[104:119], a[172:175], a[196:199], v[104:119]
  ds_read_b64_tr_b16 a[156:157], v7 offset:29184
  ds_read_b64_tr_b16 a[158:159], v7 offset:31232
  buffer_load_dwordx4 v[236:239], v37, s[16:19], s51 offen offset:3072 sc0 sc1
  v_fma_f32 v47, v47, v35, v34
  v_mul_f32 v46, v122, v46
  s_waitcnt lgkmcnt(8)
  v_mfma_f32_32x32x16_bf16 v[56:71], a[176:179], a[200:203], v[56:71]
  ds_read_b64_tr_b16 a[160:161], v7 offset:4096
  ds_read_b64_tr_b16 a[162:163], v7 offset:6144
  buffer_load_dwordx4 v9, s[12:15], s34 offen offset:3072 lds
  v_mul_f32 v47, v123, v47
  v_exp_f32 v46, v46
  v_mfma_f32_32x32x16_bf16 v[72:87], a[180:183], a[200:203], v[72:87]
  ds_read_b64_tr_b16 a[164:165], v7 offset:4608
  ds_read_b64_tr_b16 a[166:167], v7 offset:6656
  s_add_u32 s34, s55, 0
  v_mul_f32 v138, v122, v138
  v_exp_f32 v47, v47
  v_mfma_f32_32x32x16_bf16 v[88:103], a[184:187], a[200:203], v[88:103]
  ds_read_b64_tr_b16 a[168:169], v7 offset:5120
  ds_read_b64_tr_b16 a[170:171], v7 offset:7168
  s_add_u32 m0, s31, 4096
  v_mul_f32 v139, v123, v139
  v_fma_f32 v46, v46, v36, v36
  v_fma_f32 v47, v47, v36, v36
  v_mfma_f32_32x32x16_bf16 v[104:119], a[188:191], a[200:203], v[104:119]
  ds_read_b64_tr_b16 a[172:173], v7 offset:5632
  ds_read_b64_tr_b16 a[174:175], v7 offset:7680
  s_add_u32 s51, s43, 0
  buffer_load_dwordx4 v[240:243], v37, s[16:19], s51 offen sc0 sc1
  v_mul_f32 v44, v124, v124
  s_waitcnt lgkmcnt(8)
  v_mfma_f32_32x32x16_bf16 v[56:71], a[144:147], a[204:207], v[56:71]
  ds_read_b64_tr_b16 a[176:177], v7 offset:13312
  ds_read_b64_tr_b16 a[178:179], v7 offset:15360
  buffer_load_dwordx4 v26, s[12:15], s34 offen lds
  v_rcp_f32 v46, v46
  v_mul_f32 v45, v125, v125
  v_mfma_f32_32x32x16_bf16 v[72:87], a[148:151], a[204:207], v[72:87]
  ds_read_b64_tr_b16 a[180:181], v7 offset:13824
  ds_read_b64_tr_b16 a[182:183], v7 offset:15872
  v_rcp_f32 v47, v47
  v_mul_f32 v46, v138, v46
  v_mul_f32 v47, v139, v47
  v_mfma_f32_32x32x16_bf16 v[88:103], a[152:155], a[204:207], v[88:103]
  ds_read_b64_tr_b16 a[184:185], v7 offset:14336
  ds_read_b64_tr_b16 a[186:187], v7 offset:16384
  v_cvt_pk_bf16_f32 v185, v46, v47
  v_fma_f32 v44, v44, v35, v34
  v_fma_f32 v45, v45, v35, v34
  v_mul_f32 v44, v124, v44
  v_mfma_f32_32x32x16_bf16 v[104:119], a[156:159], a[204:207], v[104:119]
  ds_read_b64_tr_b16 a[188:189], v7 offset:14848
  ds_read_b64_tr_b16 a[190:191], v7 offset:16896
  buffer_load_dwordx4 v27, s[12:15], s34 offen offset:1024 lds
  v_mul_f32 v45, v125, v45
  v_mul_f32 v140, v124, v140
  s_waitcnt lgkmcnt(8)
  v_mfma_f32_32x32x16_bf16 v[56:71], a[160:163], a[208:211], v[56:71]
  ds_read_b64_tr_b16 a[144:145], v7 offset:22528
  ds_read_b64_tr_b16 a[146:147], v7 offset:24576
  buffer_load_dwordx4 v[244:247], v37, s[16:19], s51 offen offset:1024 sc0 sc1
  v_exp_f32 v44, v44
  v_mul_f32 v141, v125, v141
  v_mfma_f32_32x32x16_bf16 v[72:87], a[164:167], a[208:211], v[72:87]
  ds_read_b64_tr_b16 a[148:149], v7 offset:23040
  ds_read_b64_tr_b16 a[150:151], v7 offset:25088
  v_exp_f32 v45, v45
  v_fma_f32 v44, v44, v36, v36
  v_fma_f32 v45, v45, v36, v36
  v_mfma_f32_32x32x16_bf16 v[88:103], a[168:171], a[208:211], v[88:103]
  ds_read_b64_tr_b16 a[152:153], v7 offset:23552
  ds_read_b64_tr_b16 a[154:155], v7 offset:25600
  s_waitcnt vmcnt(12)
  buffer_atomic_add v42, v49, s[16:19], s42 offen sc1
  v_mul_f32 v46, v126, v126
  v_mfma_f32_32x32x16_bf16 v[104:119], a[172:175], a[208:211], v[104:119]
  ds_read_b64_tr_b16 a[156:157], v7 offset:24064
  ds_read_b64_tr_b16 a[158:159], v7 offset:26112
  buffer_load_dwordx4 v8, s[12:15], s34 offen offset:2048 lds
  v_rcp_f32 v44, v44
  s_waitcnt lgkmcnt(8)
  v_mfma_f32_32x32x16_bf16 v[56:71], a[176:179], a[212:215], v[56:71]
  ds_read_b64_tr_b16 a[160:161], v7 offset:31744
  ds_read_b64_tr_b16 a[162:163], v7 offset:33792
  buffer_load_dwordx4 v[248:251], v37, s[16:19], s51 offen offset:2048 sc0 sc1
  v_rcp_f32 v45, v45
  v_mul_f32 v44, v140, v44
  v_mfma_f32_32x32x16_bf16 v[72:87], a[180:183], a[212:215], v[72:87]
  ds_read_b64_tr_b16 a[164:165], v7 offset:32256
  ds_read_b64_tr_b16 a[166:167], v7 offset:34304
  v_mul_f32 v45, v141, v45
  v_cvt_pk_bf16_f32 v186, v44, v45
  v_mul_f32 v47, v127, v127
  v_fma_f32 v46, v46, v35, v34
  v_mfma_f32_32x32x16_bf16 v[88:103], a[184:187], a[212:215], v[88:103]
  ds_read_b64_tr_b16 a[168:169], v7 offset:32768
  ds_read_b64_tr_b16 a[170:171], v7 offset:34816
  buffer_load_dwordx4 v9, s[12:15], s34 offen offset:3072 lds
  v_fma_f32 v47, v47, v35, v34
  v_mul_f32 v46, v126, v46
  v_mul_f32 v47, v127, v47
  v_mfma_f32_32x32x16_bf16 v[104:119], a[188:191], a[212:215], v[104:119]
  ds_read_b64_tr_b16 a[172:173], v7 offset:33280
  ds_read_b64_tr_b16 a[174:175], v7 offset:35328
  v_exp_f32 v46, v46
  v_mul_f32 v142, v126, v142
  s_waitcnt lgkmcnt(8)
  v_mfma_f32_32x32x16_bf16 v[56:71], a[144:147], a[216:219], v[56:71]
  s_barrier
  ds_read_b64_tr_b16 a[176:177], v6 offset:0
  ds_read_b64_tr_b16 a[178:179], v6 offset:2048
  v_exp_f32 v47, v47
  v_mfma_f32_32x32x16_bf16 v[72:87], a[148:151], a[216:219], v[72:87]
  ds_read_b64_tr_b16 a[180:181], v6 offset:512
  ds_read_b64_tr_b16 a[182:183], v6 offset:2560
  buffer_load_dwordx4 v[252:255], v37, s[16:19], s51 offen offset:3072 sc0 sc1
  v_mul_f32 v143, v127, v143
  v_fma_f32 v46, v46, v36, v36
  v_fma_f32 v47, v47, v36, v36
  v_mfma_f32_32x32x16_bf16 v[88:103], a[152:155], a[216:219], v[88:103]
HP_k3_p14:
  s_cbranch_execz HP_k3_p18
  ds_read_b64_tr_b16 a[184:185], v6 offset:1024
  ds_read_b64_tr_b16 a[186:187], v6 offset:3072
  s_add_u32 s34, s56, 147456
  v_rcp_f32 v46, v46
  v_mul_f32 v44, v128, v128
  v_mfma_f32_32x32x16_bf16 v[104:119], a[156:159], a[216:219], v[104:119]
  ds_read_b64_tr_b16 a[188:189], v6 offset:1536
  ds_read_b64_tr_b16 a[190:191], v6 offset:3584
  v_rcp_f32 v47, v47
  v_mul_f32 v46, v142, v46
  s_waitcnt lgkmcnt(8)
  v_mfma_f32_32x32x16_bf16 v[56:71], a[160:163], a[220:223], v[56:71]
  ds_read_b64_tr_b16 a[144:145], v6 offset:9216
  ds_read_b64_tr_b16 a[146:147], v6 offset:11264
  s_add_u32 m0, s31, 36864
  v_mul_f32 v47, v143, v47
  v_cvt_pk_bf16_f32 v187, v46, v47
  v_mul_f32 v45, v129, v129
  v_mfma_f32_32x32x16_bf16 v[72:87], a[164:167], a[220:223], v[72:87]
  ds_read_b64_tr_b16 a[148:149], v6 offset:9728
  ds_read_b64_tr_b16 a[150:151], v6 offset:11776
  buffer_store_dwordx4 v[184:187], v37, s[16:19], s50 offen sc0 sc1
  v_fma_f32 v44, v44, v35, v34
  v_fma_f32 v45, v45, v35, v34
  v_mul_f32 v44, v128, v44
  v_mfma_f32_32x32x16_bf16 v[88:103], a[168:171], a[220:223], v[88:103]
  ds_read_b64_tr_b16 a[152:153], v6 offset:10240
  ds_read_b64_tr_b16 a[154:155], v6 offset:12288
  buffer_load_dwordx4 v26, s[12:15], s34 offen lds
  v_mul_f32 v45, v129, v45
  v_exp_f32 v44, v44
  v_mfma_f32_32x32x16_bf16 v[104:119], a[172:175], a[220:223], v[104:119]
  ds_read_b64_tr_b16 a[156:157], v6 offset:10752
  ds_read_b64_tr_b16 a[158:159], v6 offset:12800
  s_add_u32 s51, s99, 0
  buffer_load_dwordx4 a[0:3], v37, s[16:19], s51 offen sc0 sc1
  v_mul_f32 v144, v128, v144
  s_waitcnt lgkmcnt(8)
  v_mfma_f32_32x32x16_bf16 v[56:71], a[176:179], v[208:211], v[56:71]
  ds_read_b64_tr_b16 a[160:161], v6 offset:18432
  ds_read_b64_tr_b16 a[162:163], v6 offset:20480
  v_exp_f32 v45, v45
  v_mul_f32 v145, v129, v145
  v_fma_f32 v44, v44, v36, v36
  v_mfma_f32_32x32x16_bf16 v[72:87], a[180:183], v[208:211], v[72:87]
  ds_read_b64_tr_b16 a[164:165], v6 offset:18944
  ds_read_b64_tr_b16 a[166:167], v6 offset:20992
  buffer_load_dwordx4 v27, s[12:15], s34 offen offset:1024 lds
  v_fma_f32 v45, v45, v36, v36
  v_rcp_f32 v44, v44
  v_mfma_f32_32x32x16_bf16 v[88:103], a[184:187], v[208:211], v[88:103]
  ds_read_b64_tr_b16 a[168:169], v6 offset:19456
  ds_read_b64_tr_b16 a[170:171], v6 offset:21504
  v_rcp_f32 v45, v45
  v_mul_f32 v44, v144, v44
  v_mul_f32 v45, v145, v45
  v_mfma_f32_32x32x16_bf16 v[104:119], a[188:191], v[208:211], v[104:119]
  ds_read_b64_tr_b16 a[172:173], v6 offset:19968
  ds_read_b64_tr_b16 a[174:175], v6 offset:22016
  buffer_load_dwordx4 a[4:7], v37, s[16:19], s51 offen offset:1024 sc0 sc1
  v_cvt_pk_bf16_f32 v188, v44, v45
  v_mul_f32 v46, v130, v130
  s_waitcnt lgkmcnt(8)
  v_mfma_f32_32x32x16_bf16 v[56:71], a[144:147], v[212:215], v[56:71]
  ds_read_b64_tr_b16 a[176:177], v6 offset:27648
  ds_read_b64_tr_b16 a[178:179], v6 offset:29696
  v_mul_f32 v47, v131, v131
  v_fma_f32 v46, v46, v35, v34
  v_fma_f32 v47, v47, v35, v34
  v_mul_f32 v46, v130, v46
  v_mfma_f32_32x32x16_bf16 v[72:87], a[148:151], v[212:215], v[72:87]
  ds_read_b64_tr_b16 a[180:181], v6 offset:28160
  ds_read_b64_tr_b16 a[182:183], v6 offset:30208
  buffer_load_dwordx4 v8, s[12:15], s34 offen offset:2048 lds
  v_mul_f32 v47, v131, v47
  v_exp_f32 v46, v46
  v_mfma_f32_32x32x16_bf16 v[88:103], a[152:155], v[212:215], v[88:103]
  ds_read_b64_tr_b16 a[184:185], v6 offset:28672
  ds_read_b64_tr_b16 a[186:187], v6 offset:30720
  v_mul_f32 v146, v130, v146
  v_exp_f32 v47, v47
  v_mul_f32 v147, v131, v147
  v_mfma_f32_32x32x16_bf16 v[104:119], a[156:159], v[212:215], v[104:119]
  ds_read_b64_tr_b16 a[188:189], v6 offset:29184
  ds_read_b64_tr_b16 a[190:191], v6 offset:31232
  buffer_load_dwordx4 a[8:11], v37, s[16:19], s51 offen offset:2048 sc0 sc1
  v_fma_f32 v46, v46, v36, v36
  v_fma_f32 v47, v47, v36, v36
  s_waitcnt lgkmcnt(8)
  v_mfma_f32_32x32x16_bf16 v[56:71], a[160:163], v[216:219], v[56:71]
  ds_read_b64_tr_b16 a[144:145], v6 offset:4096
  ds_read_b64_tr_b16 a[146:147], v6 offset:6144
  buffer_load_dwordx4 v9, s[12:15], s34 offen offset:3072 lds
  v_rcp_f32 v46, v46
  v_mul_f32 v44, v132, v132
  v_mfma_f32_32x32x16_bf16 v[72:87], a[164:167], v[216:219], v[72:87]
  ds_read_b64_tr_b16 a[148:149], v6 offset:4608
  ds_read_b64_tr_b16 a[150:151], v6 offset:6656
  s_add_u32 s34, s54, 73728
  v_rcp_f32 v47, v47
  v_mul_f32 v46, v146, v46
  v_mfma_f32_32x32x16_bf16 v[88:103], a[168:171], v[216:219], v[88:103]
  ds_read_b64_tr_b16 a[152:153], v6 offset:5120
  ds_read_b64_tr_b16 a[154:155], v6 offset:7168
  v_subrev_u32 v10, 2048, v26
  v_subrev_u32 v11, 2048, v29
  v_add_u32 v54, 4096, v3
  v_mul_f32 v47, v147, v47
  v_mfma_f32_32x32x16_bf16 v[104:119], a[172:175], v[216:219], v[104:119]
  ds_read_b64_tr_b16 a[156:157], v6 offset:5632
  ds_read_b64_tr_b16 a[158:159], v6 offset:7680
  s_add_u32 m0, s31, 40960
  v_cvt_pk_bf16_f32 v189, v46, v47
  v_mul_f32 v45, v133, v133
  s_waitcnt lgkmcnt(8)
  v_mfma_f32_32x32x16_bf16 v[56:71], a[176:179], v[220:223], v[56:71]
  ds_read_b64_tr_b16 a[160:161], v6 offset:13312
  ds_read_b64_tr_b16 a[162:163], v6 offset:15360
  buffer_load_dwordx4 v26, s[12:15], s34 offen lds
  v_fma_f32 v44, v44, v35, v34
  v_fma_f32 v45, v45, v35, v34
  v_mul_f32 v44, v132, v44
  v_mfma_f32_32x32x16_bf16 v[72:87], a[180:183], v[220:223], v[72:87]
  ds_read_b64_tr_b16 a[164:165], v6 offset:13824
  ds_read_b64_tr_b16 a[166:167], v6 offset:15872
  buffer_load_dwordx4 a[12:15], v37, s[16:19], s51 offen offset:3072 sc0 sc1
  v_mul_f32 v45, v133, v45
  v_exp_f32 v44, v44
  v_mfma_f32_32x32x16_bf16 v[88:103], a[184:187], v[220:223], v[88:103]
  ds_read_b64_tr_b16 a[168:169], v6 offset:14336
  ds_read_b64_tr_b16 a[170:171], v6 offset:16384
  s_lshl_b32 s20, s52, 4
  s_add_u32 s20, s20, 48234496
  v_mul_f32 v148, v132, v148
  v_mul_f32 v149, v133, v149
  v_mfma_f32_32x32x16_bf16 v[104:119], a[188:191], v[220:223], v[104:119]
  ds_read_b64_tr_b16 a[172:173], v6 offset:14848
  ds_read_b64_tr_b16 a[174:175], v6 offset:16896
  buffer_load_dwordx4 v27, s[12:15], s34 offen offset:1024 lds
  v_exp_f32 v45, v45
  s_waitcnt lgkmcnt(8)
  s_waitcnt vmcnt(27)
  v_mfma_f32_32x32x16_bf16 v[56:71], a[144:147], v[224:227], v[56:71]
  ds_read_b64_tr_b16 a[176:177], v6 offset:22528
  ds_read_b64_tr_b16 a[178:179], v6 offset:24576
  v_fma_f32 v44, v44, v36, v36
  v_fma_f32 v45, v45, v36, v36
  v_rcp_f32 v44, v44
  v_mfma_f32_32x32x16_bf16 v[72:87], a[148:151], v[224:227], v[72:87]
  ds_read_b64_tr_b16 a[180:181], v6 offset:23040
  ds_read_b64_tr_b16 a[182:183], v6 offset:25088
HP_k3_p15:
  s_cbranch_execz HP_k3_p19
  s_add_u32 s51, s43, 4096
  buffer_load_dwordx4 a[16:19], v37, s[16:19], s51 offen sc0 sc1
  v_rcp_f32 v45, v45
  v_mfma_f32_32x32x16_bf16 v[88:103], a[152:155], v[224:227], v[88:103]
  ds_read_b64_tr_b16 a[184:185], v6 offset:23552
  ds_read_b64_tr_b16 a[186:187], v6 offset:25600
  s_lshl_b32 s52, s28, 18
  s_add_u32 s52, s52, s20
  v_mul_f32 v44, v148, v44
  v_mul_f32 v45, v149, v45
  v_mfma_f32_32x32x16_bf16 v[104:119], a[156:159], v[224:227], v[104:119]
  ds_read_b64_tr_b16 a[188:189], v6 offset:24064
  ds_read_b64_tr_b16 a[190:191], v6 offset:26112
  buffer_load_dwordx4 v8, s[12:15], s34 offen offset:2048 lds
  v_cvt_pk_bf16_f32 v190, v44, v45
  v_mul_f32 v46, v134, v134
  s_waitcnt lgkmcnt(8)
  s_waitcnt vmcnt(27)
  v_mfma_f32_32x32x16_bf16 v[56:71], a[160:163], v[228:231], v[56:71]
  ds_read_b64_tr_b16 a[144:145], v6 offset:31744
  ds_read_b64_tr_b16 a[146:147], v6 offset:33792
  v_mul_f32 v47, v135, v135
  v_fma_f32 v46, v46, v35, v34
  v_fma_f32 v47, v47, v35, v34
  v_mul_f32 v46, v134, v46
  v_mfma_f32_32x32x16_bf16 v[72:87], a[164:167], v[228:231], v[72:87]
  ds_read_b64_tr_b16 a[148:149], v6 offset:32256
  ds_read_b64_tr_b16 a[150:151], v6 offset:34304
  buffer_load_dwordx4 a[20:23], v37, s[16:19], s51 offen offset:1024 sc0 sc1
  v_mul_f32 v47, v135, v47
  v_exp_f32 v46, v46
  v_mfma_f32_32x32x16_bf16 v[88:103], a[168:171], v[228:231], v[88:103]
  ds_read_b64_tr_b16 a[152:153], v6 offset:32768
  ds_read_b64_tr_b16 a[154:155], v6 offset:34816
  buffer_load_dwordx4 v9, s[12:15], s34 offen offset:3072 lds
  v_mul_f32 v150, v134, v150
  v_exp_f32 v47, v47
  v_mfma_f32_32x32x16_bf16 v[104:119], a[172:175], v[228:231], v[104:119]
  ds_read_b64_tr_b16 a[156:157], v6 offset:33280
  ds_read_b64_tr_b16 a[158:159], v6 offset:35328
  v_mul_f32 v151, v135, v151
  v_fma_f32 v46, v46, v36, v36
  v_fma_f32 v47, v47, v36, v36
  s_waitcnt lgkmcnt(8)
  s_waitcnt vmcnt(27)
  v_mfma_f32_32x32x16_bf16 v[56:71], a[176:179], v[232:235], v[56:71]
  s_waitcnt vmcnt(16)
  s_barrier
  ds_read_b64_tr_b16 a[160:161], v4 offset:0
  ds_read_b64_tr_b16 a[162:163], v4 offset:2048
  v_mul_f32 v44, v152, v152
  v_mfma_f32_32x32x16_bf16 v[72:87], a[180:183], v[232:235], v[72:87]
  ds_read_b64_tr_b16 a[164:165], v4 offset:512
  ds_read_b64_tr_b16 a[166:167], v4 offset:2560
  buffer_load_dwordx4 a[24:27], v37, s[16:19], s51 offen offset:2048 sc0 sc1
  v_rcp_f32 v46, v46
  v_mul_f32 v45, v153, v153
  v_mfma_f32_32x32x16_bf16 v[88:103], a[184:187], v[232:235], v[88:103]
  ds_read_b64_tr_b16 a[168:169], v4 offset:1024
  ds_read_b64_tr_b16 a[170:171], v4 offset:3072
  s_add_u32 s34, s58, 0
  v_rcp_f32 v47, v47
  v_mul_f32 v46, v150, v46
  v_mfma_f32_32x32x16_bf16 v[104:119], a[188:191], v[232:235], v[104:119]
  ds_read_b64_tr_b16 a[172:173], v4 offset:1536
  ds_read_b64_tr_b16 a[174:175], v4 offset:3584
  v_mul_f32 v47, v151, v47
  v_cvt_pk_bf16_f32 v191, v46, v47
  v_fma_f32 v44, v44, v35, v34
  s_waitcnt lgkmcnt(8)
  v_mfma_f32_32x32x16_bf16 v[56:71], a[144:147], v[236:239], v[56:71]
  ds_read_b64_tr_b16 a[176:177], v4 offset:9216
  ds_read_b64_tr_b16 a[178:179], v4 offset:11264
  s_add_u32 m0, s31, 110592
  v_fma_f32 v45, v45, v35, v34
  v_mul_f32 v44, v152, v44
  v_mul_f32 v45, v153, v45
  v_mfma_f32_32x32x16_bf16 v[72:87], a[148:151], v[236:239], v[72:87]
  ds_read_b64_tr_b16 a[180:181], v4 offset:9728
  ds_read_b64_tr_b16 a[182:183], v4 offset:11776
  buffer_store_dwordx4 v[188:191], v37, s[16:19], s50 offen offset:1024 sc0 sc1
  v_exp_f32 v44, v44
  v_mul_f32 v168, v152, v168
  v_mfma_f32_32x32x16_bf16 v[88:103], a[152:155], v[236:239], v[88:103]
  ds_read_b64_tr_b16 a[184:185], v4 offset:10240
  ds_read_b64_tr_b16 a[186:187], v4 offset:12288
  buffer_load_dwordx4 v26, s[12:15], s34 offen lds
  v_exp_f32 v45, v45
  v_mul_f32 v169, v153, v169
  v_mfma_f32_32x32x16_bf16 v[104:119], a[156:159], v[236:239], v[104:119]
  ds_read_b64_tr_b16 a[188:189], v4 offset:10752
  ds_read_b64_tr_b16 a[190:191], v4 offset:12800
  buffer_load_dwordx4 a[28:31], v37, s[16:19], s51 offen offset:3072 sc0 sc1
  v_fma_f32 v44, v44, v36, v36
  v_fma_f32 v45, v45, v36, v36
  s_waitcnt lgkmcnt(8)
  v_mfma_f32_32x32x16_bf16 v[56:71], a[160:163], v[240:243], v[56:71]
  ds_read_b64_tr_b16 a[144:145], v4 offset:18432
  ds_read_b64_tr_b16 a[146:147], v4 offset:20480
  v_rcp_f32 v44, v44
  v_rcp_f32 v45, v45
  v_mfma_f32_32x32x16_bf16 v[72:87], a[164:167], v[240:243], v[72:87]
  ds_read_b64_tr_b16 a[148:149], v4 offset:18944
  ds_read_b64_tr_b16 a[150:151], v4 offset:20992
  buffer_load_dwordx4 v27, s[12:15], s34 offen offset:1024 lds
  v_mul_f32 v44, v168, v44
  v_mul_f32 v45, v169, v45
  v_cvt_pk_bf16_f32 v192, v44, v45
  v_mfma_f32_32x32x16_bf16 v[88:103], a[168:171], v[240:243], v[88:103]
  ds_read_b64_tr_b16 a[152:153], v4 offset:19456
  ds_read_b64_tr_b16 a[154:155], v4 offset:21504
  v_mul_f32 v46, v154, v154
  v_mul_f32 v47, v155, v155
  v_fma_f32 v46, v46, v35, v34
  v_fma_f32 v47, v47, v35, v34
  v_mfma_f32_32x32x16_bf16 v[104:119], a[172:175], v[240:243], v[104:119]
  ds_read_b64_tr_b16 a[156:157], v4 offset:19968
  ds_read_b64_tr_b16 a[158:159], v4 offset:22016
  s_add_u32 s51, s41, 16384
  buffer_load_dwordx4 a[32:35], v37, s[16:19], s51 offen sc0 sc1
  v_mul_f32 v46, v154, v46
  s_waitcnt lgkmcnt(8)
  v_mfma_f32_32x32x16_bf16 v[56:71], a[176:179], v[244:247], v[56:71]
  ds_read_b64_tr_b16 a[160:161], v4 offset:27648
  ds_read_b64_tr_b16 a[162:163], v4 offset:29696
  v_mov_b32 v40, 0
  buffer_atomic_add v40, v30, s[16:19], 0 offen sc0 sc1
  v_mul_f32 v47, v155, v47
  v_mfma_f32_32x32x16_bf16 v[72:87], a[180:183], v[244:247], v[72:87]
  ds_read_b64_tr_b16 a[164:165], v4 offset:28160
  ds_read_b64_tr_b16 a[166:167], v4 offset:30208
  buffer_load_dwordx4 v8, s[12:15], s34 offen offset:2048 lds
  v_exp_f32 v46, v46
  v_mul_f32 v170, v154, v170
  v_mfma_f32_32x32x16_bf16 v[88:103], a[184:187], v[244:247], v[88:103]
  ds_read_b64_tr_b16 a[168:169], v4 offset:28672
  ds_read_b64_tr_b16 a[170:171], v4 offset:30720
  v_exp_f32 v47, v47
  v_mul_f32 v171, v155, v171
  v_fma_f32 v46, v46, v36, v36
  v_mfma_f32_32x32x16_bf16 v[104:119], a[188:191], v[244:247], v[104:119]
  ds_read_b64_tr_b16 a[172:173], v4 offset:29184
  ds_read_b64_tr_b16 a[174:175], v4 offset:31232
  buffer_load_dwordx4 a[36:39], v37, s[16:19], s51 offen offset:1024 sc0 sc1
  v_fma_f32 v47, v47, v36, v36
  v_mul_f32 v44, v156, v156
  s_waitcnt lgkmcnt(8)
  v_mfma_f32_32x32x16_bf16 v[56:71], a[144:147], v[248:251], v[56:71]
  ds_read_b64_tr_b16 a[176:177], v4 offset:4096
  ds_read_b64_tr_b16 a[178:179], v4 offset:6144
  buffer_load_dwordx4 v9, s[12:15], s34 offen offset:3072 lds
  v_rcp_f32 v46, v46
  v_mul_f32 v45, v157, v157
HP_k3_p16:
  s_cbranch_execz HP_k3_p20
  v_mfma_f32_32x32x16_bf16 v[72:87], a[148:151], v[248:251], v[72:87]
  ds_read_b64_tr_b16 a[180:181], v4 offset:4608
  ds_read_b64_tr_b16 a[182:183], v4 offset:6656
  s_add_u32 s34, s55, 73728
  v_rcp_f32 v47, v47
  v_mul_f32 v46, v170, v46
  v_mfma_f32_32x32x16_bf16 v[88:103], a[152:155], v[248:251], v[88:103]
  ds_read_b64_tr_b16 a[184:185], v4 offset:5120
  ds_read_b64_tr_b16 a[186:187], v4 offset:7168
  s_add_u32 m0, s31, 114688
  v_mul_f32 v47, v171, v47
  v_cvt_pk_bf16_f32 v193, v46, v47
  v_fma_f32 v44, v44, v35, v34
  v_mfma_f32_32x32x16_bf16 v[104:119], a[156:159], v[248:251], v[104:119]
  ds_read_b64_tr_b16 a[188:189], v4 offset:5632
  ds_read_b64_tr_b16 a[190:191], v4 offset:7680
  s_add_u32 s51, s99, 4096
  buffer_load_dwordx4 a[40:43], v37, s[16:19], s51 offen sc0 sc1
  v_fma_f32 v45, v45, v35, v34
  s_waitcnt lgkmcnt(8)
  s_waitcnt vmcnt(26)
  v_mfma_f32_32x32x16_bf16 v[56:71], a[160:163], v[252:255], v[56:71]
  ds_read_b64_tr_b16 a[144:145], v4 offset:13312
  ds_read_b64_tr_b16 a[146:147], v4 offset:15360
  buffer_load_dwordx4 v26, s[12:15], s34 offen lds
  v_mul_f32 v44, v156, v44
  v_mul_f32 v45, v157, v45
  v_mul_f32 v172, v156, v172
  v_mfma_f32_32x32x16_bf16 v[72:87], a[164:167], v[252:255], v[72:87]
  ds_read_b64_tr_b16 a[148:149], v4 offset:13824
  ds_read_b64_tr_b16 a[150:151], v4 offset:15872
  v_exp_f32 v44, v44
  v_exp_f32 v45, v45
  v_mfma_f32_32x32x16_bf16 v[88:103], a[168:171], v[252:255], v[88:103]
  ds_read_b64_tr_b16 a[152:153], v4 offset:14336
  ds_read_b64_tr_b16 a[154:155], v4 offset:16384
  v_mul_f32 v173, v157, v173
  v_fma_f32 v44, v44, v36, v36
  v_fma_f32 v45, v45, v36, v36
  v_mul_f32 v46, v158, v158
  v_mfma_f32_32x32x16_bf16 v[104:119], a[172:175], v[252:255], v[104:119]
  ds_read_b64_tr_b16 a[156:157], v4 offset:14848
  ds_read_b64_tr_b16 a[158:159], v4 offset:16896
  buffer_load_dwordx4 v27, s[12:15], s34 offen offset:1024 lds
  v_rcp_f32 v44, v44
  s_waitcnt lgkmcnt(8)
  s_waitcnt vmcnt(25)
  v_mfma_f32_32x32x16_bf16 v[56:71], a[176:179], a[0:3], v[56:71]
  ds_read_b64_tr_b16 a[160:161], v4 offset:22528
  ds_read_b64_tr_b16 a[162:163], v4 offset:24576
  buffer_load_dwordx4 a[44:47], v37, s[16:19], s51 offen offset:1024 sc0 sc1
  v_rcp_f32 v45, v45
  v_mul_f32 v44, v172, v44
  v_mfma_f32_32x32x16_bf16 v[72:87], a[180:183], a[0:3], v[72:87]
  ds_read_b64_tr_b16 a[164:165], v4 offset:23040
  ds_read_b64_tr_b16 a[166:167], v4 offset:25088
  v_mul_f32 v45, v173, v45
  v_cvt_pk_bf16_f32 v194, v44, v45
  v_mul_f32 v47, v159, v159
  v_fma_f32 v46, v46, v35, v34
  v_mfma_f32_32x32x16_bf16 v[88:103], a[184:187], a[0:3], v[88:103]
  ds_read_b64_tr_b16 a[168:169], v4 offset:23552
  ds_read_b64_tr_b16 a[170:171], v4 offset:25600
  v_fma_f32 v47, v47, v35, v34
  v_mul_f32 v46, v158, v46
  v_mul_f32 v47, v159, v47
  v_mul_f32 v174, v158, v174
  v_mfma_f32_32x32x16_bf16 v[104:119], a[188:191], a[0:3], v[104:119]
  ds_read_b64_tr_b16 a[172:173], v4 offset:24064
  ds_read_b64_tr_b16 a[174:175], v4 offset:26112
  buffer_load_dwordx4 v8, s[12:15], s34 offen offset:2048 lds
  v_exp_f32 v46, v46
  s_waitcnt lgkmcnt(8)
  s_waitcnt vmcnt(25)
  v_mfma_f32_32x32x16_bf16 v[56:71], a[144:147], a[4:7], v[56:71]
  ds_read_b64_tr_b16 a[176:177], v4 offset:31744
  ds_read_b64_tr_b16 a[178:179], v4 offset:33792
  buffer_load_dwordx4 a[48:51], v37, s[16:19], s51 offen offset:2048 sc0 sc1
  v_exp_f32 v47, v47
  v_mul_f32 v175, v159, v175
  v_mfma_f32_32x32x16_bf16 v[72:87], a[148:151], a[4:7], v[72:87]
  ds_read_b64_tr_b16 a[180:181], v4 offset:32256
  ds_read_b64_tr_b16 a[182:183], v4 offset:34304
  v_fma_f32 v46, v46, v36, v36
  v_fma_f32 v47, v47, v36, v36
  v_rcp_f32 v46, v46
  v_mfma_f32_32x32x16_bf16 v[88:103], a[152:155], a[4:7], v[88:103]
  ds_read_b64_tr_b16 a[184:185], v4 offset:32768
  ds_read_b64_tr_b16 a[186:187], v4 offset:34816
  buffer_load_dwordx4 v9, s[12:15], s34 offen offset:3072 lds
  v_rcp_f32 v47, v47
  v_mul_f32 v46, v174, v46
  v_mfma_f32_32x32x16_bf16 v[104:119], a[156:159], a[4:7], v[104:119]
  ds_read_b64_tr_b16 a[188:189], v4 offset:33280
  ds_read_b64_tr_b16 a[190:191], v4 offset:35328
  v_mul_f32 v47, v175, v47
  v_cvt_pk_bf16_f32 v195, v46, v47
  v_mul_f32 v44, v160, v160
  s_waitcnt lgkmcnt(8)
  s_waitcnt vmcnt(25)
  v_mfma_f32_32x32x16_bf16 v[56:71], a[160:163], a[8:11], v[56:71]
  s_waitcnt vmcnt(17)
  s_barrier
  ds_read_b64_tr_b16 a[144:145], v5 offset:0
  ds_read_b64_tr_b16 a[146:147], v5 offset:2048
  v_mul_f32 v45, v161, v161
  v_mfma_f32_32x32x16_bf16 v[72:87], a[164:167], a[8:11], v[72:87]
  ds_read_b64_tr_b16 a[148:149], v5 offset:512
  ds_read_b64_tr_b16 a[150:151], v5 offset:2560
  buffer_store_dwordx4 v[192:195], v37, s[16:19], s50 offen offset:2048 sc0 sc1
  v_fma_f32 v44, v44, v35, v34
  v_fma_f32 v45, v45, v35, v34
  v_mul_f32 v44, v160, v44
  v_mfma_f32_32x32x16_bf16 v[88:103], a[168:171], a[8:11], v[88:103]
  ds_read_b64_tr_b16 a[152:153], v5 offset:1024
  ds_read_b64_tr_b16 a[154:155], v5 offset:3072
  s_waitcnt vmcnt(11)
  v_cmp_le_u32 vcc, 4, v40
  s_nop 1
  s_cmp_eq_u32 vcc_lo, 7
  s_cbranch_scc0 K3_spinA
K3_retA:
  v_mfma_f32_32x32x16_bf16 v[104:119], a[172:175], a[8:11], v[104:119]
  ds_read_b64_tr_b16 a[156:157], v5 offset:1536
  ds_read_b64_tr_b16 a[158:159], v5 offset:3584
  s_add_u32 s34, s100, 0
  v_mul_f32 v45, v161, v45
  v_mul_f32 v176, v160, v176
  s_waitcnt lgkmcnt(8)
  v_mfma_f32_32x32x16_bf16 v[56:71], a[176:179], a[12:15], v[56:71]
  ds_read_b64_tr_b16 a[160:161], v5 offset:9216
  ds_read_b64_tr_b16 a[162:163], v5 offset:11264
  s_add_u32 m0, s31, 73728
  v_exp_f32 v44, v44
  v_mul_f32 v177, v161, v177
  v_mfma_f32_32x32x16_bf16 v[72:87], a[180:183], a[12:15], v[72:87]
  ds_read_b64_tr_b16 a[164:165], v5 offset:9728
  ds_read_b64_tr_b16 a[166:167], v5 offset:11776
  buffer_load_dwordx4 a[52:55], v37, s[16:19], s51 offen offset:3072 sc0 sc1
  v_exp_f32 v45, v45
  v_fma_f32 v44, v44, v36, v36
  v_mfma_f32_32x32x16_bf16 v[88:103], a[184:187], a[12:15], v[88:103]
  ds_read_b64_tr_b16 a[168:169], v5 offset:10240
  ds_read_b64_tr_b16 a[170:171], v5 offset:12288
  buffer_load_dwordx4 v26, s[12:15], s34 offen lds
  v_fma_f32 v45, v45, v36, v36
  v_rcp_f32 v44, v44
  v_mfma_f32_32x32x16_bf16 v[104:119], a[188:191], a[12:15], v[104:119]
  ds_read_b64_tr_b16 a[172:173], v5 offset:10752
  ds_read_b64_tr_b16 a[174:175], v5 offset:12800
  v_rcp_f32 v45, v45
  v_mul_f32 v44, v176, v44
  s_waitcnt lgkmcnt(8)
  v_mfma_f32_32x32x16_bf16 v[56:71], a[144:147], a[224:227], v[56:71]
  ds_read_b64_tr_b16 a[176:177], v5 offset:18432
  ds_read_b64_tr_b16 a[178:179], v5 offset:20480
HP_k3_p17:
  s_cbranch_execz HP_k3_p21
  v_mul_f32 v45, v177, v45
  v_cvt_pk_bf16_f32 v196, v44, v45
  v_mul_f32 v46, v162, v162
  v_mul_f32 v47, v163, v163
  v_mfma_f32_32x32x16_bf16 v[72:87], a[148:151], a[224:227], v[72:87]
  ds_read_b64_tr_b16 a[180:181], v5 offset:18944
  ds_read_b64_tr_b16 a[182:183], v5 offset:20992
  buffer_load_dwordx4 v27, s[12:15], s34 offen offset:1024 lds
  v_fma_f32 v46, v46, v35, v34
  v_fma_f32 v47, v47, v35, v34
  v_mul_f32 v46, v162, v46
  v_mfma_f32_32x32x16_bf16 v[88:103], a[152:155], a[224:227], v[88:103]
  ds_read_b64_tr_b16 a[184:185], v5 offset:19456
  ds_read_b64_tr_b16 a[186:187], v5 offset:21504
  s_add_u32 s51, s43, 16384
  buffer_load_dwordx4 a[56:59], v37, s[16:19], s51 offen sc0 sc1
  v_mul_f32 v47, v163, v47
  v_mul_f32 v178, v162, v178
  v_mfma_f32_32x32x16_bf16 v[104:119], a[156:159], a[224:227], v[104:119]
  ds_read_b64_tr_b16 a[188:189], v5 offset:19968
  ds_read_b64_tr_b16 a[190:191], v5 offset:22016
  v_exp_f32 v46, v46
  v_mul_f32 v179, v163, v179
  s_waitcnt lgkmcnt(8)
  v_mfma_f32_32x32x16_bf16 v[56:71], a[160:163], a[228:231], v[56:71]
  ds_read_b64_tr_b16 a[144:145], v5 offset:27648
  ds_read_b64_tr_b16 a[146:147], v5 offset:29696
  v_exp_f32 v47, v47
  v_fma_f32 v46, v46, v36, v36
  v_fma_f32 v47, v47, v36, v36
  v_mfma_f32_32x32x16_bf16 v[72:87], a[164:167], a[228:231], v[72:87]
  ds_read_b64_tr_b16 a[148:149], v5 offset:28160
  ds_read_b64_tr_b16 a[150:151], v5 offset:30208
  buffer_load_dwordx4 v8, s[12:15], s34 offen offset:2048 lds
  v_rcp_f32 v46, v46
  v_mul_f32 v44, v164, v164
  v_mfma_f32_32x32x16_bf16 v[88:103], a[168:171], a[228:231], v[88:103]
  ds_read_b64_tr_b16 a[152:153], v5 offset:28672
  ds_read_b64_tr_b16 a[154:155], v5 offset:30720
  buffer_load_dwordx4 a[60:63], v37, s[16:19], s51 offen offset:1024 sc0 sc1
  v_rcp_f32 v47, v47
  v_mul_f32 v46, v178, v46
  v_mfma_f32_32x32x16_bf16 v[104:119], a[172:175], a[228:231], v[104:119]
  ds_read_b64_tr_b16 a[156:157], v5 offset:29184
  ds_read_b64_tr_b16 a[158:159], v5 offset:31232
  v_mul_f32 v47, v179, v47
  v_cvt_pk_bf16_f32 v197, v46, v47
  v_mul_f32 v45, v165, v165
  s_waitcnt lgkmcnt(8)
  v_mfma_f32_32x32x16_bf16 v[56:71], a[176:179], a[232:235], v[56:71]
  ds_read_b64_tr_b16 a[160:161], v5 offset:4096
  ds_read_b64_tr_b16 a[162:163], v5 offset:6144
  buffer_load_dwordx4 v9, s[12:15], s34 offen offset:3072 lds
  v_fma_f32 v44, v44, v35, v34
  v_fma_f32 v45, v45, v35, v34
  v_mul_f32 v44, v164, v44
  v_mfma_f32_32x32x16_bf16 v[72:87], a[180:183], a[232:235], v[72:87]
  ds_read_b64_tr_b16 a[164:165], v5 offset:4608
  ds_read_b64_tr_b16 a[166:167], v5 offset:6656
  s_add_u32 s34, s57, 147456
  v_mul_f32 v45, v165, v45
  v_exp_f32 v44, v44
  v_mfma_f32_32x32x16_bf16 v[88:103], a[184:187], a[232:235], v[88:103]
  ds_read_b64_tr_b16 a[168:169], v5 offset:5120
  ds_read_b64_tr_b16 a[170:171], v5 offset:7168
  s_add_u32 m0, s31, 77824
  v_mul_f32 v180, v164, v180
  v_exp_f32 v45, v45
  v_mfma_f32_32x32x16_bf16 v[104:119], a[188:191], a[232:235], v[104:119]
  ds_read_b64_tr_b16 a[172:173], v5 offset:5632
  ds_read_b64_tr_b16 a[174:175], v5 offset:7680
  s_add_u32 s51, s99, 16384
  buffer_load_dwordx4 a[64:67], v37, s[16:19], s51 offen sc0 sc1
  v_mul_f32 v181, v165, v181
  s_waitcnt lgkmcnt(8)
  v_mfma_f32_32x32x16_bf16 v[56:71], a[144:147], a[236:239], v[56:71]
  ds_read_b64_tr_b16 a[176:177], v5 offset:13312
  ds_read_b64_tr_b16 a[178:179], v5 offset:15360
  buffer_load_dwordx4 v26, s[12:15], s34 offen lds
  v_fma_f32 v44, v44, v36, v36
  v_fma_f32 v45, v45, v36, v36
  v_mul_f32 v46, v166, v166
  v_mfma_f32_32x32x16_bf16 v[72:87], a[148:151], a[236:239], v[72:87]
  ds_read_b64_tr_b16 a[180:181], v5 offset:13824
  ds_read_b64_tr_b16 a[182:183], v5 offset:15872
  v_rcp_f32 v44, v44
  v_rcp_f32 v45, v45
  v_mfma_f32_32x32x16_bf16 v[88:103], a[152:155], a[236:239], v[88:103]
  ds_read_b64_tr_b16 a[184:185], v5 offset:14336
  ds_read_b64_tr_b16 a[186:187], v5 offset:16384
  v_mul_f32 v44, v180, v44
  v_mul_f32 v45, v181, v45
  v_cvt_pk_bf16_f32 v198, v44, v45
  v_mul_f32 v47, v167, v167
  v_mfma_f32_32x32x16_bf16 v[104:119], a[156:159], a[236:239], v[104:119]
  ds_read_b64_tr_b16 a[188:189], v5 offset:14848
  ds_read_b64_tr_b16 a[190:191], v5 offset:16896
  buffer_load_dwordx4 v27, s[12:15], s34 offen offset:1024 lds
  v_fma_f32 v46, v46, v35, v34
  v_fma_f32 v47, v47, v35, v34
  s_waitcnt lgkmcnt(8)
  v_mfma_f32_32x32x16_bf16 v[56:71], a[160:163], a[16:19], v[56:71]
  ds_read_b64_tr_b16 a[144:145], v5 offset:22528
  ds_read_b64_tr_b16 a[146:147], v5 offset:24576
  buffer_load_dwordx4 a[68:71], v37, s[16:19], s51 offen offset:1024 sc0 sc1
  v_mul_f32 v46, v166, v46
  v_mul_f32 v47, v167, v47
  v_mul_f32 v182, v166, v182
  v_mfma_f32_32x32x16_bf16 v[72:87], a[164:167], a[16:19], v[72:87]
  ds_read_b64_tr_b16 a[148:149], v5 offset:23040
  ds_read_b64_tr_b16 a[150:151], v5 offset:25088
  v_exp_f32 v46, v46
  v_exp_f32 v47, v47
  v_mfma_f32_32x32x16_bf16 v[88:103], a[168:171], a[16:19], v[88:103]
  ds_read_b64_tr_b16 a[152:153], v5 offset:23552
  ds_read_b64_tr_b16 a[154:155], v5 offset:25600
  v_mul_f32 v183, v167, v183
  v_fma_f32 v46, v46, v36, v36
  v_fma_f32 v47, v47, v36, v36
  v_mfma_f32_32x32x16_bf16 v[104:119], a[172:175], a[16:19], v[104:119]
  ds_read_b64_tr_b16 a[156:157], v5 offset:24064
  ds_read_b64_tr_b16 a[158:159], v5 offset:26112
  buffer_load_dwordx4 v8, s[12:15], s34 offen offset:2048 lds
  v_rcp_f32 v46, v46
  s_waitcnt lgkmcnt(8)
  v_mfma_f32_32x32x16_bf16 v[56:71], a[176:179], a[20:23], v[56:71]
  ds_read_b64_tr_b16 a[160:161], v5 offset:31744
  ds_read_b64_tr_b16 a[162:163], v5 offset:33792
  s_add_u32 s51, s41, 8192
  buffer_load_dwordx4 a[72:75], v37, s[16:19], s51 offen sc0 sc1
  v_rcp_f32 v47, v47
  v_mfma_f32_32x32x16_bf16 v[72:87], a[180:183], a[20:23], v[72:87]
  ds_read_b64_tr_b16 a[164:165], v5 offset:32256
  ds_read_b64_tr_b16 a[166:167], v5 offset:34304
  v_mul_f32 v46, v182, v46
  v_mul_f32 v47, v183, v47
  v_cvt_pk_bf16_f32 v199, v46, v47
  v_mfma_f32_32x32x16_bf16 v[88:103], a[184:187], a[20:23], v[88:103]
  ds_read_b64_tr_b16 a[168:169], v5 offset:32768
  ds_read_b64_tr_b16 a[170:171], v5 offset:34816
  buffer_load_dwordx4 v9, s[12:15], s34 offen offset:3072 lds
  v_mfma_f32_32x32x16_bf16 v[104:119], a[188:191], a[20:23], v[104:119]
  ds_read_b64_tr_b16 a[172:173], v5 offset:33280
  ds_read_b64_tr_b16 a[174:175], v5 offset:35328
  buffer_store_dwordx4 v[196:199], v37, s[16:19], s50 offen offset:3072 sc0 sc1
  s_waitcnt lgkmcnt(8)
  v_mfma_f32_32x32x16_bf16 v[56:71], a[144:147], a[24:27], v[56:71]
  s_waitcnt vmcnt(16)
  s_barrier
  ds_read_b64_tr_b16 a[176:177], v7 offset:0
HP_k3_p18:
  s_cbranch_execz HP_k3_p22
  ds_read_b64_tr_b16 a[178:179], v7 offset:2048
  v_mfma_f32_32x32x16_bf16 v[72:87], a[148:151], a[24:27], v[72:87]
  ds_read_b64_tr_b16 a[180:181], v7 offset:512
  ds_read_b64_tr_b16 a[182:183], v7 offset:2560
  buffer_load_dwordx4 a[76:79], v37, s[16:19], s51 offen offset:1024 sc0 sc1
  v_mfma_f32_32x32x16_bf16 v[88:103], a[152:155], a[24:27], v[88:103]
  ds_read_b64_tr_b16 a[184:185], v7 offset:1024
  ds_read_b64_tr_b16 a[186:187], v7 offset:3072
  s_add_u32 s34, s54, 147456
  v_mfma_f32_32x32x16_bf16 v[104:119], a[156:159], a[24:27], v[104:119]
  ds_read_b64_tr_b16 a[188:189], v7 offset:1536
  ds_read_b64_tr_b16 a[190:191], v7 offset:3584
  s_waitcnt lgkmcnt(8)
  v_mfma_f32_32x32x16_bf16 v[56:71], a[160:163], a[28:31], v[56:71]
  ds_read_b64_tr_b16 a[144:145], v7 offset:9216
  ds_read_b64_tr_b16 a[146:147], v7 offset:11264
  s_add_u32 m0, s31, 0
  v_mfma_f32_32x32x16_bf16 v[72:87], a[164:167], a[28:31], v[72:87]
  ds_read_b64_tr_b16 a[148:149], v7 offset:9728
  ds_read_b64_tr_b16 a[150:151], v7 offset:11776
  buffer_load_dwordx4 a[80:83], v37, s[16:19], s51 offen offset:2048 sc0 sc1
  v_mfma_f32_32x32x16_bf16 v[88:103], a[168:171], a[28:31], v[88:103]
  ds_read_b64_tr_b16 a[152:153], v7 offset:10240
  ds_read_b64_tr_b16 a[154:155], v7 offset:12288
  buffer_load_dwordx4 v26, s[12:15], s34 offen lds
  v_mfma_f32_32x32x16_bf16 v[104:119], a[172:175], a[28:31], v[104:119]
  ds_read_b64_tr_b16 a[156:157], v7 offset:10752
  ds_read_b64_tr_b16 a[158:159], v7 offset:12800
  s_waitcnt lgkmcnt(8)
  v_mfma_f32_32x32x16_bf16 v[56:71], a[176:179], v[200:203], v[56:71]
  ds_read_b64_tr_b16 a[160:161], v7 offset:18432
  ds_read_b64_tr_b16 a[162:163], v7 offset:20480
  v_mfma_f32_32x32x16_bf16 v[72:87], a[180:183], v[200:203], v[72:87]
  ds_read_b64_tr_b16 a[164:165], v7 offset:18944
  ds_read_b64_tr_b16 a[166:167], v7 offset:20992
  buffer_load_dwordx4 v27, s[12:15], s34 offen offset:1024 lds
  v_mfma_f32_32x32x16_bf16 v[88:103], a[184:187], v[200:203], v[88:103]
  ds_read_b64_tr_b16 a[168:169], v7 offset:19456
  ds_read_b64_tr_b16 a[170:171], v7 offset:21504
  buffer_load_dwordx4 a[84:87], v37, s[16:19], s51 offen offset:3072 sc0 sc1
  v_mfma_f32_32x32x16_bf16 v[104:119], a[188:191], v[200:203], v[104:119]
  ds_read_b64_tr_b16 a[172:173], v7 offset:19968
  ds_read_b64_tr_b16 a[174:175], v7 offset:22016
  s_waitcnt lgkmcnt(8)
  v_mfma_f32_32x32x16_bf16 v[56:71], a[144:147], v[204:207], v[56:71]
  ds_read_b64_tr_b16 a[176:177], v7 offset:27648
  ds_read_b64_tr_b16 a[178:179], v7 offset:29696
  v_mfma_f32_32x32x16_bf16 v[72:87], a[148:151], v[204:207], v[72:87]
  ds_read_b64_tr_b16 a[180:181], v7 offset:28160
  ds_read_b64_tr_b16 a[182:183], v7 offset:30208
  buffer_load_dwordx4 v8, s[12:15], s34 offen offset:2048 lds
  v_mfma_f32_32x32x16_bf16 v[88:103], a[152:155], v[204:207], v[88:103]
  ds_read_b64_tr_b16 a[184:185], v7 offset:28672
  ds_read_b64_tr_b16 a[186:187], v7 offset:30720
  s_add_u32 s51, s43, 8192
  buffer_load_dwordx4 a[88:91], v37, s[16:19], s51 offen sc0 sc1
  v_mfma_f32_32x32x16_bf16 v[104:119], a[156:159], v[204:207], v[104:119]
  ds_read_b64_tr_b16 a[188:189], v7 offset:29184
  ds_read_b64_tr_b16 a[190:191], v7 offset:31232
  s_waitcnt lgkmcnt(8)
  v_mfma_f32_32x32x16_bf16 v[56:71], a[160:163], a[32:35], v[56:71]
  ds_read_b64_tr_b16 a[144:145], v7 offset:4096
  ds_read_b64_tr_b16 a[146:147], v7 offset:6144
  buffer_load_dwordx4 v9, s[12:15], s34 offen offset:3072 lds
  v_mfma_f32_32x32x16_bf16 v[72:87], a[164:167], a[32:35], v[72:87]
  ds_read_b64_tr_b16 a[148:149], v7 offset:4608
  ds_read_b64_tr_b16 a[150:151], v7 offset:6656
  s_add_u32 s34, s55, 147456
  v_mfma_f32_32x32x16_bf16 v[88:103], a[168:171], a[32:35], v[88:103]
  ds_read_b64_tr_b16 a[152:153], v7 offset:5120
  ds_read_b64_tr_b16 a[154:155], v7 offset:7168
  s_add_u32 m0, s31, 4096
  v_mfma_f32_32x32x16_bf16 v[104:119], a[172:175], a[32:35], v[104:119]
  ds_read_b64_tr_b16 a[156:157], v7 offset:5632
  ds_read_b64_tr_b16 a[158:159], v7 offset:7680
  buffer_load_dwordx4 a[92:95], v37, s[16:19], s51 offen offset:1024 sc0 sc1
  s_waitcnt lgkmcnt(8)
  v_mfma_f32_32x32x16_bf16 v[56:71], a[176:179], a[36:39], v[56:71]
  ds_read_b64_tr_b16 a[160:161], v7 offset:13312
  ds_read_b64_tr_b16 a[162:163], v7 offset:15360
  buffer_load_dwordx4 v26, s[12:15], s34 offen lds
  v_mfma_f32_32x32x16_bf16 v[72:87], a[180:183], a[36:39], v[72:87]
  ds_read_b64_tr_b16 a[164:165], v7 offset:13824
  ds_read_b64_tr_b16 a[166:167], v7 offset:15872
  v_mfma_f32_32x32x16_bf16 v[88:103], a[184:187], a[36:39], v[88:103]
  ds_read_b64_tr_b16 a[168:169], v7 offset:14336
  ds_read_b64_tr_b16 a[170:171], v7 offset:16384
  s_waitcnt vmcnt(10)
  buffer_atomic_add v42, v49, s[16:19], s42 offen sc1
  v_mfma_f32_32x32x16_bf16 v[104:119], a[188:191], a[36:39], v[104:119]
  ds_read_b64_tr_b16 a[172:173], v7 offset:14848
  ds_read_b64_tr_b16 a[174:175], v7 offset:16896
  buffer_load_dwordx4 v27, s[12:15], s34 offen offset:1024 lds
  s_waitcnt lgkmcnt(8)
  v_mfma_f32_32x32x16_bf16 v[56:71], a[144:147], a[40:43], v[56:71]
  ds_read_b64_tr_b16 a[176:177], v7 offset:22528
  ds_read_b64_tr_b16 a[178:179], v7 offset:24576
  buffer_load_dwordx4 a[96:99], v37, s[16:19], s51 offen offset:2048 sc0 sc1
  v_mfma_f32_32x32x16_bf16 v[72:87], a[148:151], a[40:43], v[72:87]
  ds_read_b64_tr_b16 a[180:181], v7 offset:23040
  ds_read_b64_tr_b16 a[182:183], v7 offset:25088
  v_mfma_f32_32x32x16_bf16 v[88:103], a[152:155], a[40:43], v[88:103]
  ds_read_b64_tr_b16 a[184:185], v7 offset:23552
  ds_read_b64_tr_b16 a[186:187], v7 offset:25600
  v_mfma_f32_32x32x16_bf16 v[104:119], a[156:159], a[40:43], v[104:119]
  ds_read_b64_tr_b16 a[188:189], v7 offset:24064
  ds_read_b64_tr_b16 a[190:191], v7 offset:26112
  buffer_load_dwordx4 v8, s[12:15], s34 offen offset:2048 lds
  s_waitcnt lgkmcnt(8)
  v_mfma_f32_32x32x16_bf16 v[56:71], a[160:163], a[44:47], v[56:71]
  ds_read_b64_tr_b16 a[144:145], v7 offset:31744
  ds_read_b64_tr_b16 a[146:147], v7 offset:33792
  buffer_load_dwordx4 a[100:103], v37, s[16:19], s51 offen offset:3072 sc0 sc1
  v_mfma_f32_32x32x16_bf16 v[72:87], a[164:167], a[44:47], v[72:87]
  ds_read_b64_tr_b16 a[148:149], v7 offset:32256
  ds_read_b64_tr_b16 a[150:151], v7 offset:34304
  v_mfma_f32_32x32x16_bf16 v[88:103], a[168:171], a[44:47], v[88:103]
  ds_read_b64_tr_b16 a[152:153], v7 offset:32768
  ds_read_b64_tr_b16 a[154:155], v7 offset:34816
  buffer_load_dwordx4 v9, s[12:15], s34 offen offset:3072 lds
  v_mfma_f32_32x32x16_bf16 v[104:119], a[172:175], a[44:47], v[104:119]
  ds_read_b64_tr_b16 a[156:157], v7 offset:33280
  ds_read_b64_tr_b16 a[158:159], v7 offset:35328
  s_waitcnt lgkmcnt(8)
  v_mfma_f32_32x32x16_bf16 v[56:71], a[176:179], a[48:51], v[56:71]
  s_barrier
  ds_read_b64_tr_b16 a[160:161], v6 offset:0
  ds_read_b64_tr_b16 a[162:163], v6 offset:2048
  v_mfma_f32_32x32x16_bf16 v[72:87], a[180:183], a[48:51], v[72:87]
  ds_read_b64_tr_b16 a[164:165], v6 offset:512
  ds_read_b64_tr_b16 a[166:167], v6 offset:2560
  s_add_u32 s51, s99, 8192
  buffer_load_dwordx4 a[104:107], v37, s[16:19], s51 offen sc0 sc1
HP_k3_p19:
  s_cbranch_execz HP_k3_p23
  v_mfma_f32_32x32x16_bf16 v[88:103], a[184:187], a[48:51], v[88:103]
  ds_read_b64_tr_b16 a[168:169], v6 offset:1024
  ds_read_b64_tr_b16 a[170:171], v6 offset:3072
  s_add_u32 s34, s101, 0
  v_mfma_f32_32x32x16_bf16 v[104:119], a[188:191], a[48:51], v[104:119]
  ds_read_b64_tr_b16 a[172:173], v6 offset:1536
  ds_read_b64_tr_b16 a[174:175], v6 offset:3584
  s_waitcnt lgkmcnt(8)
  v_mfma_f32_32x32x16_bf16 v[56:71], a[144:147], a[52:55], v[56:71]
  ds_read_b64_tr_b16 a[176:177], v6 offset:9216
  ds_read_b64_tr_b16 a[178:179], v6 offset:11264
  s_add_u32 m0, s31, 36864
  v_mfma_f32_32x32x16_bf16 v[72:87], a[148:151], a[52:55], v[72:87]
  ds_read_b64_tr_b16 a[180:181], v6 offset:9728
  ds_read_b64_tr_b16 a[182:183], v6 offset:11776
  buffer_load_dwordx4 a[108:111], v37, s[16:19], s51 offen offset:1024 sc0 sc1
  v_mfma_f32_32x32x16_bf16 v[88:103], a[152:155], a[52:55], v[88:103]
  ds_read_b64_tr_b16 a[184:185], v6 offset:10240
  ds_read_b64_tr_b16 a[186:187], v6 offset:12288
  buffer_load_dwordx4 v26, s[12:15], s34 offen lds
  v_mfma_f32_32x32x16_bf16 v[104:119], a[156:159], a[52:55], v[104:119]
  ds_read_b64_tr_b16 a[188:189], v6 offset:10752
  ds_read_b64_tr_b16 a[190:191], v6 offset:12800
  s_waitcnt lgkmcnt(8)
  v_mfma_f32_32x32x16_bf16 v[56:71], a[160:163], a[56:59], v[56:71]
  ds_read_b64_tr_b16 a[144:145], v6 offset:18432
  ds_read_b64_tr_b16 a[146:147], v6 offset:20480
  v_mfma_f32_32x32x16_bf16 v[72:87], a[164:167], a[56:59], v[72:87]
  ds_read_b64_tr_b16 a[148:149], v6 offset:18944
  ds_read_b64_tr_b16 a[150:151], v6 offset:20992
  buffer_load_dwordx4 v29, s[12:15], s34 offen offset:1024 lds
  v_mfma_f32_32x32x16_bf16 v[88:103], a[168:171], a[56:59], v[88:103]
  ds_read_b64_tr_b16 a[152:153], v6 offset:19456
  ds_read_b64_tr_b16 a[154:155], v6 offset:21504
  s_add_u32 s34, s101, 73728
  v_mfma_f32_32x32x16_bf16 v[104:119], a[172:175], a[56:59], v[104:119]
  ds_read_b64_tr_b16 a[156:157], v6 offset:19968
  ds_read_b64_tr_b16 a[158:159], v6 offset:22016
  buffer_load_dwordx4 a[112:115], v37, s[16:19], s51 offen offset:2048 sc0 sc1
  s_waitcnt lgkmcnt(8)
  v_mfma_f32_32x32x16_bf16 v[56:71], a[176:179], a[60:63], v[56:71]
  ds_read_b64_tr_b16 a[160:161], v6 offset:27648
  ds_read_b64_tr_b16 a[162:163], v6 offset:29696
  buffer_load_dwordx4 v10, s[12:15], s34 offen offset:2048 lds
  v_mfma_f32_32x32x16_bf16 v[72:87], a[180:183], a[60:63], v[72:87]
  ds_read_b64_tr_b16 a[164:165], v6 offset:28160
  ds_read_b64_tr_b16 a[166:167], v6 offset:30208
  v_mfma_f32_32x32x16_bf16 v[88:103], a[184:187], a[60:63], v[88:103]
  ds_read_b64_tr_b16 a[168:169], v6 offset:28672
  ds_read_b64_tr_b16 a[170:171], v6 offset:30720
  v_mfma_f32_32x32x16_bf16 v[104:119], a[188:191], a[60:63], v[104:119]
  ds_read_b64_tr_b16 a[172:173], v6 offset:29184
  ds_read_b64_tr_b16 a[174:175], v6 offset:31232
  buffer_load_dwordx4 v11, s[12:15], s34 offen offset:3072 lds
  s_waitcnt lgkmcnt(8)
  v_mfma_f32_32x32x16_bf16 v[56:71], a[144:147], a[64:67], v[56:71]
  ds_read_b64_tr_b16 a[176:177], v6 offset:4096
  ds_read_b64_tr_b16 a[178:179], v6 offset:6144
  s_add_u32 s34, s101, 147456
  v_mfma_f32_32x32x16_bf16 v[72:87], a[148:151], a[64:67], v[72:87]
  ds_read_b64_tr_b16 a[180:181], v6 offset:4608
  ds_read_b64_tr_b16 a[182:183], v6 offset:6656
  s_add_u32 m0, s31, 40960
  v_mfma_f32_32x32x16_bf16 v[88:103], a[152:155], a[64:67], v[88:103]
  ds_read_b64_tr_b16 a[184:185], v6 offset:5120
  ds_read_b64_tr_b16 a[186:187], v6 offset:7168
  buffer_load_dwordx4 v26, s[12:15], s34 offen lds
  v_mfma_f32_32x32x16_bf16 v[104:119], a[156:159], a[64:67], v[104:119]
  ds_read_b64_tr_b16 a[188:189], v6 offset:5632
  ds_read_b64_tr_b16 a[190:191], v6 offset:7680
  buffer_load_dwordx4 a[116:119], v37, s[16:19], s51 offen offset:3072 sc0 sc1
  s_waitcnt lgkmcnt(8)
  v_mfma_f32_32x32x16_bf16 v[56:71], a[160:163], a[68:71], v[56:71]
  ds_read_b64_tr_b16 a[144:145], v6 offset:13312
  ds_read_b64_tr_b16 a[146:147], v6 offset:15360
  v_mfma_f32_32x32x16_bf16 v[72:87], a[164:167], a[68:71], v[72:87]
  ds_read_b64_tr_b16 a[148:149], v6 offset:13824
  ds_read_b64_tr_b16 a[150:151], v6 offset:15872
  buffer_load_dwordx4 v29, s[12:15], s34 offen offset:1024 lds
  v_mfma_f32_32x32x16_bf16 v[88:103], a[168:171], a[68:71], v[88:103]
  ds_read_b64_tr_b16 a[152:153], v6 offset:14336
  ds_read_b64_tr_b16 a[154:155], v6 offset:16384
  s_add_u32 s34, s101, 221184
  v_mfma_f32_32x32x16_bf16 v[104:119], a[172:175], a[68:71], v[104:119]
  ds_read_b64_tr_b16 a[156:157], v6 offset:14848
  ds_read_b64_tr_b16 a[158:159], v6 offset:16896
  s_waitcnt lgkmcnt(8)
  v_mfma_f32_32x32x16_bf16 v[56:71], a[176:179], a[72:75], v[56:71]
  ds_read_b64_tr_b16 a[160:161], v6 offset:22528
  ds_read_b64_tr_b16 a[162:163], v6 offset:24576
  v_mov_b32 v40, 0
  buffer_atomic_add v40, v30, s[16:19], 0 offen sc0 sc1
  v_mfma_f32_32x32x16_bf16 v[72:87], a[180:183], a[72:75], v[72:87]
  ds_read_b64_tr_b16 a[164:165], v6 offset:23040
  ds_read_b64_tr_b16 a[166:167], v6 offset:25088
  buffer_load_dwordx4 v10, s[12:15], s34 offen offset:2048 lds
  v_mfma_f32_32x32x16_bf16 v[88:103], a[184:187], a[72:75], v[88:103]
  ds_read_b64_tr_b16 a[168:169], v6 offset:23552
  ds_read_b64_tr_b16 a[170:171], v6 offset:25600
  v_mfma_f32_32x32x16_bf16 v[104:119], a[188:191], a[72:75], v[104:119]
  ds_read_b64_tr_b16 a[172:173], v6 offset:24064
  ds_read_b64_tr_b16 a[174:175], v6 offset:26112
  buffer_load_dwordx4 v11, s[12:15], s34 offen offset:3072 lds
  s_waitcnt lgkmcnt(8)
  s_waitcnt vmcnt(28)
  v_mfma_f32_32x32x16_bf16 v[56:71], a[144:147], a[76:79], v[56:71]
  ds_read_b64_tr_b16 a[176:177], v6 offset:31744
  ds_read_b64_tr_b16 a[178:179], v6 offset:33792
  s_mov_b32 s34, s37
  v_mfma_f32_32x32x16_bf16 v[72:87], a[148:151], a[76:79], v[72:87]
  ds_read_b64_tr_b16 a[180:181], v6 offset:32256
  ds_read_b64_tr_b16 a[182:183], v6 offset:34304
  s_add_u32 m0, s31, 45056
  v_mfma_f32_32x32x16_bf16 v[88:103], a[152:155], a[76:79], v[88:103]
  ds_read_b64_tr_b16 a[184:185], v6 offset:32768
  ds_read_b64_tr_b16 a[186:187], v6 offset:34816
  buffer_load_dwordx4 v26, s[12:15], s34 offen lds
  v_mfma_f32_32x32x16_bf16 v[104:119], a[156:159], a[76:79], v[104:119]
  ds_read_b64_tr_b16 a[188:189], v6 offset:33280
  ds_read_b64_tr_b16 a[190:191], v6 offset:35328
  s_waitcnt lgkmcnt(8)
  s_waitcnt vmcnt(28)
  v_mfma_f32_32x32x16_bf16 v[56:71], a[160:163], a[80:83], v[56:71]
  s_waitcnt vmcnt(14)
  s_barrier
  ds_read_b64_tr_b16 a[144:145], v4 offset:0
  ds_read_b64_tr_b16 a[146:147], v4 offset:2048
  v_mfma_f32_32x32x16_bf16 v[72:87], a[164:167], a[80:83], v[72:87]
  ds_read_b64_tr_b16 a[148:149], v4 offset:512
  ds_read_b64_tr_b16 a[150:151], v4 offset:2560
  v_mfma_f32_32x32x16_bf16 v[88:103], a[168:171], a[80:83], v[88:103]
  ds_read_b64_tr_b16 a[152:153], v4 offset:1024
  ds_read_b64_tr_b16 a[154:155], v4 offset:3072
  s_add_u32 s34, s56, 221184
  v_mfma_f32_32x32x16_bf16 v[104:119], a[172:175], a[80:83], v[104:119]
HP_k3_p20:
  s_cbranch_execz HP_k3_p24
  ds_read_b64_tr_b16 a[156:157], v4 offset:1536
  ds_read_b64_tr_b16 a[158:159], v4 offset:3584
  s_waitcnt lgkmcnt(8)
  v_mfma_f32_32x32x16_bf16 v[56:71], a[176:179], a[84:87], v[56:71]
  ds_read_b64_tr_b16 a[160:161], v4 offset:9216
  ds_read_b64_tr_b16 a[162:163], v4 offset:11264
  s_add_u32 m0, s31, 110592
  v_mfma_f32_32x32x16_bf16 v[72:87], a[180:183], a[84:87], v[72:87]
  ds_read_b64_tr_b16 a[164:165], v4 offset:9728
  ds_read_b64_tr_b16 a[166:167], v4 offset:11776
  v_mfma_f32_32x32x16_bf16 v[88:103], a[184:187], a[84:87], v[88:103]
  ds_read_b64_tr_b16 a[168:169], v4 offset:10240
  ds_read_b64_tr_b16 a[170:171], v4 offset:12288
  buffer_load_dwordx4 v26, s[12:15], s34 offen lds
  v_mfma_f32_32x32x16_bf16 v[104:119], a[188:191], a[84:87], v[104:119]
  ds_read_b64_tr_b16 a[172:173], v4 offset:10752
  ds_read_b64_tr_b16 a[174:175], v4 offset:12800
  s_waitcnt lgkmcnt(8)
  v_mfma_f32_32x32x16_bf16 v[56:71], a[144:147], a[88:91], v[56:71]
  ds_read_b64_tr_b16 a[176:177], v4 offset:18432
  ds_read_b64_tr_b16 a[178:179], v4 offset:20480
  v_mfma_f32_32x32x16_bf16 v[72:87], a[148:151], a[88:91], v[72:87]
  ds_read_b64_tr_b16 a[180:181], v4 offset:18944
  ds_read_b64_tr_b16 a[182:183], v4 offset:20992
  buffer_load_dwordx4 v29, s[12:15], s34 offen offset:1024 lds
  v_mfma_f32_32x32x16_bf16 v[88:103], a[152:155], a[88:91], v[88:103]
  ds_read_b64_tr_b16 a[184:185], v4 offset:19456
  ds_read_b64_tr_b16 a[186:187], v4 offset:21504
  v_mfma_f32_32x32x16_bf16 v[104:119], a[156:159], a[88:91], v[104:119]
  ds_read_b64_tr_b16 a[188:189], v4 offset:19968
  ds_read_b64_tr_b16 a[190:191], v4 offset:22016
  s_add_u32 s34, s57, 221184
  s_waitcnt lgkmcnt(8)
  v_mfma_f32_32x32x16_bf16 v[56:71], a[160:163], a[92:95], v[56:71]
  ds_read_b64_tr_b16 a[144:145], v4 offset:27648
  ds_read_b64_tr_b16 a[146:147], v4 offset:29696
  v_mfma_f32_32x32x16_bf16 v[72:87], a[164:167], a[92:95], v[72:87]
  ds_read_b64_tr_b16 a[148:149], v4 offset:28160
  ds_read_b64_tr_b16 a[150:151], v4 offset:30208
  buffer_load_dwordx4 v10, s[12:15], s34 offen offset:2048 lds
  v_mfma_f32_32x32x16_bf16 v[88:103], a[168:171], a[92:95], v[88:103]
  ds_read_b64_tr_b16 a[152:153], v4 offset:28672
  ds_read_b64_tr_b16 a[154:155], v4 offset:30720
  s_waitcnt vmcnt(6)
  v_cmp_le_u32 vcc, 5, v40
  s_nop 1
  s_cmp_eq_u32 vcc_lo, 7
  s_cbranch_scc0 K3_spinB
K3_retB:
  v_mfma_f32_32x32x16_bf16 v[104:119], a[172:175], a[92:95], v[104:119]
  ds_read_b64_tr_b16 a[156:157], v4 offset:29184
  ds_read_b64_tr_b16 a[158:159], v4 offset:31232
  s_add_u32 s51, s41, 12288
  buffer_load_dwordx4 v[208:211], v37, s[16:19], s51 offen sc0 sc1
  s_waitcnt lgkmcnt(8)
  v_mfma_f32_32x32x16_bf16 v[56:71], a[176:179], a[96:99], v[56:71]
  ds_read_b64_tr_b16 a[160:161], v4 offset:4096
  ds_read_b64_tr_b16 a[162:163], v4 offset:6144
  buffer_load_dwordx4 v11, s[12:15], s34 offen offset:3072 lds
  v_mfma_f32_32x32x16_bf16 v[72:87], a[180:183], a[96:99], v[72:87]
  ds_read_b64_tr_b16 a[164:165], v4 offset:4608
  ds_read_b64_tr_b16 a[166:167], v4 offset:6656
  s_add_u32 s34, s54, 221184
  v_mfma_f32_32x32x16_bf16 v[88:103], a[184:187], a[96:99], v[88:103]
  ds_read_b64_tr_b16 a[168:169], v4 offset:5120
  ds_read_b64_tr_b16 a[170:171], v4 offset:7168
  s_add_u32 m0, s31, 114688
  v_mfma_f32_32x32x16_bf16 v[104:119], a[188:191], a[96:99], v[104:119]
  ds_read_b64_tr_b16 a[172:173], v4 offset:5632
  ds_read_b64_tr_b16 a[174:175], v4 offset:7680
  buffer_load_dwordx4 v[212:215], v37, s[16:19], s51 offen offset:1024 sc0 sc1
  s_waitcnt lgkmcnt(8)
  v_mfma_f32_32x32x16_bf16 v[56:71], a[144:147], a[100:103], v[56:71]
  ds_read_b64_tr_b16 a[176:177], v4 offset:13312
  ds_read_b64_tr_b16 a[178:179], v4 offset:15360
  buffer_load_dwordx4 v26, s[12:15], s34 offen lds
  v_mfma_f32_32x32x16_bf16 v[72:87], a[148:151], a[100:103], v[72:87]
  ds_read_b64_tr_b16 a[180:181], v4 offset:13824
  ds_read_b64_tr_b16 a[182:183], v4 offset:15872
  v_mfma_f32_32x32x16_bf16 v[88:103], a[152:155], a[100:103], v[88:103]
  ds_read_b64_tr_b16 a[184:185], v4 offset:14336
  ds_read_b64_tr_b16 a[186:187], v4 offset:16384
  v_mfma_f32_32x32x16_bf16 v[104:119], a[156:159], a[100:103], v[104:119]
  ds_read_b64_tr_b16 a[188:189], v4 offset:14848
  ds_read_b64_tr_b16 a[190:191], v4 offset:16896
  buffer_load_dwordx4 v29, s[12:15], s34 offen offset:1024 lds
  s_waitcnt lgkmcnt(8)
  v_mfma_f32_32x32x16_bf16 v[56:71], a[160:163], a[104:107], v[56:71]
  ds_read_b64_tr_b16 a[144:145], v4 offset:22528
  ds_read_b64_tr_b16 a[146:147], v4 offset:24576
  buffer_load_dwordx4 v[216:219], v37, s[16:19], s51 offen offset:2048 sc0 sc1
  v_mfma_f32_32x32x16_bf16 v[72:87], a[164:167], a[104:107], v[72:87]
  ds_read_b64_tr_b16 a[148:149], v4 offset:23040
  ds_read_b64_tr_b16 a[150:151], v4 offset:25088
  s_add_u32 s34, s55, 221184
  v_mfma_f32_32x32x16_bf16 v[88:103], a[168:171], a[104:107], v[88:103]
  ds_read_b64_tr_b16 a[152:153], v4 offset:23552
  ds_read_b64_tr_b16 a[154:155], v4 offset:25600
  v_mfma_f32_32x32x16_bf16 v[104:119], a[172:175], a[104:107], v[104:119]
  ds_read_b64_tr_b16 a[156:157], v4 offset:24064
  ds_read_b64_tr_b16 a[158:159], v4 offset:26112
  buffer_load_dwordx4 v10, s[12:15], s34 offen offset:2048 lds
  s_waitcnt lgkmcnt(8)
  v_mfma_f32_32x32x16_bf16 v[56:71], a[176:179], a[108:111], v[56:71]
  ds_read_b64_tr_b16 a[160:161], v4 offset:31744
  ds_read_b64_tr_b16 a[162:163], v4 offset:33792
  buffer_load_dwordx4 v[220:223], v37, s[16:19], s51 offen offset:3072 sc0 sc1
  v_mfma_f32_32x32x16_bf16 v[72:87], a[180:183], a[108:111], v[72:87]
  ds_read_b64_tr_b16 a[164:165], v4 offset:32256
  ds_read_b64_tr_b16 a[166:167], v4 offset:34304
  v_mfma_f32_32x32x16_bf16 v[88:103], a[184:187], a[108:111], v[88:103]
  ds_read_b64_tr_b16 a[168:169], v4 offset:32768
  ds_read_b64_tr_b16 a[170:171], v4 offset:34816
  buffer_load_dwordx4 v11, s[12:15], s34 offen offset:3072 lds
  v_mfma_f32_32x32x16_bf16 v[104:119], a[188:191], a[108:111], v[104:119]
  ds_read_b64_tr_b16 a[172:173], v4 offset:33280
  ds_read_b64_tr_b16 a[174:175], v4 offset:35328
  s_waitcnt lgkmcnt(8)
  v_mfma_f32_32x32x16_bf16 v[56:71], a[144:147], a[112:115], v[56:71]
  s_waitcnt vmcnt(12)
  s_barrier
  ds_read_b64_tr_b16 a[176:177], v5 offset:8192
  ds_read_b64_tr_b16 a[178:179], v5 offset:17408
  v_mfma_f32_32x32x16_bf16 v[72:87], a[148:151], a[112:115], v[72:87]
  ds_read_b64_tr_b16 a[180:181], v5 offset:26624
  ds_read_b64_tr_b16 a[182:183], v5 offset:35840
  s_add_u32 s51, s43, 12288
  buffer_load_dwordx4 v[224:227], v37, s[16:19], s51 offen sc0 sc1
  v_mfma_f32_32x32x16_bf16 v[88:103], a[152:155], a[112:115], v[88:103]
  ds_read_b64_tr_b16 a[184:185], v5 offset:0
  ds_read_b64_tr_b16 a[186:187], v5 offset:1024
  s_add_u32 s34, s56, 221312
  v_mfma_f32_32x32x16_bf16 v[104:119], a[156:159], a[112:115], v[104:119]
  ds_read_b64_tr_b16 a[188:189], v5 offset:9216
  ds_read_b64_tr_b16 a[190:191], v5 offset:10240
  s_waitcnt lgkmcnt(8)
HP_k3_p21:
  s_cbranch_execz HP_k3_p25
  v_mfma_f32_32x32x16_bf16 v[56:71], a[160:163], a[116:119], v[56:71]
  ds_read_b64_tr_b16 a[144:145], v5 offset:18432
  ds_read_b64_tr_b16 a[146:147], v5 offset:19456
  s_add_u32 m0, s31, 73728
  v_mfma_f32_32x32x16_bf16 v[72:87], a[164:167], a[116:119], v[72:87]
  ds_read_b64_tr_b16 a[148:149], v5 offset:27648
  ds_read_b64_tr_b16 a[150:151], v5 offset:28672
  buffer_load_dwordx4 v[228:231], v37, s[16:19], s51 offen offset:1024 sc0 sc1
  v_mfma_f32_32x32x16_bf16 v[88:103], a[168:171], a[116:119], v[88:103]
  ds_read_b64_tr_b16 a[152:153], v5 offset:2048
  ds_read_b64_tr_b16 a[154:155], v5 offset:3072
  buffer_load_dwordx4 v26, s[12:15], s34 offen lds
  v_mfma_f32_32x32x16_bf16 v[104:119], a[172:175], a[116:119], v[104:119]
  ds_read_b64_tr_b16 a[156:157], v5 offset:11264
  ds_read_b64_tr_b16 a[158:159], v5 offset:12288
  s_waitcnt lgkmcnt(8)
  v_mfma_f32_32x32x16_bf16 v[120:135], a[176:179], v[200:203], 0
  ds_read_b64_tr_b16 a[160:161], v5 offset:20480
  ds_read_b64_tr_b16 a[162:163], v5 offset:21504
  v_mfma_f32_32x32x16_bf16 v[120:135], a[180:183], v[204:207], v[120:135]
  ds_read_b64_tr_b16 a[164:165], v5 offset:29696
  ds_read_b64_tr_b16 a[166:167], v5 offset:30720
  buffer_load_dwordx4 v[232:235], v37, s[16:19], s51 offen offset:2048 sc0 sc1
  v_mfma_f32_32x32x16_bf16 v[120:135], a[184:187], a[192:195], v[120:135]
  ds_read_b64_tr_b16 a[168:169], v5 offset:4096
  ds_read_b64_tr_b16 a[170:171], v5 offset:5120
  buffer_load_dwordx4 v29, s[12:15], s34 offen offset:1024 lds
  v_mfma_f32_32x32x16_bf16 v[120:135], a[188:191], a[196:199], v[120:135]
  ds_read_b64_tr_b16 a[172:173], v5 offset:13312
  ds_read_b64_tr_b16 a[174:175], v5 offset:14336
  s_waitcnt lgkmcnt(8)
  v_mfma_f32_32x32x16_bf16 v[120:135], a[144:147], a[200:203], v[120:135]
  ds_read_b64_tr_b16 a[176:177], v5 offset:22528
  ds_read_b64_tr_b16 a[178:179], v5 offset:23552
  s_add_u32 s34, s57, 221312
  v_mfma_f32_32x32x16_bf16 v[120:135], a[148:151], a[204:207], v[120:135]
  ds_read_b64_tr_b16 a[180:181], v5 offset:31744
  ds_read_b64_tr_b16 a[182:183], v5 offset:32768
  buffer_load_dwordx4 v[236:239], v37, s[16:19], s51 offen offset:3072 sc0 sc1
  v_mfma_f32_32x32x16_bf16 v[120:135], a[152:155], a[208:211], v[120:135]
  ds_read_b64_tr_b16 a[184:185], v5 offset:6144
  ds_read_b64_tr_b16 a[186:187], v5 offset:7168
  buffer_load_dwordx4 v10, s[12:15], s34 offen offset:2048 lds
  v_mfma_f32_32x32x16_bf16 v[120:135], a[156:159], a[212:215], v[120:135]
  ds_read_b64_tr_b16 a[188:189], v5 offset:15360
  ds_read_b64_tr_b16 a[190:191], v5 offset:16384
  s_waitcnt lgkmcnt(8)
  v_mfma_f32_32x32x16_bf16 v[120:135], a[160:163], a[216:219], v[120:135]
  ds_read_b64_tr_b16 a[144:145], v5 offset:24576
  ds_read_b64_tr_b16 a[146:147], v5 offset:25600
  v_mfma_f32_32x32x16_bf16 v[120:135], a[164:167], a[220:223], v[120:135]
  ds_read_b64_tr_b16 a[148:149], v5 offset:33792
  ds_read_b64_tr_b16 a[150:151], v5 offset:34816
  s_add_u32 s51, s99, 12288
  buffer_load_dwordx4 v[240:243], v37, s[16:19], s51 offen sc0 sc1
  v_mfma_f32_32x32x16_bf16 v[120:135], a[168:171], a[224:227], v[120:135]
  ds_read_b64_tr_b16 a[152:153], v5 offset:8704
  ds_read_b64_tr_b16 a[154:155], v5 offset:17920
  buffer_load_dwordx4 v11, s[12:15], s34 offen offset:3072 lds
  v_mfma_f32_32x32x16_bf16 v[120:135], a[172:175], a[228:231], v[120:135]
  ds_read_b64_tr_b16 a[156:157], v5 offset:27136
  ds_read_b64_tr_b16 a[158:159], v5 offset:36352
  s_add_u32 s34, s54, 221312
  s_waitcnt lgkmcnt(8)
  v_mfma_f32_32x32x16_bf16 v[120:135], a[176:179], a[232:235], v[120:135]
  ds_read_b64_tr_b16 a[160:161], v5 offset:512
  ds_read_b64_tr_b16 a[162:163], v5 offset:1536
  s_add_u32 m0, s31, 77824
  v_mfma_f32_32x32x16_bf16 v[120:135], a[180:183], a[236:239], v[120:135]
  ds_read_b64_tr_b16 a[164:165], v5 offset:9728
  ds_read_b64_tr_b16 a[166:167], v5 offset:10752
  buffer_load_dwordx4 v[244:247], v37, s[16:19], s51 offen offset:1024 sc0 sc1
  v_mfma_f32_32x32x16_bf16 v[120:135], a[184:187], v[184:187], v[120:135]
  ds_read_b64_tr_b16 a[168:169], v5 offset:18944
  ds_read_b64_tr_b16 a[170:171], v5 offset:19968
  buffer_load_dwordx4 v26, s[12:15], s34 offen lds
  v_mfma_f32_32x32x16_bf16 v[120:135], a[188:191], v[188:191], v[120:135]
  ds_read_b64_tr_b16 a[172:173], v5 offset:28160
  ds_read_b64_tr_b16 a[174:175], v5 offset:29184
  s_waitcnt lgkmcnt(8)
  v_mfma_f32_32x32x16_bf16 v[120:135], a[144:147], v[192:195], v[120:135]
  ds_read_b64_tr_b16 a[176:177], v5 offset:2560
  ds_read_b64_tr_b16 a[178:179], v5 offset:3584
  v_mfma_f32_32x32x16_bf16 v[120:135], a[148:151], v[196:199], v[120:135]
  ds_read_b64_tr_b16 a[180:181], v5 offset:11776
  ds_read_b64_tr_b16 a[182:183], v5 offset:12800
  buffer_load_dwordx4 v[248:251], v37, s[16:19], s51 offen offset:2048 sc0 sc1
  v_mfma_f32_32x32x16_bf16 v[136:151], a[152:155], v[200:203], 0
  ds_read_b64_tr_b16 a[184:185], v5 offset:20992
  ds_read_b64_tr_b16 a[186:187], v5 offset:22016
  buffer_load_dwordx4 v29, s[12:15], s34 offen offset:1024 lds
  v_mfma_f32_32x32x16_bf16 v[136:151], a[156:159], v[204:207], v[136:151]
  ds_read_b64_tr_b16 a[188:189], v5 offset:30208
  ds_read_b64_tr_b16 a[190:191], v5 offset:31232
  s_waitcnt lgkmcnt(8)
  v_mfma_f32_32x32x16_bf16 v[136:151], a[160:163], a[192:195], v[136:151]
  ds_read_b64_tr_b16 a[144:145], v5 offset:4608
  ds_read_b64_tr_b16 a[146:147], v5 offset:5632
  s_add_u32 s34, s55, 221312
  v_cvt_pk_bf16_f32 v120, v120, v121
  v_cvt_pk_bf16_f32 v121, v122, v123
  v_mfma_f32_32x32x16_bf16 v[136:151], a[164:167], a[196:199], v[136:151]
  ds_read_b64_tr_b16 a[148:149], v5 offset:13824
  ds_read_b64_tr_b16 a[150:151], v5 offset:14848
  buffer_load_dwordx4 v[252:255], v37, s[16:19], s51 offen offset:3072 sc0 sc1
  v_cvt_pk_bf16_f32 v122, v124, v125
  v_cvt_pk_bf16_f32 v123, v126, v127
  v_mfma_f32_32x32x16_bf16 v[136:151], a[168:171], a[200:203], v[136:151]
  ds_read_b64_tr_b16 a[152:153], v5 offset:23040
  ds_read_b64_tr_b16 a[154:155], v5 offset:24064
  buffer_load_dwordx4 v10, s[12:15], s34 offen offset:2048 lds
  v_cvt_pk_bf16_f32 v124, v128, v129
  v_cvt_pk_bf16_f32 v125, v130, v131
  v_mfma_f32_32x32x16_bf16 v[136:151], a[172:175], a[204:207], v[136:151]
  ds_read_b64_tr_b16 a[156:157], v5 offset:32256
  ds_read_b64_tr_b16 a[158:159], v5 offset:33280
  s_mov_b32 s59, s52
  buffer_store_dwordx4 v[120:123], v33, s[16:19], s59 offen sc0 sc1
  s_waitcnt lgkmcnt(8)
  v_mfma_f32_32x32x16_bf16 v[136:151], a[176:179], a[208:211], v[136:151]
  ds_read_b64_tr_b16 a[160:161], v5 offset:6656
  ds_read_b64_tr_b16 a[162:163], v5 offset:7680
  v_cvt_pk_bf16_f32 v126, v132, v133
  v_cvt_pk_bf16_f32 v127, v134, v135
  v_mfma_f32_32x32x16_bf16 v[136:151], a[180:183], a[212:215], v[136:151]
  ds_read_b64_tr_b16 a[164:165], v5 offset:15872
  ds_read_b64_tr_b16 a[166:167], v5 offset:16896
  buffer_store_dwordx4 v[124:127], v33, s[16:19], s59 offen offset:256 sc0 sc1
  v_mfma_f32_32x32x16_bf16 v[136:151], a[184:187], a[216:219], v[136:151]
  ds_read_b64_tr_b16 a[168:169], v5 offset:25088
  ds_read_b64_tr_b16 a[170:171], v5 offset:26112
  buffer_load_dwordx4 v11, s[12:15], s34 offen offset:3072 lds
HP_k3_p22:
  s_cbranch_execz HP_k3_p26
  v_mfma_f32_32x32x16_bf16 v[136:151], a[188:191], a[220:223], v[136:151]
  ds_read_b64_tr_b16 a[172:173], v5 offset:34304
  ds_read_b64_tr_b16 a[174:175], v5 offset:35328
  s_waitcnt lgkmcnt(8)
  v_mfma_f32_32x32x16_bf16 v[136:151], a[144:147], a[224:227], v[136:151]
  s_waitcnt vmcnt(18)
  s_barrier
  ds_read_b64_tr_b16 a[176:177], v7 offset:0
  ds_read_b64_tr_b16 a[178:179], v7 offset:1024
  v_mfma_f32_32x32x16_bf16 v[136:151], a[148:151], a[228:231], v[136:151]
  ds_read_b64_tr_b16 a[180:181], v7 offset:9216
  ds_read_b64_tr_b16 a[182:183], v7 offset:10240
  v_mfma_f32_32x32x16_bf16 v[136:151], a[152:155], a[232:235], v[136:151]
  ds_read_b64_tr_b16 a[184:185], v7 offset:18432
  ds_read_b64_tr_b16 a[186:187], v7 offset:19456
  v_mfma_f32_32x32x16_bf16 v[136:151], a[156:159], a[236:239], v[136:151]
  ds_read_b64_tr_b16 a[188:189], v7 offset:27648
  ds_read_b64_tr_b16 a[190:191], v7 offset:28672
  s_waitcnt lgkmcnt(8)
  v_mfma_f32_32x32x16_bf16 v[136:151], a[160:163], v[184:187], v[136:151]
  ds_read_b64_tr_b16 a[144:145], v7 offset:2048
  ds_read_b64_tr_b16 a[146:147], v7 offset:3072
  v_mfma_f32_32x32x16_bf16 v[136:151], a[164:167], v[188:191], v[136:151]
  ds_read_b64_tr_b16 a[148:149], v7 offset:11264
  ds_read_b64_tr_b16 a[150:151], v7 offset:12288
  v_mfma_f32_32x32x16_bf16 v[136:151], a[168:171], v[192:195], v[136:151]
  ds_read_b64_tr_b16 a[152:153], v7 offset:20480
  ds_read_b64_tr_b16 a[154:155], v7 offset:21504
  v_mfma_f32_32x32x16_bf16 v[136:151], a[172:175], v[196:199], v[136:151]
  ds_read_b64_tr_b16 a[156:157], v7 offset:29696
  ds_read_b64_tr_b16 a[158:159], v7 offset:30720
  s_waitcnt lgkmcnt(8)
  v_mfma_f32_32x32x16_bf16 v[56:71], a[176:179], v[184:187], v[56:71]
  ds_read_b64_tr_b16 a[160:161], v7 offset:4096
  ds_read_b64_tr_b16 a[162:163], v7 offset:5120
  v_mfma_f32_32x32x16_bf16 v[56:71], a[180:183], v[188:191], v[56:71]
  ds_read_b64_tr_b16 a[164:165], v7 offset:13312
  ds_read_b64_tr_b16 a[166:167], v7 offset:14336
  v_mfma_f32_32x32x16_bf16 v[56:71], a[184:187], v[192:195], v[56:71]
  ds_read_b64_tr_b16 a[168:169], v7 offset:22528
  ds_read_b64_tr_b16 a[170:171], v7 offset:23552
  v_mfma_f32_32x32x16_bf16 v[56:71], a[188:191], v[196:199], v[56:71]
  ds_read_b64_tr_b16 a[172:173], v7 offset:31744
  ds_read_b64_tr_b16 a[174:175], v7 offset:32768
  v_cvt_pk_bf16_f32 v136, v136, v137
  v_cvt_pk_bf16_f32 v137, v138, v139
  s_waitcnt lgkmcnt(8)
  v_mfma_f32_32x32x16_bf16 v[56:71], a[144:147], v[208:211], v[56:71]
  ds_read_b64_tr_b16 a[176:177], v7 offset:6144
  ds_read_b64_tr_b16 a[178:179], v7 offset:7168
  v_cvt_pk_bf16_f32 v138, v140, v141
  v_cvt_pk_bf16_f32 v139, v142, v143
  v_cvt_pk_bf16_f32 v140, v144, v145
  v_mfma_f32_32x32x16_bf16 v[56:71], a[148:151], v[212:215], v[56:71]
  ds_read_b64_tr_b16 a[180:181], v7 offset:15360
  ds_read_b64_tr_b16 a[182:183], v7 offset:16384
  buffer_store_dwordx4 v[136:139], v33, s[16:19], s59 offen offset:512 sc0 sc1
  v_cvt_pk_bf16_f32 v141, v146, v147
  v_cvt_pk_bf16_f32 v142, v148, v149
  v_mfma_f32_32x32x16_bf16 v[56:71], a[152:155], v[216:219], v[56:71]
  ds_read_b64_tr_b16 a[184:185], v7 offset:24576
  ds_read_b64_tr_b16 a[186:187], v7 offset:25600
  v_cvt_pk_bf16_f32 v143, v150, v151
  v_mfma_f32_32x32x16_bf16 v[56:71], a[156:159], v[220:223], v[56:71]
  ds_read_b64_tr_b16 a[188:189], v7 offset:33792
  ds_read_b64_tr_b16 a[190:191], v7 offset:34816
  buffer_store_dwordx4 v[140:143], v33, s[16:19], s59 offen offset:768 sc0 sc1
  s_waitcnt lgkmcnt(8)
  s_waitcnt vmcnt(19)
  v_mfma_f32_32x32x16_bf16 v[56:71], a[160:163], v[224:227], v[56:71]
  ds_read_b64_tr_b16 a[144:145], v7 offset:512
  ds_read_b64_tr_b16 a[146:147], v7 offset:1536
  s_waitcnt vmcnt(18)
  v_mfma_f32_32x32x16_bf16 v[56:71], a[164:167], v[228:231], v[56:71]
  ds_read_b64_tr_b16 a[148:149], v7 offset:9728
  ds_read_b64_tr_b16 a[150:151], v7 offset:10752
  s_waitcnt vmcnt(16)
  v_mfma_f32_32x32x16_bf16 v[56:71], a[168:171], v[232:235], v[56:71]
  ds_read_b64_tr_b16 a[152:153], v7 offset:18944
  ds_read_b64_tr_b16 a[154:155], v7 offset:19968
  s_waitcnt vmcnt(14)
  v_mfma_f32_32x32x16_bf16 v[56:71], a[172:175], v[236:239], v[56:71]
  ds_read_b64_tr_b16 a[156:157], v7 offset:28160
  ds_read_b64_tr_b16 a[158:159], v7 offset:29184
  s_waitcnt lgkmcnt(8)
  s_waitcnt vmcnt(12)
  v_mfma_f32_32x32x16_bf16 v[56:71], a[176:179], v[240:243], v[56:71]
  ds_read_b64_tr_b16 a[160:161], v7 offset:2560
  ds_read_b64_tr_b16 a[162:163], v7 offset:3584
  s_waitcnt vmcnt(10)
  v_mfma_f32_32x32x16_bf16 v[56:71], a[180:183], v[244:247], v[56:71]
  ds_read_b64_tr_b16 a[164:165], v7 offset:11776
  ds_read_b64_tr_b16 a[166:167], v7 offset:12800
  s_waitcnt vmcnt(8)
  v_mfma_f32_32x32x16_bf16 v[56:71], a[184:187], v[248:251], v[56:71]
  ds_read_b64_tr_b16 a[168:169], v7 offset:20992
  ds_read_b64_tr_b16 a[170:171], v7 offset:22016
  s_waitcnt vmcnt(6)
  v_mfma_f32_32x32x16_bf16 v[56:71], a[188:191], v[252:255], v[56:71]
  ds_read_b64_tr_b16 a[172:173], v7 offset:30208
  ds_read_b64_tr_b16 a[174:175], v7 offset:31232
  s_waitcnt lgkmcnt(8)
  v_mfma_f32_32x32x16_bf16 v[72:87], a[144:147], v[184:187], v[72:87]
  ds_read_b64_tr_b16 a[176:177], v7 offset:4608
  ds_read_b64_tr_b16 a[178:179], v7 offset:5632
  v_mfma_f32_32x32x16_bf16 v[72:87], a[148:151], v[188:191], v[72:87]
  ds_read_b64_tr_b16 a[180:181], v7 offset:13824
  ds_read_b64_tr_b16 a[182:183], v7 offset:14848
  v_mfma_f32_32x32x16_bf16 v[72:87], a[152:155], v[192:195], v[72:87]
  ds_read_b64_tr_b16 a[184:185], v7 offset:23040
  ds_read_b64_tr_b16 a[186:187], v7 offset:24064
  v_mfma_f32_32x32x16_bf16 v[72:87], a[156:159], v[196:199], v[72:87]
  ds_read_b64_tr_b16 a[188:189], v7 offset:32256
  ds_read_b64_tr_b16 a[190:191], v7 offset:33280
  v_cvt_pk_bf16_f32 v56, v56, v57
  v_cvt_pk_bf16_f32 v57, v58, v59
  s_waitcnt lgkmcnt(8)
  v_mfma_f32_32x32x16_bf16 v[72:87], a[160:163], v[208:211], v[72:87]
  ds_read_b64_tr_b16 a[144:145], v7 offset:6656
  ds_read_b64_tr_b16 a[146:147], v7 offset:7680
  v_cvt_pk_bf16_f32 v58, v60, v61
  v_cvt_pk_bf16_f32 v59, v62, v63
  v_cvt_pk_bf16_f32 v60, v64, v65
  v_mfma_f32_32x32x16_bf16 v[72:87], a[164:167], v[212:215], v[72:87]
  ds_read_b64_tr_b16 a[148:149], v7 offset:15872
  ds_read_b64_tr_b16 a[150:151], v7 offset:16896
  s_add_u32 s59, s36, 0
  buffer_store_dwordx4 v[56:59], v48, s[16:19], s59 offen sc0 sc1
  v_cvt_pk_bf16_f32 v61, v66, v67
  v_mfma_f32_32x32x16_bf16 v[72:87], a[168:171], v[216:219], v[72:87]
  ds_read_b64_tr_b16 a[152:153], v7 offset:25088
  ds_read_b64_tr_b16 a[154:155], v7 offset:26112
  v_cvt_pk_bf16_f32 v62, v68, v69
  v_cvt_pk_bf16_f32 v63, v70, v71
  ds_write_b128 v41, v[56:59] offset:0
  v_mfma_f32_32x32x16_bf16 v[72:87], a[172:175], v[220:223], v[72:87]
  ds_read_b64_tr_b16 a[156:157], v7 offset:34304
HP_k3_p23:
  s_cbranch_execz HP_k3_p27
  ds_read_b64_tr_b16 a[158:159], v7 offset:35328
  buffer_store_dwordx4 v[60:63], v48, s[16:19], s59 offen offset:256 sc0 sc1
  ds_write_b128 v41, v[60:63] offset:256
  s_waitcnt lgkmcnt(10)
  v_mfma_f32_32x32x16_bf16 v[72:87], a[176:179], v[224:227], v[72:87]
  s_waitcnt vmcnt(4)
  s_barrier
  ds_read_b64_tr_b16 a[160:161], v6 offset:0
  ds_read_b64_tr_b16 a[162:163], v6 offset:1024
  v_mfma_f32_32x32x16_bf16 v[72:87], a[180:183], v[228:231], v[72:87]
  ds_read_b64_tr_b16 a[164:165], v6 offset:9216
  ds_read_b64_tr_b16 a[166:167], v6 offset:10240
  v_mfma_f32_32x32x16_bf16 v[72:87], a[184:187], v[232:235], v[72:87]
  ds_read_b64_tr_b16 a[168:169], v6 offset:18432
  ds_read_b64_tr_b16 a[170:171], v6 offset:19456
  v_mfma_f32_32x32x16_bf16 v[72:87], a[188:191], v[236:239], v[72:87]
  ds_read_b64_tr_b16 a[172:173], v6 offset:27648
  ds_read_b64_tr_b16 a[174:175], v6 offset:28672
  s_waitcnt lgkmcnt(9)
  v_mfma_f32_32x32x16_bf16 v[72:87], a[144:147], v[240:243], v[72:87]
  ds_read_b64_tr_b16 a[176:177], v6 offset:2048
  ds_read_b64_tr_b16 a[178:179], v6 offset:3072
  v_mfma_f32_32x32x16_bf16 v[72:87], a[148:151], v[244:247], v[72:87]
  ds_read_b64_tr_b16 a[180:181], v6 offset:11264
  ds_read_b64_tr_b16 a[182:183], v6 offset:12288
  s_waitcnt vmcnt(2)
  buffer_atomic_add v42, v49, s[16:19], s24 offen offset:128 sc1
  v_mfma_f32_32x32x16_bf16 v[72:87], a[152:155], v[248:251], v[72:87]
  ds_read_b64_tr_b16 a[184:185], v6 offset:20480
  ds_read_b64_tr_b16 a[186:187], v6 offset:21504
  v_mfma_f32_32x32x16_bf16 v[72:87], a[156:159], v[252:255], v[72:87]
  ds_read_b64_tr_b16 a[188:189], v6 offset:29696
  ds_read_b64_tr_b16 a[190:191], v6 offset:30720
  s_waitcnt lgkmcnt(8)
  v_mfma_f32_32x32x16_bf16 v[88:103], a[160:163], v[184:187], v[88:103]
  ds_read_b64_tr_b16 a[144:145], v6 offset:4096
  ds_read_b64_tr_b16 a[146:147], v6 offset:5120
  v_mfma_f32_32x32x16_bf16 v[88:103], a[164:167], v[188:191], v[88:103]
  ds_read_b64_tr_b16 a[148:149], v6 offset:13312
  ds_read_b64_tr_b16 a[150:151], v6 offset:14336
  v_mfma_f32_32x32x16_bf16 v[88:103], a[168:171], v[192:195], v[88:103]
  ds_read_b64_tr_b16 a[152:153], v6 offset:22528
  ds_read_b64_tr_b16 a[154:155], v6 offset:23552
  v_mfma_f32_32x32x16_bf16 v[88:103], a[172:175], v[196:199], v[88:103]
  ds_read_b64_tr_b16 a[156:157], v6 offset:31744
  ds_read_b64_tr_b16 a[158:159], v6 offset:32768
  v_cvt_pk_bf16_f32 v72, v72, v73
  v_cvt_pk_bf16_f32 v73, v74, v75
  s_waitcnt lgkmcnt(8)
  v_mfma_f32_32x32x16_bf16 v[88:103], a[176:179], v[208:211], v[88:103]
  ds_read_b64_tr_b16 a[160:161], v6 offset:6144
  ds_read_b64_tr_b16 a[162:163], v6 offset:7168
  v_cvt_pk_bf16_f32 v74, v76, v77
  v_cvt_pk_bf16_f32 v75, v78, v79
  v_cvt_pk_bf16_f32 v76, v80, v81
  v_mfma_f32_32x32x16_bf16 v[88:103], a[180:183], v[212:215], v[88:103]
  ds_read_b64_tr_b16 a[164:165], v6 offset:15360
  ds_read_b64_tr_b16 a[166:167], v6 offset:16384
  buffer_store_dwordx4 v[72:75], v48, s[16:19], s59 offen offset:512 sc0 sc1
  v_cvt_pk_bf16_f32 v77, v82, v83
  v_cvt_pk_bf16_f32 v78, v84, v85
  v_mfma_f32_32x32x16_bf16 v[88:103], a[184:187], v[216:219], v[88:103]
  ds_read_b64_tr_b16 a[168:169], v6 offset:24576
  ds_read_b64_tr_b16 a[170:171], v6 offset:25600
  v_cvt_pk_bf16_f32 v79, v86, v87
  ds_write_b128 v41, v[72:75] offset:512
  ds_write_b128 v41, v[76:79] offset:768
  v_mfma_f32_32x32x16_bf16 v[88:103], a[188:191], v[220:223], v[88:103]
  ds_read_b64_tr_b16 a[172:173], v6 offset:33792
  ds_read_b64_tr_b16 a[174:175], v6 offset:34816
  buffer_store_dwordx4 v[76:79], v48, s[16:19], s59 offen offset:768 sc0 sc1
  s_waitcnt lgkmcnt(10)
  v_mfma_f32_32x32x16_bf16 v[88:103], a[144:147], v[224:227], v[88:103]
  ds_read_b64_tr_b16 a[176:177], v6 offset:512
  ds_read_b64_tr_b16 a[178:179], v6 offset:1536
  v_mfma_f32_32x32x16_bf16 v[88:103], a[148:151], v[228:231], v[88:103]
  ds_read_b64_tr_b16 a[180:181], v6 offset:9728
  ds_read_b64_tr_b16 a[182:183], v6 offset:10752
  v_mfma_f32_32x32x16_bf16 v[88:103], a[152:155], v[232:235], v[88:103]
  ds_read_b64_tr_b16 a[184:185], v6 offset:18944
  ds_read_b64_tr_b16 a[186:187], v6 offset:19968
  v_mfma_f32_32x32x16_bf16 v[88:103], a[156:159], v[236:239], v[88:103]
  ds_read_b64_tr_b16 a[188:189], v6 offset:28160
  ds_read_b64_tr_b16 a[190:191], v6 offset:29184
  s_waitcnt lgkmcnt(8)
  v_mfma_f32_32x32x16_bf16 v[88:103], a[160:163], v[240:243], v[88:103]
  ds_read_b64_tr_b16 a[144:145], v6 offset:2560
  ds_read_b64_tr_b16 a[146:147], v6 offset:3584
  v_mfma_f32_32x32x16_bf16 v[88:103], a[164:167], v[244:247], v[88:103]
  ds_read_b64_tr_b16 a[148:149], v6 offset:11776
  ds_read_b64_tr_b16 a[150:151], v6 offset:12800
  v_mfma_f32_32x32x16_bf16 v[88:103], a[168:171], v[248:251], v[88:103]
  ds_read_b64_tr_b16 a[152:153], v6 offset:20992
  ds_read_b64_tr_b16 a[154:155], v6 offset:22016
  v_mfma_f32_32x32x16_bf16 v[88:103], a[172:175], v[252:255], v[88:103]
  ds_read_b64_tr_b16 a[156:157], v6 offset:30208
  ds_read_b64_tr_b16 a[158:159], v6 offset:31232
  s_waitcnt lgkmcnt(8)
  v_mfma_f32_32x32x16_bf16 v[104:119], a[176:179], v[184:187], v[104:119]
  ds_read_b64_tr_b16 a[160:161], v6 offset:4608
  ds_read_b64_tr_b16 a[162:163], v6 offset:5632
  v_mfma_f32_32x32x16_bf16 v[104:119], a[180:183], v[188:191], v[104:119]
  ds_read_b64_tr_b16 a[164:165], v6 offset:13824
  ds_read_b64_tr_b16 a[166:167], v6 offset:14848
  v_mfma_f32_32x32x16_bf16 v[104:119], a[184:187], v[192:195], v[104:119]
  ds_read_b64_tr_b16 a[168:169], v6 offset:23040
  ds_read_b64_tr_b16 a[170:171], v6 offset:24064
  v_mfma_f32_32x32x16_bf16 v[104:119], a[188:191], v[196:199], v[104:119]
  ds_read_b64_tr_b16 a[172:173], v6 offset:32256
  ds_read_b64_tr_b16 a[174:175], v6 offset:33280
  v_cvt_pk_bf16_f32 v88, v88, v89
  v_cvt_pk_bf16_f32 v89, v90, v91
  s_waitcnt lgkmcnt(8)
  v_mfma_f32_32x32x16_bf16 v[104:119], a[144:147], v[208:211], v[104:119]
  ds_read_b64_tr_b16 a[176:177], v6 offset:6656
  ds_read_b64_tr_b16 a[178:179], v6 offset:7680
  v_cvt_pk_bf16_f32 v90, v92, v93
  v_cvt_pk_bf16_f32 v91, v94, v95
  v_cvt_pk_bf16_f32 v92, v96, v97
  v_mfma_f32_32x32x16_bf16 v[104:119], a[148:151], v[212:215], v[104:119]
  ds_read_b64_tr_b16 a[180:181], v6 offset:15872
  ds_read_b64_tr_b16 a[182:183], v6 offset:16896
  s_add_u32 s59, s36, 4096
  buffer_store_dwordx4 v[88:91], v48, s[16:19], s59 offen sc0 sc1
  v_cvt_pk_bf16_f32 v93, v98, v99
  v_mfma_f32_32x32x16_bf16 v[104:119], a[152:155], v[216:219], v[104:119]
  ds_read_b64_tr_b16 a[184:185], v6 offset:25088
  ds_read_b64_tr_b16 a[186:187], v6 offset:26112
  v_cvt_pk_bf16_f32 v94, v100, v101
  v_cvt_pk_bf16_f32 v95, v102, v103
  ds_write_b128 v41, v[88:91] offset:1024
  v_mfma_f32_32x32x16_bf16 v[104:119], a[156:159], v[220:223], v[104:119]
  ds_read_b64_tr_b16 a[188:189], v6 offset:34304
HP_k3_p24:
  s_cbranch_execz HP_k3_ret
  ds_read_b64_tr_b16 a[190:191], v6 offset:35328
  buffer_store_dwordx4 v[92:95], v48, s[16:19], s59 offen offset:256 sc0 sc1
  ds_write_b128 v41, v[92:95] offset:1280
  s_waitcnt lgkmcnt(10)
  v_mfma_f32_32x32x16_bf16 v[104:119], a[160:163], v[224:227], v[104:119]
  v_mfma_f32_32x32x16_bf16 v[104:119], a[164:167], v[228:231], v[104:119]
  v_mfma_f32_32x32x16_bf16 v[104:119], a[168:171], v[232:235], v[104:119]
  v_mfma_f32_32x32x16_bf16 v[104:119], a[172:175], v[236:239], v[104:119]
  s_waitcnt lgkmcnt(1)
  v_mfma_f32_32x32x16_bf16 v[104:119], a[176:179], v[240:243], v[104:119]
  v_mfma_f32_32x32x16_bf16 v[104:119], a[180:183], v[244:247], v[104:119]
  s_waitcnt vmcnt(2)
  buffer_atomic_add v42, v49, s[16:19], s25 offen sc1
  v_mfma_f32_32x32x16_bf16 v[104:119], a[184:187], v[248:251], v[104:119]
  v_mfma_f32_32x32x16_bf16 v[104:119], a[188:191], v[252:255], v[104:119]
  s_nop 12
  v_cvt_pk_bf16_f32 v104, v104, v105
  v_cvt_pk_bf16_f32 v105, v106, v107
  v_cvt_pk_bf16_f32 v106, v108, v109
  v_cvt_pk_bf16_f32 v107, v110, v111
  buffer_store_dwordx4 v[104:107], v48, s[16:19], s59 offen offset:512 sc0 sc1
  v_cvt_pk_bf16_f32 v108, v112, v113
  v_cvt_pk_bf16_f32 v109, v114, v115
  v_cvt_pk_bf16_f32 v110, v116, v117
  v_cvt_pk_bf16_f32 v111, v118, v119
  buffer_store_dwordx4 v[108:111], v48, s[16:19], s59 offen offset:768 sc0 sc1
  ds_write_b128 v41, v[104:107] offset:1536
  ds_write_b128 v41, v[108:111] offset:1792
  v_mov_b32 v4, 0
  buffer_atomic_add v4, v49, s[16:19], s24 offen offset:128 sc0 sc1
  v_mov_b32 v40, 0
  buffer_atomic_add v40, v49, s[16:19], s25 offen sc0 sc1
  s_mov_b32 s8, s26
  s_and_b32 s9, s27, 0xffff
  s_mov_b32 s10, 2359296
  s_mov_b32 s11, 0x20000
  v_mov_b32 v14, 0x3f80
  v_mov_b32 v15, 0x3f800000
  s_mov_b32 s54, 0xaaaaaaaa
  s_mov_b32 s55, 0xaaaaaaaa
  v_mov_b32 v1, 0x100
  v_accvgpr_read_b32 v184, a240
  v_accvgpr_read_b32 v185, a241
  v_accvgpr_read_b32 v186, a242
  v_accvgpr_read_b32 v187, a243
  v_accvgpr_read_b32 v188, a244
  v_accvgpr_read_b32 v189, a245
  v_accvgpr_read_b32 v190, a246
  v_accvgpr_read_b32 v191, a247
  v_accvgpr_read_b32 v192, a248
  v_accvgpr_read_b32 v193, a249
  v_accvgpr_read_b32 v194, a250
  v_accvgpr_read_b32 v195, a251
  s_add_u32 s4, s23, 1
  s_and_b32 s4, s4, 3
  s_lshl_b32 s4, s4, 21
  s_add_u32 s29, s48, s4
  s_add_u32 s4, s23, 2
  s_and_b32 s4, s4, 3
  s_lshl_b32 s4, s4, 21
  s_add_u32 s30, s48, s4
  s_add_u32 s4, s23, 3
  s_and_b32 s4, s4, 3
  s_lshl_b32 s4, s4, 21
  s_add_u32 s32, s48, s4
  s_waitcnt vmcnt(2)
  buffer_atomic_add v1, v49, s[16:19], s25 offen sc0 sc1
  s_waitcnt vmcnt(2)
  v_readfirstlane_b32 s5, v4
  s_nop 1
  s_cmp_eq_u32 s5, 16
  s_cbranch_scc1 K3_R
K3_S:
  v_mov_b32 v4, 0
  buffer_atomic_add v4, v49, s[16:19], s24 offen offset:128 sc0 sc1
  s_waitcnt vmcnt(0)
  v_readfirstlane_b32 s5, v4
  s_nop 1
  s_cmp_eq_u32 s5, 16
  s_cbranch_scc0 K3_S
K3_R:
  s_add_u32 s51, s20, 0
  buffer_load_dwordx4 v[152:155], v51, s[16:19], s51 offen sc0 sc1
  s_add_u32 s51, s20, 1048576
  buffer_load_dwordx4 v[156:159], v51, s[16:19], s51 offen sc0 sc1
  s_add_u32 s51, s20, 2097152
  buffer_load_dwordx4 v[160:163], v51, s[16:19], s51 offen sc0 sc1
  s_add_u32 s51, s20, 3145728
  buffer_load_dwordx4 v[164:167], v51, s[16:19], s51 offen sc0 sc1
  s_waitcnt vmcnt(5)
  v_readfirstlane_b32 s5, v40
  s_nop 1
  s_add_u32 s5, s5, 0x100
  s_bfe_u32 s4, s5, 0x80000
  s_cmp_eq_u32 s4, 4
  s_cbranch_scc1 K3_L0
  s_waitcnt vmcnt(4)
  v_readfirstlane_b32 s7, v1
  s_nop 1
  s_add_u32 s7, s7, 0x100
  s_max_u32 s5, s5, s7
  s_bfe_u32 s4, s5, 0x80000
  s_cmp_eq_u32 s4, 4
  s_cbranch_scc1 K3_L0
K3_P0:
  v_mov_b32 v40, 0
  buffer_atomic_add v40, v49, s[16:19], s25 offen sc0 sc1
  s_waitcnt vmcnt(0)
  v_readfirstlane_b32 s5, v40
  s_nop 1
  s_bfe_u32 s4, s5, 0x80000
  s_cmp_eq_u32 s4, 4
  s_cbranch_scc0 K3_P0
K3_L0:
  ds_read_b128 v[208:211], v43
  buffer_load_dwordx4 v[212:215], v3, s[16:19], s29 offen sc0 sc1
  buffer_load_dwordx4 v[216:219], v3, s[16:19], s30 offen sc0 sc1
  buffer_load_dwordx4 v[220:223], v3, s[16:19], s32 offen sc0 sc1
  s_bfe_u32 s4, s5, 0x80008
  s_cmp_eq_u32 s4, 4
  s_cbranch_scc1 K3_L1
  s_waitcnt vmcnt(7)
  v_readfirstlane_b32 s7, v1
  s_nop 1
  s_add_u32 s7, s7, 0x100
  s_max_u32 s5, s5, s7
  s_bfe_u32 s4, s5, 0x80008
  s_cmp_eq_u32 s4, 4
  s_cbranch_scc1 K3_L1
K3_P1:
  v_mov_b32 v40, 0
  buffer_atomic_add v40, v49, s[16:19], s25 offen sc0 sc1
  s_waitcnt vmcnt(0)
  v_readfirstlane_b32 s5, v40
  s_nop 1
  s_bfe_u32 s4, s5, 0x80008
  s_cmp_eq_u32 s4, 4
  s_cbranch_scc0 K3_P1
K3_L1:
  ds_read_b128 v[224:227], v43 offset:1024
  buffer_load_dwordx4 v[228:231], v54, s[16:19], s29 offen sc0 sc1
  buffer_load_dwordx4 v[232:235], v54, s[16:19], s30 offen sc0 sc1
  buffer_load_dwordx4 v[236:239], v54, s[16:19], s32 offen sc0 sc1
  s_waitcnt vmcnt(9)
  v_lshlrev_b32 v28, 16, v152
  v_and_b32 v29, 0xffff0000, v152
  v_lshlrev_b32 v30, 16, v153
  v_and_b32 v31, 0xffff0000, v153
  v_lshlrev_b32 v32, 16, v154
  v_and_b32 v33, 0xffff0000, v154
  v_lshlrev_b32 v34, 16, v155
  v_and_b32 v35, 0xffff0000, v155
  s_waitcnt vmcnt(8)
  v_dot2c_f32_bf16 v28, v156, v14
  v_dot2c_f32_bf16 v29, v156, v15
  v_dot2c_f32_bf16 v30, v157, v14
  v_dot2c_f32_bf16 v31, v157, v15
  v_dot2c_f32_bf16 v32, v158, v14
  v_dot2c_f32_bf16 v33, v158, v15
  v_dot2c_f32_bf16 v34, v159, v14
  v_dot2c_f32_bf16 v35, v159, v15
  s_waitcnt vmcnt(7)
  v_dot2c_f32_bf16 v28, v160, v14
  v_dot2c_f32_bf16 v29, v160, v15
  v_dot2c_f32_bf16 v30, v161, v14
  v_dot2c_f32_bf16 v31, v161, v15
  v_dot2c_f32_bf16 v32, v162, v14
  v_dot2c_f32_bf16 v33, v162, v15
  v_dot2c_f32_bf16 v34, v163, v14
  v_dot2c_f32_bf16 v35, v163, v15
  s_waitcnt vmcnt(6)
  v_dot2c_f32_bf16 v28, v164, v14
  v_dot2c_f32_bf16 v29, v164, v15
  v_dot2c_f32_bf16 v30, v165, v14
  v_dot2c_f32_bf16 v31, v165, v15
  v_dot2c_f32_bf16 v32, v166, v14
  v_dot2c_f32_bf16 v33, v166, v15
  v_dot2c_f32_bf16 v34, v167, v14
  v_dot2c_f32_bf16 v35, v167, v15
  s_nop 1
  v_pk_mov_b32 v[152:153], v[28:29], v[28:29] op_sel:[0,1]
  v_pk_mov_b32 v[154:155], v[30:31], v[30:31] op_sel:[0,1]
HP_k3_p25:
  s_cbranch_execz HP_k3_ret
  v_pk_mov_b32 v[156:157], v[32:33], v[32:33] op_sel:[0,1]
  v_pk_mov_b32 v[158:159], v[34:35], v[34:35] op_sel:[0,1]
  s_nop 0
  v_permlane32_swap_b32 v28, v152
  v_permlane32_swap_b32 v29, v153
  v_permlane32_swap_b32 v30, v154
  v_permlane32_swap_b32 v31, v155
  v_permlane32_swap_b32 v32, v156
  v_permlane32_swap_b32 v33, v157
  v_permlane32_swap_b32 v34, v158
  v_permlane32_swap_b32 v35, v159
  v_pk_add_f32 v[28:29], v[28:29], v[152:153]
  v_pk_add_f32 v[30:31], v[30:31], v[154:155]
  v_pk_add_f32 v[32:33], v[32:33], v[156:157]
  v_pk_add_f32 v[34:35], v[34:35], v[158:159]
  v_pk_mov_b32 v[152:153], v[28:29], v[28:29] op_sel:[0,1]
  v_pk_mov_b32 v[154:155], v[30:31], v[30:31] op_sel:[0,1]
  v_pk_mov_b32 v[156:157], v[32:33], v[32:33] op_sel:[0,1]
  v_pk_mov_b32 v[158:159], v[34:35], v[34:35] op_sel:[0,1]
  s_nop 0
  v_permlane16_swap_b32 v28, v152
  v_permlane16_swap_b32 v29, v153
  v_permlane16_swap_b32 v30, v154
  v_permlane16_swap_b32 v31, v155
  v_permlane16_swap_b32 v32, v156
  v_permlane16_swap_b32 v33, v157
  v_permlane16_swap_b32 v34, v158
  v_permlane16_swap_b32 v35, v159
  v_pk_add_f32 v[28:29], v[28:29], v[152:153]
  v_pk_add_f32 v[30:31], v[30:31], v[154:155]
  v_pk_add_f32 v[32:33], v[32:33], v[156:157]
  v_pk_add_f32 v[34:35], v[34:35], v[158:159]
  v_cvt_pk_bf16_f32 v24, v28, v29
  v_cvt_pk_bf16_f32 v25, v30, v31
  v_cvt_pk_bf16_f32 v26, v32, v33
  v_cvt_pk_bf16_f32 v27, v34, v35
  v_lshlrev_b32 v28, 16, v192
  v_and_b32 v29, 0xffff0000, v192
  v_lshlrev_b32 v30, 16, v193
  v_and_b32 v31, 0xffff0000, v193
  v_lshlrev_b32 v32, 16, v194
  v_and_b32 v33, 0xffff0000, v194
  v_lshlrev_b32 v34, 16, v195
  v_and_b32 v35, 0xffff0000, v195
  v_dot2c_f32_bf16 v28, v24, v14
  v_dot2c_f32_bf16 v29, v24, v15
  v_dot2c_f32_bf16 v30, v25, v14
  v_dot2c_f32_bf16 v31, v25, v15
  v_dot2c_f32_bf16 v32, v26, v14
  v_dot2c_f32_bf16 v33, v26, v15
  v_dot2c_f32_bf16 v34, v27, v14
  v_dot2c_f32_bf16 v35, v27, v15
  s_nop 1
  v_cvt_pk_bf16_f32 v24, v28, v29
  v_cvt_pk_bf16_f32 v25, v30, v31
  v_cvt_pk_bf16_f32 v26, v32, v33
  v_cvt_pk_bf16_f32 v27, v34, v35
  s_nop 0
  v_mov_b32_dpp v28, v24 quad_perm:[1,0,3,2] row_mask:0xf bank_mask:0xf
  v_mov_b32_dpp v29, v25 quad_perm:[1,0,3,2] row_mask:0xf bank_mask:0xf
  v_mov_b32_dpp v30, v26 quad_perm:[1,0,3,2] row_mask:0xf bank_mask:0xf
  v_mov_b32_dpp v31, v27 quad_perm:[1,0,3,2] row_mask:0xf bank_mask:0xf
  v_cndmask_b32 v24, v24, v30, s[54:55]
  v_cndmask_b32 v26, v28, v26, s[54:55]
  v_cndmask_b32 v25, v25, v31, s[54:55]
  v_cndmask_b32 v27, v29, v27, s[54:55]
  buffer_store_dwordx4 v[24:27], v53, s[8:11], s35 offen sc1
  s_waitcnt lgkmcnt(0)
  v_lshlrev_b32 v28, 16, v208
  v_and_b32 v29, 0xffff0000, v208
  v_lshlrev_b32 v30, 16, v209
  v_and_b32 v31, 0xffff0000, v209
  v_lshlrev_b32 v32, 16, v210
  v_and_b32 v33, 0xffff0000, v210
  v_lshlrev_b32 v34, 16, v211
  v_and_b32 v35, 0xffff0000, v211
  s_waitcnt vmcnt(6)
  v_dot2c_f32_bf16 v28, v212, v14
  v_dot2c_f32_bf16 v29, v212, v15
  v_dot2c_f32_bf16 v30, v213, v14
  v_dot2c_f32_bf16 v31, v213, v15
  v_dot2c_f32_bf16 v32, v214, v14
  v_dot2c_f32_bf16 v33, v214, v15
  v_dot2c_f32_bf16 v34, v215, v14
  v_dot2c_f32_bf16 v35, v215, v15
  s_waitcnt vmcnt(5)
  v_dot2c_f32_bf16 v28, v216, v14
  v_dot2c_f32_bf16 v29, v216, v15
  v_dot2c_f32_bf16 v30, v217, v14
  v_dot2c_f32_bf16 v31, v217, v15
  v_dot2c_f32_bf16 v32, v218, v14
  v_dot2c_f32_bf16 v33, v218, v15
  v_dot2c_f32_bf16 v34, v219, v14
  v_dot2c_f32_bf16 v35, v219, v15
  s_waitcnt vmcnt(4)
  v_dot2c_f32_bf16 v28, v220, v14
  v_dot2c_f32_bf16 v29, v220, v15
  v_dot2c_f32_bf16 v30, v221, v14
  v_dot2c_f32_bf16 v31, v221, v15
  v_dot2c_f32_bf16 v32, v222, v14
  v_dot2c_f32_bf16 v33, v222, v15
  v_dot2c_f32_bf16 v34, v223, v14
  v_dot2c_f32_bf16 v35, v223, v15
  s_nop 1
  v_cvt_pk_bf16_f32 v16, v28, v29
  v_cvt_pk_bf16_f32 v17, v30, v31
  v_cvt_pk_bf16_f32 v18, v32, v33
  v_cvt_pk_bf16_f32 v19, v34, v35
  v_lshlrev_b32 v28, 16, v184
  v_and_b32 v29, 0xffff0000, v184
  v_lshlrev_b32 v30, 16, v185
  v_and_b32 v31, 0xffff0000, v185
  v_lshlrev_b32 v32, 16, v186
  v_and_b32 v33, 0xffff0000, v186
  v_lshlrev_b32 v34, 16, v187
  v_and_b32 v35, 0xffff0000, v187
  v_dot2c_f32_bf16 v28, v16, v14
  v_dot2c_f32_bf16 v29, v16, v15
  v_dot2c_f32_bf16 v30, v17, v14
  v_dot2c_f32_bf16 v31, v17, v15
  v_dot2c_f32_bf16 v32, v18, v14
  v_dot2c_f32_bf16 v33, v18, v15
  v_dot2c_f32_bf16 v34, v19, v14
  v_dot2c_f32_bf16 v35, v19, v15
  s_nop 1
  v_cvt_pk_bf16_f32 v16, v28, v29
  v_cvt_pk_bf16_f32 v17, v30, v31
  v_cvt_pk_bf16_f32 v18, v32, v33
  v_cvt_pk_bf16_f32 v19, v34, v35
  s_nop 0
  v_mov_b32_dpp v28, v16 quad_perm:[1,0,3,2] row_mask:0xf bank_mask:0xf
  v_mov_b32_dpp v29, v17 quad_perm:[1,0,3,2] row_mask:0xf bank_mask:0xf
  v_mov_b32_dpp v30, v18 quad_perm:[1,0,3,2] row_mask:0xf bank_mask:0xf
  v_mov_b32_dpp v31, v19 quad_perm:[1,0,3,2] row_mask:0xf bank_mask:0xf
  v_cndmask_b32 v16, v16, v30, s[54:55]
  v_cndmask_b32 v18, v28, v18, s[54:55]
  v_cndmask_b32 v17, v17, v31, s[54:55]
  v_cndmask_b32 v19, v29, v19, s[54:55]
  buffer_store_dwordx4 v[16:19], v52, s[8:11], s35 offen sc1
  s_waitcnt lgkmcnt(0)
  v_lshlrev_b32 v28, 16, v224
  v_and_b32 v29, 0xffff0000, v224
  v_lshlrev_b32 v30, 16, v225
  v_and_b32 v31, 0xffff0000, v225
  v_lshlrev_b32 v32, 16, v226
  v_and_b32 v33, 0xffff0000, v226
  v_lshlrev_b32 v34, 16, v227
  v_and_b32 v35, 0xffff0000, v227
  s_waitcnt vmcnt(4)
  v_dot2c_f32_bf16 v28, v228, v14
  v_dot2c_f32_bf16 v29, v228, v15
  v_dot2c_f32_bf16 v30, v229, v14
  v_dot2c_f32_bf16 v31, v229, v15
  v_dot2c_f32_bf16 v32, v230, v14
  v_dot2c_f32_bf16 v33, v230, v15
  v_dot2c_f32_bf16 v34, v231, v14
  v_dot2c_f32_bf16 v35, v231, v15
  s_waitcnt vmcnt(3)
  v_dot2c_f32_bf16 v28, v232, v14
  v_dot2c_f32_bf16 v29, v232, v15
  v_dot2c_f32_bf16 v30, v233, v14
  v_dot2c_f32_bf16 v31, v233, v15
  v_dot2c_f32_bf16 v32, v234, v14
  v_dot2c_f32_bf16 v33, v234, v15
  v_dot2c_f32_bf16 v34, v235, v14
  v_dot2c_f32_bf16 v35, v235, v15
  s_waitcnt vmcnt(2)
  v_dot2c_f32_bf16 v28, v236, v14
  v_dot2c_f32_bf16 v29, v236, v15
  v_dot2c_f32_bf16 v30, v237, v14
  v_dot2c_f32_bf16 v31, v237, v15
  v_dot2c_f32_bf16 v32, v238, v14
  v_dot2c_f32_bf16 v33, v238, v15
  v_dot2c_f32_bf16 v34, v239, v14
  v_dot2c_f32_bf16 v35, v239, v15
  s_nop 1
  v_cvt_pk_bf16_f32 v20, v28, v29
  v_cvt_pk_bf16_f32 v21, v30, v31
  v_cvt_pk_bf16_f32 v22, v32, v33
  v_cvt_pk_bf16_f32 v23, v34, v35
  v_lshlrev_b32 v28, 16, v188
  v_and_b32 v29, 0xffff0000, v188
  v_lshlrev_b32 v30, 16, v189
  v_and_b32 v31, 0xffff0000, v189
HP_k3_p26:
  s_cbranch_execz HP_k3_ret
  v_lshlrev_b32 v32, 16, v190
  v_and_b32 v33, 0xffff0000, v190
  v_lshlrev_b32 v34, 16, v191
  v_and_b32 v35, 0xffff0000, v191
  v_dot2c_f32_bf16 v28, v20, v14
  v_dot2c_f32_bf16 v29, v20, v15
  v_dot2c_f32_bf16 v30, v21, v14
  v_dot2c_f32_bf16 v31, v21, v15
  v_dot2c_f32_bf16 v32, v22, v14
  v_dot2c_f32_bf16 v33, v22, v15
  v_dot2c_f32_bf16 v34, v23, v14
  v_dot2c_f32_bf16 v35, v23, v15
  s_nop 1
  v_cvt_pk_bf16_f32 v20, v28, v29
  v_cvt_pk_bf16_f32 v21, v30, v31
  v_cvt_pk_bf16_f32 v22, v32, v33
  v_cvt_pk_bf16_f32 v23, v34, v35
  s_nop 0
  v_mov_b32_dpp v28, v20 quad_perm:[1,0,3,2] row_mask:0xf bank_mask:0xf
  v_mov_b32_dpp v29, v21 quad_perm:[1,0,3,2] row_mask:0xf bank_mask:0xf
  v_mov_b32_dpp v30, v22 quad_perm:[1,0,3,2] row_mask:0xf bank_mask:0xf
  v_mov_b32_dpp v31, v23 quad_perm:[1,0,3,2] row_mask:0xf bank_mask:0xf
  v_cndmask_b32 v20, v20, v30, s[54:55]
  v_cndmask_b32 v22, v28, v22, s[54:55]
  v_cndmask_b32 v21, v21, v31, s[54:55]
  v_cndmask_b32 v23, v29, v23, s[54:55]
  buffer_store_dwordx4 v[20:23], v52, s[8:11], s35 offen offset:128 sc1
K3_end:
  s_endpgm
K3_head0:
  v_mfma_f32_32x32x16_bf16 v[56:71], a[160:163], a[136:139], v[56:71]
  s_waitcnt vmcnt(9)
  s_barrier
  ds_read_b64_tr_b16 a[144:145], v7 offset:0
  ds_read_b64_tr_b16 a[146:147], v7 offset:1024
  s_add_u32 s50, s50, 4096
  v_mfma_f32_32x32x16_bf16 v[72:87], a[164:167], a[136:139], v[72:87]
  ds_read_b64_tr_b16 a[148:149], v7 offset:18432
  ds_read_b64_tr_b16 a[150:151], v7 offset:19456
  v_accvgpr_write_b32 a192, v184
  v_accvgpr_write_b32 a193, v185
  v_accvgpr_write_b32 a194, v186
  v_accvgpr_write_b32 a195, v187
  v_mfma_f32_32x32x16_bf16 v[120:135], a[168:171], a[140:143], v[56:71]
  ds_read_b64_tr_b16 a[152:153], v7 offset:512
  ds_read_b64_tr_b16 a[154:155], v7 offset:1536
  v_accvgpr_write_b32 a196, v188
  v_accvgpr_write_b32 a197, v189
  v_accvgpr_write_b32 a198, v190
  v_accvgpr_write_b32 a199, v191
  v_mfma_f32_32x32x16_bf16 v[136:151], a[172:175], a[140:143], v[72:87]
  ds_read_b64_tr_b16 a[156:157], v7 offset:18944
  ds_read_b64_tr_b16 a[158:159], v7 offset:19968
  v_accvgpr_write_b32 a200, v192
  v_accvgpr_write_b32 a201, v193
  v_accvgpr_write_b32 a202, v194
  s_waitcnt lgkmcnt(8)
  v_mfma_f32_32x32x16_bf16 v[88:103], a[176:179], a[136:139], v[88:103]
  ds_read_b64_tr_b16 a[160:161], v7 offset:2048
  ds_read_b64_tr_b16 a[162:163], v7 offset:3072
  v_accvgpr_write_b32 a203, v195
  v_accvgpr_write_b32 a204, v196
  v_accvgpr_write_b32 a205, v197
  v_accvgpr_write_b32 a206, v198
  v_mfma_f32_32x32x16_bf16 v[104:119], a[180:183], a[136:139], v[104:119]
  ds_read_b64_tr_b16 a[164:165], v7 offset:20480
  ds_read_b64_tr_b16 a[166:167], v7 offset:21504
  v_accvgpr_write_b32 a207, v199
  v_mfma_f32_32x32x16_bf16 v[152:167], a[184:187], a[140:143], v[88:103]
  ds_read_b64_tr_b16 a[168:169], v7 offset:2560
  ds_read_b64_tr_b16 a[170:171], v7 offset:3584
  s_branch K3_body
K3_head1:
  v_mfma_f32_32x32x16_bf16 v[56:71], a[160:163], a[136:139], v[56:71]
  s_waitcnt vmcnt(9)
  s_barrier
  ds_read_b64_tr_b16 a[144:145], v7 offset:0
  ds_read_b64_tr_b16 a[146:147], v7 offset:1024
  s_add_u32 s50, s50, 4096
  v_cmp_le_u32 vcc, 2, v40
  s_nop 1
  s_cmp_eq_u32 vcc_lo, 7
  s_cbranch_scc0 K3_spinY
K3_retY:
  v_mfma_f32_32x32x16_bf16 v[72:87], a[164:167], a[136:139], v[72:87]
  ds_read_b64_tr_b16 a[148:149], v7 offset:18432
  ds_read_b64_tr_b16 a[150:151], v7 offset:19456
  s_mov_b32 s38, s56
  v_add_u32 v17, 0, v26
  s_mov_b32 s39, s57
  v_add_u32 v18, 4294966400, v26
  s_add_u32 s51, s41, 0
  buffer_load_dwordx4 v[208:211], v37, s[16:19], s51 offen sc0 sc1
  buffer_load_dwordx4 v[212:215], v37, s[16:19], s51 offen offset:1024 sc0 sc1
  v_mfma_f32_32x32x16_bf16 v[120:135], a[168:171], a[140:143], v[56:71]
  ds_read_b64_tr_b16 a[152:153], v7 offset:512
  ds_read_b64_tr_b16 a[154:155], v7 offset:1536
  v_add_u32 v19, 7168, v26
  v_add_u32 v20, 9344, v26
  s_mov_b64 s[44:45], s[12:13]
  v_add_u32 v21, 72704, v26
  buffer_load_dwordx4 v[216:219], v37, s[16:19], s51 offen offset:2048 sc0 sc1
  buffer_load_dwordx4 v[220:223], v37, s[16:19], s51 offen offset:3072 sc0 sc1
  v_mfma_f32_32x32x16_bf16 v[136:151], a[172:175], a[140:143], v[72:87]
  ds_read_b64_tr_b16 a[156:157], v7 offset:18944
  ds_read_b64_tr_b16 a[158:159], v7 offset:19968
  v_add_u32 v22, 71808, v26
  v_add_u32 v23, 82944, v26
  s_mov_b32 s46, s14
  s_waitcnt lgkmcnt(8)
  v_mfma_f32_32x32x16_bf16 v[88:103], a[176:179], a[136:139], v[88:103]
  ds_read_b64_tr_b16 a[160:161], v7 offset:2048
  ds_read_b64_tr_b16 a[162:163], v7 offset:3072
  v_add_u32 v24, 82048, v26
  v_mov_b32 v25, 0x40000000
  v_accvgpr_write_b32 a208, v184
  v_accvgpr_write_b32 a209, v185
  v_mfma_f32_32x32x16_bf16 v[104:119], a[180:183], a[136:139], v[104:119]
  ds_read_b64_tr_b16 a[164:165], v7 offset:20480
  ds_read_b64_tr_b16 a[166:167], v7 offset:21504
  v_accvgpr_write_b32 a210, v186
  v_accvgpr_write_b32 a211, v187
  v_accvgpr_write_b32 a212, v188
  v_accvgpr_write_b32 a213, v189
  v_mfma_f32_32x32x16_bf16 v[152:167], a[184:187], a[140:143], v[88:103]
  ds_read_b64_tr_b16 a[168:169], v7 offset:2560
  ds_read_b64_tr_b16 a[170:171], v7 offset:3584
  v_accvgpr_write_b32 a214, v190
  v_accvgpr_write_b32 a215, v191
  v_accvgpr_write_b32 a216, v192
  v_accvgpr_write_b32 a217, v193
  v_accvgpr_write_b32 a218, v194
  v_accvgpr_write_b32 a219, v195
  v_accvgpr_write_b32 a220, v196
  v_accvgpr_write_b32 a221, v197
  v_accvgpr_write_b32 a222, v198
  v_accvgpr_write_b32 a223, v199
  s_branch K3_body
K3_spinY:
  v_mov_b32 v40, 0
  buffer_atomic_add v40, v30, s[16:19], 0 offen sc0 sc1
  s_waitcnt vmcnt(0)
  v_cmp_le_u32 vcc, 2, v40
  s_nop 1
  s_cmp_eq_u32 vcc_lo, 7
  s_cbranch_scc0 K3_spinY
  s_branch K3_retY
K3_spinZ:
  v_mov_b32 v40, 0
  buffer_atomic_add v40, v30, s[16:19], 0 offen sc0 sc1
  s_waitcnt vmcnt(0)
  v_cmp_le_u32 vcc, 3, v40
  s_nop 1
  s_cmp_eq_u32 vcc_lo, 7
  s_cbranch_scc0 K3_spinZ
  s_branch K3_retZ
K3_spinA:
  v_mov_b32 v40, 0
HP_k3_p27:
  s_cbranch_execz HP_k3_ret
  buffer_atomic_add v40, v30, s[16:19], 0 offen sc0 sc1
  s_waitcnt vmcnt(0)
  v_cmp_le_u32 vcc, 4, v40
  s_nop 1
  s_cmp_eq_u32 vcc_lo, 7
  s_cbranch_scc0 K3_spinA
  s_branch K3_retA
K3_spinB:
  v_mov_b32 v40, 0
  buffer_atomic_add v40, v30, s[16:19], 0 offen sc0 sc1
  s_waitcnt vmcnt(0)
  v_cmp_le_u32 vcc, 5, v40
  s_nop 1
  s_cmp_eq_u32 vcc_lo, 7
  s_cbranch_scc0 K3_spinB
  s_branch K3_retB
KB_last:
  s_endpgm
.section .rodata,"a"
.p2align 6
.amdhsa_kernel sequential_preLN__linear_attn_block__geglu_ffn__prompt_kernel
  .amdhsa_next_free_vgpr 512
  .amdhsa_next_free_sgpr 102
  .amdhsa_accum_offset 256
  .amdhsa_group_segment_fixed_size 0
  .amdhsa_kernarg_size 80
  .amdhsa_user_sgpr_count 2
  .amdhsa_user_sgpr_kernarg_segment_ptr 1
  .amdhsa_system_sgpr_workgroup_id_x 1
  .amdhsa_float_denorm_mode_32 3
.end_amdhsa_kernel
.text
```
